```python
import torch

def _softmax(x, axis=-1):
    return torch.softmax(x, dim=axis)

def _gelu(x):
    return torch.nn.functional.gelu(x, approximate='tanh')

def _silu(x):
    return torch.nn.functional.silu(x)

def _sigmoid(x):
    return torch.sigmoid(x)

def _layernorm(x, axis=-1, eps=1e-05):
    m = x.mean(dim=axis, keepdim=True)
    v = x.var(dim=axis, keepdim=True, unbiased=False)
    return (x - m) / torch.sqrt(v + eps)

def _scatter_add(tgt, idx, src, axis=0):
    return tgt.clone().index_add_(axis, idx, src)

def _segment_sum(src, seg, n):
    out = torch.zeros((n,) + src.shape[1:], dtype=src.dtype)
    return out.index_add_(0, seg, src)

def _pad(x, pw):
    flat = tuple((v for pair in reversed(pw) for v in pair))
    return torch.nn.functional.pad(x, flat)
kernel_name = 'parallel_sum__memory_aug_recurrent_mem_tr__dense_activation_relu__prompt'

def setup_inputs():

    _w = lambda a: (lambda t: t.to(torch.bfloat16) if t.is_floating_point() else t)(torch.as_tensor(a))

    def _A_setup():
        B, S, Dm = (1, 2048, 640)
        H, Dh = (32, 192)
        M, seg = (8, 32)
        seg = min(seg, S)
        S = S // seg * seg
        return {'x': _w((lambda *s: torch.randn(*s, dtype=torch.bfloat16) * 0.05)(B, S, Dm)), 'mem0': _w((lambda *s: torch.randn(*s, dtype=torch.bfloat16) * 1.6)(B, M, Dm)), 'Wq': _w((lambda *s: torch.randn(*s, dtype=torch.bfloat16) * 0.8)(Dm, H, Dh) * Dm ** (-0.5)), 'Wk': _w((lambda *s: torch.randn(*s, dtype=torch.bfloat16) * 0.8)(Dm, H, Dh) * Dm ** (-0.5)), 'Wv': _w((lambda *s: torch.randn(*s, dtype=torch.bfloat16) * 1.6)(Dm, H, Dh) * Dm ** (-0.5)), 'Wo': _w((lambda *s: torch.randn(*s, dtype=torch.bfloat16) * 1.6)(H, Dh, Dm) * (H * Dh) ** (-0.5)), 'seg_len': seg}
    _A_in = _A_setup()

    def _B_setup():
        B, S, D, Dff = (1, 2048, 640, 1536)
        return {'x': _w((lambda *s: torch.randn(*s, dtype=torch.bfloat16) * 0.05)(B, S, D)), 'w1': _w((lambda *s: torch.randn(*s, dtype=torch.bfloat16) * 0.05)(D, Dff)), 'w2': _w((lambda *s: torch.randn(*s, dtype=torch.bfloat16) * 0.05)(Dff, D))}
    _B_in = _B_setup()
    return {'A_x': _A_in['x'], 'A_mem0': _A_in['mem0'], 'A_Wq': _A_in['Wq'], 'A_Wk': _A_in['Wk'], 'A_Wv': _A_in['Wv'], 'A_Wo': _A_in['Wo'], 'A_seg_len': _A_in['seg_len'], 'B_x': _B_in['x'], 'B_w1': _B_in['w1'], 'B_w2': _B_in['w2']}

def reference(A_x, A_mem0, A_Wq, A_Wk, A_Wv, A_Wo, A_seg_len, B_x, B_w1, B_w2):

    def _A_ref(x, mem0, Wq, Wk, Wv, Wo, seg_len):
        B, S, Dm = x.shape
        H, Dh = (Wq.shape[1], Wq.shape[2])
        M = mem0.shape[1]
        scale = Dh ** (-0.5)
        n_seg = S // seg_len
        L = M + seg_len
        idx = torch.arange(L)
        mask = (idx[:, None] < M) | (idx[:, None] >= idx[None, :])
        mem = mem0
        outs = []
        for s in range(n_seg):
            xs = x[:, s * seg_len:(s + 1) * seg_len, :].clone()
            h = torch.concatenate([mem, xs], axis=1)
            q = torch.einsum('btd,dhe->bhte', h, Wq)
            k = torch.einsum('btd,dhe->bhte', h, Wk)
            v = torch.einsum('btd,dhe->bhte', h, Wv)
            scores = torch.einsum('bhqe,bhke->bhqk', q, k) * scale
            scores = torch.where(mask[None, None], scores, -1000000000.0)
            p = _softmax(scores, axis=-1)
            o = torch.einsum('bhqk,bhke->bhqe', p, v)
            o = torch.einsum('bhte,hed->btd', o, Wo)
            mem = o[:, :M, :].clone()
            outs.append(o[:, M:, :])
        return torch.concatenate(outs, axis=1)

    def _B_ref(x, w1, w2):
        h = torch.einsum('bsd,df->bsf', x, w1)
        zero = torch.zeros_like(h)
        h = torch.maximum(h, zero)
        return torch.einsum('bsf,fd->bsd', h, w2)
    x = A_x
    xn = _layernorm(x, axis=-1)
    return x + _A_ref(xn, A_mem0, A_Wq, A_Wk, A_Wv, A_Wo, A_seg_len) + _B_ref(xn, B_w1, B_w2)
```

```asm
; @launch grid=(256,1,1) block=(256,1,1) lds=163840
.amdgcn_target "amdgcn-amd-amdhsa--gfx950"
.text
.globl parallel_sum__memory_aug_recurrent_mem_tr__dense_activation_relu__prompt_kernel
.p2align 8
.type parallel_sum__memory_aug_recurrent_mem_tr__dense_activation_relu__prompt_kernel,@function
parallel_sum__memory_aug_recurrent_mem_tr__dense_activation_relu__prompt_kernel:
    s_cmp_ge_u32 s2, 256
    s_cbranch_scc1 L_end
    s_load_dwordx16 s[40:55], s[0:1], 0
    s_load_dwordx8 s[56:63], s[0:1], 64
    s_load_dwordx2 s[64:65], s[0:1], 96
    v_lshrrev_b32 v2, 6, v0
    v_and_b32 v1, 63, v0
    v_readfirstlane_b32 s4, v2
    s_mov_b32 s36, 65536
    s_getreg_b32 s39, hwreg(HW_REG_XCC_ID)
    s_and_b32 s39, s39, 15
    s_waitcnt lgkmcnt(0)
    s_mov_b32 s8, s64
    s_and_b32 s9, s65, 0xffff
    s_mov_b32 s10, 0x10000000
    s_mov_b32 s11, 0x20000
    s_mov_b32 s12, s40
    s_and_b32 s13, s41, 0xffff
    s_mov_b32 s14, 0x280000
    s_mov_b32 s15, 0x20000
    s_mov_b32 s16, s44
    s_and_b32 s17, s45, 0xffff
    s_mov_b32 s18, 0x780000
    s_mov_b32 s19, 0x20000
    s_mov_b32 s20, s46
    s_and_b32 s21, s47, 0xffff
    s_mov_b32 s22, 0x780000
    s_mov_b32 s23, 0x20000
    s_mov_b32 s24, s60
    s_and_b32 s25, s61, 0xffff
    s_mov_b32 s26, 0x280000
    s_mov_b32 s27, 0x20000
    s_mov_b32 s28, s62
    s_and_b32 s29, s63, 0xffff
    s_mov_b32 s30, 0x100
    s_mov_b32 s31, 0x20000
    s_mov_b32 s32, s42
    s_and_b32 s33, s43, 0xffff
    s_mov_b32 s34, 0x2800
    s_mov_b32 s35, 0x20000
    s_cmp_lg_u32 s4, 0
    s_cbranch_scc1 L_tk_done
    s_mov_b64 exec, 1
    s_and_b32 s6, s39, 7
    s_mov_b32 s38, 8
L_tk_try:
    s_lshl_b32 s37, s6, 5
    v_mov_b32 v2, 1
    v_mov_b32 v3, s37
    buffer_atomic_add v2, v3, s[28:31], 0 offen sc0
    s_waitcnt vmcnt(0)
    v_readfirstlane_b32 s5, v2
    s_nop 0
    s_cmp_lt_u32 s5, 32
    s_cbranch_scc1 L_tk_got
    s_sub_u32 s38, s38, 1
    s_mov_b32 s6, s38
    s_cbranch_scc0 L_tk_try
    s_mov_b32 s6, 8
    s_mov_b32 s5, 0
L_tk_got:
    s_lshl_b32 s37, s6, 5
    s_add_u32 s37, s37, s5
    v_mov_b32 v2, s37
    v_mov_b32 v3, 0
    ds_write_b32 v3, v2
    s_waitcnt lgkmcnt(0)
    s_mov_b64 exec, -1
L_tk_done:
    s_barrier
    v_mov_b32 v3, 0
    ds_read_b32 v2, v3
    s_waitcnt lgkmcnt(0)
    v_readfirstlane_b32 s37, v2
    s_barrier
    s_lshr_b32 s6, s37, 5
    s_and_b32 s5, s37, 31
    s_getpc_b64 s[72:73]
L_pc:
    s_and_b32 s73, s73, 0xffff
    s_mov_b32 s74, L_end - L_pc
    s_mov_b32 s75, 0x20000
    s_lshl_b32 s37, s5, 2
    s_add_u32 s37, s37, s4
    s_lshl_b32 s37, s37, 13
    v_lshl_add_u32 v2, v1, 7, s37
    buffer_load_dword v255, v2, s[72:75], 0 offen
    s_mov_b32 s7, 0
    s_cmp_ge_u32 s6, 8
    s_cbranch_scc1 L_end
    s_cmp_ge_u32 s6, 4
    s_cbranch_scc1 L_notR
    s_cmp_ge_u32 s5, 26
    s_cbranch_scc1 L_SP
    s_cmp_lg_u32 s6, s39
    s_cselect_b32 s7, 1, 0
    s_cmp_ge_u32 s5, 16
    s_cbranch_scc1 L_C
    s_and_b32 s67, s5, 7
    s_lshl_b32 s68, s6, 3
    s_add_u32 s68, s68, s67
    s_cmp_lt_u32 s5, 8
    s_cbranch_scc1 L_RQ
    s_branch L_RV
L_notR:
    s_sub_u32 s6, s6, 4
    s_mov_b32 s3, 0
    s_lshl_b32 s37, s6, 3
    s_and_b32 s38, s5, 7
    s_add_u32 s37, s37, s38
    s_add_u32 s67, s37, 64
    s_cmp_lt_u32 s5, 8
    s_cbranch_scc1 L_P1
    s_mov_b32 s67, s37
    s_cmp_lt_u32 s5, 16
    s_cbranch_scc1 L_P2
    s_cmp_lt_u32 s5, 24
    s_cselect_b32 s38, 32, 0
    s_add_u32 s67, s37, s38
    s_xor_b32 s66, s67, 32
    v_and_b32 v4, 7, v1
    v_lshrrev_b32 v5, 3, v1
    s_lshl_b32 s37, s4, 3
    v_add_u32 v2, s37, v4
    v_mul_u32_u24 v2, 1280, v2
    v_lshl_add_u32 v2, v5, 4, v2
    s_and_b32 s37, s4, 1
    s_lshl_b32 s37, s37, 7
    s_lshr_b32 s38, s4, 1
    s_mul_i32 s38, s38, 20480
    s_add_u32 s37, s37, s38
    v_lshlrev_b32 v3, 8, v5
    v_lshl_add_u32 v3, v4, 4, v3
    v_add_u32 v3, s37, v3
L_ln_loop:
    s_mul_i32 s37, s66, 40960
    buffer_load_dwordx4 v[8:11], v2, s[12:15], s37 offen offset:0
    buffer_load_dwordx4 v[12:15], v2, s[12:15], s37 offen offset:128
    buffer_load_dwordx4 v[16:19], v2, s[12:15], s37 offen offset:256
    buffer_load_dwordx4 v[20:23], v2, s[12:15], s37 offen offset:384
    buffer_load_dwordx4 v[24:27], v2, s[12:15], s37 offen offset:512
    buffer_load_dwordx4 v[28:31], v2, s[12:15], s37 offen offset:640
    buffer_load_dwordx4 v[32:35], v2, s[12:15], s37 offen offset:768
    buffer_load_dwordx4 v[36:39], v2, s[12:15], s37 offen offset:896
    buffer_load_dwordx4 v[40:43], v2, s[12:15], s37 offen offset:1024
    buffer_load_dwordx4 v[44:47], v2, s[12:15], s37 offen offset:1152
    v_mov_b32 v6, 0
    v_mov_b32 v7, 0
    s_waitcnt vmcnt(9)
    v_lshlrev_b32 v48, 16, v8
    v_and_b32 v49, 0xffff0000, v8
    v_add_f32 v6, v6, v48
    v_add_f32 v7, v7, v49
    v_lshlrev_b32 v50, 16, v9
    v_and_b32 v51, 0xffff0000, v9
    v_add_f32 v6, v6, v50
    v_add_f32 v7, v7, v51
    v_lshlrev_b32 v52, 16, v10
    v_and_b32 v53, 0xffff0000, v10
    v_add_f32 v6, v6, v52
    v_add_f32 v7, v7, v53
    v_lshlrev_b32 v54, 16, v11
    v_and_b32 v55, 0xffff0000, v11
    v_add_f32 v6, v6, v54
    v_add_f32 v7, v7, v55
    s_waitcnt vmcnt(8)
    v_lshlrev_b32 v56, 16, v12
    v_and_b32 v57, 0xffff0000, v12
    v_add_f32 v6, v6, v56
    v_add_f32 v7, v7, v57
    v_lshlrev_b32 v58, 16, v13
    v_and_b32 v59, 0xffff0000, v13
    v_add_f32 v6, v6, v58
    v_add_f32 v7, v7, v59
    v_lshlrev_b32 v60, 16, v14
    v_and_b32 v61, 0xffff0000, v14
    v_add_f32 v6, v6, v60
    v_add_f32 v7, v7, v61
    v_lshlrev_b32 v62, 16, v15
    v_and_b32 v63, 0xffff0000, v15
    v_add_f32 v6, v6, v62
    v_add_f32 v7, v7, v63
    s_waitcnt vmcnt(7)
    v_lshlrev_b32 v64, 16, v16
    v_and_b32 v65, 0xffff0000, v16
    v_add_f32 v6, v6, v64
    v_add_f32 v7, v7, v65
    v_lshlrev_b32 v66, 16, v17
    v_and_b32 v67, 0xffff0000, v17
    v_add_f32 v6, v6, v66
    v_add_f32 v7, v7, v67
    v_lshlrev_b32 v68, 16, v18
    v_and_b32 v69, 0xffff0000, v18
    v_add_f32 v6, v6, v68
    v_add_f32 v7, v7, v69
    v_lshlrev_b32 v70, 16, v19
    v_and_b32 v71, 0xffff0000, v19
    v_add_f32 v6, v6, v70
    v_add_f32 v7, v7, v71
    s_waitcnt vmcnt(6)
    v_lshlrev_b32 v72, 16, v20
    v_and_b32 v73, 0xffff0000, v20
    v_add_f32 v6, v6, v72
    v_add_f32 v7, v7, v73
    v_lshlrev_b32 v74, 16, v21
    v_and_b32 v75, 0xffff0000, v21
    v_add_f32 v6, v6, v74
    v_add_f32 v7, v7, v75
    v_lshlrev_b32 v76, 16, v22
    v_and_b32 v77, 0xffff0000, v22
    v_add_f32 v6, v6, v76
    v_add_f32 v7, v7, v77
    v_lshlrev_b32 v78, 16, v23
    v_and_b32 v79, 0xffff0000, v23
    v_add_f32 v6, v6, v78
    v_add_f32 v7, v7, v79
    s_waitcnt vmcnt(5)
    v_lshlrev_b32 v80, 16, v24
    v_and_b32 v81, 0xffff0000, v24
    v_add_f32 v6, v6, v80
    v_add_f32 v7, v7, v81
    v_lshlrev_b32 v82, 16, v25
    v_and_b32 v83, 0xffff0000, v25
    v_add_f32 v6, v6, v82
    v_add_f32 v7, v7, v83
    v_lshlrev_b32 v84, 16, v26
    v_and_b32 v85, 0xffff0000, v26
    v_add_f32 v6, v6, v84
    v_add_f32 v7, v7, v85
    v_lshlrev_b32 v86, 16, v27
    v_and_b32 v87, 0xffff0000, v27
    v_add_f32 v6, v6, v86
    v_add_f32 v7, v7, v87
    s_waitcnt vmcnt(4)
    v_lshlrev_b32 v88, 16, v28
    v_and_b32 v89, 0xffff0000, v28
    v_add_f32 v6, v6, v88
    v_add_f32 v7, v7, v89
    v_lshlrev_b32 v90, 16, v29
    v_and_b32 v91, 0xffff0000, v29
    v_add_f32 v6, v6, v90
    v_add_f32 v7, v7, v91
    v_lshlrev_b32 v92, 16, v30
    v_and_b32 v93, 0xffff0000, v30
    v_add_f32 v6, v6, v92
    v_add_f32 v7, v7, v93
    v_lshlrev_b32 v94, 16, v31
    v_and_b32 v95, 0xffff0000, v31
    v_add_f32 v6, v6, v94
    v_add_f32 v7, v7, v95
    s_waitcnt vmcnt(3)
    v_lshlrev_b32 v96, 16, v32
    v_and_b32 v97, 0xffff0000, v32
    v_add_f32 v6, v6, v96
    v_add_f32 v7, v7, v97
    v_lshlrev_b32 v98, 16, v33
    v_and_b32 v99, 0xffff0000, v33
    v_add_f32 v6, v6, v98
    v_add_f32 v7, v7, v99
    v_lshlrev_b32 v100, 16, v34
    v_and_b32 v101, 0xffff0000, v34
    v_add_f32 v6, v6, v100
    v_add_f32 v7, v7, v101
    v_lshlrev_b32 v102, 16, v35
    v_and_b32 v103, 0xffff0000, v35
    v_add_f32 v6, v6, v102
    v_add_f32 v7, v7, v103
    s_waitcnt vmcnt(2)
    v_lshlrev_b32 v104, 16, v36
    v_and_b32 v105, 0xffff0000, v36
    v_add_f32 v6, v6, v104
    v_add_f32 v7, v7, v105
    v_lshlrev_b32 v106, 16, v37
    v_and_b32 v107, 0xffff0000, v37
    v_add_f32 v6, v6, v106
    v_add_f32 v7, v7, v107
    v_lshlrev_b32 v108, 16, v38
    v_and_b32 v109, 0xffff0000, v38
    v_add_f32 v6, v6, v108
    v_add_f32 v7, v7, v109
    v_lshlrev_b32 v110, 16, v39
    v_and_b32 v111, 0xffff0000, v39
    v_add_f32 v6, v6, v110
    v_add_f32 v7, v7, v111
    s_waitcnt vmcnt(1)
    v_lshlrev_b32 v112, 16, v40
    v_and_b32 v113, 0xffff0000, v40
    v_add_f32 v6, v6, v112
    v_add_f32 v7, v7, v113
    v_lshlrev_b32 v114, 16, v41
    v_and_b32 v115, 0xffff0000, v41
    v_add_f32 v6, v6, v114
    v_add_f32 v7, v7, v115
    v_lshlrev_b32 v116, 16, v42
    v_and_b32 v117, 0xffff0000, v42
    v_add_f32 v6, v6, v116
    v_add_f32 v7, v7, v117
    v_lshlrev_b32 v118, 16, v43
    v_and_b32 v119, 0xffff0000, v43
    v_add_f32 v6, v6, v118
    v_add_f32 v7, v7, v119
    s_waitcnt vmcnt(0)
    v_lshlrev_b32 v120, 16, v44
    v_and_b32 v121, 0xffff0000, v44
    v_add_f32 v6, v6, v120
    v_add_f32 v7, v7, v121
    v_lshlrev_b32 v122, 16, v45
    v_and_b32 v123, 0xffff0000, v45
    v_add_f32 v6, v6, v122
    v_add_f32 v7, v7, v123
    v_lshlrev_b32 v124, 16, v46
    v_and_b32 v125, 0xffff0000, v46
    v_add_f32 v6, v6, v124
    v_add_f32 v7, v7, v125
    v_lshlrev_b32 v126, 16, v47
    v_and_b32 v127, 0xffff0000, v47
    v_add_f32 v6, v6, v126
    v_add_f32 v7, v7, v127
    v_add_f32 v6, v6, v7
    s_nop 1
    v_add_f32_dpp v6, v6, v6 row_ror:8 row_mask:0xf bank_mask:0xf
    v_mov_b32 v4, v6
    s_nop 1
    v_permlane16_swap_b32 v6, v4
    v_add_f32 v6, v6, v4
    v_mov_b32 v4, v6
    s_nop 1
    v_permlane32_swap_b32 v6, v4
    v_add_f32 v6, v6, v4
    v_mul_f32 v6, 0x3acccccd, v6
    v_mov_b32 v7, 0
    v_mov_b32 v5, 0
    v_sub_f32 v8, v48, v6
    v_sub_f32 v9, v49, v6
    v_fmac_f32 v7, v8, v8
    v_fmac_f32 v5, v9, v9
    v_sub_f32 v8, v50, v6
    v_sub_f32 v9, v51, v6
    v_fmac_f32 v7, v8, v8
    v_fmac_f32 v5, v9, v9
    v_sub_f32 v8, v52, v6
    v_sub_f32 v9, v53, v6
    v_fmac_f32 v7, v8, v8
    v_fmac_f32 v5, v9, v9
    v_sub_f32 v8, v54, v6
    v_sub_f32 v9, v55, v6
    v_fmac_f32 v7, v8, v8
    v_fmac_f32 v5, v9, v9
    v_sub_f32 v8, v56, v6
    v_sub_f32 v9, v57, v6
    v_fmac_f32 v7, v8, v8
    v_fmac_f32 v5, v9, v9
    v_sub_f32 v8, v58, v6
    v_sub_f32 v9, v59, v6
    v_fmac_f32 v7, v8, v8
    v_fmac_f32 v5, v9, v9
    v_sub_f32 v8, v60, v6
    v_sub_f32 v9, v61, v6
    v_fmac_f32 v7, v8, v8
    v_fmac_f32 v5, v9, v9
    v_sub_f32 v8, v62, v6
    v_sub_f32 v9, v63, v6
    v_fmac_f32 v7, v8, v8
    v_fmac_f32 v5, v9, v9
    v_sub_f32 v8, v64, v6
    v_sub_f32 v9, v65, v6
    v_fmac_f32 v7, v8, v8
    v_fmac_f32 v5, v9, v9
    v_sub_f32 v8, v66, v6
    v_sub_f32 v9, v67, v6
    v_fmac_f32 v7, v8, v8
    v_fmac_f32 v5, v9, v9
    v_sub_f32 v8, v68, v6
    v_sub_f32 v9, v69, v6
    v_fmac_f32 v7, v8, v8
    v_fmac_f32 v5, v9, v9
    v_sub_f32 v8, v70, v6
    v_sub_f32 v9, v71, v6
    v_fmac_f32 v7, v8, v8
    v_fmac_f32 v5, v9, v9
    v_sub_f32 v8, v72, v6
    v_sub_f32 v9, v73, v6
    v_fmac_f32 v7, v8, v8
    v_fmac_f32 v5, v9, v9
    v_sub_f32 v8, v74, v6
    v_sub_f32 v9, v75, v6
    v_fmac_f32 v7, v8, v8
    v_fmac_f32 v5, v9, v9
    v_sub_f32 v8, v76, v6
    v_sub_f32 v9, v77, v6
    v_fmac_f32 v7, v8, v8
    v_fmac_f32 v5, v9, v9
    v_sub_f32 v8, v78, v6
    v_sub_f32 v9, v79, v6
    v_fmac_f32 v7, v8, v8
    v_fmac_f32 v5, v9, v9
    v_sub_f32 v8, v80, v6
    v_sub_f32 v9, v81, v6
    v_fmac_f32 v7, v8, v8
    v_fmac_f32 v5, v9, v9
    v_sub_f32 v8, v82, v6
    v_sub_f32 v9, v83, v6
    v_fmac_f32 v7, v8, v8
    v_fmac_f32 v5, v9, v9
    v_sub_f32 v8, v84, v6
    v_sub_f32 v9, v85, v6
    v_fmac_f32 v7, v8, v8
    v_fmac_f32 v5, v9, v9
    v_sub_f32 v8, v86, v6
    v_sub_f32 v9, v87, v6
    v_fmac_f32 v7, v8, v8
    v_fmac_f32 v5, v9, v9
    v_sub_f32 v8, v88, v6
    v_sub_f32 v9, v89, v6
    v_fmac_f32 v7, v8, v8
    v_fmac_f32 v5, v9, v9
    v_sub_f32 v8, v90, v6
    v_sub_f32 v9, v91, v6
    v_fmac_f32 v7, v8, v8
    v_fmac_f32 v5, v9, v9
    v_sub_f32 v8, v92, v6
    v_sub_f32 v9, v93, v6
    v_fmac_f32 v7, v8, v8
    v_fmac_f32 v5, v9, v9
    v_sub_f32 v8, v94, v6
    v_sub_f32 v9, v95, v6
    v_fmac_f32 v7, v8, v8
    v_fmac_f32 v5, v9, v9
    v_sub_f32 v8, v96, v6
    v_sub_f32 v9, v97, v6
    v_fmac_f32 v7, v8, v8
    v_fmac_f32 v5, v9, v9
    v_sub_f32 v8, v98, v6
    v_sub_f32 v9, v99, v6
    v_fmac_f32 v7, v8, v8
    v_fmac_f32 v5, v9, v9
    v_sub_f32 v8, v100, v6
    v_sub_f32 v9, v101, v6
    v_fmac_f32 v7, v8, v8
    v_fmac_f32 v5, v9, v9
    v_sub_f32 v8, v102, v6
    v_sub_f32 v9, v103, v6
    v_fmac_f32 v7, v8, v8
    v_fmac_f32 v5, v9, v9
    v_sub_f32 v8, v104, v6
    v_sub_f32 v9, v105, v6
    v_fmac_f32 v7, v8, v8
    v_fmac_f32 v5, v9, v9
    v_sub_f32 v8, v106, v6
    v_sub_f32 v9, v107, v6
    v_fmac_f32 v7, v8, v8
    v_fmac_f32 v5, v9, v9
    v_sub_f32 v8, v108, v6
    v_sub_f32 v9, v109, v6
    v_fmac_f32 v7, v8, v8
    v_fmac_f32 v5, v9, v9
    v_sub_f32 v8, v110, v6
    v_sub_f32 v9, v111, v6
    v_fmac_f32 v7, v8, v8
    v_fmac_f32 v5, v9, v9
    v_sub_f32 v8, v112, v6
    v_sub_f32 v9, v113, v6
    v_fmac_f32 v7, v8, v8
    v_fmac_f32 v5, v9, v9
    v_sub_f32 v8, v114, v6
    v_sub_f32 v9, v115, v6
    v_fmac_f32 v7, v8, v8
    v_fmac_f32 v5, v9, v9
    v_sub_f32 v8, v116, v6
    v_sub_f32 v9, v117, v6
    v_fmac_f32 v7, v8, v8
    v_fmac_f32 v5, v9, v9
    v_sub_f32 v8, v118, v6
    v_sub_f32 v9, v119, v6
    v_fmac_f32 v7, v8, v8
    v_fmac_f32 v5, v9, v9
    v_sub_f32 v8, v120, v6
    v_sub_f32 v9, v121, v6
    v_fmac_f32 v7, v8, v8
    v_fmac_f32 v5, v9, v9
    v_sub_f32 v8, v122, v6
    v_sub_f32 v9, v123, v6
    v_fmac_f32 v7, v8, v8
    v_fmac_f32 v5, v9, v9
    v_sub_f32 v8, v124, v6
    v_sub_f32 v9, v125, v6
    v_fmac_f32 v7, v8, v8
    v_fmac_f32 v5, v9, v9
    v_sub_f32 v8, v126, v6
    v_sub_f32 v9, v127, v6
    v_fmac_f32 v7, v8, v8
    v_fmac_f32 v5, v9, v9
    v_add_f32 v7, v7, v5
    s_nop 1
    v_add_f32_dpp v7, v7, v7 row_ror:8 row_mask:0xf bank_mask:0xf
    v_mov_b32 v4, v7
    s_nop 1
    v_permlane16_swap_b32 v7, v4
    v_add_f32 v7, v7, v4
    v_mov_b32 v4, v7
    s_nop 1
    v_permlane32_swap_b32 v7, v4
    v_add_f32 v7, v7, v4
    v_mul_f32 v7, 0x3acccccd, v7
    v_cvt_pk_bf16_f32 v4, v6, v7
    v_lshlrev_b32 v6, 16, v4
    v_and_b32 v7, 0xffff0000, v4
    v_add_f32 v7, 0x3727c5ac, v7
    v_cvt_pk_bf16_f32 v7, v7, v7
    v_and_b32 v7, 0xffff0000, v7
    v_sqrt_f32 v7, v7
    s_nop 0
    v_cvt_pk_bf16_f32 v7, v7, v7
    v_and_b32 v7, 0xffff0000, v7
    v_rcp_f32 v7, v7
    s_add_u32 s37, s37, 1048576
    v_sub_f32 v48, v48, v6
    v_sub_f32 v49, v49, v6
    v_cvt_pk_bf16_f32 v4, v48, v49
    v_lshlrev_b32 v5, 16, v4
    v_and_b32 v4, 0xffff0000, v4
    v_mul_f32 v5, v5, v7
    v_mul_f32 v4, v4, v7
    v_cvt_pk_bf16_f32 v8, v5, v4
    v_sub_f32 v50, v50, v6
    v_sub_f32 v51, v51, v6
    v_cvt_pk_bf16_f32 v4, v50, v51
    v_lshlrev_b32 v5, 16, v4
    v_and_b32 v4, 0xffff0000, v4
    v_mul_f32 v5, v5, v7
    v_mul_f32 v4, v4, v7
    v_cvt_pk_bf16_f32 v9, v5, v4
    v_sub_f32 v52, v52, v6
    v_sub_f32 v53, v53, v6
    v_cvt_pk_bf16_f32 v4, v52, v53
    v_lshlrev_b32 v5, 16, v4
    v_and_b32 v4, 0xffff0000, v4
    v_mul_f32 v5, v5, v7
    v_mul_f32 v4, v4, v7
    v_cvt_pk_bf16_f32 v10, v5, v4
    v_sub_f32 v54, v54, v6
    v_sub_f32 v55, v55, v6
    v_cvt_pk_bf16_f32 v4, v54, v55
    v_lshlrev_b32 v5, 16, v4
    v_and_b32 v4, 0xffff0000, v4
    v_mul_f32 v5, v5, v7
    v_mul_f32 v4, v4, v7
    v_cvt_pk_bf16_f32 v11, v5, v4
    buffer_store_dwordx4 v[8:11], v3, s[8:11], s37 offen offset:0 sc1
    v_sub_f32 v56, v56, v6
    v_sub_f32 v57, v57, v6
    v_cvt_pk_bf16_f32 v4, v56, v57
    v_lshlrev_b32 v5, 16, v4
    v_and_b32 v4, 0xffff0000, v4
    v_mul_f32 v5, v5, v7
    v_mul_f32 v4, v4, v7
    v_cvt_pk_bf16_f32 v12, v5, v4
    v_sub_f32 v58, v58, v6
    v_sub_f32 v59, v59, v6
    v_cvt_pk_bf16_f32 v4, v58, v59
    v_lshlrev_b32 v5, 16, v4
    v_and_b32 v4, 0xffff0000, v4
    v_mul_f32 v5, v5, v7
    v_mul_f32 v4, v4, v7
    v_cvt_pk_bf16_f32 v13, v5, v4
    v_sub_f32 v60, v60, v6
    v_sub_f32 v61, v61, v6
    v_cvt_pk_bf16_f32 v4, v60, v61
    v_lshlrev_b32 v5, 16, v4
    v_and_b32 v4, 0xffff0000, v4
    v_mul_f32 v5, v5, v7
    v_mul_f32 v4, v4, v7
    v_cvt_pk_bf16_f32 v14, v5, v4
    v_sub_f32 v62, v62, v6
    v_sub_f32 v63, v63, v6
    v_cvt_pk_bf16_f32 v4, v62, v63
    v_lshlrev_b32 v5, 16, v4
    v_and_b32 v4, 0xffff0000, v4
    v_mul_f32 v5, v5, v7
    v_mul_f32 v4, v4, v7
    v_cvt_pk_bf16_f32 v15, v5, v4
    buffer_store_dwordx4 v[12:15], v3, s[8:11], s37 offen offset:2048 sc1
    s_add_u32 s37, s37, 4096
    v_sub_f32 v64, v64, v6
    v_sub_f32 v65, v65, v6
    v_cvt_pk_bf16_f32 v4, v64, v65
    v_lshlrev_b32 v5, 16, v4
    v_and_b32 v4, 0xffff0000, v4
    v_mul_f32 v5, v5, v7
    v_mul_f32 v4, v4, v7
    v_cvt_pk_bf16_f32 v16, v5, v4
    v_sub_f32 v66, v66, v6
    v_sub_f32 v67, v67, v6
    v_cvt_pk_bf16_f32 v4, v66, v67
    v_lshlrev_b32 v5, 16, v4
    v_and_b32 v4, 0xffff0000, v4
    v_mul_f32 v5, v5, v7
    v_mul_f32 v4, v4, v7
    v_cvt_pk_bf16_f32 v17, v5, v4
    v_sub_f32 v68, v68, v6
    v_sub_f32 v69, v69, v6
    v_cvt_pk_bf16_f32 v4, v68, v69
    v_lshlrev_b32 v5, 16, v4
    v_and_b32 v4, 0xffff0000, v4
    v_mul_f32 v5, v5, v7
    v_mul_f32 v4, v4, v7
    v_cvt_pk_bf16_f32 v18, v5, v4
    v_sub_f32 v70, v70, v6
    v_sub_f32 v71, v71, v6
    v_cvt_pk_bf16_f32 v4, v70, v71
    v_lshlrev_b32 v5, 16, v4
    v_and_b32 v4, 0xffff0000, v4
    v_mul_f32 v5, v5, v7
    v_mul_f32 v4, v4, v7
    v_cvt_pk_bf16_f32 v19, v5, v4
    buffer_store_dwordx4 v[16:19], v3, s[8:11], s37 offen offset:0 sc1
    v_sub_f32 v72, v72, v6
    v_sub_f32 v73, v73, v6
    v_cvt_pk_bf16_f32 v4, v72, v73
    v_lshlrev_b32 v5, 16, v4
    v_and_b32 v4, 0xffff0000, v4
    v_mul_f32 v5, v5, v7
    v_mul_f32 v4, v4, v7
    v_cvt_pk_bf16_f32 v20, v5, v4
    v_sub_f32 v74, v74, v6
    v_sub_f32 v75, v75, v6
    v_cvt_pk_bf16_f32 v4, v74, v75
    v_lshlrev_b32 v5, 16, v4
    v_and_b32 v4, 0xffff0000, v4
    v_mul_f32 v5, v5, v7
    v_mul_f32 v4, v4, v7
    v_cvt_pk_bf16_f32 v21, v5, v4
    v_sub_f32 v76, v76, v6
    v_sub_f32 v77, v77, v6
    v_cvt_pk_bf16_f32 v4, v76, v77
    v_lshlrev_b32 v5, 16, v4
    v_and_b32 v4, 0xffff0000, v4
    v_mul_f32 v5, v5, v7
    v_mul_f32 v4, v4, v7
    v_cvt_pk_bf16_f32 v22, v5, v4
    v_sub_f32 v78, v78, v6
    v_sub_f32 v79, v79, v6
    v_cvt_pk_bf16_f32 v4, v78, v79
    v_lshlrev_b32 v5, 16, v4
    v_and_b32 v4, 0xffff0000, v4
    v_mul_f32 v5, v5, v7
    v_mul_f32 v4, v4, v7
    v_cvt_pk_bf16_f32 v23, v5, v4
    buffer_store_dwordx4 v[20:23], v3, s[8:11], s37 offen offset:2048 sc1
    s_add_u32 s37, s37, 4096
    v_sub_f32 v80, v80, v6
    v_sub_f32 v81, v81, v6
    v_cvt_pk_bf16_f32 v4, v80, v81
    v_lshlrev_b32 v5, 16, v4
    v_and_b32 v4, 0xffff0000, v4
    v_mul_f32 v5, v5, v7
    v_mul_f32 v4, v4, v7
    v_cvt_pk_bf16_f32 v24, v5, v4
    v_sub_f32 v82, v82, v6
    v_sub_f32 v83, v83, v6
    v_cvt_pk_bf16_f32 v4, v82, v83
    v_lshlrev_b32 v5, 16, v4
    v_and_b32 v4, 0xffff0000, v4
    v_mul_f32 v5, v5, v7
    v_mul_f32 v4, v4, v7
    v_cvt_pk_bf16_f32 v25, v5, v4
    v_sub_f32 v84, v84, v6
    v_sub_f32 v85, v85, v6
    v_cvt_pk_bf16_f32 v4, v84, v85
    v_lshlrev_b32 v5, 16, v4
    v_and_b32 v4, 0xffff0000, v4
    v_mul_f32 v5, v5, v7
    v_mul_f32 v4, v4, v7
    v_cvt_pk_bf16_f32 v26, v5, v4
    v_sub_f32 v86, v86, v6
    v_sub_f32 v87, v87, v6
    v_cvt_pk_bf16_f32 v4, v86, v87
    v_lshlrev_b32 v5, 16, v4
    v_and_b32 v4, 0xffff0000, v4
    v_mul_f32 v5, v5, v7
    v_mul_f32 v4, v4, v7
    v_cvt_pk_bf16_f32 v27, v5, v4
    buffer_store_dwordx4 v[24:27], v3, s[8:11], s37 offen offset:0 sc1
    v_sub_f32 v88, v88, v6
    v_sub_f32 v89, v89, v6
    v_cvt_pk_bf16_f32 v4, v88, v89
    v_lshlrev_b32 v5, 16, v4
    v_and_b32 v4, 0xffff0000, v4
    v_mul_f32 v5, v5, v7
    v_mul_f32 v4, v4, v7
    v_cvt_pk_bf16_f32 v28, v5, v4
    v_sub_f32 v90, v90, v6
    v_sub_f32 v91, v91, v6
    v_cvt_pk_bf16_f32 v4, v90, v91
    v_lshlrev_b32 v5, 16, v4
    v_and_b32 v4, 0xffff0000, v4
    v_mul_f32 v5, v5, v7
    v_mul_f32 v4, v4, v7
    v_cvt_pk_bf16_f32 v29, v5, v4
    v_sub_f32 v92, v92, v6
    v_sub_f32 v93, v93, v6
    v_cvt_pk_bf16_f32 v4, v92, v93
    v_lshlrev_b32 v5, 16, v4
    v_and_b32 v4, 0xffff0000, v4
    v_mul_f32 v5, v5, v7
    v_mul_f32 v4, v4, v7
    v_cvt_pk_bf16_f32 v30, v5, v4
    v_sub_f32 v94, v94, v6
    v_sub_f32 v95, v95, v6
    v_cvt_pk_bf16_f32 v4, v94, v95
    v_lshlrev_b32 v5, 16, v4
    v_and_b32 v4, 0xffff0000, v4
    v_mul_f32 v5, v5, v7
    v_mul_f32 v4, v4, v7
    v_cvt_pk_bf16_f32 v31, v5, v4
    buffer_store_dwordx4 v[28:31], v3, s[8:11], s37 offen offset:2048 sc1
    s_add_u32 s37, s37, 4096
    v_sub_f32 v96, v96, v6
    v_sub_f32 v97, v97, v6
    v_cvt_pk_bf16_f32 v4, v96, v97
    v_lshlrev_b32 v5, 16, v4
    v_and_b32 v4, 0xffff0000, v4
    v_mul_f32 v5, v5, v7
    v_mul_f32 v4, v4, v7
    v_cvt_pk_bf16_f32 v32, v5, v4
    v_sub_f32 v98, v98, v6
    v_sub_f32 v99, v99, v6
    v_cvt_pk_bf16_f32 v4, v98, v99
    v_lshlrev_b32 v5, 16, v4
    v_and_b32 v4, 0xffff0000, v4
    v_mul_f32 v5, v5, v7
    v_mul_f32 v4, v4, v7
    v_cvt_pk_bf16_f32 v33, v5, v4
    v_sub_f32 v100, v100, v6
    v_sub_f32 v101, v101, v6
    v_cvt_pk_bf16_f32 v4, v100, v101
    v_lshlrev_b32 v5, 16, v4
    v_and_b32 v4, 0xffff0000, v4
    v_mul_f32 v5, v5, v7
    v_mul_f32 v4, v4, v7
    v_cvt_pk_bf16_f32 v34, v5, v4
    v_sub_f32 v102, v102, v6
    v_sub_f32 v103, v103, v6
    v_cvt_pk_bf16_f32 v4, v102, v103
    v_lshlrev_b32 v5, 16, v4
    v_and_b32 v4, 0xffff0000, v4
    v_mul_f32 v5, v5, v7
    v_mul_f32 v4, v4, v7
    v_cvt_pk_bf16_f32 v35, v5, v4
    buffer_store_dwordx4 v[32:35], v3, s[8:11], s37 offen offset:0 sc1
    v_sub_f32 v104, v104, v6
    v_sub_f32 v105, v105, v6
    v_cvt_pk_bf16_f32 v4, v104, v105
    v_lshlrev_b32 v5, 16, v4
    v_and_b32 v4, 0xffff0000, v4
    v_mul_f32 v5, v5, v7
    v_mul_f32 v4, v4, v7
    v_cvt_pk_bf16_f32 v36, v5, v4
    v_sub_f32 v106, v106, v6
    v_sub_f32 v107, v107, v6
    v_cvt_pk_bf16_f32 v4, v106, v107
    v_lshlrev_b32 v5, 16, v4
    v_and_b32 v4, 0xffff0000, v4
    v_mul_f32 v5, v5, v7
    v_mul_f32 v4, v4, v7
    v_cvt_pk_bf16_f32 v37, v5, v4
    v_sub_f32 v108, v108, v6
    v_sub_f32 v109, v109, v6
    v_cvt_pk_bf16_f32 v4, v108, v109
    v_lshlrev_b32 v5, 16, v4
    v_and_b32 v4, 0xffff0000, v4
    v_mul_f32 v5, v5, v7
    v_mul_f32 v4, v4, v7
    v_cvt_pk_bf16_f32 v38, v5, v4
    v_sub_f32 v110, v110, v6
    v_sub_f32 v111, v111, v6
    v_cvt_pk_bf16_f32 v4, v110, v111
    v_lshlrev_b32 v5, 16, v4
    v_and_b32 v4, 0xffff0000, v4
    v_mul_f32 v5, v5, v7
    v_mul_f32 v4, v4, v7
    v_cvt_pk_bf16_f32 v39, v5, v4
    buffer_store_dwordx4 v[36:39], v3, s[8:11], s37 offen offset:2048 sc1
    s_add_u32 s37, s37, 4096
    v_sub_f32 v112, v112, v6
    v_sub_f32 v113, v113, v6
    v_cvt_pk_bf16_f32 v4, v112, v113
    v_lshlrev_b32 v5, 16, v4
    v_and_b32 v4, 0xffff0000, v4
    v_mul_f32 v5, v5, v7
    v_mul_f32 v4, v4, v7
    v_cvt_pk_bf16_f32 v40, v5, v4
    v_sub_f32 v114, v114, v6
    v_sub_f32 v115, v115, v6
    v_cvt_pk_bf16_f32 v4, v114, v115
    v_lshlrev_b32 v5, 16, v4
    v_and_b32 v4, 0xffff0000, v4
    v_mul_f32 v5, v5, v7
    v_mul_f32 v4, v4, v7
    v_cvt_pk_bf16_f32 v41, v5, v4
    v_sub_f32 v116, v116, v6
    v_sub_f32 v117, v117, v6
    v_cvt_pk_bf16_f32 v4, v116, v117
    v_lshlrev_b32 v5, 16, v4
    v_and_b32 v4, 0xffff0000, v4
    v_mul_f32 v5, v5, v7
    v_mul_f32 v4, v4, v7
    v_cvt_pk_bf16_f32 v42, v5, v4
    v_sub_f32 v118, v118, v6
    v_sub_f32 v119, v119, v6
    v_cvt_pk_bf16_f32 v4, v118, v119
    v_lshlrev_b32 v5, 16, v4
    v_and_b32 v4, 0xffff0000, v4
    v_mul_f32 v5, v5, v7
    v_mul_f32 v4, v4, v7
    v_cvt_pk_bf16_f32 v43, v5, v4
    buffer_store_dwordx4 v[40:43], v3, s[8:11], s37 offen offset:0 sc1
    v_sub_f32 v120, v120, v6
    v_sub_f32 v121, v121, v6
    v_cvt_pk_bf16_f32 v4, v120, v121
    v_lshlrev_b32 v5, 16, v4
    v_and_b32 v4, 0xffff0000, v4
    v_mul_f32 v5, v5, v7
    v_mul_f32 v4, v4, v7
    v_cvt_pk_bf16_f32 v44, v5, v4
    v_sub_f32 v122, v122, v6
    v_sub_f32 v123, v123, v6
    v_cvt_pk_bf16_f32 v4, v122, v123
    v_lshlrev_b32 v5, 16, v4
    v_and_b32 v4, 0xffff0000, v4
    v_mul_f32 v5, v5, v7
    v_mul_f32 v4, v4, v7
    v_cvt_pk_bf16_f32 v45, v5, v4
    v_sub_f32 v124, v124, v6
    v_sub_f32 v125, v125, v6
    v_cvt_pk_bf16_f32 v4, v124, v125
    v_lshlrev_b32 v5, 16, v4
    v_and_b32 v4, 0xffff0000, v4
    v_mul_f32 v5, v5, v7
    v_mul_f32 v4, v4, v7
    v_cvt_pk_bf16_f32 v46, v5, v4
    v_sub_f32 v126, v126, v6
    v_sub_f32 v127, v127, v6
    v_cvt_pk_bf16_f32 v4, v126, v127
    v_lshlrev_b32 v5, 16, v4
    v_and_b32 v4, 0xffff0000, v4
    v_mul_f32 v5, v5, v7
    v_mul_f32 v4, v4, v7
    v_cvt_pk_bf16_f32 v47, v5, v4
    buffer_store_dwordx4 v[44:47], v3, s[8:11], s37 offen offset:2048 sc1
    s_add_u32 s37, s37, 4096
    s_branch L_P1
L_P1:
    s_lshr_b32 s37, s67, 5
    s_and_b32 s68, s67, 31
    s_mov_b32 s70, 12288
    s_mov_b32 s76, 0x80008000
    s_cmp_eq_u32 s37, 1
    s_cselect_b32 s16, s46, s44
    s_cselect_b32 s17, s47, s45
    s_cmp_eq_u32 s37, 2
    s_cselect_b32 s16, s48, s16
    s_cselect_b32 s17, s49, s17
    s_lshr_b32 s38, s68, 3
    s_and_b32 s39, s68, 7
    s_cmp_eq_u32 s37, 3
    s_cselect_b32 s16, s56, s16
    s_cselect_b32 s17, s57, s17
    s_cselect_b32 s18, 0x1e0000, s18
    s_cselect_b32 s70, 3072, s70
    s_cselect_b32 s76, 0, s76
    s_cselect_b32 s68, s39, s68
    s_cselect_b32 s78, s38, 0
    s_cselect_b32 s52, 4, 1
    s_cselect_b32 s69, 16, 64
    s_and_b32 s17, s17, 0xffff
    s_mul_i32 s71, s68, 384
    s_lshl_b32 s37, s37, 5
    s_add_u32 s37, s37, s68
    s_lshl_b32 s37, s37, 6
    s_add_u32 s37, s37, s78
    s_mul_i32 s72, s37, 12288
    s_mul_i32 s37, s4, 3072
    s_add_u32 s72, s72, s37
    s_add_u32 s72, s72, 4194304
    s_mul_i32 s79, s52, 12288
    s_mul_i32 s53, s52, 40960
    s_lshl_b32 s73, s67, 7
    s_lshl_b32 s37, s4, 2
    s_add_u32 s73, s73, s37
    s_add_u32 s73, s73, 4096
    s_cmp_lg_u32 s3, 0
    s_cbranch_scc1 L_P1_nz
    s_mov_b64 exec, 1
    v_mov_b32 v2, 0
    buffer_store_dword v2, v2, s[8:11], s73 offen sc1
    s_mov_b64 exec, -1
    s_cmp_ge_u32 s67, 64
    s_cselect_b32 s37, 4096, 0
    s_add_u32 s37, s37, s73
    s_add_u32 s37, s37, 8192
    s_cmp_ge_u32 s67, 32
    s_cselect_b32 s37, s37, s73
    s_mov_b64 exec, 1
    v_mov_b32 v2, 0
    buffer_store_dword v2, v2, s[8:11], s37 offen sc1
    s_mov_b64 exec, -1
L_P1_nz:
    v_add_u32 v16, 0, v1
    v_mul_u32_u24 v17, 2731, v16
    v_lshrrev_b32 v17, 16, v17
    v_mul_u32_u24 v18, 24, v17
    v_sub_u32 v16, v16, v18
    v_and_b32 v18, 2, v17
    v_xor_b32 v16, v16, v18
    v_and_b32 v18, 8, v17
    v_lshrrev_b32 v18, 1, v18
    v_xor_b32 v16, v16, v18
    s_lshl_b32 s37, s4, 4
    v_add_u32 v17, s37, v17
    v_mul_lo_u32 v17, v17, s70
    v_lshl_add_u32 v16, v16, 4, v17
    v_add_u32 v4, s71, v16
    v_add_u32 v16, 64, v1
    v_mul_u32_u24 v17, 2731, v16
    v_lshrrev_b32 v17, 16, v17
    v_mul_u32_u24 v18, 24, v17
    v_sub_u32 v16, v16, v18
    v_and_b32 v18, 2, v17
    v_xor_b32 v16, v16, v18
    v_and_b32 v18, 8, v17
    v_lshrrev_b32 v18, 1, v18
    v_xor_b32 v16, v16, v18
    s_lshl_b32 s37, s4, 4
    v_add_u32 v17, s37, v17
    v_mul_lo_u32 v17, v17, s70
    v_lshl_add_u32 v16, v16, 4, v17
    v_add_u32 v5, s71, v16
    v_add_u32 v16, 128, v1
    v_mul_u32_u24 v17, 2731, v16
    v_lshrrev_b32 v17, 16, v17
    v_mul_u32_u24 v18, 24, v17
    v_sub_u32 v16, v16, v18
    v_and_b32 v18, 2, v17
    v_xor_b32 v16, v16, v18
    v_and_b32 v18, 8, v17
    v_lshrrev_b32 v18, 1, v18
    v_xor_b32 v16, v16, v18
    s_lshl_b32 s37, s4, 4
    v_add_u32 v17, s37, v17
    v_mul_lo_u32 v17, v17, s70
    v_lshl_add_u32 v16, v16, 4, v17
    v_add_u32 v6, s71, v16
    v_add_u32 v16, 192, v1
    v_mul_u32_u24 v17, 2731, v16
    v_lshrrev_b32 v17, 16, v17
    v_mul_u32_u24 v18, 24, v17
    v_sub_u32 v16, v16, v18
    v_and_b32 v18, 2, v17
    v_xor_b32 v16, v16, v18
    v_and_b32 v18, 8, v17
    v_lshrrev_b32 v18, 1, v18
    v_xor_b32 v16, v16, v18
    s_lshl_b32 s37, s4, 4
    v_add_u32 v17, s37, v17
    v_mul_lo_u32 v17, v17, s70
    v_lshl_add_u32 v16, v16, 4, v17
    v_add_u32 v7, s71, v16
    v_add_u32 v16, 256, v1
    v_mul_u32_u24 v17, 2731, v16
    v_lshrrev_b32 v17, 16, v17
    v_mul_u32_u24 v18, 24, v17
    v_sub_u32 v16, v16, v18
    v_and_b32 v18, 2, v17
    v_xor_b32 v16, v16, v18
    v_and_b32 v18, 8, v17
    v_lshrrev_b32 v18, 1, v18
    v_xor_b32 v16, v16, v18
    s_lshl_b32 s37, s4, 4
    v_add_u32 v17, s37, v17
    v_mul_lo_u32 v17, v17, s70
    v_lshl_add_u32 v16, v16, 4, v17
    v_add_u32 v8, s71, v16
    v_add_u32 v16, 320, v1
    v_mul_u32_u24 v17, 2731, v16
    v_lshrrev_b32 v17, 16, v17
    v_mul_u32_u24 v18, 24, v17
    v_sub_u32 v16, v16, v18
    v_and_b32 v18, 2, v17
    v_xor_b32 v16, v16, v18
    v_and_b32 v18, 8, v17
    v_lshrrev_b32 v18, 1, v18
    v_xor_b32 v16, v16, v18
    s_lshl_b32 s37, s4, 4
    v_add_u32 v17, s37, v17
    v_mul_lo_u32 v17, v17, s70
    v_lshl_add_u32 v16, v16, 4, v17
    v_add_u32 v9, s71, v16
    v_lshrrev_b32 v16, 4, v1
    v_bfe_u32 v17, v1, 2, 2
    v_lshl_add_u32 v18, v16, 3, v17
    v_mul_u32_u24 v13, 384, v18
    v_and_b32 v14, 1, v1
    v_lshl_add_u32 v13, v14, 3, v13
    v_and_b32 v17, 2, v17
    v_and_b32 v16, 1, v16
    v_lshl_or_b32 v17, v16, 2, v17
    v_bfe_u32 v16, v1, 1, 1
    s_mul_i32 s37, s4, 6
    v_add_u32 v18, s37, v16
    v_add_u32 v18, 0, v18
    v_xor_b32 v18, v18, v17
    v_lshl_add_u32 v10, v18, 4, v13
    v_add_u32 v18, s37, v16
    v_add_u32 v18, 2, v18
    v_xor_b32 v18, v18, v17
    v_lshl_add_u32 v11, v18, 4, v13
    v_add_u32 v18, s37, v16
    v_add_u32 v18, 4, v18
    v_xor_b32 v18, v18, v17
    v_lshl_add_u32 v12, v18, 4, v13
    s_mul_i32 s90, s4, 6144
    s_lshl_b32 s92, s70, 6
    s_mul_i32 s37, s92, 0
    s_add_u32 m0, s90, 0
    s_nop 0
    buffer_load_dwordx4 v4, s[16:19], s37 offen lds
    s_add_u32 m0, s90, 1024
    s_nop 0
    buffer_load_dwordx4 v5, s[16:19], s37 offen lds
    s_add_u32 m0, s90, 2048
    s_nop 0
    buffer_load_dwordx4 v6, s[16:19], s37 offen lds
    s_add_u32 m0, s90, 3072
    s_nop 0
    buffer_load_dwordx4 v7, s[16:19], s37 offen lds
    s_add_u32 m0, s90, 4096
    s_nop 0
    buffer_load_dwordx4 v8, s[16:19], s37 offen lds
    s_add_u32 m0, s90, 5120
    s_nop 0
    buffer_load_dwordx4 v9, s[16:19], s37 offen lds
    s_mul_i32 s37, s92, 1
    s_add_u32 m0, s90, 24576
    s_nop 0
    buffer_load_dwordx4 v4, s[16:19], s37 offen lds
    s_add_u32 m0, s90, 25600
    s_nop 0
    buffer_load_dwordx4 v5, s[16:19], s37 offen lds
    s_add_u32 m0, s90, 26624
    s_nop 0
    buffer_load_dwordx4 v6, s[16:19], s37 offen lds
    s_add_u32 m0, s90, 27648
    s_nop 0
    buffer_load_dwordx4 v7, s[16:19], s37 offen lds
    s_add_u32 m0, s90, 28672
    s_nop 0
    buffer_load_dwordx4 v8, s[16:19], s37 offen lds
    s_add_u32 m0, s90, 29696
    s_nop 0
    buffer_load_dwordx4 v9, s[16:19], s37 offen lds
    s_waitcnt vmcnt(12)
    s_barrier
    s_cmp_lg_u32 s3, 0
    s_cbranch_scc1 Lao_1
    s_cmp_lg_u32 s4, 0
    s_cbranch_scc1 Larr_2
    s_lshl_b32 s37, s7, 16
    s_add_u32 s37, s37, 1
    s_mov_b64 exec, 1
    v_mov_b32 v2, s37
    v_mov_b32 v3, 36
    buffer_atomic_add v2, v3, s[28:31], 0 offen
    s_mov_b64 exec, -1
Larr_2:
Lao_1:
    s_mul_i32 s37, s92, 2
    s_add_u32 m0, s90, 49152
    s_nop 0
    buffer_load_dwordx4 v4, s[16:19], s37 offen lds
    s_add_u32 m0, s90, 50176
    s_nop 0
    buffer_load_dwordx4 v5, s[16:19], s37 offen lds
    s_add_u32 m0, s90, 51200
    s_nop 0
    buffer_load_dwordx4 v6, s[16:19], s37 offen lds
    s_add_u32 m0, s90, 52224
    s_nop 0
    buffer_load_dwordx4 v7, s[16:19], s37 offen lds
    s_add_u32 m0, s90, 53248
    s_nop 0
    buffer_load_dwordx4 v8, s[16:19], s37 offen lds
    s_add_u32 m0, s90, 54272
    s_nop 0
    buffer_load_dwordx4 v9, s[16:19], s37 offen lds
    s_mul_i32 s37, s92, 3
    s_add_u32 m0, s90, 73728
    s_nop 0
    buffer_load_dwordx4 v4, s[16:19], s37 offen lds
    s_add_u32 m0, s90, 74752
    s_nop 0
    buffer_load_dwordx4 v5, s[16:19], s37 offen lds
    s_add_u32 m0, s90, 75776
    s_nop 0
    buffer_load_dwordx4 v6, s[16:19], s37 offen lds
    s_add_u32 m0, s90, 76800
    s_nop 0
    buffer_load_dwordx4 v7, s[16:19], s37 offen lds
    s_add_u32 m0, s90, 77824
    s_nop 0
    buffer_load_dwordx4 v8, s[16:19], s37 offen lds
    s_add_u32 m0, s90, 78848
    s_nop 0
    buffer_load_dwordx4 v9, s[16:19], s37 offen lds
    s_mul_i32 s37, s92, 4
    s_add_u32 m0, s90, 98304
    s_nop 0
    buffer_load_dwordx4 v4, s[16:19], s37 offen lds
    s_add_u32 m0, s90, 99328
    s_nop 0
    buffer_load_dwordx4 v5, s[16:19], s37 offen lds
    s_add_u32 m0, s90, 100352
    s_nop 0
    buffer_load_dwordx4 v6, s[16:19], s37 offen lds
    s_add_u32 m0, s90, 101376
    s_nop 0
    buffer_load_dwordx4 v7, s[16:19], s37 offen lds
    s_add_u32 m0, s90, 102400
    s_nop 0
    buffer_load_dwordx4 v8, s[16:19], s37 offen lds
    s_add_u32 m0, s90, 103424
    s_nop 0
    buffer_load_dwordx4 v9, s[16:19], s37 offen lds
    s_mul_i32 s37, s92, 5
    s_add_u32 m0, s90, 122880
    s_nop 0
    buffer_load_dwordx4 v4, s[16:19], s37 offen lds
    s_add_u32 m0, s90, 123904
    s_nop 0
    buffer_load_dwordx4 v5, s[16:19], s37 offen lds
    s_add_u32 m0, s90, 124928
    s_nop 0
    buffer_load_dwordx4 v6, s[16:19], s37 offen lds
    s_add_u32 m0, s90, 125952
    s_nop 0
    buffer_load_dwordx4 v7, s[16:19], s37 offen lds
    s_add_u32 m0, s90, 126976
    s_nop 0
    buffer_load_dwordx4 v8, s[16:19], s37 offen lds
    s_add_u32 m0, s90, 128000
    s_nop 0
    buffer_load_dwordx4 v9, s[16:19], s37 offen lds
    s_waitcnt vmcnt(30)
    s_barrier
    v_add_u32 v13, 0, v10
    v_add_u32 v14, 0, v11
    v_add_u32 v15, 0, v12
    ds_read_b64_tr_b16 a[0:1], v13 offset:0
    ds_read_b64_tr_b16 a[4:5], v14 offset:0
    ds_read_b64_tr_b16 a[8:9], v15 offset:0
    ds_read_b64_tr_b16 a[2:3], v13 offset:1536
    ds_read_b64_tr_b16 a[6:7], v14 offset:1536
    ds_read_b64_tr_b16 a[10:11], v15 offset:1536
    ds_read_b64_tr_b16 a[12:13], v13 offset:12288
    ds_read_b64_tr_b16 a[16:17], v14 offset:12288
    ds_read_b64_tr_b16 a[20:21], v15 offset:12288
    ds_read_b64_tr_b16 a[14:15], v13 offset:13824
    ds_read_b64_tr_b16 a[18:19], v14 offset:13824
    ds_read_b64_tr_b16 a[22:23], v15 offset:13824
    s_waitcnt lgkmcnt(0)
    s_barrier
    s_mul_i32 s37, s92, 6
    s_add_u32 m0, s90, 0
    s_nop 0
    buffer_load_dwordx4 v4, s[16:19], s37 offen lds
    s_add_u32 m0, s90, 1024
    s_nop 0
    buffer_load_dwordx4 v5, s[16:19], s37 offen lds
    s_add_u32 m0, s90, 2048
    s_nop 0
    buffer_load_dwordx4 v6, s[16:19], s37 offen lds
    s_add_u32 m0, s90, 3072
    s_nop 0
    buffer_load_dwordx4 v7, s[16:19], s37 offen lds
    s_add_u32 m0, s90, 4096
    s_nop 0
    buffer_load_dwordx4 v8, s[16:19], s37 offen lds
    s_add_u32 m0, s90, 5120
    s_nop 0
    buffer_load_dwordx4 v9, s[16:19], s37 offen lds
    s_waitcnt vmcnt(30)
    s_barrier
    v_add_u32 v13, 24576, v10
    v_add_u32 v14, 24576, v11
    v_add_u32 v15, 24576, v12
    ds_read_b64_tr_b16 a[24:25], v13 offset:0
    ds_read_b64_tr_b16 a[28:29], v14 offset:0
    ds_read_b64_tr_b16 a[32:33], v15 offset:0
    ds_read_b64_tr_b16 a[26:27], v13 offset:1536
    ds_read_b64_tr_b16 a[30:31], v14 offset:1536
    ds_read_b64_tr_b16 a[34:35], v15 offset:1536
    ds_read_b64_tr_b16 a[36:37], v13 offset:12288
    ds_read_b64_tr_b16 a[40:41], v14 offset:12288
    ds_read_b64_tr_b16 a[44:45], v15 offset:12288
    ds_read_b64_tr_b16 a[38:39], v13 offset:13824
    ds_read_b64_tr_b16 a[42:43], v14 offset:13824
    ds_read_b64_tr_b16 a[46:47], v15 offset:13824
    s_waitcnt lgkmcnt(0)
    s_barrier
    s_mul_i32 s37, s92, 7
    s_add_u32 m0, s90, 24576
    s_nop 0
    buffer_load_dwordx4 v4, s[16:19], s37 offen lds
    s_add_u32 m0, s90, 25600
    s_nop 0
    buffer_load_dwordx4 v5, s[16:19], s37 offen lds
    s_add_u32 m0, s90, 26624
    s_nop 0
    buffer_load_dwordx4 v6, s[16:19], s37 offen lds
    s_add_u32 m0, s90, 27648
    s_nop 0
    buffer_load_dwordx4 v7, s[16:19], s37 offen lds
    s_add_u32 m0, s90, 28672
    s_nop 0
    buffer_load_dwordx4 v8, s[16:19], s37 offen lds
    s_add_u32 m0, s90, 29696
    s_nop 0
    buffer_load_dwordx4 v9, s[16:19], s37 offen lds
    s_waitcnt vmcnt(30)
    s_barrier
    v_add_u32 v13, 49152, v10
    v_add_u32 v14, 49152, v11
    v_add_u32 v15, 49152, v12
    ds_read_b64_tr_b16 a[48:49], v13 offset:0
    ds_read_b64_tr_b16 a[52:53], v14 offset:0
    ds_read_b64_tr_b16 a[56:57], v15 offset:0
    ds_read_b64_tr_b16 a[50:51], v13 offset:1536
    ds_read_b64_tr_b16 a[54:55], v14 offset:1536
    ds_read_b64_tr_b16 a[58:59], v15 offset:1536
    ds_read_b64_tr_b16 a[60:61], v13 offset:12288
    ds_read_b64_tr_b16 a[64:65], v14 offset:12288
    ds_read_b64_tr_b16 a[68:69], v15 offset:12288
    ds_read_b64_tr_b16 a[62:63], v13 offset:13824
    ds_read_b64_tr_b16 a[66:67], v14 offset:13824
    ds_read_b64_tr_b16 a[70:71], v15 offset:13824
    s_waitcnt lgkmcnt(0)
    s_barrier
    s_mul_i32 s37, s92, 8
    s_add_u32 m0, s90, 49152
    s_nop 0
    buffer_load_dwordx4 v4, s[16:19], s37 offen lds
    s_add_u32 m0, s90, 50176
    s_nop 0
    buffer_load_dwordx4 v5, s[16:19], s37 offen lds
    s_add_u32 m0, s90, 51200
    s_nop 0
    buffer_load_dwordx4 v6, s[16:19], s37 offen lds
    s_add_u32 m0, s90, 52224
    s_nop 0
    buffer_load_dwordx4 v7, s[16:19], s37 offen lds
    s_add_u32 m0, s90, 53248
    s_nop 0
    buffer_load_dwordx4 v8, s[16:19], s37 offen lds
    s_add_u32 m0, s90, 54272
    s_nop 0
    buffer_load_dwordx4 v9, s[16:19], s37 offen lds
    s_waitcnt vmcnt(30)
    s_barrier
    v_add_u32 v13, 73728, v10
    v_add_u32 v14, 73728, v11
    v_add_u32 v15, 73728, v12
    ds_read_b64_tr_b16 a[72:73], v13 offset:0
    ds_read_b64_tr_b16 a[76:77], v14 offset:0
    ds_read_b64_tr_b16 a[80:81], v15 offset:0
    ds_read_b64_tr_b16 a[74:75], v13 offset:1536
    ds_read_b64_tr_b16 a[78:79], v14 offset:1536
    ds_read_b64_tr_b16 a[82:83], v15 offset:1536
    ds_read_b64_tr_b16 a[84:85], v13 offset:12288
    ds_read_b64_tr_b16 a[88:89], v14 offset:12288
    ds_read_b64_tr_b16 a[92:93], v15 offset:12288
    ds_read_b64_tr_b16 a[86:87], v13 offset:13824
    ds_read_b64_tr_b16 a[90:91], v14 offset:13824
    ds_read_b64_tr_b16 a[94:95], v15 offset:13824
    s_waitcnt lgkmcnt(0)
    s_barrier
    s_mul_i32 s37, s92, 9
    s_add_u32 m0, s90, 73728
    s_nop 0
    buffer_load_dwordx4 v4, s[16:19], s37 offen lds
    s_add_u32 m0, s90, 74752
    s_nop 0
    buffer_load_dwordx4 v5, s[16:19], s37 offen lds
    s_add_u32 m0, s90, 75776
    s_nop 0
    buffer_load_dwordx4 v6, s[16:19], s37 offen lds
    s_add_u32 m0, s90, 76800
    s_nop 0
    buffer_load_dwordx4 v7, s[16:19], s37 offen lds
    s_add_u32 m0, s90, 77824
    s_nop 0
    buffer_load_dwordx4 v8, s[16:19], s37 offen lds
    s_add_u32 m0, s90, 78848
    s_nop 0
    buffer_load_dwordx4 v9, s[16:19], s37 offen lds
    s_waitcnt vmcnt(30)
    s_barrier
    v_add_u32 v13, 98304, v10
    v_add_u32 v14, 98304, v11
    v_add_u32 v15, 98304, v12
    ds_read_b64_tr_b16 a[96:97], v13 offset:0
    ds_read_b64_tr_b16 a[100:101], v14 offset:0
    ds_read_b64_tr_b16 a[104:105], v15 offset:0
    ds_read_b64_tr_b16 a[98:99], v13 offset:1536
    ds_read_b64_tr_b16 a[102:103], v14 offset:1536
    ds_read_b64_tr_b16 a[106:107], v15 offset:1536
    ds_read_b64_tr_b16 a[108:109], v13 offset:12288
    ds_read_b64_tr_b16 a[112:113], v14 offset:12288
    ds_read_b64_tr_b16 a[116:117], v15 offset:12288
    ds_read_b64_tr_b16 a[110:111], v13 offset:13824
    ds_read_b64_tr_b16 a[114:115], v14 offset:13824
    ds_read_b64_tr_b16 a[118:119], v15 offset:13824
    s_waitcnt lgkmcnt(0)
    s_waitcnt vmcnt(24)
    s_barrier
    v_add_u32 v13, 122880, v10
    v_add_u32 v14, 122880, v11
    v_add_u32 v15, 122880, v12
    ds_read_b64_tr_b16 a[120:121], v13 offset:0
    ds_read_b64_tr_b16 a[124:125], v14 offset:0
    ds_read_b64_tr_b16 a[128:129], v15 offset:0
    ds_read_b64_tr_b16 a[122:123], v13 offset:1536
    ds_read_b64_tr_b16 a[126:127], v14 offset:1536
    ds_read_b64_tr_b16 a[130:131], v15 offset:1536
    ds_read_b64_tr_b16 a[132:133], v13 offset:12288
    ds_read_b64_tr_b16 a[136:137], v14 offset:12288
    ds_read_b64_tr_b16 a[140:141], v15 offset:12288
    ds_read_b64_tr_b16 a[134:135], v13 offset:13824
    ds_read_b64_tr_b16 a[138:139], v14 offset:13824
    ds_read_b64_tr_b16 a[142:143], v15 offset:13824
    s_waitcnt lgkmcnt(0)
    s_waitcnt vmcnt(18)
    s_barrier
    v_add_u32 v13, 0, v10
    v_add_u32 v14, 0, v11
    v_add_u32 v15, 0, v12
    ds_read_b64_tr_b16 a[144:145], v13 offset:0
    ds_read_b64_tr_b16 a[148:149], v14 offset:0
    ds_read_b64_tr_b16 a[152:153], v15 offset:0
    ds_read_b64_tr_b16 a[146:147], v13 offset:1536
    ds_read_b64_tr_b16 a[150:151], v14 offset:1536
    ds_read_b64_tr_b16 a[154:155], v15 offset:1536
    ds_read_b64_tr_b16 a[156:157], v13 offset:12288
    ds_read_b64_tr_b16 a[160:161], v14 offset:12288
    ds_read_b64_tr_b16 a[164:165], v15 offset:12288
    ds_read_b64_tr_b16 a[158:159], v13 offset:13824
    ds_read_b64_tr_b16 a[162:163], v14 offset:13824
    ds_read_b64_tr_b16 a[166:167], v15 offset:13824
    s_waitcnt lgkmcnt(0)
    s_waitcnt vmcnt(12)
    s_barrier
    v_add_u32 v13, 24576, v10
    v_add_u32 v14, 24576, v11
    v_add_u32 v15, 24576, v12
    ds_read_b64_tr_b16 a[168:169], v13 offset:0
    ds_read_b64_tr_b16 a[172:173], v14 offset:0
    ds_read_b64_tr_b16 a[176:177], v15 offset:0
    ds_read_b64_tr_b16 a[170:171], v13 offset:1536
    ds_read_b64_tr_b16 a[174:175], v14 offset:1536
    ds_read_b64_tr_b16 a[178:179], v15 offset:1536
    ds_read_b64_tr_b16 a[180:181], v13 offset:12288
    ds_read_b64_tr_b16 a[184:185], v14 offset:12288
    ds_read_b64_tr_b16 a[188:189], v15 offset:12288
    ds_read_b64_tr_b16 a[182:183], v13 offset:13824
    ds_read_b64_tr_b16 a[186:187], v14 offset:13824
    ds_read_b64_tr_b16 a[190:191], v15 offset:13824
    s_waitcnt lgkmcnt(0)
    s_waitcnt vmcnt(6)
    s_barrier
    v_add_u32 v13, 49152, v10
    v_add_u32 v14, 49152, v11
    v_add_u32 v15, 49152, v12
    ds_read_b64_tr_b16 a[192:193], v13 offset:0
    ds_read_b64_tr_b16 a[196:197], v14 offset:0
    ds_read_b64_tr_b16 a[200:201], v15 offset:0
    ds_read_b64_tr_b16 a[194:195], v13 offset:1536
    ds_read_b64_tr_b16 a[198:199], v14 offset:1536
    ds_read_b64_tr_b16 a[202:203], v15 offset:1536
    ds_read_b64_tr_b16 a[204:205], v13 offset:12288
    ds_read_b64_tr_b16 a[208:209], v14 offset:12288
    ds_read_b64_tr_b16 a[212:213], v15 offset:12288
    ds_read_b64_tr_b16 a[206:207], v13 offset:13824
    ds_read_b64_tr_b16 a[210:211], v14 offset:13824
    ds_read_b64_tr_b16 a[214:215], v15 offset:13824
    s_waitcnt lgkmcnt(0)
    s_waitcnt vmcnt(0)
    s_barrier
    v_add_u32 v13, 73728, v10
    v_add_u32 v14, 73728, v11
    v_add_u32 v15, 73728, v12
    ds_read_b64_tr_b16 a[216:217], v13 offset:0
    ds_read_b64_tr_b16 a[220:221], v14 offset:0
    ds_read_b64_tr_b16 a[224:225], v15 offset:0
    ds_read_b64_tr_b16 a[218:219], v13 offset:1536
    ds_read_b64_tr_b16 a[222:223], v14 offset:1536
    ds_read_b64_tr_b16 a[226:227], v15 offset:1536
    ds_read_b64_tr_b16 a[228:229], v13 offset:12288
    ds_read_b64_tr_b16 a[232:233], v14 offset:12288
    ds_read_b64_tr_b16 a[236:237], v15 offset:12288
    ds_read_b64_tr_b16 a[230:231], v13 offset:13824
    ds_read_b64_tr_b16 a[234:235], v14 offset:13824
    ds_read_b64_tr_b16 a[238:239], v15 offset:13824
    s_waitcnt lgkmcnt(0)
    v_mov_b32 v3, 36
    s_cmp_lg_u32 s4, 0
    s_cbranch_scc1 Lwik_5
Lwi_3:
    buffer_load_dword v2, v3, s[28:31], 0 offen sc1
    s_waitcnt vmcnt(0)
    v_readfirstlane_b32 s37, v2
    s_nop 0
    s_and_b32 s38, s37, 0xffff
    s_cmp_eq_u32 s38, 0x100
    s_cbranch_scc1 Lwid_4
    s_sleep 6
    s_sub_u32 s36, s36, 1
    s_cbranch_scc0 Lwi_3
    s_mov_b32 s36, 0
Lwid_4:
    v_mov_b32 v3, 163836
    ds_write_b32 v3, v2
    s_waitcnt lgkmcnt(0)
Lwik_5:
    s_waitcnt vmcnt(0)
    s_barrier
    v_mov_b32 v3, 163836
    ds_read_b32 v2, v3
    s_waitcnt lgkmcnt(0)
    v_readfirstlane_b32 s37, v2
    s_nop 0
    s_bfe_u32 s7, s37, 0x80010
    v_lshlrev_b32 v2, 4, v1
    v_mov_b32 v3, v2
    v_mov_b32 v4, s76
    v_mov_b32 v5, 0
    s_mul_i32 s75, s4, 10240
    s_mul_i32 s74, s78, 40960
    s_add_u32 s74, s74, s75
    s_add_u32 s74, s74, 1048576
    s_mov_b32 s77, 0
    s_add_u32 s37, s75, s77
    s_add_u32 m0, s37, 0
    s_add_u32 s38, s74, 0
    buffer_load_dwordx4 v2, s[8:11], s38 offen offset:0 lds
    buffer_load_dwordx4 v2, s[8:11], s38 offen offset:1024 lds
    buffer_load_dwordx4 v2, s[8:11], s38 offen offset:2048 lds
    buffer_load_dwordx4 v2, s[8:11], s38 offen offset:3072 lds
    s_add_u32 s37, s75, s77
    s_add_u32 m0, s37, 4096
    s_add_u32 s38, s74, 4096
    buffer_load_dwordx4 v2, s[8:11], s38 offen offset:0 lds
    buffer_load_dwordx4 v2, s[8:11], s38 offen offset:1024 lds
    buffer_load_dwordx4 v2, s[8:11], s38 offen offset:2048 lds
    buffer_load_dwordx4 v2, s[8:11], s38 offen offset:3072 lds
    s_add_u32 s37, s75, s77
    s_add_u32 m0, s37, 8192
    s_add_u32 s38, s74, 8192
    buffer_load_dwordx4 v2, s[8:11], s38 offen offset:0 lds
    buffer_load_dwordx4 v2, s[8:11], s38 offen offset:1024 lds
    s_add_u32 s74, s74, s53
    s_add_u32 s77, s77, 40960
    s_cmp_eq_u32 s77, 122880
    s_cselect_b32 s77, 0, s77
    s_waitcnt vmcnt(0)
    s_barrier
    ds_read_b128 v[44:47], v3 offset:0
    ds_read_b128 v[48:51], v3 offset:1024
    ds_read_b128 v[52:55], v3 offset:2048
    ds_read_b128 v[56:59], v3 offset:3072
    ds_read_b128 v[60:63], v3 offset:4096
    ds_read_b128 v[64:67], v3 offset:5120
    s_mov_b32 s66, 0
    s_mov_b32 s76, 40960
    s_waitcnt lgkmcnt(5)
    v_mfma_f32_16x16x32_bf16 v[8:11], a[0:3], v[44:47], 0
    ds_read_b128 v[68:71], v3 offset:6144
    v_mfma_f32_16x16x32_bf16 v[12:15], a[4:7], v[44:47], 0
    s_add_u32 s37, s75, s77
    s_add_u32 m0, s37, 0
    s_add_u32 s38, s74, 0
    v_mfma_f32_16x16x32_bf16 v[16:19], a[8:11], v[44:47], 0
    s_waitcnt lgkmcnt(5)
    v_mfma_f32_16x16x32_bf16 v[8:11], a[12:15], v[48:51], v[8:11]
    ds_read_b128 v[72:75], v3 offset:7168
    v_mfma_f32_16x16x32_bf16 v[12:15], a[16:19], v[48:51], v[12:15]
    buffer_load_dwordx4 v2, s[8:11], s38 offen offset:0 lds
    v_mfma_f32_16x16x32_bf16 v[16:19], a[20:23], v[48:51], v[16:19]
    s_waitcnt lgkmcnt(5)
    v_mfma_f32_16x16x32_bf16 v[8:11], a[24:27], v[52:55], v[8:11]
    ds_read_b128 v[44:47], v3 offset:8192
    v_mfma_f32_16x16x32_bf16 v[12:15], a[28:31], v[52:55], v[12:15]
    buffer_load_dwordx4 v2, s[8:11], s38 offen offset:1024 lds
    v_mfma_f32_16x16x32_bf16 v[16:19], a[32:35], v[52:55], v[16:19]
    s_waitcnt lgkmcnt(5)
    v_mfma_f32_16x16x32_bf16 v[8:11], a[36:39], v[56:59], v[8:11]
    ds_read_b128 v[48:51], v3 offset:9216
    v_mfma_f32_16x16x32_bf16 v[12:15], a[40:43], v[56:59], v[12:15]
    buffer_load_dwordx4 v2, s[8:11], s38 offen offset:2048 lds
    v_mfma_f32_16x16x32_bf16 v[16:19], a[44:47], v[56:59], v[16:19]
    s_waitcnt lgkmcnt(5)
    v_mfma_f32_16x16x32_bf16 v[8:11], a[48:51], v[60:63], v[8:11]
    ds_read_b128 v[52:55], v3 offset:10240
    v_mfma_f32_16x16x32_bf16 v[12:15], a[52:55], v[60:63], v[12:15]
    buffer_load_dwordx4 v2, s[8:11], s38 offen offset:3072 lds
    v_mfma_f32_16x16x32_bf16 v[16:19], a[56:59], v[60:63], v[16:19]
    s_waitcnt lgkmcnt(5)
    v_mfma_f32_16x16x32_bf16 v[8:11], a[60:63], v[64:67], v[8:11]
    ds_read_b128 v[56:59], v3 offset:11264
    v_mfma_f32_16x16x32_bf16 v[12:15], a[64:67], v[64:67], v[12:15]
    s_add_u32 s37, s75, s77
    s_add_u32 m0, s37, 4096
    s_add_u32 s38, s74, 4096
    v_mfma_f32_16x16x32_bf16 v[16:19], a[68:71], v[64:67], v[16:19]
    s_waitcnt lgkmcnt(5)
    v_mfma_f32_16x16x32_bf16 v[8:11], a[72:75], v[68:71], v[8:11]
    ds_read_b128 v[60:63], v3 offset:12288
    v_mfma_f32_16x16x32_bf16 v[12:15], a[76:79], v[68:71], v[12:15]
    buffer_load_dwordx4 v2, s[8:11], s38 offen offset:0 lds
    v_mfma_f32_16x16x32_bf16 v[16:19], a[80:83], v[68:71], v[16:19]
    s_waitcnt lgkmcnt(5)
    v_mfma_f32_16x16x32_bf16 v[8:11], a[84:87], v[72:75], v[8:11]
    ds_read_b128 v[64:67], v3 offset:13312
    v_mfma_f32_16x16x32_bf16 v[12:15], a[88:91], v[72:75], v[12:15]
    buffer_load_dwordx4 v2, s[8:11], s38 offen offset:1024 lds
    v_mfma_f32_16x16x32_bf16 v[16:19], a[92:95], v[72:75], v[16:19]
    s_waitcnt lgkmcnt(5)
    v_mfma_f32_16x16x32_bf16 v[8:11], a[96:99], v[44:47], v[8:11]
    ds_read_b128 v[68:71], v3 offset:14336
    v_mfma_f32_16x16x32_bf16 v[12:15], a[100:103], v[44:47], v[12:15]
    buffer_load_dwordx4 v2, s[8:11], s38 offen offset:2048 lds
    v_mfma_f32_16x16x32_bf16 v[16:19], a[104:107], v[44:47], v[16:19]
    s_waitcnt lgkmcnt(5)
    v_mfma_f32_16x16x32_bf16 v[8:11], a[108:111], v[48:51], v[8:11]
    ds_read_b128 v[72:75], v3 offset:15360
    v_mfma_f32_16x16x32_bf16 v[12:15], a[112:115], v[48:51], v[12:15]
    buffer_load_dwordx4 v2, s[8:11], s38 offen offset:3072 lds
    v_mfma_f32_16x16x32_bf16 v[16:19], a[116:119], v[48:51], v[16:19]
    s_waitcnt lgkmcnt(5)
    v_mfma_f32_16x16x32_bf16 v[8:11], a[120:123], v[52:55], v[8:11]
    ds_read_b128 v[44:47], v3 offset:16384
    v_mfma_f32_16x16x32_bf16 v[12:15], a[124:127], v[52:55], v[12:15]
    s_add_u32 s37, s75, s77
    s_add_u32 m0, s37, 8192
    s_add_u32 s38, s74, 8192
    v_mfma_f32_16x16x32_bf16 v[16:19], a[128:131], v[52:55], v[16:19]
    s_waitcnt lgkmcnt(5)
    v_mfma_f32_16x16x32_bf16 v[8:11], a[132:135], v[56:59], v[8:11]
    ds_read_b128 v[48:51], v3 offset:17408
    v_mfma_f32_16x16x32_bf16 v[12:15], a[136:139], v[56:59], v[12:15]
    buffer_load_dwordx4 v2, s[8:11], s38 offen offset:0 lds
    v_mfma_f32_16x16x32_bf16 v[16:19], a[140:143], v[56:59], v[16:19]
    s_waitcnt lgkmcnt(5)
    v_mfma_f32_16x16x32_bf16 v[8:11], a[144:147], v[60:63], v[8:11]
    ds_read_b128 v[52:55], v3 offset:18432
    v_mfma_f32_16x16x32_bf16 v[12:15], a[148:151], v[60:63], v[12:15]
    buffer_load_dwordx4 v2, s[8:11], s38 offen offset:1024 lds
    v_mfma_f32_16x16x32_bf16 v[16:19], a[152:155], v[60:63], v[16:19]
    s_waitcnt lgkmcnt(5)
    v_mfma_f32_16x16x32_bf16 v[8:11], a[156:159], v[64:67], v[8:11]
    ds_read_b128 v[56:59], v3 offset:19456
    v_mfma_f32_16x16x32_bf16 v[12:15], a[160:163], v[64:67], v[12:15]
    s_add_u32 s74, s74, s53
    s_add_u32 s77, s77, 40960
    s_cmp_eq_u32 s77, 122880
    s_cselect_b32 s77, 0, s77
    v_mfma_f32_16x16x32_bf16 v[16:19], a[164:167], v[64:67], v[16:19]
    s_waitcnt lgkmcnt(5)
    v_mfma_f32_16x16x32_bf16 v[8:11], a[168:171], v[68:71], v[8:11]
    ds_read_b128 v[60:63], v3 offset:20480
    v_mfma_f32_16x16x32_bf16 v[12:15], a[172:175], v[68:71], v[12:15]
    s_add_u32 s37, s75, s77
    s_add_u32 m0, s37, 0
    s_add_u32 s38, s74, 0
    v_mfma_f32_16x16x32_bf16 v[16:19], a[176:179], v[68:71], v[16:19]
    s_waitcnt lgkmcnt(5)
    v_mfma_f32_16x16x32_bf16 v[8:11], a[180:183], v[72:75], v[8:11]
    ds_read_b128 v[64:67], v3 offset:21504
    v_mfma_f32_16x16x32_bf16 v[12:15], a[184:187], v[72:75], v[12:15]
    buffer_load_dwordx4 v2, s[8:11], s38 offen offset:0 lds
    v_mfma_f32_16x16x32_bf16 v[16:19], a[188:191], v[72:75], v[16:19]
    s_waitcnt lgkmcnt(5)
    v_mfma_f32_16x16x32_bf16 v[8:11], a[192:195], v[44:47], v[8:11]
    ds_read_b128 v[68:71], v3 offset:22528
    v_mfma_f32_16x16x32_bf16 v[12:15], a[196:199], v[44:47], v[12:15]
    buffer_load_dwordx4 v2, s[8:11], s38 offen offset:1024 lds
    v_mfma_f32_16x16x32_bf16 v[16:19], a[200:203], v[44:47], v[16:19]
    s_waitcnt lgkmcnt(5)
    v_mfma_f32_16x16x32_bf16 v[8:11], a[204:207], v[48:51], v[8:11]
    ds_read_b128 v[72:75], v3 offset:23552
    v_mfma_f32_16x16x32_bf16 v[12:15], a[208:211], v[48:51], v[12:15]
    buffer_load_dwordx4 v2, s[8:11], s38 offen offset:2048 lds
    v_mfma_f32_16x16x32_bf16 v[16:19], a[212:215], v[48:51], v[16:19]
    s_waitcnt lgkmcnt(5)
    v_mfma_f32_16x16x32_bf16 v[8:11], a[216:219], v[52:55], v[8:11]
    ds_read_b128 v[44:47], v3 offset:24576
    v_mfma_f32_16x16x32_bf16 v[12:15], a[220:223], v[52:55], v[12:15]
    buffer_load_dwordx4 v2, s[8:11], s38 offen offset:3072 lds
    v_mfma_f32_16x16x32_bf16 v[16:19], a[224:227], v[52:55], v[16:19]
    s_waitcnt lgkmcnt(5)
    v_mfma_f32_16x16x32_bf16 v[8:11], a[228:231], v[56:59], v[8:11]
    ds_read_b128 v[48:51], v3 offset:25600
    v_mfma_f32_16x16x32_bf16 v[12:15], a[232:235], v[56:59], v[12:15]
    s_add_u32 s37, s75, s77
    s_add_u32 m0, s37, 4096
    s_add_u32 s38, s74, 4096
    v_mfma_f32_16x16x32_bf16 v[16:19], a[236:239], v[56:59], v[16:19]
    s_waitcnt lgkmcnt(5)
    v_mfma_f32_16x16x32_bf16 v[20:23], a[0:3], v[60:63], 0
    ds_read_b128 v[52:55], v3 offset:26624
    v_mfma_f32_16x16x32_bf16 v[24:27], a[4:7], v[60:63], 0
    buffer_load_dwordx4 v2, s[8:11], s38 offen offset:0 lds
    v_mfma_f32_16x16x32_bf16 v[28:31], a[8:11], v[60:63], 0
    s_waitcnt lgkmcnt(5)
    v_mfma_f32_16x16x32_bf16 v[20:23], a[12:15], v[64:67], v[20:23]
    ds_read_b128 v[56:59], v3 offset:27648
    v_mfma_f32_16x16x32_bf16 v[24:27], a[16:19], v[64:67], v[24:27]
    buffer_load_dwordx4 v2, s[8:11], s38 offen offset:1024 lds
    v_mfma_f32_16x16x32_bf16 v[28:31], a[20:23], v[64:67], v[28:31]
    s_waitcnt lgkmcnt(5)
    v_mfma_f32_16x16x32_bf16 v[20:23], a[24:27], v[68:71], v[20:23]
    ds_read_b128 v[60:63], v3 offset:28672
    v_mfma_f32_16x16x32_bf16 v[24:27], a[28:31], v[68:71], v[24:27]
    buffer_load_dwordx4 v2, s[8:11], s38 offen offset:2048 lds
    v_mfma_f32_16x16x32_bf16 v[28:31], a[32:35], v[68:71], v[28:31]
    s_waitcnt lgkmcnt(5)
    v_mfma_f32_16x16x32_bf16 v[20:23], a[36:39], v[72:75], v[20:23]
    ds_read_b128 v[64:67], v3 offset:29696
    v_mfma_f32_16x16x32_bf16 v[24:27], a[40:43], v[72:75], v[24:27]
    buffer_load_dwordx4 v2, s[8:11], s38 offen offset:3072 lds
    v_mfma_f32_16x16x32_bf16 v[28:31], a[44:47], v[72:75], v[28:31]
    s_waitcnt lgkmcnt(5)
    v_mfma_f32_16x16x32_bf16 v[20:23], a[48:51], v[44:47], v[20:23]
    ds_read_b128 v[68:71], v3 offset:30720
    v_mfma_f32_16x16x32_bf16 v[24:27], a[52:55], v[44:47], v[24:27]
    s_add_u32 s37, s75, s77
    s_add_u32 m0, s37, 8192
    s_add_u32 s38, s74, 8192
    v_mfma_f32_16x16x32_bf16 v[28:31], a[56:59], v[44:47], v[28:31]
    s_waitcnt lgkmcnt(5)
    v_mfma_f32_16x16x32_bf16 v[20:23], a[60:63], v[48:51], v[20:23]
    ds_read_b128 v[72:75], v3 offset:31744
    v_mfma_f32_16x16x32_bf16 v[24:27], a[64:67], v[48:51], v[24:27]
    buffer_load_dwordx4 v2, s[8:11], s38 offen offset:0 lds
    v_mfma_f32_16x16x32_bf16 v[28:31], a[68:71], v[48:51], v[28:31]
    s_waitcnt lgkmcnt(5)
    v_mfma_f32_16x16x32_bf16 v[20:23], a[72:75], v[52:55], v[20:23]
    ds_read_b128 v[44:47], v3 offset:32768
    v_mfma_f32_16x16x32_bf16 v[24:27], a[76:79], v[52:55], v[24:27]
    buffer_load_dwordx4 v2, s[8:11], s38 offen offset:1024 lds
    v_mfma_f32_16x16x32_bf16 v[28:31], a[80:83], v[52:55], v[28:31]
    s_waitcnt lgkmcnt(5)
    v_mfma_f32_16x16x32_bf16 v[20:23], a[84:87], v[56:59], v[20:23]
    ds_read_b128 v[48:51], v3 offset:33792
    v_mfma_f32_16x16x32_bf16 v[24:27], a[88:91], v[56:59], v[24:27]
    s_add_u32 s74, s74, s53
    s_add_u32 s77, s77, 40960
    s_cmp_eq_u32 s77, 122880
    s_cselect_b32 s77, 0, s77
    v_mfma_f32_16x16x32_bf16 v[28:31], a[92:95], v[56:59], v[28:31]
    v_cvt_pk_bf16_f32 v32, v8, v9
    s_waitcnt lgkmcnt(5)
    v_mfma_f32_16x16x32_bf16 v[20:23], a[96:99], v[60:63], v[20:23]
    ds_read_b128 v[52:55], v3 offset:34816
    v_mfma_f32_16x16x32_bf16 v[24:27], a[100:103], v[60:63], v[24:27]
    v_cvt_pk_bf16_f32 v33, v10, v11
    v_mfma_f32_16x16x32_bf16 v[28:31], a[104:107], v[60:63], v[28:31]
    v_cvt_pk_bf16_f32 v34, v12, v13
    s_waitcnt lgkmcnt(5)
    v_mfma_f32_16x16x32_bf16 v[20:23], a[108:111], v[64:67], v[20:23]
    ds_read_b128 v[56:59], v3 offset:35840
    v_mfma_f32_16x16x32_bf16 v[24:27], a[112:115], v[64:67], v[24:27]
    v_cvt_pk_bf16_f32 v35, v14, v15
    v_mfma_f32_16x16x32_bf16 v[28:31], a[116:119], v[64:67], v[28:31]
    v_cvt_pk_bf16_f32 v40, v16, v17
    s_waitcnt lgkmcnt(5)
    v_mfma_f32_16x16x32_bf16 v[20:23], a[120:123], v[68:71], v[20:23]
    ds_read_b128 v[60:63], v3 offset:36864
    v_mfma_f32_16x16x32_bf16 v[24:27], a[124:127], v[68:71], v[24:27]
    v_cvt_pk_bf16_f32 v41, v18, v19
    v_mfma_f32_16x16x32_bf16 v[28:31], a[128:131], v[68:71], v[28:31]
    v_pk_max_i16 v32, v32, v4
    s_waitcnt lgkmcnt(5)
    v_mfma_f32_16x16x32_bf16 v[20:23], a[132:135], v[72:75], v[20:23]
    ds_read_b128 v[64:67], v3 offset:37888
    v_mfma_f32_16x16x32_bf16 v[24:27], a[136:139], v[72:75], v[24:27]
    v_pk_max_i16 v33, v33, v4
    v_mfma_f32_16x16x32_bf16 v[28:31], a[140:143], v[72:75], v[28:31]
    v_pk_max_i16 v34, v34, v4
    s_waitcnt lgkmcnt(5)
    v_mfma_f32_16x16x32_bf16 v[20:23], a[144:147], v[44:47], v[20:23]
    ds_read_b128 v[68:71], v3 offset:38912
    v_mfma_f32_16x16x32_bf16 v[24:27], a[148:151], v[44:47], v[24:27]
    v_pk_max_i16 v35, v35, v4
    v_mfma_f32_16x16x32_bf16 v[28:31], a[152:155], v[44:47], v[28:31]
    s_waitcnt vmcnt(10)
    s_barrier
    s_waitcnt lgkmcnt(5)
    v_mfma_f32_16x16x32_bf16 v[20:23], a[156:159], v[48:51], v[20:23]
    ds_read_b128 v[72:75], v3 offset:39936
    v_mfma_f32_16x16x32_bf16 v[24:27], a[160:163], v[48:51], v[24:27]
    v_pk_max_i16 v40, v40, v4
    v_mfma_f32_16x16x32_bf16 v[28:31], a[164:167], v[48:51], v[28:31]
    v_pk_max_i16 v41, v41, v4
    s_waitcnt lgkmcnt(5)
    v_mfma_f32_16x16x32_bf16 v[20:23], a[168:171], v[52:55], v[20:23]
    v_add_u32 v3, s76, v2
    ds_read_b128 v[44:47], v3 offset:0
    v_mfma_f32_16x16x32_bf16 v[24:27], a[172:175], v[52:55], v[24:27]
    v_mfma_f32_16x16x32_bf16 v[28:31], a[176:179], v[52:55], v[28:31]
    s_waitcnt lgkmcnt(5)
    v_mfma_f32_16x16x32_bf16 v[20:23], a[180:183], v[56:59], v[20:23]
    ds_read_b128 v[48:51], v3 offset:1024
    v_mfma_f32_16x16x32_bf16 v[24:27], a[184:187], v[56:59], v[24:27]
    v_mfma_f32_16x16x32_bf16 v[28:31], a[188:191], v[56:59], v[28:31]
    s_waitcnt lgkmcnt(5)
    v_mfma_f32_16x16x32_bf16 v[20:23], a[192:195], v[60:63], v[20:23]
    ds_read_b128 v[52:55], v3 offset:2048
    v_mfma_f32_16x16x32_bf16 v[24:27], a[196:199], v[60:63], v[24:27]
    v_mfma_f32_16x16x32_bf16 v[28:31], a[200:203], v[60:63], v[28:31]
    s_waitcnt lgkmcnt(5)
    v_mfma_f32_16x16x32_bf16 v[20:23], a[204:207], v[64:67], v[20:23]
    ds_read_b128 v[56:59], v3 offset:3072
    v_mfma_f32_16x16x32_bf16 v[24:27], a[208:211], v[64:67], v[24:27]
    v_mfma_f32_16x16x32_bf16 v[28:31], a[212:215], v[64:67], v[28:31]
    s_waitcnt lgkmcnt(5)
    v_mfma_f32_16x16x32_bf16 v[20:23], a[216:219], v[68:71], v[20:23]
    ds_read_b128 v[60:63], v3 offset:4096
    v_mfma_f32_16x16x32_bf16 v[24:27], a[220:223], v[68:71], v[24:27]
    v_mfma_f32_16x16x32_bf16 v[28:31], a[224:227], v[68:71], v[28:31]
    s_waitcnt lgkmcnt(5)
    v_mfma_f32_16x16x32_bf16 v[20:23], a[228:231], v[72:75], v[20:23]
    ds_read_b128 v[64:67], v3 offset:5120
    v_mfma_f32_16x16x32_bf16 v[24:27], a[232:235], v[72:75], v[24:27]
    v_mfma_f32_16x16x32_bf16 v[28:31], a[236:239], v[72:75], v[28:31]
    s_add_u32 s76, s76, 40960
    s_cmp_eq_u32 s76, 122880
    s_cselect_b32 s76, 0, s76
    s_add_u32 s66, s66, 1
    buffer_store_dwordx4 v[32:35], v2, s[8:11], s72 offen offset:0 sc1
    v_cvt_pk_bf16_f32 v36, v20, v21
    v_cvt_pk_bf16_f32 v37, v22, v23
    v_cvt_pk_bf16_f32 v38, v24, v25
    v_cvt_pk_bf16_f32 v39, v26, v27
    v_cvt_pk_bf16_f32 v42, v28, v29
    v_cvt_pk_bf16_f32 v43, v30, v31
    v_pk_max_i16 v36, v36, v4
    v_pk_max_i16 v37, v37, v4
    v_pk_max_i16 v38, v38, v4
    v_pk_max_i16 v39, v39, v4
    v_pk_max_i16 v42, v42, v4
    v_pk_max_i16 v43, v43, v4
    buffer_store_dwordx4 v[36:39], v2, s[8:11], s72 offen offset:1024 sc1
    buffer_store_dwordx4 v[40:43], v2, s[8:11], s72 offen offset:2048 sc1
    s_add_u32 s72, s72, s79
    s_waitcnt vmcnt(0)
    v_mov_b32 v6, s66
    s_mov_b64 exec, 1
    buffer_store_dword v6, v5, s[8:11], s73 offen sc1
    s_mov_b64 exec, -1
    s_waitcnt lgkmcnt(5)
    v_mfma_f32_16x16x32_bf16 v[8:11], a[0:3], v[44:47], 0
    ds_read_b128 v[68:71], v3 offset:6144
    v_mfma_f32_16x16x32_bf16 v[12:15], a[4:7], v[44:47], 0
    s_barrier
    v_mfma_f32_16x16x32_bf16 v[16:19], a[8:11], v[44:47], 0
    s_waitcnt lgkmcnt(5)
    v_mfma_f32_16x16x32_bf16 v[8:11], a[12:15], v[48:51], v[8:11]
    ds_read_b128 v[72:75], v3 offset:7168
    v_mfma_f32_16x16x32_bf16 v[12:15], a[16:19], v[48:51], v[12:15]
    s_add_u32 s37, s75, s77
    s_add_u32 m0, s37, 0
    s_add_u32 s38, s74, 0
    v_mfma_f32_16x16x32_bf16 v[16:19], a[20:23], v[48:51], v[16:19]
    s_waitcnt lgkmcnt(5)
    v_mfma_f32_16x16x32_bf16 v[8:11], a[24:27], v[52:55], v[8:11]
    ds_read_b128 v[44:47], v3 offset:8192
    v_mfma_f32_16x16x32_bf16 v[12:15], a[28:31], v[52:55], v[12:15]
    buffer_load_dwordx4 v2, s[8:11], s38 offen offset:0 lds
    v_mfma_f32_16x16x32_bf16 v[16:19], a[32:35], v[52:55], v[16:19]
    s_waitcnt lgkmcnt(5)
    v_mfma_f32_16x16x32_bf16 v[8:11], a[36:39], v[56:59], v[8:11]
    ds_read_b128 v[48:51], v3 offset:9216
    v_mfma_f32_16x16x32_bf16 v[12:15], a[40:43], v[56:59], v[12:15]
    buffer_load_dwordx4 v2, s[8:11], s38 offen offset:1024 lds
    v_mfma_f32_16x16x32_bf16 v[16:19], a[44:47], v[56:59], v[16:19]
    s_waitcnt lgkmcnt(5)
    v_mfma_f32_16x16x32_bf16 v[8:11], a[48:51], v[60:63], v[8:11]
    ds_read_b128 v[52:55], v3 offset:10240
    v_mfma_f32_16x16x32_bf16 v[12:15], a[52:55], v[60:63], v[12:15]
    buffer_load_dwordx4 v2, s[8:11], s38 offen offset:2048 lds
    v_mfma_f32_16x16x32_bf16 v[16:19], a[56:59], v[60:63], v[16:19]
    s_waitcnt lgkmcnt(5)
    v_mfma_f32_16x16x32_bf16 v[8:11], a[60:63], v[64:67], v[8:11]
    ds_read_b128 v[56:59], v3 offset:11264
    v_mfma_f32_16x16x32_bf16 v[12:15], a[64:67], v[64:67], v[12:15]
    buffer_load_dwordx4 v2, s[8:11], s38 offen offset:3072 lds
    v_mfma_f32_16x16x32_bf16 v[16:19], a[68:71], v[64:67], v[16:19]
    s_waitcnt lgkmcnt(5)
    v_mfma_f32_16x16x32_bf16 v[8:11], a[72:75], v[68:71], v[8:11]
    ds_read_b128 v[60:63], v3 offset:12288
    v_mfma_f32_16x16x32_bf16 v[12:15], a[76:79], v[68:71], v[12:15]
    s_add_u32 s37, s75, s77
    s_add_u32 m0, s37, 4096
    s_add_u32 s38, s74, 4096
    v_mfma_f32_16x16x32_bf16 v[16:19], a[80:83], v[68:71], v[16:19]
    s_waitcnt lgkmcnt(5)
    v_mfma_f32_16x16x32_bf16 v[8:11], a[84:87], v[72:75], v[8:11]
    ds_read_b128 v[64:67], v3 offset:13312
    v_mfma_f32_16x16x32_bf16 v[12:15], a[88:91], v[72:75], v[12:15]
    buffer_load_dwordx4 v2, s[8:11], s38 offen offset:0 lds
    v_mfma_f32_16x16x32_bf16 v[16:19], a[92:95], v[72:75], v[16:19]
    s_waitcnt lgkmcnt(5)
    v_mfma_f32_16x16x32_bf16 v[8:11], a[96:99], v[44:47], v[8:11]
    ds_read_b128 v[68:71], v3 offset:14336
    v_mfma_f32_16x16x32_bf16 v[12:15], a[100:103], v[44:47], v[12:15]
    buffer_load_dwordx4 v2, s[8:11], s38 offen offset:1024 lds
    v_mfma_f32_16x16x32_bf16 v[16:19], a[104:107], v[44:47], v[16:19]
    s_waitcnt lgkmcnt(5)
    v_mfma_f32_16x16x32_bf16 v[8:11], a[108:111], v[48:51], v[8:11]
    ds_read_b128 v[72:75], v3 offset:15360
    v_mfma_f32_16x16x32_bf16 v[12:15], a[112:115], v[48:51], v[12:15]
    buffer_load_dwordx4 v2, s[8:11], s38 offen offset:2048 lds
    v_mfma_f32_16x16x32_bf16 v[16:19], a[116:119], v[48:51], v[16:19]
    s_waitcnt lgkmcnt(5)
    v_mfma_f32_16x16x32_bf16 v[8:11], a[120:123], v[52:55], v[8:11]
    ds_read_b128 v[44:47], v3 offset:16384
    v_mfma_f32_16x16x32_bf16 v[12:15], a[124:127], v[52:55], v[12:15]
    buffer_load_dwordx4 v2, s[8:11], s38 offen offset:3072 lds
    v_mfma_f32_16x16x32_bf16 v[16:19], a[128:131], v[52:55], v[16:19]
    s_waitcnt lgkmcnt(5)
    v_mfma_f32_16x16x32_bf16 v[8:11], a[132:135], v[56:59], v[8:11]
    ds_read_b128 v[48:51], v3 offset:17408
    v_mfma_f32_16x16x32_bf16 v[12:15], a[136:139], v[56:59], v[12:15]
    s_add_u32 s37, s75, s77
    s_add_u32 m0, s37, 8192
    s_add_u32 s38, s74, 8192
    v_mfma_f32_16x16x32_bf16 v[16:19], a[140:143], v[56:59], v[16:19]
    s_waitcnt lgkmcnt(5)
    v_mfma_f32_16x16x32_bf16 v[8:11], a[144:147], v[60:63], v[8:11]
    ds_read_b128 v[52:55], v3 offset:18432
    v_mfma_f32_16x16x32_bf16 v[12:15], a[148:151], v[60:63], v[12:15]
    buffer_load_dwordx4 v2, s[8:11], s38 offen offset:0 lds
    v_mfma_f32_16x16x32_bf16 v[16:19], a[152:155], v[60:63], v[16:19]
    s_waitcnt lgkmcnt(5)
    v_mfma_f32_16x16x32_bf16 v[8:11], a[156:159], v[64:67], v[8:11]
    ds_read_b128 v[56:59], v3 offset:19456
    v_mfma_f32_16x16x32_bf16 v[12:15], a[160:163], v[64:67], v[12:15]
    buffer_load_dwordx4 v2, s[8:11], s38 offen offset:1024 lds
    v_mfma_f32_16x16x32_bf16 v[16:19], a[164:167], v[64:67], v[16:19]
    s_waitcnt lgkmcnt(5)
    v_mfma_f32_16x16x32_bf16 v[8:11], a[168:171], v[68:71], v[8:11]
    ds_read_b128 v[60:63], v3 offset:20480
    v_mfma_f32_16x16x32_bf16 v[12:15], a[172:175], v[68:71], v[12:15]
    s_add_u32 s74, s74, s53
    s_add_u32 s77, s77, 40960
    s_cmp_eq_u32 s77, 122880
    s_cselect_b32 s77, 0, s77
    v_mfma_f32_16x16x32_bf16 v[16:19], a[176:179], v[68:71], v[16:19]
    s_waitcnt lgkmcnt(5)
    v_mfma_f32_16x16x32_bf16 v[8:11], a[180:183], v[72:75], v[8:11]
    ds_read_b128 v[64:67], v3 offset:21504
    v_mfma_f32_16x16x32_bf16 v[12:15], a[184:187], v[72:75], v[12:15]
    v_mfma_f32_16x16x32_bf16 v[16:19], a[188:191], v[72:75], v[16:19]
    s_waitcnt lgkmcnt(5)
    v_mfma_f32_16x16x32_bf16 v[8:11], a[192:195], v[44:47], v[8:11]
    ds_read_b128 v[68:71], v3 offset:22528
    v_mfma_f32_16x16x32_bf16 v[12:15], a[196:199], v[44:47], v[12:15]
    v_mfma_f32_16x16x32_bf16 v[16:19], a[200:203], v[44:47], v[16:19]
    s_waitcnt lgkmcnt(5)
    v_mfma_f32_16x16x32_bf16 v[8:11], a[204:207], v[48:51], v[8:11]
    ds_read_b128 v[72:75], v3 offset:23552
    v_mfma_f32_16x16x32_bf16 v[12:15], a[208:211], v[48:51], v[12:15]
    v_mfma_f32_16x16x32_bf16 v[16:19], a[212:215], v[48:51], v[16:19]
    s_waitcnt lgkmcnt(5)
    v_mfma_f32_16x16x32_bf16 v[8:11], a[216:219], v[52:55], v[8:11]
    ds_read_b128 v[44:47], v3 offset:24576
    v_mfma_f32_16x16x32_bf16 v[12:15], a[220:223], v[52:55], v[12:15]
    v_mfma_f32_16x16x32_bf16 v[16:19], a[224:227], v[52:55], v[16:19]
    s_waitcnt lgkmcnt(5)
    v_mfma_f32_16x16x32_bf16 v[8:11], a[228:231], v[56:59], v[8:11]
    ds_read_b128 v[48:51], v3 offset:25600
    v_mfma_f32_16x16x32_bf16 v[12:15], a[232:235], v[56:59], v[12:15]
    v_mfma_f32_16x16x32_bf16 v[16:19], a[236:239], v[56:59], v[16:19]
    s_waitcnt lgkmcnt(5)
    v_mfma_f32_16x16x32_bf16 v[20:23], a[0:3], v[60:63], 0
    ds_read_b128 v[52:55], v3 offset:26624
    v_mfma_f32_16x16x32_bf16 v[24:27], a[4:7], v[60:63], 0
    v_mfma_f32_16x16x32_bf16 v[28:31], a[8:11], v[60:63], 0
    s_waitcnt lgkmcnt(5)
    v_mfma_f32_16x16x32_bf16 v[20:23], a[12:15], v[64:67], v[20:23]
    ds_read_b128 v[56:59], v3 offset:27648
    v_mfma_f32_16x16x32_bf16 v[24:27], a[16:19], v[64:67], v[24:27]
    v_mfma_f32_16x16x32_bf16 v[28:31], a[20:23], v[64:67], v[28:31]
    s_waitcnt lgkmcnt(5)
    v_mfma_f32_16x16x32_bf16 v[20:23], a[24:27], v[68:71], v[20:23]
    ds_read_b128 v[60:63], v3 offset:28672
    v_mfma_f32_16x16x32_bf16 v[24:27], a[28:31], v[68:71], v[24:27]
    v_mfma_f32_16x16x32_bf16 v[28:31], a[32:35], v[68:71], v[28:31]
    s_waitcnt lgkmcnt(5)
    v_mfma_f32_16x16x32_bf16 v[20:23], a[36:39], v[72:75], v[20:23]
    ds_read_b128 v[64:67], v3 offset:29696
    v_mfma_f32_16x16x32_bf16 v[24:27], a[40:43], v[72:75], v[24:27]
    v_mfma_f32_16x16x32_bf16 v[28:31], a[44:47], v[72:75], v[28:31]
    s_waitcnt lgkmcnt(5)
    v_mfma_f32_16x16x32_bf16 v[20:23], a[48:51], v[44:47], v[20:23]
    ds_read_b128 v[68:71], v3 offset:30720
    v_mfma_f32_16x16x32_bf16 v[24:27], a[52:55], v[44:47], v[24:27]
    v_mfma_f32_16x16x32_bf16 v[28:31], a[56:59], v[44:47], v[28:31]
    s_waitcnt lgkmcnt(5)
    v_mfma_f32_16x16x32_bf16 v[20:23], a[60:63], v[48:51], v[20:23]
    ds_read_b128 v[72:75], v3 offset:31744
    v_mfma_f32_16x16x32_bf16 v[24:27], a[64:67], v[48:51], v[24:27]
    v_mfma_f32_16x16x32_bf16 v[28:31], a[68:71], v[48:51], v[28:31]
    s_waitcnt lgkmcnt(5)
    v_mfma_f32_16x16x32_bf16 v[20:23], a[72:75], v[52:55], v[20:23]
    ds_read_b128 v[44:47], v3 offset:32768
    v_mfma_f32_16x16x32_bf16 v[24:27], a[76:79], v[52:55], v[24:27]
    v_mfma_f32_16x16x32_bf16 v[28:31], a[80:83], v[52:55], v[28:31]
    s_waitcnt lgkmcnt(5)
    v_mfma_f32_16x16x32_bf16 v[20:23], a[84:87], v[56:59], v[20:23]
    ds_read_b128 v[48:51], v3 offset:33792
    v_mfma_f32_16x16x32_bf16 v[24:27], a[88:91], v[56:59], v[24:27]
    v_cvt_pk_bf16_f32 v32, v8, v9
    v_mfma_f32_16x16x32_bf16 v[28:31], a[92:95], v[56:59], v[28:31]
    v_cvt_pk_bf16_f32 v33, v10, v11
    s_waitcnt lgkmcnt(5)
    v_mfma_f32_16x16x32_bf16 v[20:23], a[96:99], v[60:63], v[20:23]
    ds_read_b128 v[52:55], v3 offset:34816
    v_mfma_f32_16x16x32_bf16 v[24:27], a[100:103], v[60:63], v[24:27]
    v_cvt_pk_bf16_f32 v34, v12, v13
    v_mfma_f32_16x16x32_bf16 v[28:31], a[104:107], v[60:63], v[28:31]
    v_cvt_pk_bf16_f32 v35, v14, v15
    s_waitcnt lgkmcnt(5)
    v_mfma_f32_16x16x32_bf16 v[20:23], a[108:111], v[64:67], v[20:23]
    ds_read_b128 v[56:59], v3 offset:35840
    v_mfma_f32_16x16x32_bf16 v[24:27], a[112:115], v[64:67], v[24:27]
    v_cvt_pk_bf16_f32 v40, v16, v17
    v_mfma_f32_16x16x32_bf16 v[28:31], a[116:119], v[64:67], v[28:31]
    v_cvt_pk_bf16_f32 v41, v18, v19
    s_waitcnt lgkmcnt(5)
    v_mfma_f32_16x16x32_bf16 v[20:23], a[120:123], v[68:71], v[20:23]
    ds_read_b128 v[60:63], v3 offset:36864
    v_mfma_f32_16x16x32_bf16 v[24:27], a[124:127], v[68:71], v[24:27]
    v_pk_max_i16 v32, v32, v4
    v_mfma_f32_16x16x32_bf16 v[28:31], a[128:131], v[68:71], v[28:31]
    v_pk_max_i16 v33, v33, v4
    s_waitcnt lgkmcnt(5)
    v_mfma_f32_16x16x32_bf16 v[20:23], a[132:135], v[72:75], v[20:23]
    ds_read_b128 v[64:67], v3 offset:37888
    v_mfma_f32_16x16x32_bf16 v[24:27], a[136:139], v[72:75], v[24:27]
    v_pk_max_i16 v34, v34, v4
    v_mfma_f32_16x16x32_bf16 v[28:31], a[140:143], v[72:75], v[28:31]
    v_pk_max_i16 v35, v35, v4
    s_waitcnt lgkmcnt(5)
    v_mfma_f32_16x16x32_bf16 v[20:23], a[144:147], v[44:47], v[20:23]
    ds_read_b128 v[68:71], v3 offset:38912
    v_mfma_f32_16x16x32_bf16 v[24:27], a[148:151], v[44:47], v[24:27]
    v_pk_max_i16 v40, v40, v4
    v_mfma_f32_16x16x32_bf16 v[28:31], a[152:155], v[44:47], v[28:31]
    v_pk_max_i16 v41, v41, v4
    s_waitcnt lgkmcnt(5)
    v_mfma_f32_16x16x32_bf16 v[20:23], a[156:159], v[48:51], v[20:23]
    ds_read_b128 v[72:75], v3 offset:39936
    v_mfma_f32_16x16x32_bf16 v[24:27], a[160:163], v[48:51], v[24:27]
    v_mfma_f32_16x16x32_bf16 v[28:31], a[164:167], v[48:51], v[28:31]
    s_waitcnt lgkmcnt(5)
    v_mfma_f32_16x16x32_bf16 v[20:23], a[168:171], v[52:55], v[20:23]
    v_add_u32 v3, s76, v2
    ds_read_b128 v[44:47], v3 offset:0
    v_mfma_f32_16x16x32_bf16 v[24:27], a[172:175], v[52:55], v[24:27]
    v_mfma_f32_16x16x32_bf16 v[28:31], a[176:179], v[52:55], v[28:31]
    s_waitcnt lgkmcnt(5)
    v_mfma_f32_16x16x32_bf16 v[20:23], a[180:183], v[56:59], v[20:23]
    ds_read_b128 v[48:51], v3 offset:1024
    v_mfma_f32_16x16x32_bf16 v[24:27], a[184:187], v[56:59], v[24:27]
    v_mfma_f32_16x16x32_bf16 v[28:31], a[188:191], v[56:59], v[28:31]
    s_waitcnt lgkmcnt(5)
    v_mfma_f32_16x16x32_bf16 v[20:23], a[192:195], v[60:63], v[20:23]
    ds_read_b128 v[52:55], v3 offset:2048
    v_mfma_f32_16x16x32_bf16 v[24:27], a[196:199], v[60:63], v[24:27]
    v_mfma_f32_16x16x32_bf16 v[28:31], a[200:203], v[60:63], v[28:31]
    s_waitcnt vmcnt(0)
    s_waitcnt lgkmcnt(5)
    v_mfma_f32_16x16x32_bf16 v[20:23], a[204:207], v[64:67], v[20:23]
    ds_read_b128 v[56:59], v3 offset:3072
    v_mfma_f32_16x16x32_bf16 v[24:27], a[208:211], v[64:67], v[24:27]
    v_mfma_f32_16x16x32_bf16 v[28:31], a[212:215], v[64:67], v[28:31]
    s_waitcnt lgkmcnt(5)
    v_mfma_f32_16x16x32_bf16 v[20:23], a[216:219], v[68:71], v[20:23]
    ds_read_b128 v[60:63], v3 offset:4096
    v_mfma_f32_16x16x32_bf16 v[24:27], a[220:223], v[68:71], v[24:27]
    v_mfma_f32_16x16x32_bf16 v[28:31], a[224:227], v[68:71], v[28:31]
    s_waitcnt lgkmcnt(5)
    v_mfma_f32_16x16x32_bf16 v[20:23], a[228:231], v[72:75], v[20:23]
    ds_read_b128 v[64:67], v3 offset:5120
    v_mfma_f32_16x16x32_bf16 v[24:27], a[232:235], v[72:75], v[24:27]
    v_mfma_f32_16x16x32_bf16 v[28:31], a[236:239], v[72:75], v[28:31]
    s_add_u32 s76, s76, 40960
    s_cmp_eq_u32 s76, 122880
    s_cselect_b32 s76, 0, s76
    s_add_u32 s66, s66, 1
L_P1_loop:
    s_waitcnt lgkmcnt(5)
    v_mfma_f32_16x16x32_bf16 v[8:11], a[0:3], v[44:47], 0
    ds_read_b128 v[68:71], v3 offset:6144
    v_mfma_f32_16x16x32_bf16 v[12:15], a[4:7], v[44:47], 0
    s_waitcnt vmcnt(1)
    s_barrier
    v_mfma_f32_16x16x32_bf16 v[16:19], a[8:11], v[44:47], 0
    buffer_store_dwordx4 v[32:35], v2, s[8:11], s72 offen offset:0 sc1
    s_waitcnt lgkmcnt(5)
    v_mfma_f32_16x16x32_bf16 v[8:11], a[12:15], v[48:51], v[8:11]
    ds_read_b128 v[72:75], v3 offset:7168
    v_mfma_f32_16x16x32_bf16 v[12:15], a[16:19], v[48:51], v[12:15]
    v_cvt_pk_bf16_f32 v36, v20, v21
    v_mfma_f32_16x16x32_bf16 v[16:19], a[20:23], v[48:51], v[16:19]
    v_cvt_pk_bf16_f32 v37, v22, v23
    s_waitcnt lgkmcnt(5)
    v_mfma_f32_16x16x32_bf16 v[8:11], a[24:27], v[52:55], v[8:11]
    ds_read_b128 v[44:47], v3 offset:8192
    v_mfma_f32_16x16x32_bf16 v[12:15], a[28:31], v[52:55], v[12:15]
    v_cvt_pk_bf16_f32 v38, v24, v25
    v_mfma_f32_16x16x32_bf16 v[16:19], a[32:35], v[52:55], v[16:19]
    v_cvt_pk_bf16_f32 v39, v26, v27
    s_waitcnt lgkmcnt(5)
    v_mfma_f32_16x16x32_bf16 v[8:11], a[36:39], v[56:59], v[8:11]
    ds_read_b128 v[48:51], v3 offset:9216
    v_mfma_f32_16x16x32_bf16 v[12:15], a[40:43], v[56:59], v[12:15]
    v_cvt_pk_bf16_f32 v42, v28, v29
    v_mfma_f32_16x16x32_bf16 v[16:19], a[44:47], v[56:59], v[16:19]
    v_cvt_pk_bf16_f32 v43, v30, v31
    s_waitcnt lgkmcnt(5)
    v_mfma_f32_16x16x32_bf16 v[8:11], a[48:51], v[60:63], v[8:11]
    ds_read_b128 v[52:55], v3 offset:10240
    v_mfma_f32_16x16x32_bf16 v[12:15], a[52:55], v[60:63], v[12:15]
    v_pk_max_i16 v36, v36, v4
    v_mfma_f32_16x16x32_bf16 v[16:19], a[56:59], v[60:63], v[16:19]
    v_pk_max_i16 v37, v37, v4
    s_waitcnt lgkmcnt(5)
    v_mfma_f32_16x16x32_bf16 v[8:11], a[60:63], v[64:67], v[8:11]
    ds_read_b128 v[56:59], v3 offset:11264
    v_mfma_f32_16x16x32_bf16 v[12:15], a[64:67], v[64:67], v[12:15]
    v_pk_max_i16 v38, v38, v4
    v_mfma_f32_16x16x32_bf16 v[16:19], a[68:71], v[64:67], v[16:19]
    v_pk_max_i16 v39, v39, v4
    s_waitcnt lgkmcnt(5)
    v_mfma_f32_16x16x32_bf16 v[8:11], a[72:75], v[68:71], v[8:11]
    ds_read_b128 v[60:63], v3 offset:12288
    v_mfma_f32_16x16x32_bf16 v[12:15], a[76:79], v[68:71], v[12:15]
    v_pk_max_i16 v42, v42, v4
    v_mfma_f32_16x16x32_bf16 v[16:19], a[80:83], v[68:71], v[16:19]
    v_pk_max_i16 v43, v43, v4
    s_waitcnt lgkmcnt(5)
    v_mfma_f32_16x16x32_bf16 v[8:11], a[84:87], v[72:75], v[8:11]
    ds_read_b128 v[64:67], v3 offset:13312
    v_mfma_f32_16x16x32_bf16 v[12:15], a[88:91], v[72:75], v[12:15]
    buffer_store_dwordx4 v[36:39], v2, s[8:11], s72 offen offset:1024 sc1
    v_mfma_f32_16x16x32_bf16 v[16:19], a[92:95], v[72:75], v[16:19]
    buffer_store_dwordx4 v[40:43], v2, s[8:11], s72 offen offset:2048 sc1
    s_add_u32 s72, s72, s79
    s_waitcnt lgkmcnt(5)
    v_mfma_f32_16x16x32_bf16 v[8:11], a[96:99], v[44:47], v[8:11]
    ds_read_b128 v[68:71], v3 offset:14336
    v_mfma_f32_16x16x32_bf16 v[12:15], a[100:103], v[44:47], v[12:15]
    s_add_u32 s37, s75, s77
    s_add_u32 m0, s37, 0
    s_add_u32 s38, s74, 0
    v_mfma_f32_16x16x32_bf16 v[16:19], a[104:107], v[44:47], v[16:19]
    s_waitcnt lgkmcnt(5)
    v_mfma_f32_16x16x32_bf16 v[8:11], a[108:111], v[48:51], v[8:11]
    ds_read_b128 v[72:75], v3 offset:15360
    v_mfma_f32_16x16x32_bf16 v[12:15], a[112:115], v[48:51], v[12:15]
    buffer_load_dwordx4 v2, s[8:11], s38 offen offset:0 lds
    v_mfma_f32_16x16x32_bf16 v[16:19], a[116:119], v[48:51], v[16:19]
    s_waitcnt lgkmcnt(5)
    v_mfma_f32_16x16x32_bf16 v[8:11], a[120:123], v[52:55], v[8:11]
    ds_read_b128 v[44:47], v3 offset:16384
    v_mfma_f32_16x16x32_bf16 v[12:15], a[124:127], v[52:55], v[12:15]
    buffer_load_dwordx4 v2, s[8:11], s38 offen offset:1024 lds
    v_mfma_f32_16x16x32_bf16 v[16:19], a[128:131], v[52:55], v[16:19]
    s_waitcnt lgkmcnt(5)
    v_mfma_f32_16x16x32_bf16 v[8:11], a[132:135], v[56:59], v[8:11]
    ds_read_b128 v[48:51], v3 offset:17408
    v_mfma_f32_16x16x32_bf16 v[12:15], a[136:139], v[56:59], v[12:15]
    buffer_load_dwordx4 v2, s[8:11], s38 offen offset:2048 lds
    v_mfma_f32_16x16x32_bf16 v[16:19], a[140:143], v[56:59], v[16:19]
    s_waitcnt lgkmcnt(5)
    v_mfma_f32_16x16x32_bf16 v[8:11], a[144:147], v[60:63], v[8:11]
    ds_read_b128 v[52:55], v3 offset:18432
    v_mfma_f32_16x16x32_bf16 v[12:15], a[148:151], v[60:63], v[12:15]
    buffer_load_dwordx4 v2, s[8:11], s38 offen offset:3072 lds
    v_mfma_f32_16x16x32_bf16 v[16:19], a[152:155], v[60:63], v[16:19]
    s_waitcnt lgkmcnt(5)
    v_mfma_f32_16x16x32_bf16 v[8:11], a[156:159], v[64:67], v[8:11]
    ds_read_b128 v[56:59], v3 offset:19456
    v_mfma_f32_16x16x32_bf16 v[12:15], a[160:163], v[64:67], v[12:15]
    s_add_u32 s37, s75, s77
    s_add_u32 m0, s37, 4096
    s_add_u32 s38, s74, 4096
    v_mfma_f32_16x16x32_bf16 v[16:19], a[164:167], v[64:67], v[16:19]
    s_waitcnt lgkmcnt(5)
    v_mfma_f32_16x16x32_bf16 v[8:11], a[168:171], v[68:71], v[8:11]
    ds_read_b128 v[60:63], v3 offset:20480
    v_mfma_f32_16x16x32_bf16 v[12:15], a[172:175], v[68:71], v[12:15]
    buffer_load_dwordx4 v2, s[8:11], s38 offen offset:0 lds
    v_mfma_f32_16x16x32_bf16 v[16:19], a[176:179], v[68:71], v[16:19]
    s_waitcnt lgkmcnt(5)
    v_mfma_f32_16x16x32_bf16 v[8:11], a[180:183], v[72:75], v[8:11]
    ds_read_b128 v[64:67], v3 offset:21504
    v_mfma_f32_16x16x32_bf16 v[12:15], a[184:187], v[72:75], v[12:15]
    buffer_load_dwordx4 v2, s[8:11], s38 offen offset:1024 lds
    v_mfma_f32_16x16x32_bf16 v[16:19], a[188:191], v[72:75], v[16:19]
    s_waitcnt lgkmcnt(5)
    v_mfma_f32_16x16x32_bf16 v[8:11], a[192:195], v[44:47], v[8:11]
    ds_read_b128 v[68:71], v3 offset:22528
    v_mfma_f32_16x16x32_bf16 v[12:15], a[196:199], v[44:47], v[12:15]
    buffer_load_dwordx4 v2, s[8:11], s38 offen offset:2048 lds
    v_mfma_f32_16x16x32_bf16 v[16:19], a[200:203], v[44:47], v[16:19]
    s_waitcnt lgkmcnt(5)
    v_mfma_f32_16x16x32_bf16 v[8:11], a[204:207], v[48:51], v[8:11]
    ds_read_b128 v[72:75], v3 offset:23552
    v_mfma_f32_16x16x32_bf16 v[12:15], a[208:211], v[48:51], v[12:15]
    buffer_load_dwordx4 v2, s[8:11], s38 offen offset:3072 lds
    v_mfma_f32_16x16x32_bf16 v[16:19], a[212:215], v[48:51], v[16:19]
    s_waitcnt lgkmcnt(5)
    v_mfma_f32_16x16x32_bf16 v[8:11], a[216:219], v[52:55], v[8:11]
    ds_read_b128 v[44:47], v3 offset:24576
    v_mfma_f32_16x16x32_bf16 v[12:15], a[220:223], v[52:55], v[12:15]
    s_add_u32 s37, s75, s77
    s_add_u32 m0, s37, 8192
    s_add_u32 s38, s74, 8192
    v_mfma_f32_16x16x32_bf16 v[16:19], a[224:227], v[52:55], v[16:19]
    s_waitcnt lgkmcnt(5)
    v_mfma_f32_16x16x32_bf16 v[8:11], a[228:231], v[56:59], v[8:11]
    ds_read_b128 v[48:51], v3 offset:25600
    v_mfma_f32_16x16x32_bf16 v[12:15], a[232:235], v[56:59], v[12:15]
    buffer_load_dwordx4 v2, s[8:11], s38 offen offset:0 lds
    v_mfma_f32_16x16x32_bf16 v[16:19], a[236:239], v[56:59], v[16:19]
    s_waitcnt lgkmcnt(5)
    v_mfma_f32_16x16x32_bf16 v[20:23], a[0:3], v[60:63], 0
    ds_read_b128 v[52:55], v3 offset:26624
    v_mfma_f32_16x16x32_bf16 v[24:27], a[4:7], v[60:63], 0
    buffer_load_dwordx4 v2, s[8:11], s38 offen offset:1024 lds
    v_mfma_f32_16x16x32_bf16 v[28:31], a[8:11], v[60:63], 0
    s_waitcnt lgkmcnt(5)
    v_mfma_f32_16x16x32_bf16 v[20:23], a[12:15], v[64:67], v[20:23]
    ds_read_b128 v[56:59], v3 offset:27648
    v_mfma_f32_16x16x32_bf16 v[24:27], a[16:19], v[64:67], v[24:27]
    s_add_u32 s74, s74, s53
    s_add_u32 s77, s77, 40960
    s_cmp_eq_u32 s77, 122880
    s_cselect_b32 s77, 0, s77
    v_mfma_f32_16x16x32_bf16 v[28:31], a[20:23], v[64:67], v[28:31]
    s_waitcnt vmcnt(10)
    v_mov_b32 v6, s66
    s_waitcnt lgkmcnt(5)
    v_mfma_f32_16x16x32_bf16 v[20:23], a[24:27], v[68:71], v[20:23]
    ds_read_b128 v[60:63], v3 offset:28672
    v_mfma_f32_16x16x32_bf16 v[24:27], a[28:31], v[68:71], v[24:27]
    s_mov_b64 exec, 1
    buffer_store_dword v6, v5, s[8:11], s73 offen sc1
    s_mov_b64 exec, -1
    v_mfma_f32_16x16x32_bf16 v[28:31], a[32:35], v[68:71], v[28:31]
    s_waitcnt lgkmcnt(5)
    v_mfma_f32_16x16x32_bf16 v[20:23], a[36:39], v[72:75], v[20:23]
    ds_read_b128 v[64:67], v3 offset:29696
    v_mfma_f32_16x16x32_bf16 v[24:27], a[40:43], v[72:75], v[24:27]
    v_mfma_f32_16x16x32_bf16 v[28:31], a[44:47], v[72:75], v[28:31]
    s_waitcnt lgkmcnt(5)
    v_mfma_f32_16x16x32_bf16 v[20:23], a[48:51], v[44:47], v[20:23]
    ds_read_b128 v[68:71], v3 offset:30720
    v_mfma_f32_16x16x32_bf16 v[24:27], a[52:55], v[44:47], v[24:27]
    v_mfma_f32_16x16x32_bf16 v[28:31], a[56:59], v[44:47], v[28:31]
    s_waitcnt lgkmcnt(5)
    v_mfma_f32_16x16x32_bf16 v[20:23], a[60:63], v[48:51], v[20:23]
    ds_read_b128 v[72:75], v3 offset:31744
    v_mfma_f32_16x16x32_bf16 v[24:27], a[64:67], v[48:51], v[24:27]
    v_mfma_f32_16x16x32_bf16 v[28:31], a[68:71], v[48:51], v[28:31]
    s_waitcnt lgkmcnt(5)
    v_mfma_f32_16x16x32_bf16 v[20:23], a[72:75], v[52:55], v[20:23]
    ds_read_b128 v[44:47], v3 offset:32768
    v_mfma_f32_16x16x32_bf16 v[24:27], a[76:79], v[52:55], v[24:27]
    v_mfma_f32_16x16x32_bf16 v[28:31], a[80:83], v[52:55], v[28:31]
    s_waitcnt lgkmcnt(5)
    v_mfma_f32_16x16x32_bf16 v[20:23], a[84:87], v[56:59], v[20:23]
    ds_read_b128 v[48:51], v3 offset:33792
    v_mfma_f32_16x16x32_bf16 v[24:27], a[88:91], v[56:59], v[24:27]
    v_cvt_pk_bf16_f32 v32, v8, v9
    v_mfma_f32_16x16x32_bf16 v[28:31], a[92:95], v[56:59], v[28:31]
    v_cvt_pk_bf16_f32 v33, v10, v11
    s_waitcnt lgkmcnt(5)
    v_mfma_f32_16x16x32_bf16 v[20:23], a[96:99], v[60:63], v[20:23]
    ds_read_b128 v[52:55], v3 offset:34816
    v_mfma_f32_16x16x32_bf16 v[24:27], a[100:103], v[60:63], v[24:27]
    v_cvt_pk_bf16_f32 v34, v12, v13
    v_mfma_f32_16x16x32_bf16 v[28:31], a[104:107], v[60:63], v[28:31]
    v_cvt_pk_bf16_f32 v35, v14, v15
    s_waitcnt lgkmcnt(5)
    v_mfma_f32_16x16x32_bf16 v[20:23], a[108:111], v[64:67], v[20:23]
    ds_read_b128 v[56:59], v3 offset:35840
    v_mfma_f32_16x16x32_bf16 v[24:27], a[112:115], v[64:67], v[24:27]
    v_cvt_pk_bf16_f32 v40, v16, v17
    v_mfma_f32_16x16x32_bf16 v[28:31], a[116:119], v[64:67], v[28:31]
    v_cvt_pk_bf16_f32 v41, v18, v19
    s_waitcnt lgkmcnt(5)
    v_mfma_f32_16x16x32_bf16 v[20:23], a[120:123], v[68:71], v[20:23]
    ds_read_b128 v[60:63], v3 offset:36864
    v_mfma_f32_16x16x32_bf16 v[24:27], a[124:127], v[68:71], v[24:27]
    v_pk_max_i16 v32, v32, v4
    v_mfma_f32_16x16x32_bf16 v[28:31], a[128:131], v[68:71], v[28:31]
    v_pk_max_i16 v33, v33, v4
    s_waitcnt lgkmcnt(5)
    v_mfma_f32_16x16x32_bf16 v[20:23], a[132:135], v[72:75], v[20:23]
    ds_read_b128 v[64:67], v3 offset:37888
    v_mfma_f32_16x16x32_bf16 v[24:27], a[136:139], v[72:75], v[24:27]
    v_pk_max_i16 v34, v34, v4
    v_mfma_f32_16x16x32_bf16 v[28:31], a[140:143], v[72:75], v[28:31]
    v_pk_max_i16 v35, v35, v4
    s_waitcnt lgkmcnt(5)
    v_mfma_f32_16x16x32_bf16 v[20:23], a[144:147], v[44:47], v[20:23]
    ds_read_b128 v[68:71], v3 offset:38912
    v_mfma_f32_16x16x32_bf16 v[24:27], a[148:151], v[44:47], v[24:27]
    v_pk_max_i16 v40, v40, v4
    v_mfma_f32_16x16x32_bf16 v[28:31], a[152:155], v[44:47], v[28:31]
    v_pk_max_i16 v41, v41, v4
    s_waitcnt lgkmcnt(5)
    v_mfma_f32_16x16x32_bf16 v[20:23], a[156:159], v[48:51], v[20:23]
    ds_read_b128 v[72:75], v3 offset:39936
    v_mfma_f32_16x16x32_bf16 v[24:27], a[160:163], v[48:51], v[24:27]
    v_mfma_f32_16x16x32_bf16 v[28:31], a[164:167], v[48:51], v[28:31]
    s_waitcnt lgkmcnt(5)
    v_mfma_f32_16x16x32_bf16 v[20:23], a[168:171], v[52:55], v[20:23]
    v_add_u32 v3, s76, v2
    ds_read_b128 v[44:47], v3 offset:0
    v_mfma_f32_16x16x32_bf16 v[24:27], a[172:175], v[52:55], v[24:27]
    v_mfma_f32_16x16x32_bf16 v[28:31], a[176:179], v[52:55], v[28:31]
    s_waitcnt lgkmcnt(5)
    v_mfma_f32_16x16x32_bf16 v[20:23], a[180:183], v[56:59], v[20:23]
    ds_read_b128 v[48:51], v3 offset:1024
    v_mfma_f32_16x16x32_bf16 v[24:27], a[184:187], v[56:59], v[24:27]
    v_mfma_f32_16x16x32_bf16 v[28:31], a[188:191], v[56:59], v[28:31]
    s_waitcnt lgkmcnt(5)
    v_mfma_f32_16x16x32_bf16 v[20:23], a[192:195], v[60:63], v[20:23]
    ds_read_b128 v[52:55], v3 offset:2048
    v_mfma_f32_16x16x32_bf16 v[24:27], a[196:199], v[60:63], v[24:27]
    v_mfma_f32_16x16x32_bf16 v[28:31], a[200:203], v[60:63], v[28:31]
    s_waitcnt lgkmcnt(5)
    v_mfma_f32_16x16x32_bf16 v[20:23], a[204:207], v[64:67], v[20:23]
    ds_read_b128 v[56:59], v3 offset:3072
    v_mfma_f32_16x16x32_bf16 v[24:27], a[208:211], v[64:67], v[24:27]
    v_mfma_f32_16x16x32_bf16 v[28:31], a[212:215], v[64:67], v[28:31]
    s_waitcnt lgkmcnt(5)
    v_mfma_f32_16x16x32_bf16 v[20:23], a[216:219], v[68:71], v[20:23]
    ds_read_b128 v[60:63], v3 offset:4096
    v_mfma_f32_16x16x32_bf16 v[24:27], a[220:223], v[68:71], v[24:27]
    v_mfma_f32_16x16x32_bf16 v[28:31], a[224:227], v[68:71], v[28:31]
    s_waitcnt lgkmcnt(5)
    v_mfma_f32_16x16x32_bf16 v[20:23], a[228:231], v[72:75], v[20:23]
    ds_read_b128 v[64:67], v3 offset:5120
    v_mfma_f32_16x16x32_bf16 v[24:27], a[232:235], v[72:75], v[24:27]
    v_mfma_f32_16x16x32_bf16 v[28:31], a[236:239], v[72:75], v[28:31]
    s_add_u32 s76, s76, 40960
    s_cmp_eq_u32 s76, 122880
    s_cselect_b32 s76, 0, s76
    s_add_u32 s66, s66, 1
    s_cmp_lt_u32 s66, s69
    s_cbranch_scc1 L_P1_loop
    buffer_store_dwordx4 v[32:35], v2, s[8:11], s72 offen offset:0 sc1
    v_cvt_pk_bf16_f32 v36, v20, v21
    v_cvt_pk_bf16_f32 v37, v22, v23
    v_cvt_pk_bf16_f32 v38, v24, v25
    v_cvt_pk_bf16_f32 v39, v26, v27
    v_cvt_pk_bf16_f32 v42, v28, v29
    v_cvt_pk_bf16_f32 v43, v30, v31
    v_pk_max_i16 v36, v36, v4
    v_pk_max_i16 v37, v37, v4
    v_pk_max_i16 v38, v38, v4
    v_pk_max_i16 v39, v39, v4
    v_pk_max_i16 v42, v42, v4
    v_pk_max_i16 v43, v43, v4
    buffer_store_dwordx4 v[36:39], v2, s[8:11], s72 offen offset:1024 sc1
    buffer_store_dwordx4 v[40:43], v2, s[8:11], s72 offen offset:2048 sc1
    s_waitcnt vmcnt(0)
    v_mov_b32 v6, s66
    s_mov_b64 exec, 1
    buffer_store_dword v6, v5, s[8:11], s73 offen sc1
    s_mov_b64 exec, -1
    s_sub_u32 s37, s67, 32
    s_cmp_ge_u32 s37, 64
    s_cbranch_scc1 L_P1_fin
    s_waitcnt vmcnt(0) lgkmcnt(0)
    s_barrier
    s_mov_b32 s3, 1
    s_mov_b32 s67, s37
    s_cmp_ge_u32 s37, 32
    s_cbranch_scc1 L_P2
    s_add_u32 s67, s37, 96
    s_branch L_P1
L_P1_fin:
    s_waitcnt vmcnt(0)
    s_cmp_lg_u32 s36, 0
    s_cbranch_scc1 Lfin_6
    s_mov_b64 exec, 1
    v_mov_b32 v2, 1
    v_mov_b32 v3, 44
    buffer_atomic_add v2, v3, s[28:31], 0 offen
    s_mov_b64 exec, -1
Lfin_6:
    s_endpgm
L_P2:
    s_bfe_u32 s38, s67, 0x20003
    s_and_b32 s39, s67, 7
    s_cmp_lt_u32 s67, 32
    s_cselect_b32 s16, s50, s58
    s_cselect_b32 s17, s51, s59
    s_cselect_b32 s18, s18, 0x1e0000
    s_cselect_b32 s37, s67, s39
    s_cselect_b32 s53, 0, s38
    s_cselect_b32 s52, 1, 4
    s_cselect_b32 s69, 64, 16
    s_cselect_b32 s68, 0, 32
    s_add_u32 s68, s68, s37
    s_and_b32 s17, s17, 0xffff
    s_mul_i32 s70, s37, 245760
    s_mul_i32 s54, s52, 12288
    s_mul_i32 s55, s52, 1638400
    s_lshl_b32 s73, s67, 7
    s_lshl_b32 s37, s4, 2
    s_add_u32 s73, s73, s37
    s_add_u32 s74, s73, 12288
    s_add_u32 s73, s73, 20480
    s_cmp_lg_u32 s3, 0
    s_cbranch_scc1 L_P2_nz
    s_mov_b64 exec, 1
    v_mov_b32 v2, 0
    buffer_store_dword v2, v2, s[8:11], s73 offen sc1
    s_mov_b64 exec, -1
L_P2_nz:
    s_lshl_b32 s37, s4, 2
    v_add_u32 v2, 0, v1
    v_mul_u32_u24 v3, 820, v2
    v_lshrrev_b32 v3, 16, v3
    v_mul_u32_u24 v16, 80, v3
    v_sub_u32 v2, v2, v16
    v_add_u32 v3, s37, v3
    v_and_b32 v16, 7, v3
    v_lshlrev_b32 v16, 1, v16
    v_xor_b32 v2, v2, v16
    v_mul_u32_u24 v3, 1280, v3
    v_lshl_add_u32 v19, v2, 4, v3
    v_add_u32 v2, 64, v1
    v_mul_u32_u24 v3, 820, v2
    v_lshrrev_b32 v3, 16, v3
    v_mul_u32_u24 v16, 80, v3
    v_sub_u32 v2, v2, v16
    v_add_u32 v3, s37, v3
    v_and_b32 v16, 7, v3
    v_lshlrev_b32 v16, 1, v16
    v_xor_b32 v2, v2, v16
    v_mul_u32_u24 v3, 1280, v3
    v_lshl_add_u32 v20, v2, 4, v3
    v_add_u32 v2, 128, v1
    v_mul_u32_u24 v3, 820, v2
    v_lshrrev_b32 v3, 16, v3
    v_mul_u32_u24 v16, 80, v3
    v_sub_u32 v2, v2, v16
    v_add_u32 v3, s37, v3
    v_and_b32 v16, 7, v3
    v_lshlrev_b32 v16, 1, v16
    v_xor_b32 v2, v2, v16
    v_mul_u32_u24 v3, 1280, v3
    v_lshl_add_u32 v21, v2, 4, v3
    v_add_u32 v2, 192, v1
    v_mul_u32_u24 v3, 820, v2
    v_lshrrev_b32 v3, 16, v3
    v_mul_u32_u24 v16, 80, v3
    v_sub_u32 v2, v2, v16
    v_add_u32 v3, s37, v3
    v_and_b32 v16, 7, v3
    v_lshlrev_b32 v16, 1, v16
    v_xor_b32 v2, v2, v16
    v_mul_u32_u24 v3, 1280, v3
    v_lshl_add_u32 v22, v2, 4, v3
    v_add_u32 v2, 256, v1
    v_mul_u32_u24 v3, 820, v2
    v_lshrrev_b32 v3, 16, v3
    v_mul_u32_u24 v16, 80, v3
    v_sub_u32 v2, v2, v16
    v_add_u32 v3, s37, v3
    v_and_b32 v16, 7, v3
    v_lshlrev_b32 v16, 1, v16
    v_xor_b32 v2, v2, v16
    v_mul_u32_u24 v3, 1280, v3
    v_lshl_add_u32 v23, v2, 4, v3
    s_mul_i32 s91, s4, 5120
    s_add_u32 s37, s70, 0
    s_add_u32 m0, s91, 0
    s_nop 0
    buffer_load_dwordx4 v19, s[16:19], s37 offen lds
    s_add_u32 m0, s91, 1024
    s_nop 0
    buffer_load_dwordx4 v20, s[16:19], s37 offen lds
    s_add_u32 m0, s91, 2048
    s_nop 0
    buffer_load_dwordx4 v21, s[16:19], s37 offen lds
    s_add_u32 m0, s91, 3072
    s_nop 0
    buffer_load_dwordx4 v22, s[16:19], s37 offen lds
    s_add_u32 m0, s91, 4096
    s_nop 0
    buffer_load_dwordx4 v23, s[16:19], s37 offen lds
    s_add_u32 s37, s70, 20480
    s_add_u32 m0, s91, 24576
    s_nop 0
    buffer_load_dwordx4 v19, s[16:19], s37 offen lds
    s_add_u32 m0, s91, 25600
    s_nop 0
    buffer_load_dwordx4 v20, s[16:19], s37 offen lds
    s_add_u32 m0, s91, 26624
    s_nop 0
    buffer_load_dwordx4 v21, s[16:19], s37 offen lds
    s_add_u32 m0, s91, 27648
    s_nop 0
    buffer_load_dwordx4 v22, s[16:19], s37 offen lds
    s_add_u32 m0, s91, 28672
    s_nop 0
    buffer_load_dwordx4 v23, s[16:19], s37 offen lds
    s_waitcnt vmcnt(10)
    s_barrier
    s_cmp_lg_u32 s3, 0
    s_cbranch_scc1 Lao_7
    s_cmp_lg_u32 s4, 0
    s_cbranch_scc1 Larr_8
    s_lshl_b32 s37, s7, 16
    s_add_u32 s37, s37, 1
    s_mov_b64 exec, 1
    v_mov_b32 v2, s37
    v_mov_b32 v3, 36
    buffer_atomic_add v2, v3, s[28:31], 0 offen
    s_mov_b64 exec, -1
Larr_8:
Lao_7:
    s_add_u32 s37, s70, 40960
    s_add_u32 m0, s91, 49152
    s_nop 0
    buffer_load_dwordx4 v19, s[16:19], s37 offen lds
    s_add_u32 m0, s91, 50176
    s_nop 0
    buffer_load_dwordx4 v20, s[16:19], s37 offen lds
    s_add_u32 m0, s91, 51200
    s_nop 0
    buffer_load_dwordx4 v21, s[16:19], s37 offen lds
    s_add_u32 m0, s91, 52224
    s_nop 0
    buffer_load_dwordx4 v22, s[16:19], s37 offen lds
    s_add_u32 m0, s91, 53248
    s_nop 0
    buffer_load_dwordx4 v23, s[16:19], s37 offen lds
    s_add_u32 s37, s70, 61440
    s_add_u32 m0, s91, 73728
    s_nop 0
    buffer_load_dwordx4 v19, s[16:19], s37 offen lds
    s_add_u32 m0, s91, 74752
    s_nop 0
    buffer_load_dwordx4 v20, s[16:19], s37 offen lds
    s_add_u32 m0, s91, 75776
    s_nop 0
    buffer_load_dwordx4 v21, s[16:19], s37 offen lds
    s_add_u32 m0, s91, 76800
    s_nop 0
    buffer_load_dwordx4 v22, s[16:19], s37 offen lds
    s_add_u32 m0, s91, 77824
    s_nop 0
    buffer_load_dwordx4 v23, s[16:19], s37 offen lds
    s_add_u32 s37, s70, 81920
    s_add_u32 m0, s91, 98304
    s_nop 0
    buffer_load_dwordx4 v19, s[16:19], s37 offen lds
    s_add_u32 m0, s91, 99328
    s_nop 0
    buffer_load_dwordx4 v20, s[16:19], s37 offen lds
    s_add_u32 m0, s91, 100352
    s_nop 0
    buffer_load_dwordx4 v21, s[16:19], s37 offen lds
    s_add_u32 m0, s91, 101376
    s_nop 0
    buffer_load_dwordx4 v22, s[16:19], s37 offen lds
    s_add_u32 m0, s91, 102400
    s_nop 0
    buffer_load_dwordx4 v23, s[16:19], s37 offen lds
    s_add_u32 s37, s70, 102400
    s_add_u32 m0, s91, 122880
    s_nop 0
    buffer_load_dwordx4 v19, s[16:19], s37 offen lds
    s_add_u32 m0, s91, 123904
    s_nop 0
    buffer_load_dwordx4 v20, s[16:19], s37 offen lds
    s_add_u32 m0, s91, 124928
    s_nop 0
    buffer_load_dwordx4 v21, s[16:19], s37 offen lds
    s_add_u32 m0, s91, 125952
    s_nop 0
    buffer_load_dwordx4 v22, s[16:19], s37 offen lds
    s_add_u32 m0, s91, 126976
    s_nop 0
    buffer_load_dwordx4 v23, s[16:19], s37 offen lds
    s_waitcnt vmcnt(25)
    s_barrier
    v_lshrrev_b32 v14, 2, v1
    v_mul_u32_u24 v17, 1280, v14
    v_and_b32 v15, 1, v1
    v_lshl_add_u32 v17, v15, 3, v17
    v_and_b32 v14, 7, v14
    v_lshlrev_b32 v14, 1, v14
    v_bfe_u32 v15, v1, 1, 1
    s_mul_i32 s37, s4, 20
    v_add_u32 v15, s37, v15
    v_add_u32 v16, 0, v15
    v_xor_b32 v16, v16, v14
    v_lshl_add_u32 v4, v16, 4, v17
    v_add_u32 v16, 2, v15
    v_xor_b32 v16, v16, v14
    v_lshl_add_u32 v5, v16, 4, v17
    v_add_u32 v16, 4, v15
    v_xor_b32 v16, v16, v14
    v_lshl_add_u32 v6, v16, 4, v17
    v_add_u32 v16, 6, v15
    v_xor_b32 v16, v16, v14
    v_lshl_add_u32 v7, v16, 4, v17
    v_add_u32 v16, 8, v15
    v_xor_b32 v16, v16, v14
    v_lshl_add_u32 v8, v16, 4, v17
    v_add_u32 v16, 10, v15
    v_xor_b32 v16, v16, v14
    v_lshl_add_u32 v9, v16, 4, v17
    v_add_u32 v16, 12, v15
    v_xor_b32 v16, v16, v14
    v_lshl_add_u32 v10, v16, 4, v17
    v_add_u32 v16, 14, v15
    v_xor_b32 v16, v16, v14
    v_lshl_add_u32 v11, v16, 4, v17
    v_add_u32 v16, 16, v15
    v_xor_b32 v16, v16, v14
    v_lshl_add_u32 v12, v16, 4, v17
    v_add_u32 v16, 18, v15
    v_xor_b32 v16, v16, v14
    v_lshl_add_u32 v13, v16, 4, v17
    ds_read_b64_tr_b16 a[0:1], v4 offset:0
    ds_read_b64_tr_b16 a[24:25], v5 offset:0
    ds_read_b64_tr_b16 a[48:49], v6 offset:0
    ds_read_b64_tr_b16 a[72:73], v7 offset:0
    ds_read_b64_tr_b16 a[96:97], v8 offset:0
    ds_read_b64_tr_b16 a[120:121], v9 offset:0
    ds_read_b64_tr_b16 a[144:145], v10 offset:0
    ds_read_b64_tr_b16 a[168:169], v11 offset:0
    ds_read_b64_tr_b16 a[192:193], v12 offset:0
    ds_read_b64_tr_b16 a[216:217], v13 offset:0
    s_waitcnt lgkmcnt(0)
    s_barrier
    s_add_u32 s37, s70, 122880
    s_add_u32 m0, s91, 0
    s_nop 0
    buffer_load_dwordx4 v19, s[16:19], s37 offen lds
    s_add_u32 m0, s91, 1024
    s_nop 0
    buffer_load_dwordx4 v20, s[16:19], s37 offen lds
    s_add_u32 m0, s91, 2048
    s_nop 0
    buffer_load_dwordx4 v21, s[16:19], s37 offen lds
    s_add_u32 m0, s91, 3072
    s_nop 0
    buffer_load_dwordx4 v22, s[16:19], s37 offen lds
    s_add_u32 m0, s91, 4096
    s_nop 0
    buffer_load_dwordx4 v23, s[16:19], s37 offen lds
    s_waitcnt vmcnt(25)
    s_barrier
    ds_read_b64_tr_b16 a[2:3], v4 offset:24576
    ds_read_b64_tr_b16 a[26:27], v5 offset:24576
    ds_read_b64_tr_b16 a[50:51], v6 offset:24576
    ds_read_b64_tr_b16 a[74:75], v7 offset:24576
    ds_read_b64_tr_b16 a[98:99], v8 offset:24576
    ds_read_b64_tr_b16 a[122:123], v9 offset:24576
    ds_read_b64_tr_b16 a[146:147], v10 offset:24576
    ds_read_b64_tr_b16 a[170:171], v11 offset:24576
    ds_read_b64_tr_b16 a[194:195], v12 offset:24576
    ds_read_b64_tr_b16 a[218:219], v13 offset:24576
    s_waitcnt lgkmcnt(0)
    s_barrier
    s_add_u32 s37, s70, 143360
    s_add_u32 m0, s91, 24576
    s_nop 0
    buffer_load_dwordx4 v19, s[16:19], s37 offen lds
    s_add_u32 m0, s91, 25600
    s_nop 0
    buffer_load_dwordx4 v20, s[16:19], s37 offen lds
    s_add_u32 m0, s91, 26624
    s_nop 0
    buffer_load_dwordx4 v21, s[16:19], s37 offen lds
    s_add_u32 m0, s91, 27648
    s_nop 0
    buffer_load_dwordx4 v22, s[16:19], s37 offen lds
    s_add_u32 m0, s91, 28672
    s_nop 0
    buffer_load_dwordx4 v23, s[16:19], s37 offen lds
    s_waitcnt vmcnt(25)
    s_barrier
    v_add_u32 v4, 49152, v4
    v_add_u32 v5, 49152, v5
    v_add_u32 v6, 49152, v6
    v_add_u32 v7, 49152, v7
    v_add_u32 v8, 49152, v8
    v_add_u32 v9, 49152, v9
    v_add_u32 v10, 49152, v10
    v_add_u32 v11, 49152, v11
    v_add_u32 v12, 49152, v12
    v_add_u32 v13, 49152, v13
    ds_read_b64_tr_b16 a[16:17], v4 offset:0
    ds_read_b64_tr_b16 a[40:41], v5 offset:0
    ds_read_b64_tr_b16 a[64:65], v6 offset:0
    ds_read_b64_tr_b16 a[88:89], v7 offset:0
    ds_read_b64_tr_b16 a[112:113], v8 offset:0
    ds_read_b64_tr_b16 a[136:137], v9 offset:0
    ds_read_b64_tr_b16 a[160:161], v10 offset:0
    ds_read_b64_tr_b16 a[184:185], v11 offset:0
    ds_read_b64_tr_b16 a[208:209], v12 offset:0
    ds_read_b64_tr_b16 a[232:233], v13 offset:0
    s_waitcnt lgkmcnt(0)
    s_barrier
    s_add_u32 s37, s70, 163840
    s_add_u32 m0, s91, 49152
    s_nop 0
    buffer_load_dwordx4 v19, s[16:19], s37 offen lds
    s_add_u32 m0, s91, 50176
    s_nop 0
    buffer_load_dwordx4 v20, s[16:19], s37 offen lds
    s_add_u32 m0, s91, 51200
    s_nop 0
    buffer_load_dwordx4 v21, s[16:19], s37 offen lds
    s_add_u32 m0, s91, 52224
    s_nop 0
    buffer_load_dwordx4 v22, s[16:19], s37 offen lds
    s_add_u32 m0, s91, 53248
    s_nop 0
    buffer_load_dwordx4 v23, s[16:19], s37 offen lds
    s_waitcnt vmcnt(25)
    s_barrier
    ds_read_b64_tr_b16 a[4:5], v4 offset:24576
    ds_read_b64_tr_b16 a[28:29], v5 offset:24576
    ds_read_b64_tr_b16 a[52:53], v6 offset:24576
    ds_read_b64_tr_b16 a[76:77], v7 offset:24576
    ds_read_b64_tr_b16 a[100:101], v8 offset:24576
    ds_read_b64_tr_b16 a[124:125], v9 offset:24576
    ds_read_b64_tr_b16 a[148:149], v10 offset:24576
    ds_read_b64_tr_b16 a[172:173], v11 offset:24576
    ds_read_b64_tr_b16 a[196:197], v12 offset:24576
    ds_read_b64_tr_b16 a[220:221], v13 offset:24576
    s_waitcnt lgkmcnt(0)
    s_barrier
    s_add_u32 s37, s70, 184320
    s_add_u32 m0, s91, 73728
    s_nop 0
    buffer_load_dwordx4 v19, s[16:19], s37 offen lds
    s_add_u32 m0, s91, 74752
    s_nop 0
    buffer_load_dwordx4 v20, s[16:19], s37 offen lds
    s_add_u32 m0, s91, 75776
    s_nop 0
    buffer_load_dwordx4 v21, s[16:19], s37 offen lds
    s_add_u32 m0, s91, 76800
    s_nop 0
    buffer_load_dwordx4 v22, s[16:19], s37 offen lds
    s_add_u32 m0, s91, 77824
    s_nop 0
    buffer_load_dwordx4 v23, s[16:19], s37 offen lds
    s_waitcnt vmcnt(25)
    s_barrier
    v_add_u32 v4, 49152, v4
    v_add_u32 v5, 49152, v5
    v_add_u32 v6, 49152, v6
    v_add_u32 v7, 49152, v7
    v_add_u32 v8, 49152, v8
    v_add_u32 v9, 49152, v9
    v_add_u32 v10, 49152, v10
    v_add_u32 v11, 49152, v11
    v_add_u32 v12, 49152, v12
    v_add_u32 v13, 49152, v13
    ds_read_b64_tr_b16 a[6:7], v4 offset:0
    ds_read_b64_tr_b16 a[30:31], v5 offset:0
    ds_read_b64_tr_b16 a[54:55], v6 offset:0
    ds_read_b64_tr_b16 a[78:79], v7 offset:0
    ds_read_b64_tr_b16 a[102:103], v8 offset:0
    ds_read_b64_tr_b16 a[126:127], v9 offset:0
    ds_read_b64_tr_b16 a[150:151], v10 offset:0
    ds_read_b64_tr_b16 a[174:175], v11 offset:0
    ds_read_b64_tr_b16 a[198:199], v12 offset:0
    ds_read_b64_tr_b16 a[222:223], v13 offset:0
    s_waitcnt lgkmcnt(0)
    s_barrier
    s_add_u32 s37, s70, 204800
    s_add_u32 m0, s91, 98304
    s_nop 0
    buffer_load_dwordx4 v19, s[16:19], s37 offen lds
    s_add_u32 m0, s91, 99328
    s_nop 0
    buffer_load_dwordx4 v20, s[16:19], s37 offen lds
    s_add_u32 m0, s91, 100352
    s_nop 0
    buffer_load_dwordx4 v21, s[16:19], s37 offen lds
    s_add_u32 m0, s91, 101376
    s_nop 0
    buffer_load_dwordx4 v22, s[16:19], s37 offen lds
    s_add_u32 m0, s91, 102400
    s_nop 0
    buffer_load_dwordx4 v23, s[16:19], s37 offen lds
    s_waitcnt vmcnt(25)
    s_barrier
    ds_read_b64_tr_b16 a[18:19], v4 offset:24576
    ds_read_b64_tr_b16 a[42:43], v5 offset:24576
    ds_read_b64_tr_b16 a[66:67], v6 offset:24576
    ds_read_b64_tr_b16 a[90:91], v7 offset:24576
    ds_read_b64_tr_b16 a[114:115], v8 offset:24576
    ds_read_b64_tr_b16 a[138:139], v9 offset:24576
    ds_read_b64_tr_b16 a[162:163], v10 offset:24576
    ds_read_b64_tr_b16 a[186:187], v11 offset:24576
    ds_read_b64_tr_b16 a[210:211], v12 offset:24576
    ds_read_b64_tr_b16 a[234:235], v13 offset:24576
    s_waitcnt lgkmcnt(0)
    s_barrier
    s_add_u32 s37, s70, 225280
    s_add_u32 m0, s91, 122880
    s_nop 0
    buffer_load_dwordx4 v19, s[16:19], s37 offen lds
    s_add_u32 m0, s91, 123904
    s_nop 0
    buffer_load_dwordx4 v20, s[16:19], s37 offen lds
    s_add_u32 m0, s91, 124928
    s_nop 0
    buffer_load_dwordx4 v21, s[16:19], s37 offen lds
    s_add_u32 m0, s91, 125952
    s_nop 0
    buffer_load_dwordx4 v22, s[16:19], s37 offen lds
    s_add_u32 m0, s91, 126976
    s_nop 0
    buffer_load_dwordx4 v23, s[16:19], s37 offen lds
    s_waitcnt vmcnt(25)
    s_barrier
    v_add_u32 v4, -98304, v4
    v_add_u32 v5, -98304, v5
    v_add_u32 v6, -98304, v6
    v_add_u32 v7, -98304, v7
    v_add_u32 v8, -98304, v8
    v_add_u32 v9, -98304, v9
    v_add_u32 v10, -98304, v10
    v_add_u32 v11, -98304, v11
    v_add_u32 v12, -98304, v12
    v_add_u32 v13, -98304, v13
    ds_read_b64_tr_b16 a[8:9], v4 offset:0
    ds_read_b64_tr_b16 a[32:33], v5 offset:0
    ds_read_b64_tr_b16 a[56:57], v6 offset:0
    ds_read_b64_tr_b16 a[80:81], v7 offset:0
    ds_read_b64_tr_b16 a[104:105], v8 offset:0
    ds_read_b64_tr_b16 a[128:129], v9 offset:0
    ds_read_b64_tr_b16 a[152:153], v10 offset:0
    ds_read_b64_tr_b16 a[176:177], v11 offset:0
    ds_read_b64_tr_b16 a[200:201], v12 offset:0
    ds_read_b64_tr_b16 a[224:225], v13 offset:0
    s_waitcnt lgkmcnt(0)
    s_waitcnt vmcnt(20)
    s_barrier
    ds_read_b64_tr_b16 a[10:11], v4 offset:24576
    ds_read_b64_tr_b16 a[34:35], v5 offset:24576
    ds_read_b64_tr_b16 a[58:59], v6 offset:24576
    ds_read_b64_tr_b16 a[82:83], v7 offset:24576
    ds_read_b64_tr_b16 a[106:107], v8 offset:24576
    ds_read_b64_tr_b16 a[130:131], v9 offset:24576
    ds_read_b64_tr_b16 a[154:155], v10 offset:24576
    ds_read_b64_tr_b16 a[178:179], v11 offset:24576
    ds_read_b64_tr_b16 a[202:203], v12 offset:24576
    ds_read_b64_tr_b16 a[226:227], v13 offset:24576
    s_waitcnt lgkmcnt(0)
    s_waitcnt vmcnt(15)
    s_barrier
    v_add_u32 v4, 49152, v4
    v_add_u32 v5, 49152, v5
    v_add_u32 v6, 49152, v6
    v_add_u32 v7, 49152, v7
    v_add_u32 v8, 49152, v8
    v_add_u32 v9, 49152, v9
    v_add_u32 v10, 49152, v10
    v_add_u32 v11, 49152, v11
    v_add_u32 v12, 49152, v12
    v_add_u32 v13, 49152, v13
    ds_read_b64_tr_b16 a[20:21], v4 offset:0
    ds_read_b64_tr_b16 a[44:45], v5 offset:0
    ds_read_b64_tr_b16 a[68:69], v6 offset:0
    ds_read_b64_tr_b16 a[92:93], v7 offset:0
    ds_read_b64_tr_b16 a[116:117], v8 offset:0
    ds_read_b64_tr_b16 a[140:141], v9 offset:0
    ds_read_b64_tr_b16 a[164:165], v10 offset:0
    ds_read_b64_tr_b16 a[188:189], v11 offset:0
    ds_read_b64_tr_b16 a[212:213], v12 offset:0
    ds_read_b64_tr_b16 a[236:237], v13 offset:0
    s_waitcnt lgkmcnt(0)
    s_waitcnt vmcnt(10)
    s_barrier
    ds_read_b64_tr_b16 a[12:13], v4 offset:24576
    ds_read_b64_tr_b16 a[36:37], v5 offset:24576
    ds_read_b64_tr_b16 a[60:61], v6 offset:24576
    ds_read_b64_tr_b16 a[84:85], v7 offset:24576
    ds_read_b64_tr_b16 a[108:109], v8 offset:24576
    ds_read_b64_tr_b16 a[132:133], v9 offset:24576
    ds_read_b64_tr_b16 a[156:157], v10 offset:24576
    ds_read_b64_tr_b16 a[180:181], v11 offset:24576
    ds_read_b64_tr_b16 a[204:205], v12 offset:24576
    ds_read_b64_tr_b16 a[228:229], v13 offset:24576
    s_waitcnt lgkmcnt(0)
    s_waitcnt vmcnt(5)
    s_barrier
    v_add_u32 v4, 49152, v4
    v_add_u32 v5, 49152, v5
    v_add_u32 v6, 49152, v6
    v_add_u32 v7, 49152, v7
    v_add_u32 v8, 49152, v8
    v_add_u32 v9, 49152, v9
    v_add_u32 v10, 49152, v10
    v_add_u32 v11, 49152, v11
    v_add_u32 v12, 49152, v12
    v_add_u32 v13, 49152, v13
    ds_read_b64_tr_b16 a[14:15], v4 offset:0
    ds_read_b64_tr_b16 a[38:39], v5 offset:0
    ds_read_b64_tr_b16 a[62:63], v6 offset:0
    ds_read_b64_tr_b16 a[86:87], v7 offset:0
    ds_read_b64_tr_b16 a[110:111], v8 offset:0
    ds_read_b64_tr_b16 a[134:135], v9 offset:0
    ds_read_b64_tr_b16 a[158:159], v10 offset:0
    ds_read_b64_tr_b16 a[182:183], v11 offset:0
    ds_read_b64_tr_b16 a[206:207], v12 offset:0
    ds_read_b64_tr_b16 a[230:231], v13 offset:0
    s_waitcnt lgkmcnt(0)
    s_waitcnt vmcnt(0)
    s_barrier
    ds_read_b64_tr_b16 a[22:23], v4 offset:24576
    ds_read_b64_tr_b16 a[46:47], v5 offset:24576
    ds_read_b64_tr_b16 a[70:71], v6 offset:24576
    ds_read_b64_tr_b16 a[94:95], v7 offset:24576
    ds_read_b64_tr_b16 a[118:119], v8 offset:24576
    ds_read_b64_tr_b16 a[142:143], v9 offset:24576
    ds_read_b64_tr_b16 a[166:167], v10 offset:24576
    ds_read_b64_tr_b16 a[190:191], v11 offset:24576
    ds_read_b64_tr_b16 a[214:215], v12 offset:24576
    ds_read_b64_tr_b16 a[238:239], v13 offset:24576
    s_waitcnt lgkmcnt(0)
    v_mov_b32 v3, 36
    s_cmp_lg_u32 s4, 0
    s_cbranch_scc1 Lwik_11
Lwi_9:
    buffer_load_dword v2, v3, s[28:31], 0 offen sc1
    s_waitcnt vmcnt(0)
    v_readfirstlane_b32 s37, v2
    s_nop 0
    s_and_b32 s38, s37, 0xffff
    s_cmp_eq_u32 s38, 0x100
    s_cbranch_scc1 Lwid_10
    s_sleep 6
    s_sub_u32 s36, s36, 1
    s_cbranch_scc0 Lwi_9
    s_mov_b32 s36, 0
Lwid_10:
    v_mov_b32 v3, 163836
    ds_write_b32 v3, v2
    s_waitcnt lgkmcnt(0)
Lwik_11:
    s_waitcnt vmcnt(0)
    s_barrier
    v_mov_b32 v3, 163836
    ds_read_b32 v2, v3
    s_waitcnt lgkmcnt(0)
    v_readfirstlane_b32 s37, v2
    s_nop 0
    s_bfe_u32 s7, s37, 0x80010
    v_lshlrev_b32 v2, 4, v1
    v_mov_b32 v3, v2
    v_mov_b32 v5, 0
    s_mul_i32 s75, s4, 3072
    s_lshl_b32 s37, s68, 6
    s_add_u32 s37, s37, s53
    s_mul_i32 s71, s37, 12288
    s_add_u32 s71, s71, s75
    s_add_u32 s71, s71, 54525952
    s_mul_i32 s37, s53, 40
    s_add_u32 s37, s37, s68
    s_mul_i32 s72, s37, 40960
    s_mul_i32 s37, s4, 10240
    s_add_u32 s72, s72, s37
    s_add_u32 s72, s72, 112197632
    s_mov_b32 s76, 0
    s_mov_b32 s77, 0
    s_mov_b32 s78, 0
    s_sub_u32 s37, s69, 1
    s_min_u32 s37, s37, s78
    s_cmp_gt_u32 s76, s37
    s_cbranch_scc1 Lp2d_13
Lp2w_12:
    buffer_load_dword v7, v5, s[8:11], s74 offen sc1
    s_waitcnt vmcnt(0)
    v_readfirstlane_b32 s76, v7
    s_nop 0
    s_cmp_gt_u32 s76, s37
    s_cbranch_scc1 Lp2d_13
    s_sleep 1
    s_sub_u32 s36, s36, 1
    s_cbranch_scc0 Lp2w_12
    s_mov_b32 s36, 0
Lp2d_13:
    s_add_u32 m0, s75, s77
    s_nop 0
    buffer_load_dwordx4 v2, s[8:11], s71 offen offset:0 sc1 nt lds
    buffer_load_dwordx4 v2, s[8:11], s71 offen offset:1024 sc1 nt lds
    buffer_load_dwordx4 v2, s[8:11], s71 offen offset:2048 sc1 nt lds
    s_add_u32 s71, s71, s54
    s_add_u32 s77, s77, 12288
    s_cmp_eq_u32 s77, 49152
    s_cselect_b32 s77, 0, s77
    s_add_u32 s78, s78, 1
    s_waitcnt vmcnt(0)
    s_barrier
    ds_read_b128 v[32:35], v3 offset:0
    ds_read_b128 v[36:39], v3 offset:1024
    ds_read_b128 v[40:43], v3 offset:3072
    ds_read_b128 v[44:47], v3 offset:4096
    ds_read_b128 v[48:51], v3 offset:6144
    ds_read_b128 v[52:55], v3 offset:7168
    ds_read_b128 v[56:59], v3 offset:9216
    ds_read_b128 v[60:63], v3 offset:10240
    ds_read_b64 v[64:65], v3 offset:2048
    ds_read_b64 v[66:67], v3 offset:5120
    ds_read_b64 v[68:69], v3 offset:2056
    ds_read_b64 v[70:71], v3 offset:5128
    ds_read_b64 v[72:73], v3 offset:8192
    ds_read_b64 v[74:75], v3 offset:11264
    ds_read_b64 v[76:77], v3 offset:8200
    ds_read_b64 v[78:79], v3 offset:11272
    s_mov_b32 s79, 12288
    s_mov_b32 s66, 0
L_P2_drain:
    s_waitcnt lgkmcnt(0)
    v_mfma_f32_16x16x32_bf16 v[8:11], v[32:35], a[0:3], 0
    v_mfma_f32_16x16x32_bf16 v[12:15], v[36:39], a[0:3], 0
    v_mfma_f32_16x16x32_bf16 v[8:11], v[40:43], a[4:7], v[8:11]
    v_mfma_f32_16x16x32_bf16 v[12:15], v[44:47], a[4:7], v[12:15]
    v_mfma_f32_16x16x32_bf16 v[8:11], v[48:51], a[8:11], v[8:11]
    v_mfma_f32_16x16x32_bf16 v[12:15], v[52:55], a[8:11], v[12:15]
    v_mfma_f32_16x16x32_bf16 v[8:11], v[56:59], a[12:15], v[8:11]
    v_mfma_f32_16x16x32_bf16 v[12:15], v[60:63], a[12:15], v[12:15]
    v_mfma_f32_16x16x32_bf16 v[8:11], v[64:67], a[16:19], v[8:11]
    v_mfma_f32_16x16x32_bf16 v[12:15], v[68:71], a[16:19], v[12:15]
    v_mfma_f32_16x16x32_bf16 v[8:11], v[72:75], a[20:23], v[8:11]
    v_mfma_f32_16x16x32_bf16 v[12:15], v[76:79], a[20:23], v[12:15]
    v_mfma_f32_16x16x32_bf16 v[16:19], v[32:35], a[24:27], 0
    v_mfma_f32_16x16x32_bf16 v[20:23], v[36:39], a[24:27], 0
    v_mfma_f32_16x16x32_bf16 v[16:19], v[40:43], a[28:31], v[16:19]
    v_mfma_f32_16x16x32_bf16 v[20:23], v[44:47], a[28:31], v[20:23]
    v_mfma_f32_16x16x32_bf16 v[16:19], v[48:51], a[32:35], v[16:19]
    v_mfma_f32_16x16x32_bf16 v[20:23], v[52:55], a[32:35], v[20:23]
    s_nop 0
    v_cvt_pk_bf16_f32 v24, v8, v9
    v_mfma_f32_16x16x32_bf16 v[16:19], v[56:59], a[36:39], v[16:19]
    v_cvt_pk_bf16_f32 v25, v10, v11
    v_mfma_f32_16x16x32_bf16 v[20:23], v[60:63], a[36:39], v[20:23]
    v_cvt_pk_bf16_f32 v26, v12, v13
    v_mfma_f32_16x16x32_bf16 v[16:19], v[64:67], a[40:43], v[16:19]
    v_cvt_pk_bf16_f32 v27, v14, v15
    v_mfma_f32_16x16x32_bf16 v[20:23], v[68:71], a[40:43], v[20:23]
    s_add_u32 s39, s72, 0
    buffer_store_dwordx4 v[24:27], v2, s[8:11], s39 offen offset:0 sc1
    v_mfma_f32_16x16x32_bf16 v[16:19], v[72:75], a[44:47], v[16:19]
    v_mfma_f32_16x16x32_bf16 v[20:23], v[76:79], a[44:47], v[20:23]
    v_mfma_f32_16x16x32_bf16 v[8:11], v[32:35], a[48:51], 0
    v_mfma_f32_16x16x32_bf16 v[12:15], v[36:39], a[48:51], 0
    v_mfma_f32_16x16x32_bf16 v[8:11], v[40:43], a[52:55], v[8:11]
    v_mfma_f32_16x16x32_bf16 v[12:15], v[44:47], a[52:55], v[12:15]
    v_mfma_f32_16x16x32_bf16 v[8:11], v[48:51], a[56:59], v[8:11]
    v_mfma_f32_16x16x32_bf16 v[12:15], v[52:55], a[56:59], v[12:15]
    s_nop 0
    v_cvt_pk_bf16_f32 v28, v16, v17
    v_mfma_f32_16x16x32_bf16 v[8:11], v[56:59], a[60:63], v[8:11]
    v_cvt_pk_bf16_f32 v29, v18, v19
    v_mfma_f32_16x16x32_bf16 v[12:15], v[60:63], a[60:63], v[12:15]
    v_cvt_pk_bf16_f32 v30, v20, v21
    v_mfma_f32_16x16x32_bf16 v[8:11], v[64:67], a[64:67], v[8:11]
    v_cvt_pk_bf16_f32 v31, v22, v23
    v_mfma_f32_16x16x32_bf16 v[12:15], v[68:71], a[64:67], v[12:15]
    buffer_store_dwordx4 v[28:31], v2, s[8:11], s39 offen offset:1024 sc1
    v_mfma_f32_16x16x32_bf16 v[8:11], v[72:75], a[68:71], v[8:11]
    v_mfma_f32_16x16x32_bf16 v[12:15], v[76:79], a[68:71], v[12:15]
    v_mfma_f32_16x16x32_bf16 v[16:19], v[32:35], a[72:75], 0
    v_mfma_f32_16x16x32_bf16 v[20:23], v[36:39], a[72:75], 0
    v_mfma_f32_16x16x32_bf16 v[16:19], v[40:43], a[76:79], v[16:19]
    v_mfma_f32_16x16x32_bf16 v[20:23], v[44:47], a[76:79], v[20:23]
    v_mfma_f32_16x16x32_bf16 v[16:19], v[48:51], a[80:83], v[16:19]
    v_mfma_f32_16x16x32_bf16 v[20:23], v[52:55], a[80:83], v[20:23]
    s_nop 0
    v_cvt_pk_bf16_f32 v24, v8, v9
    v_mfma_f32_16x16x32_bf16 v[16:19], v[56:59], a[84:87], v[16:19]
    v_cvt_pk_bf16_f32 v25, v10, v11
    v_mfma_f32_16x16x32_bf16 v[20:23], v[60:63], a[84:87], v[20:23]
    v_cvt_pk_bf16_f32 v26, v12, v13
    v_mfma_f32_16x16x32_bf16 v[16:19], v[64:67], a[88:91], v[16:19]
    v_cvt_pk_bf16_f32 v27, v14, v15
    v_mfma_f32_16x16x32_bf16 v[20:23], v[68:71], a[88:91], v[20:23]
    buffer_store_dwordx4 v[24:27], v2, s[8:11], s39 offen offset:2048 sc1
    v_mfma_f32_16x16x32_bf16 v[16:19], v[72:75], a[92:95], v[16:19]
    v_mfma_f32_16x16x32_bf16 v[20:23], v[76:79], a[92:95], v[20:23]
    v_mfma_f32_16x16x32_bf16 v[8:11], v[32:35], a[96:99], 0
    v_mfma_f32_16x16x32_bf16 v[12:15], v[36:39], a[96:99], 0
    v_mfma_f32_16x16x32_bf16 v[8:11], v[40:43], a[100:103], v[8:11]
    v_mfma_f32_16x16x32_bf16 v[12:15], v[44:47], a[100:103], v[12:15]
    v_mfma_f32_16x16x32_bf16 v[8:11], v[48:51], a[104:107], v[8:11]
    v_mfma_f32_16x16x32_bf16 v[12:15], v[52:55], a[104:107], v[12:15]
    s_nop 0
    v_cvt_pk_bf16_f32 v28, v16, v17
    v_mfma_f32_16x16x32_bf16 v[8:11], v[56:59], a[108:111], v[8:11]
    v_cvt_pk_bf16_f32 v29, v18, v19
    v_mfma_f32_16x16x32_bf16 v[12:15], v[60:63], a[108:111], v[12:15]
    v_cvt_pk_bf16_f32 v30, v20, v21
    v_mfma_f32_16x16x32_bf16 v[8:11], v[64:67], a[112:115], v[8:11]
    v_cvt_pk_bf16_f32 v31, v22, v23
    v_mfma_f32_16x16x32_bf16 v[12:15], v[68:71], a[112:115], v[12:15]
    buffer_store_dwordx4 v[28:31], v2, s[8:11], s39 offen offset:3072 sc1
    v_mfma_f32_16x16x32_bf16 v[8:11], v[72:75], a[116:119], v[8:11]
    v_mfma_f32_16x16x32_bf16 v[12:15], v[76:79], a[116:119], v[12:15]
    v_mfma_f32_16x16x32_bf16 v[16:19], v[32:35], a[120:123], 0
    v_mfma_f32_16x16x32_bf16 v[20:23], v[36:39], a[120:123], 0
    v_mfma_f32_16x16x32_bf16 v[16:19], v[40:43], a[124:127], v[16:19]
    v_mfma_f32_16x16x32_bf16 v[20:23], v[44:47], a[124:127], v[20:23]
    v_mfma_f32_16x16x32_bf16 v[16:19], v[48:51], a[128:131], v[16:19]
    v_mfma_f32_16x16x32_bf16 v[20:23], v[52:55], a[128:131], v[20:23]
    s_nop 0
    v_cvt_pk_bf16_f32 v24, v8, v9
    v_mfma_f32_16x16x32_bf16 v[16:19], v[56:59], a[132:135], v[16:19]
    v_cvt_pk_bf16_f32 v25, v10, v11
    v_mfma_f32_16x16x32_bf16 v[20:23], v[60:63], a[132:135], v[20:23]
    v_cvt_pk_bf16_f32 v26, v12, v13
    v_mfma_f32_16x16x32_bf16 v[16:19], v[64:67], a[136:139], v[16:19]
    v_cvt_pk_bf16_f32 v27, v14, v15
    v_mfma_f32_16x16x32_bf16 v[20:23], v[68:71], a[136:139], v[20:23]
    s_add_u32 s39, s72, 4096
    buffer_store_dwordx4 v[24:27], v2, s[8:11], s39 offen offset:0 sc1
    v_mfma_f32_16x16x32_bf16 v[16:19], v[72:75], a[140:143], v[16:19]
    v_mfma_f32_16x16x32_bf16 v[20:23], v[76:79], a[140:143], v[20:23]
    v_mfma_f32_16x16x32_bf16 v[8:11], v[32:35], a[144:147], 0
    v_mfma_f32_16x16x32_bf16 v[12:15], v[36:39], a[144:147], 0
    v_mfma_f32_16x16x32_bf16 v[8:11], v[40:43], a[148:151], v[8:11]
    v_mfma_f32_16x16x32_bf16 v[12:15], v[44:47], a[148:151], v[12:15]
    v_mfma_f32_16x16x32_bf16 v[8:11], v[48:51], a[152:155], v[8:11]
    v_mfma_f32_16x16x32_bf16 v[12:15], v[52:55], a[152:155], v[12:15]
    s_nop 0
    v_cvt_pk_bf16_f32 v28, v16, v17
    v_mfma_f32_16x16x32_bf16 v[8:11], v[56:59], a[156:159], v[8:11]
    v_cvt_pk_bf16_f32 v29, v18, v19
    v_mfma_f32_16x16x32_bf16 v[12:15], v[60:63], a[156:159], v[12:15]
    v_cvt_pk_bf16_f32 v30, v20, v21
    v_mfma_f32_16x16x32_bf16 v[8:11], v[64:67], a[160:163], v[8:11]
    v_cvt_pk_bf16_f32 v31, v22, v23
    v_mfma_f32_16x16x32_bf16 v[12:15], v[68:71], a[160:163], v[12:15]
    buffer_store_dwordx4 v[28:31], v2, s[8:11], s39 offen offset:1024 sc1
    v_mfma_f32_16x16x32_bf16 v[8:11], v[72:75], a[164:167], v[8:11]
    v_mfma_f32_16x16x32_bf16 v[12:15], v[76:79], a[164:167], v[12:15]
    v_mfma_f32_16x16x32_bf16 v[16:19], v[32:35], a[168:171], 0
    v_mfma_f32_16x16x32_bf16 v[20:23], v[36:39], a[168:171], 0
    v_mfma_f32_16x16x32_bf16 v[16:19], v[40:43], a[172:175], v[16:19]
    v_mfma_f32_16x16x32_bf16 v[20:23], v[44:47], a[172:175], v[20:23]
    v_mfma_f32_16x16x32_bf16 v[16:19], v[48:51], a[176:179], v[16:19]
    v_mfma_f32_16x16x32_bf16 v[20:23], v[52:55], a[176:179], v[20:23]
    s_nop 0
    v_cvt_pk_bf16_f32 v24, v8, v9
    v_mfma_f32_16x16x32_bf16 v[16:19], v[56:59], a[180:183], v[16:19]
    v_cvt_pk_bf16_f32 v25, v10, v11
    v_mfma_f32_16x16x32_bf16 v[20:23], v[60:63], a[180:183], v[20:23]
    v_cvt_pk_bf16_f32 v26, v12, v13
    v_mfma_f32_16x16x32_bf16 v[16:19], v[64:67], a[184:187], v[16:19]
    v_cvt_pk_bf16_f32 v27, v14, v15
    v_mfma_f32_16x16x32_bf16 v[20:23], v[68:71], a[184:187], v[20:23]
    buffer_store_dwordx4 v[24:27], v2, s[8:11], s39 offen offset:2048 sc1
    v_mfma_f32_16x16x32_bf16 v[16:19], v[72:75], a[188:191], v[16:19]
    v_mfma_f32_16x16x32_bf16 v[20:23], v[76:79], a[188:191], v[20:23]
    v_mfma_f32_16x16x32_bf16 v[8:11], v[32:35], a[192:195], 0
    v_mfma_f32_16x16x32_bf16 v[12:15], v[36:39], a[192:195], 0
    v_mfma_f32_16x16x32_bf16 v[8:11], v[40:43], a[196:199], v[8:11]
    v_mfma_f32_16x16x32_bf16 v[12:15], v[44:47], a[196:199], v[12:15]
    v_mfma_f32_16x16x32_bf16 v[8:11], v[48:51], a[200:203], v[8:11]
    v_mfma_f32_16x16x32_bf16 v[12:15], v[52:55], a[200:203], v[12:15]
    s_nop 0
    v_cvt_pk_bf16_f32 v28, v16, v17
    v_mfma_f32_16x16x32_bf16 v[8:11], v[56:59], a[204:207], v[8:11]
    v_cvt_pk_bf16_f32 v29, v18, v19
    v_mfma_f32_16x16x32_bf16 v[12:15], v[60:63], a[204:207], v[12:15]
    v_cvt_pk_bf16_f32 v30, v20, v21
    v_mfma_f32_16x16x32_bf16 v[8:11], v[64:67], a[208:211], v[8:11]
    v_cvt_pk_bf16_f32 v31, v22, v23
    v_mfma_f32_16x16x32_bf16 v[12:15], v[68:71], a[208:211], v[12:15]
    buffer_store_dwordx4 v[28:31], v2, s[8:11], s39 offen offset:3072 sc1
    v_mfma_f32_16x16x32_bf16 v[8:11], v[72:75], a[212:215], v[8:11]
    v_mfma_f32_16x16x32_bf16 v[12:15], v[76:79], a[212:215], v[12:15]
    v_mfma_f32_16x16x32_bf16 v[16:19], v[32:35], a[216:219], 0
    v_mfma_f32_16x16x32_bf16 v[20:23], v[36:39], a[216:219], 0
    v_mfma_f32_16x16x32_bf16 v[16:19], v[40:43], a[220:223], v[16:19]
    v_mfma_f32_16x16x32_bf16 v[20:23], v[44:47], a[220:223], v[20:23]
    v_mfma_f32_16x16x32_bf16 v[16:19], v[48:51], a[224:227], v[16:19]
    v_mfma_f32_16x16x32_bf16 v[20:23], v[52:55], a[224:227], v[20:23]
    s_nop 0
    v_cvt_pk_bf16_f32 v24, v8, v9
    v_mfma_f32_16x16x32_bf16 v[16:19], v[56:59], a[228:231], v[16:19]
    v_cvt_pk_bf16_f32 v25, v10, v11
    v_mfma_f32_16x16x32_bf16 v[20:23], v[60:63], a[228:231], v[20:23]
    v_cvt_pk_bf16_f32 v26, v12, v13
    v_mfma_f32_16x16x32_bf16 v[16:19], v[64:67], a[232:235], v[16:19]
    v_cvt_pk_bf16_f32 v27, v14, v15
    v_mfma_f32_16x16x32_bf16 v[20:23], v[68:71], a[232:235], v[20:23]
    s_add_u32 s39, s72, 8192
    buffer_store_dwordx4 v[24:27], v2, s[8:11], s39 offen offset:0 sc1
    v_mfma_f32_16x16x32_bf16 v[16:19], v[72:75], a[236:239], v[16:19]
    v_mfma_f32_16x16x32_bf16 v[20:23], v[76:79], a[236:239], v[20:23]
    s_add_u32 s66, s66, 1
    s_nop 5
    v_cvt_pk_bf16_f32 v28, v16, v17
    v_cvt_pk_bf16_f32 v29, v18, v19
    v_cvt_pk_bf16_f32 v30, v20, v21
    v_cvt_pk_bf16_f32 v31, v22, v23
    buffer_store_dwordx4 v[28:31], v2, s[8:11], s39 offen offset:1024 sc1
    s_add_u32 s72, s72, s55
    s_waitcnt vmcnt(0)
    v_mov_b32 v6, s66
    s_mov_b64 exec, 1
    buffer_store_dword v6, v5, s[8:11], s73 offen sc1
    s_mov_b64 exec, -1
    s_sub_u32 s37, s69, 1
    s_min_u32 s37, s37, s78
    s_cmp_gt_u32 s76, s37
    s_cbranch_scc1 Lp2d_15
Lp2w_14:
    buffer_load_dword v7, v5, s[8:11], s74 offen sc1
    s_waitcnt vmcnt(0)
    v_readfirstlane_b32 s76, v7
    s_nop 0
    s_cmp_gt_u32 s76, s37
    s_cbranch_scc1 Lp2d_15
    s_sleep 1
    s_sub_u32 s36, s36, 1
    s_cbranch_scc0 Lp2w_14
    s_mov_b32 s36, 0
Lp2d_15:
    s_add_u32 m0, s75, s77
    s_nop 0
    buffer_load_dwordx4 v2, s[8:11], s71 offen offset:0 sc1 nt lds
    buffer_load_dwordx4 v2, s[8:11], s71 offen offset:1024 sc1 nt lds
    buffer_load_dwordx4 v2, s[8:11], s71 offen offset:2048 sc1 nt lds
    s_add_u32 s71, s71, s54
    s_add_u32 s77, s77, 12288
    s_cmp_eq_u32 s77, 49152
    s_cselect_b32 s77, 0, s77
    s_add_u32 s78, s78, 1
    v_add_u32 v3, s79, v2
    s_waitcnt vmcnt(0)
    s_barrier
    ds_read_b128 v[32:35], v3 offset:0
    ds_read_b128 v[36:39], v3 offset:1024
    ds_read_b128 v[40:43], v3 offset:3072
    ds_read_b128 v[44:47], v3 offset:4096
    ds_read_b128 v[48:51], v3 offset:6144
    ds_read_b128 v[52:55], v3 offset:7168
    ds_read_b128 v[56:59], v3 offset:9216
    ds_read_b128 v[60:63], v3 offset:10240
    ds_read_b64 v[64:65], v3 offset:2048
    ds_read_b64 v[66:67], v3 offset:5120
    ds_read_b64 v[68:69], v3 offset:2056
    ds_read_b64 v[70:71], v3 offset:5128
    ds_read_b64 v[72:73], v3 offset:8192
    ds_read_b64 v[74:75], v3 offset:11264
    ds_read_b64 v[76:77], v3 offset:8200
    ds_read_b64 v[78:79], v3 offset:11272
    s_add_u32 s79, s79, 12288
    s_cmp_eq_u32 s79, 49152
    s_cselect_b32 s79, 0, s79
    s_cmp_lt_u32 s66, 1
    s_cbranch_scc1 L_P2_drain
    s_sub_u32 s37, s69, 1
    s_min_u32 s37, s37, s78
    s_cmp_gt_u32 s76, s37
    s_cselect_b32 s93, 1, 0
    s_cbranch_scc0 Lp2e_16
    s_add_u32 m0, s75, s77
    s_nop 0
    buffer_load_dwordx4 v2, s[8:11], s71 offen offset:0 sc1 nt lds
    buffer_load_dwordx4 v2, s[8:11], s71 offen offset:1024 sc1 nt lds
    buffer_load_dwordx4 v2, s[8:11], s71 offen offset:2048 sc1 nt lds
    s_add_u32 s71, s71, s54
    s_add_u32 s77, s77, 12288
    s_cmp_eq_u32 s77, 49152
    s_cselect_b32 s77, 0, s77
    s_add_u32 s78, s78, 1
Lp2e_16:
    s_waitcnt lgkmcnt(0)
    v_mfma_f32_16x16x32_bf16 v[8:11], v[32:35], a[0:3], 0
    v_mfma_f32_16x16x32_bf16 v[12:15], v[36:39], a[0:3], 0
    v_mfma_f32_16x16x32_bf16 v[8:11], v[40:43], a[4:7], v[8:11]
    v_mfma_f32_16x16x32_bf16 v[12:15], v[44:47], a[4:7], v[12:15]
    v_mfma_f32_16x16x32_bf16 v[8:11], v[48:51], a[8:11], v[8:11]
    v_mfma_f32_16x16x32_bf16 v[12:15], v[52:55], a[8:11], v[12:15]
    v_mfma_f32_16x16x32_bf16 v[8:11], v[56:59], a[12:15], v[8:11]
    v_mfma_f32_16x16x32_bf16 v[12:15], v[60:63], a[12:15], v[12:15]
    v_mfma_f32_16x16x32_bf16 v[8:11], v[64:67], a[16:19], v[8:11]
    v_mfma_f32_16x16x32_bf16 v[12:15], v[68:71], a[16:19], v[12:15]
    v_mfma_f32_16x16x32_bf16 v[8:11], v[72:75], a[20:23], v[8:11]
    v_mfma_f32_16x16x32_bf16 v[12:15], v[76:79], a[20:23], v[12:15]
    v_mfma_f32_16x16x32_bf16 v[16:19], v[32:35], a[24:27], 0
    v_mfma_f32_16x16x32_bf16 v[20:23], v[36:39], a[24:27], 0
    v_mfma_f32_16x16x32_bf16 v[16:19], v[40:43], a[28:31], v[16:19]
    v_mfma_f32_16x16x32_bf16 v[20:23], v[44:47], a[28:31], v[20:23]
    v_mfma_f32_16x16x32_bf16 v[16:19], v[48:51], a[32:35], v[16:19]
    v_mfma_f32_16x16x32_bf16 v[20:23], v[52:55], a[32:35], v[20:23]
    s_nop 0
    v_cvt_pk_bf16_f32 v24, v8, v9
    v_mfma_f32_16x16x32_bf16 v[16:19], v[56:59], a[36:39], v[16:19]
    v_cvt_pk_bf16_f32 v25, v10, v11
    v_mfma_f32_16x16x32_bf16 v[20:23], v[60:63], a[36:39], v[20:23]
    v_cvt_pk_bf16_f32 v26, v12, v13
    v_mfma_f32_16x16x32_bf16 v[16:19], v[64:67], a[40:43], v[16:19]
    v_cvt_pk_bf16_f32 v27, v14, v15
    v_mfma_f32_16x16x32_bf16 v[20:23], v[68:71], a[40:43], v[20:23]
    s_add_u32 s39, s72, 0
    buffer_store_dwordx4 v[24:27], v2, s[8:11], s39 offen offset:0 sc1
    v_mfma_f32_16x16x32_bf16 v[16:19], v[72:75], a[44:47], v[16:19]
    v_mfma_f32_16x16x32_bf16 v[20:23], v[76:79], a[44:47], v[20:23]
    v_mfma_f32_16x16x32_bf16 v[8:11], v[32:35], a[48:51], 0
    v_mfma_f32_16x16x32_bf16 v[12:15], v[36:39], a[48:51], 0
    v_mfma_f32_16x16x32_bf16 v[8:11], v[40:43], a[52:55], v[8:11]
    v_mfma_f32_16x16x32_bf16 v[12:15], v[44:47], a[52:55], v[12:15]
    v_mfma_f32_16x16x32_bf16 v[8:11], v[48:51], a[56:59], v[8:11]
    v_mfma_f32_16x16x32_bf16 v[12:15], v[52:55], a[56:59], v[12:15]
    s_nop 0
    v_cvt_pk_bf16_f32 v28, v16, v17
    v_mfma_f32_16x16x32_bf16 v[8:11], v[56:59], a[60:63], v[8:11]
    v_cvt_pk_bf16_f32 v29, v18, v19
    v_mfma_f32_16x16x32_bf16 v[12:15], v[60:63], a[60:63], v[12:15]
    v_cvt_pk_bf16_f32 v30, v20, v21
    v_mfma_f32_16x16x32_bf16 v[8:11], v[64:67], a[64:67], v[8:11]
    v_cvt_pk_bf16_f32 v31, v22, v23
    v_mfma_f32_16x16x32_bf16 v[12:15], v[68:71], a[64:67], v[12:15]
    buffer_store_dwordx4 v[28:31], v2, s[8:11], s39 offen offset:1024 sc1
    v_mfma_f32_16x16x32_bf16 v[8:11], v[72:75], a[68:71], v[8:11]
    v_mfma_f32_16x16x32_bf16 v[12:15], v[76:79], a[68:71], v[12:15]
    v_mfma_f32_16x16x32_bf16 v[16:19], v[32:35], a[72:75], 0
    v_mfma_f32_16x16x32_bf16 v[20:23], v[36:39], a[72:75], 0
    v_mfma_f32_16x16x32_bf16 v[16:19], v[40:43], a[76:79], v[16:19]
    v_mfma_f32_16x16x32_bf16 v[20:23], v[44:47], a[76:79], v[20:23]
    v_mfma_f32_16x16x32_bf16 v[16:19], v[48:51], a[80:83], v[16:19]
    v_mfma_f32_16x16x32_bf16 v[20:23], v[52:55], a[80:83], v[20:23]
    s_nop 0
    v_cvt_pk_bf16_f32 v24, v8, v9
    v_mfma_f32_16x16x32_bf16 v[16:19], v[56:59], a[84:87], v[16:19]
    v_cvt_pk_bf16_f32 v25, v10, v11
    v_mfma_f32_16x16x32_bf16 v[20:23], v[60:63], a[84:87], v[20:23]
    v_cvt_pk_bf16_f32 v26, v12, v13
    v_mfma_f32_16x16x32_bf16 v[16:19], v[64:67], a[88:91], v[16:19]
    v_cvt_pk_bf16_f32 v27, v14, v15
    v_mfma_f32_16x16x32_bf16 v[20:23], v[68:71], a[88:91], v[20:23]
    buffer_store_dwordx4 v[24:27], v2, s[8:11], s39 offen offset:2048 sc1
    v_mfma_f32_16x16x32_bf16 v[16:19], v[72:75], a[92:95], v[16:19]
    v_mfma_f32_16x16x32_bf16 v[20:23], v[76:79], a[92:95], v[20:23]
    v_mfma_f32_16x16x32_bf16 v[8:11], v[32:35], a[96:99], 0
    v_mfma_f32_16x16x32_bf16 v[12:15], v[36:39], a[96:99], 0
    v_mfma_f32_16x16x32_bf16 v[8:11], v[40:43], a[100:103], v[8:11]
    v_mfma_f32_16x16x32_bf16 v[12:15], v[44:47], a[100:103], v[12:15]
    v_mfma_f32_16x16x32_bf16 v[8:11], v[48:51], a[104:107], v[8:11]
    v_mfma_f32_16x16x32_bf16 v[12:15], v[52:55], a[104:107], v[12:15]
    s_nop 0
    v_cvt_pk_bf16_f32 v28, v16, v17
    v_mfma_f32_16x16x32_bf16 v[8:11], v[56:59], a[108:111], v[8:11]
    v_cvt_pk_bf16_f32 v29, v18, v19
    v_mfma_f32_16x16x32_bf16 v[12:15], v[60:63], a[108:111], v[12:15]
    v_cvt_pk_bf16_f32 v30, v20, v21
    v_mfma_f32_16x16x32_bf16 v[8:11], v[64:67], a[112:115], v[8:11]
    v_cvt_pk_bf16_f32 v31, v22, v23
    v_mfma_f32_16x16x32_bf16 v[12:15], v[68:71], a[112:115], v[12:15]
    buffer_store_dwordx4 v[28:31], v2, s[8:11], s39 offen offset:3072 sc1
    v_mfma_f32_16x16x32_bf16 v[8:11], v[72:75], a[116:119], v[8:11]
    v_mfma_f32_16x16x32_bf16 v[12:15], v[76:79], a[116:119], v[12:15]
    v_mfma_f32_16x16x32_bf16 v[16:19], v[32:35], a[120:123], 0
    v_mfma_f32_16x16x32_bf16 v[20:23], v[36:39], a[120:123], 0
    v_mfma_f32_16x16x32_bf16 v[16:19], v[40:43], a[124:127], v[16:19]
    v_mfma_f32_16x16x32_bf16 v[20:23], v[44:47], a[124:127], v[20:23]
    v_mfma_f32_16x16x32_bf16 v[16:19], v[48:51], a[128:131], v[16:19]
    v_mfma_f32_16x16x32_bf16 v[20:23], v[52:55], a[128:131], v[20:23]
    s_nop 0
    v_cvt_pk_bf16_f32 v24, v8, v9
    v_mfma_f32_16x16x32_bf16 v[16:19], v[56:59], a[132:135], v[16:19]
    v_cvt_pk_bf16_f32 v25, v10, v11
    v_mfma_f32_16x16x32_bf16 v[20:23], v[60:63], a[132:135], v[20:23]
    v_cvt_pk_bf16_f32 v26, v12, v13
    v_mfma_f32_16x16x32_bf16 v[16:19], v[64:67], a[136:139], v[16:19]
    v_cvt_pk_bf16_f32 v27, v14, v15
    v_mfma_f32_16x16x32_bf16 v[20:23], v[68:71], a[136:139], v[20:23]
    s_add_u32 s39, s72, 4096
    buffer_store_dwordx4 v[24:27], v2, s[8:11], s39 offen offset:0 sc1
    v_mfma_f32_16x16x32_bf16 v[16:19], v[72:75], a[140:143], v[16:19]
    v_mfma_f32_16x16x32_bf16 v[20:23], v[76:79], a[140:143], v[20:23]
    s_cmp_lg_u32 s93, 0
    s_cbranch_scc1 Lp2l_17
    s_sub_u32 s37, s69, 1
    s_min_u32 s37, s37, s78
    s_cmp_gt_u32 s76, s37
    s_cbranch_scc1 Lp2d_19
Lp2w_18:
    buffer_load_dword v7, v5, s[8:11], s74 offen sc1
    s_waitcnt vmcnt(0)
    v_readfirstlane_b32 s76, v7
    s_nop 0
    s_cmp_gt_u32 s76, s37
    s_cbranch_scc1 Lp2d_19
    s_sleep 1
    s_sub_u32 s36, s36, 1
    s_cbranch_scc0 Lp2w_18
    s_mov_b32 s36, 0
Lp2d_19:
    s_add_u32 m0, s75, s77
    s_nop 0
    buffer_load_dwordx4 v2, s[8:11], s71 offen offset:0 sc1 nt lds
    buffer_load_dwordx4 v2, s[8:11], s71 offen offset:1024 sc1 nt lds
    buffer_load_dwordx4 v2, s[8:11], s71 offen offset:2048 sc1 nt lds
    s_add_u32 s71, s71, s54
    s_add_u32 s77, s77, 12288
    s_cmp_eq_u32 s77, 49152
    s_cselect_b32 s77, 0, s77
    s_add_u32 s78, s78, 1
Lp2l_17:
    v_mfma_f32_16x16x32_bf16 v[8:11], v[32:35], a[144:147], 0
    v_mfma_f32_16x16x32_bf16 v[12:15], v[36:39], a[144:147], 0
    v_mfma_f32_16x16x32_bf16 v[8:11], v[40:43], a[148:151], v[8:11]
    v_mfma_f32_16x16x32_bf16 v[12:15], v[44:47], a[148:151], v[12:15]
    v_mfma_f32_16x16x32_bf16 v[8:11], v[48:51], a[152:155], v[8:11]
    v_mfma_f32_16x16x32_bf16 v[12:15], v[52:55], a[152:155], v[12:15]
    v_cvt_pk_bf16_f32 v28, v16, v17
    v_mfma_f32_16x16x32_bf16 v[8:11], v[56:59], a[156:159], v[8:11]
    v_cvt_pk_bf16_f32 v29, v18, v19
    v_mfma_f32_16x16x32_bf16 v[12:15], v[60:63], a[156:159], v[12:15]
    v_cvt_pk_bf16_f32 v30, v20, v21
    v_mfma_f32_16x16x32_bf16 v[8:11], v[64:67], a[160:163], v[8:11]
    v_cvt_pk_bf16_f32 v31, v22, v23
    v_mfma_f32_16x16x32_bf16 v[12:15], v[68:71], a[160:163], v[12:15]
    buffer_store_dwordx4 v[28:31], v2, s[8:11], s39 offen offset:1024 sc1
    v_mfma_f32_16x16x32_bf16 v[8:11], v[72:75], a[164:167], v[8:11]
    v_mfma_f32_16x16x32_bf16 v[12:15], v[76:79], a[164:167], v[12:15]
    v_mfma_f32_16x16x32_bf16 v[16:19], v[32:35], a[168:171], 0
    v_mfma_f32_16x16x32_bf16 v[20:23], v[36:39], a[168:171], 0
    v_mfma_f32_16x16x32_bf16 v[16:19], v[40:43], a[172:175], v[16:19]
    v_mfma_f32_16x16x32_bf16 v[20:23], v[44:47], a[172:175], v[20:23]
    v_mfma_f32_16x16x32_bf16 v[16:19], v[48:51], a[176:179], v[16:19]
    v_mfma_f32_16x16x32_bf16 v[20:23], v[52:55], a[176:179], v[20:23]
    s_nop 0
    v_cvt_pk_bf16_f32 v24, v8, v9
    v_mfma_f32_16x16x32_bf16 v[16:19], v[56:59], a[180:183], v[16:19]
    v_cvt_pk_bf16_f32 v25, v10, v11
    v_mfma_f32_16x16x32_bf16 v[20:23], v[60:63], a[180:183], v[20:23]
    v_cvt_pk_bf16_f32 v26, v12, v13
    v_mfma_f32_16x16x32_bf16 v[16:19], v[64:67], a[184:187], v[16:19]
    v_cvt_pk_bf16_f32 v27, v14, v15
    v_mfma_f32_16x16x32_bf16 v[20:23], v[68:71], a[184:187], v[20:23]
    buffer_store_dwordx4 v[24:27], v2, s[8:11], s39 offen offset:2048 sc1
    v_mfma_f32_16x16x32_bf16 v[16:19], v[72:75], a[188:191], v[16:19]
    v_mfma_f32_16x16x32_bf16 v[20:23], v[76:79], a[188:191], v[20:23]
    v_mfma_f32_16x16x32_bf16 v[8:11], v[32:35], a[192:195], 0
    v_mfma_f32_16x16x32_bf16 v[12:15], v[36:39], a[192:195], 0
    v_mfma_f32_16x16x32_bf16 v[8:11], v[40:43], a[196:199], v[8:11]
    v_mfma_f32_16x16x32_bf16 v[12:15], v[44:47], a[196:199], v[12:15]
    v_mfma_f32_16x16x32_bf16 v[8:11], v[48:51], a[200:203], v[8:11]
    v_mfma_f32_16x16x32_bf16 v[12:15], v[52:55], a[200:203], v[12:15]
    s_nop 0
    v_cvt_pk_bf16_f32 v28, v16, v17
    v_mfma_f32_16x16x32_bf16 v[8:11], v[56:59], a[204:207], v[8:11]
    v_cvt_pk_bf16_f32 v29, v18, v19
    v_mfma_f32_16x16x32_bf16 v[12:15], v[60:63], a[204:207], v[12:15]
    v_cvt_pk_bf16_f32 v30, v20, v21
    v_mfma_f32_16x16x32_bf16 v[8:11], v[64:67], a[208:211], v[8:11]
    v_cvt_pk_bf16_f32 v31, v22, v23
    v_mfma_f32_16x16x32_bf16 v[12:15], v[68:71], a[208:211], v[12:15]
    buffer_store_dwordx4 v[28:31], v2, s[8:11], s39 offen offset:3072 sc1
    v_mfma_f32_16x16x32_bf16 v[8:11], v[72:75], a[212:215], v[8:11]
    s_waitcnt vmcnt(8)
    s_cmp_lg_u32 s93, 0
    s_cbranch_scc1 Lp2w_20
    s_waitcnt vmcnt(3)
Lp2w_20:
    s_barrier
    v_add_u32 v3, s79, v2
    v_mfma_f32_16x16x32_bf16 v[12:15], v[76:79], a[212:215], v[12:15]
    v_mfma_f32_16x16x32_bf16 v[16:19], v[32:35], a[216:219], 0
    ds_read_b128 v[32:35], v3 offset:0
    v_mfma_f32_16x16x32_bf16 v[20:23], v[36:39], a[216:219], 0
    ds_read_b128 v[36:39], v3 offset:1024
    v_mfma_f32_16x16x32_bf16 v[16:19], v[40:43], a[220:223], v[16:19]
    ds_read_b128 v[40:43], v3 offset:3072
    v_mfma_f32_16x16x32_bf16 v[20:23], v[44:47], a[220:223], v[20:23]
    ds_read_b128 v[44:47], v3 offset:4096
    v_mfma_f32_16x16x32_bf16 v[16:19], v[48:51], a[224:227], v[16:19]
    ds_read_b128 v[48:51], v3 offset:6144
    v_mfma_f32_16x16x32_bf16 v[20:23], v[52:55], a[224:227], v[20:23]
    ds_read_b128 v[52:55], v3 offset:7168
    v_cvt_pk_bf16_f32 v24, v8, v9
    v_mfma_f32_16x16x32_bf16 v[16:19], v[56:59], a[228:231], v[16:19]
    ds_read_b128 v[56:59], v3 offset:9216
    v_cvt_pk_bf16_f32 v25, v10, v11
    v_mfma_f32_16x16x32_bf16 v[20:23], v[60:63], a[228:231], v[20:23]
    ds_read_b128 v[60:63], v3 offset:10240
    v_cvt_pk_bf16_f32 v26, v12, v13
    v_mfma_f32_16x16x32_bf16 v[16:19], v[64:67], a[232:235], v[16:19]
    ds_read_b64 v[64:65], v3 offset:2048
    ds_read_b64 v[66:67], v3 offset:5120
    v_cvt_pk_bf16_f32 v27, v14, v15
    v_mfma_f32_16x16x32_bf16 v[20:23], v[68:71], a[232:235], v[20:23]
    ds_read_b64 v[68:69], v3 offset:2056
    ds_read_b64 v[70:71], v3 offset:5128
    s_add_u32 s39, s72, 8192
    buffer_store_dwordx4 v[24:27], v2, s[8:11], s39 offen offset:0 sc1
    v_mfma_f32_16x16x32_bf16 v[16:19], v[72:75], a[236:239], v[16:19]
    ds_read_b64 v[72:73], v3 offset:8192
    ds_read_b64 v[74:75], v3 offset:11264
    v_mfma_f32_16x16x32_bf16 v[20:23], v[76:79], a[236:239], v[20:23]
    ds_read_b64 v[76:77], v3 offset:8200
    ds_read_b64 v[78:79], v3 offset:11272
    s_add_u32 s66, s66, 1
    s_add_u32 s79, s79, 12288
    s_cmp_eq_u32 s79, 49152
    s_cselect_b32 s79, 0, s79
L_P2_loop:
    s_sub_u32 s37, s69, 1
    s_min_u32 s37, s37, s78
    s_cmp_gt_u32 s76, s37
    s_cselect_b32 s93, 1, 0
    s_cbranch_scc0 Lp2e_21
    s_add_u32 m0, s75, s77
    s_nop 0
    buffer_load_dwordx4 v2, s[8:11], s71 offen offset:0 sc1 nt lds
    buffer_load_dwordx4 v2, s[8:11], s71 offen offset:1024 sc1 nt lds
    buffer_load_dwordx4 v2, s[8:11], s71 offen offset:2048 sc1 nt lds
    s_add_u32 s71, s71, s54
    s_add_u32 s77, s77, 12288
    s_cmp_eq_u32 s77, 49152
    s_cselect_b32 s77, 0, s77
    s_add_u32 s78, s78, 1
Lp2e_21:
    s_waitcnt lgkmcnt(0)
    v_mfma_f32_16x16x32_bf16 v[8:11], v[32:35], a[0:3], 0
    v_mfma_f32_16x16x32_bf16 v[12:15], v[36:39], a[0:3], 0
    v_mfma_f32_16x16x32_bf16 v[8:11], v[40:43], a[4:7], v[8:11]
    v_mfma_f32_16x16x32_bf16 v[12:15], v[44:47], a[4:7], v[12:15]
    v_mfma_f32_16x16x32_bf16 v[8:11], v[48:51], a[8:11], v[8:11]
    v_mfma_f32_16x16x32_bf16 v[12:15], v[52:55], a[8:11], v[12:15]
    v_cvt_pk_bf16_f32 v28, v16, v17
    v_mfma_f32_16x16x32_bf16 v[8:11], v[56:59], a[12:15], v[8:11]
    v_cvt_pk_bf16_f32 v29, v18, v19
    v_mfma_f32_16x16x32_bf16 v[12:15], v[60:63], a[12:15], v[12:15]
    v_cvt_pk_bf16_f32 v30, v20, v21
    v_mfma_f32_16x16x32_bf16 v[8:11], v[64:67], a[16:19], v[8:11]
    v_cvt_pk_bf16_f32 v31, v22, v23
    v_mfma_f32_16x16x32_bf16 v[12:15], v[68:71], a[16:19], v[12:15]
    buffer_store_dwordx4 v[28:31], v2, s[8:11], s39 offen offset:1024 sc1
    s_add_u32 s72, s72, s55
    v_mfma_f32_16x16x32_bf16 v[8:11], v[72:75], a[20:23], v[8:11]
    v_mfma_f32_16x16x32_bf16 v[12:15], v[76:79], a[20:23], v[12:15]
    v_mfma_f32_16x16x32_bf16 v[16:19], v[32:35], a[24:27], 0
    v_mfma_f32_16x16x32_bf16 v[20:23], v[36:39], a[24:27], 0
    v_mfma_f32_16x16x32_bf16 v[16:19], v[40:43], a[28:31], v[16:19]
    v_mfma_f32_16x16x32_bf16 v[20:23], v[44:47], a[28:31], v[20:23]
    v_mfma_f32_16x16x32_bf16 v[16:19], v[48:51], a[32:35], v[16:19]
    v_mfma_f32_16x16x32_bf16 v[20:23], v[52:55], a[32:35], v[20:23]
    s_nop 0
    v_cvt_pk_bf16_f32 v24, v8, v9
    v_mfma_f32_16x16x32_bf16 v[16:19], v[56:59], a[36:39], v[16:19]
    v_cvt_pk_bf16_f32 v25, v10, v11
    v_mfma_f32_16x16x32_bf16 v[20:23], v[60:63], a[36:39], v[20:23]
    v_cvt_pk_bf16_f32 v26, v12, v13
    v_mfma_f32_16x16x32_bf16 v[16:19], v[64:67], a[40:43], v[16:19]
    v_cvt_pk_bf16_f32 v27, v14, v15
    v_mfma_f32_16x16x32_bf16 v[20:23], v[68:71], a[40:43], v[20:23]
    s_add_u32 s39, s72, 0
    buffer_store_dwordx4 v[24:27], v2, s[8:11], s39 offen offset:0 sc1
    v_mfma_f32_16x16x32_bf16 v[16:19], v[72:75], a[44:47], v[16:19]
    v_mfma_f32_16x16x32_bf16 v[20:23], v[76:79], a[44:47], v[20:23]
    v_mfma_f32_16x16x32_bf16 v[8:11], v[32:35], a[48:51], 0
    v_mfma_f32_16x16x32_bf16 v[12:15], v[36:39], a[48:51], 0
    v_mfma_f32_16x16x32_bf16 v[8:11], v[40:43], a[52:55], v[8:11]
    v_mfma_f32_16x16x32_bf16 v[12:15], v[44:47], a[52:55], v[12:15]
    v_mfma_f32_16x16x32_bf16 v[8:11], v[48:51], a[56:59], v[8:11]
    v_mfma_f32_16x16x32_bf16 v[12:15], v[52:55], a[56:59], v[12:15]
    s_nop 0
    v_cvt_pk_bf16_f32 v28, v16, v17
    v_mfma_f32_16x16x32_bf16 v[8:11], v[56:59], a[60:63], v[8:11]
    v_cvt_pk_bf16_f32 v29, v18, v19
    v_mfma_f32_16x16x32_bf16 v[12:15], v[60:63], a[60:63], v[12:15]
    v_cvt_pk_bf16_f32 v30, v20, v21
    v_mfma_f32_16x16x32_bf16 v[8:11], v[64:67], a[64:67], v[8:11]
    v_cvt_pk_bf16_f32 v31, v22, v23
    v_mfma_f32_16x16x32_bf16 v[12:15], v[68:71], a[64:67], v[12:15]
    buffer_store_dwordx4 v[28:31], v2, s[8:11], s39 offen offset:1024 sc1
    v_mfma_f32_16x16x32_bf16 v[8:11], v[72:75], a[68:71], v[8:11]
    v_mfma_f32_16x16x32_bf16 v[12:15], v[76:79], a[68:71], v[12:15]
    v_mfma_f32_16x16x32_bf16 v[16:19], v[32:35], a[72:75], 0
    v_mfma_f32_16x16x32_bf16 v[20:23], v[36:39], a[72:75], 0
    v_mfma_f32_16x16x32_bf16 v[16:19], v[40:43], a[76:79], v[16:19]
    v_mfma_f32_16x16x32_bf16 v[20:23], v[44:47], a[76:79], v[20:23]
    v_mfma_f32_16x16x32_bf16 v[16:19], v[48:51], a[80:83], v[16:19]
    v_mfma_f32_16x16x32_bf16 v[20:23], v[52:55], a[80:83], v[20:23]
    s_nop 0
    v_cvt_pk_bf16_f32 v24, v8, v9
    v_mfma_f32_16x16x32_bf16 v[16:19], v[56:59], a[84:87], v[16:19]
    v_cvt_pk_bf16_f32 v25, v10, v11
    v_mfma_f32_16x16x32_bf16 v[20:23], v[60:63], a[84:87], v[20:23]
    v_cvt_pk_bf16_f32 v26, v12, v13
    v_mfma_f32_16x16x32_bf16 v[16:19], v[64:67], a[88:91], v[16:19]
    v_cvt_pk_bf16_f32 v27, v14, v15
    v_mfma_f32_16x16x32_bf16 v[20:23], v[68:71], a[88:91], v[20:23]
    buffer_store_dwordx4 v[24:27], v2, s[8:11], s39 offen offset:2048 sc1
    v_mfma_f32_16x16x32_bf16 v[16:19], v[72:75], a[92:95], v[16:19]
    v_mfma_f32_16x16x32_bf16 v[20:23], v[76:79], a[92:95], v[20:23]
    v_mfma_f32_16x16x32_bf16 v[8:11], v[32:35], a[96:99], 0
    v_mfma_f32_16x16x32_bf16 v[12:15], v[36:39], a[96:99], 0
    v_mfma_f32_16x16x32_bf16 v[8:11], v[40:43], a[100:103], v[8:11]
    v_mfma_f32_16x16x32_bf16 v[12:15], v[44:47], a[100:103], v[12:15]
    v_mfma_f32_16x16x32_bf16 v[8:11], v[48:51], a[104:107], v[8:11]
    v_mfma_f32_16x16x32_bf16 v[12:15], v[52:55], a[104:107], v[12:15]
    s_nop 0
    v_cvt_pk_bf16_f32 v28, v16, v17
    v_mfma_f32_16x16x32_bf16 v[8:11], v[56:59], a[108:111], v[8:11]
    v_cvt_pk_bf16_f32 v29, v18, v19
    v_mfma_f32_16x16x32_bf16 v[12:15], v[60:63], a[108:111], v[12:15]
    v_cvt_pk_bf16_f32 v30, v20, v21
    v_mfma_f32_16x16x32_bf16 v[8:11], v[64:67], a[112:115], v[8:11]
    v_cvt_pk_bf16_f32 v31, v22, v23
    v_mfma_f32_16x16x32_bf16 v[12:15], v[68:71], a[112:115], v[12:15]
    buffer_store_dwordx4 v[28:31], v2, s[8:11], s39 offen offset:3072 sc1
    v_mfma_f32_16x16x32_bf16 v[8:11], v[72:75], a[116:119], v[8:11]
    v_mfma_f32_16x16x32_bf16 v[12:15], v[76:79], a[116:119], v[12:15]
    v_mfma_f32_16x16x32_bf16 v[16:19], v[32:35], a[120:123], 0
    v_mfma_f32_16x16x32_bf16 v[20:23], v[36:39], a[120:123], 0
    s_waitcnt vmcnt(4)
    v_mov_b32 v6, s66
    v_mfma_f32_16x16x32_bf16 v[16:19], v[40:43], a[124:127], v[16:19]
    s_mov_b64 exec, 1
    buffer_store_dword v6, v5, s[8:11], s73 offen sc1
    s_mov_b64 exec, -1
    v_mfma_f32_16x16x32_bf16 v[20:23], v[44:47], a[124:127], v[20:23]
    v_mfma_f32_16x16x32_bf16 v[16:19], v[48:51], a[128:131], v[16:19]
    v_mfma_f32_16x16x32_bf16 v[20:23], v[52:55], a[128:131], v[20:23]
    v_cvt_pk_bf16_f32 v24, v8, v9
    v_mfma_f32_16x16x32_bf16 v[16:19], v[56:59], a[132:135], v[16:19]
    v_cvt_pk_bf16_f32 v25, v10, v11
    v_mfma_f32_16x16x32_bf16 v[20:23], v[60:63], a[132:135], v[20:23]
    v_cvt_pk_bf16_f32 v26, v12, v13
    v_mfma_f32_16x16x32_bf16 v[16:19], v[64:67], a[136:139], v[16:19]
    v_cvt_pk_bf16_f32 v27, v14, v15
    v_mfma_f32_16x16x32_bf16 v[20:23], v[68:71], a[136:139], v[20:23]
    s_add_u32 s39, s72, 4096
    buffer_store_dwordx4 v[24:27], v2, s[8:11], s39 offen offset:0 sc1
    v_mfma_f32_16x16x32_bf16 v[16:19], v[72:75], a[140:143], v[16:19]
    v_mfma_f32_16x16x32_bf16 v[20:23], v[76:79], a[140:143], v[20:23]
    s_cmp_lg_u32 s93, 0
    s_cbranch_scc1 Lp2l_22
    s_sub_u32 s37, s69, 1
    s_min_u32 s37, s37, s78
    s_cmp_gt_u32 s76, s37
    s_cbranch_scc1 Lp2d_24
Lp2w_23:
    buffer_load_dword v7, v5, s[8:11], s74 offen sc1
    s_waitcnt vmcnt(0)
    v_readfirstlane_b32 s76, v7
    s_nop 0
    s_cmp_gt_u32 s76, s37
    s_cbranch_scc1 Lp2d_24
    s_sleep 1
    s_sub_u32 s36, s36, 1
    s_cbranch_scc0 Lp2w_23
    s_mov_b32 s36, 0
Lp2d_24:
    s_add_u32 m0, s75, s77
    s_nop 0
    buffer_load_dwordx4 v2, s[8:11], s71 offen offset:0 sc1 nt lds
    buffer_load_dwordx4 v2, s[8:11], s71 offen offset:1024 sc1 nt lds
    buffer_load_dwordx4 v2, s[8:11], s71 offen offset:2048 sc1 nt lds
    s_add_u32 s71, s71, s54
    s_add_u32 s77, s77, 12288
    s_cmp_eq_u32 s77, 49152
    s_cselect_b32 s77, 0, s77
    s_add_u32 s78, s78, 1
Lp2l_22:
    v_mfma_f32_16x16x32_bf16 v[8:11], v[32:35], a[144:147], 0
    v_mfma_f32_16x16x32_bf16 v[12:15], v[36:39], a[144:147], 0
    v_mfma_f32_16x16x32_bf16 v[8:11], v[40:43], a[148:151], v[8:11]
    v_mfma_f32_16x16x32_bf16 v[12:15], v[44:47], a[148:151], v[12:15]
    v_mfma_f32_16x16x32_bf16 v[8:11], v[48:51], a[152:155], v[8:11]
    v_mfma_f32_16x16x32_bf16 v[12:15], v[52:55], a[152:155], v[12:15]
    v_cvt_pk_bf16_f32 v28, v16, v17
    v_mfma_f32_16x16x32_bf16 v[8:11], v[56:59], a[156:159], v[8:11]
    v_cvt_pk_bf16_f32 v29, v18, v19
    v_mfma_f32_16x16x32_bf16 v[12:15], v[60:63], a[156:159], v[12:15]
    v_cvt_pk_bf16_f32 v30, v20, v21
    v_mfma_f32_16x16x32_bf16 v[8:11], v[64:67], a[160:163], v[8:11]
    v_cvt_pk_bf16_f32 v31, v22, v23
    v_mfma_f32_16x16x32_bf16 v[12:15], v[68:71], a[160:163], v[12:15]
    buffer_store_dwordx4 v[28:31], v2, s[8:11], s39 offen offset:1024 sc1
    v_mfma_f32_16x16x32_bf16 v[8:11], v[72:75], a[164:167], v[8:11]
    v_mfma_f32_16x16x32_bf16 v[12:15], v[76:79], a[164:167], v[12:15]
    v_mfma_f32_16x16x32_bf16 v[16:19], v[32:35], a[168:171], 0
    v_mfma_f32_16x16x32_bf16 v[20:23], v[36:39], a[168:171], 0
    v_mfma_f32_16x16x32_bf16 v[16:19], v[40:43], a[172:175], v[16:19]
    v_mfma_f32_16x16x32_bf16 v[20:23], v[44:47], a[172:175], v[20:23]
    v_mfma_f32_16x16x32_bf16 v[16:19], v[48:51], a[176:179], v[16:19]
    v_mfma_f32_16x16x32_bf16 v[20:23], v[52:55], a[176:179], v[20:23]
    s_nop 0
    v_cvt_pk_bf16_f32 v24, v8, v9
    v_mfma_f32_16x16x32_bf16 v[16:19], v[56:59], a[180:183], v[16:19]
    v_cvt_pk_bf16_f32 v25, v10, v11
    v_mfma_f32_16x16x32_bf16 v[20:23], v[60:63], a[180:183], v[20:23]
    v_cvt_pk_bf16_f32 v26, v12, v13
    v_mfma_f32_16x16x32_bf16 v[16:19], v[64:67], a[184:187], v[16:19]
    v_cvt_pk_bf16_f32 v27, v14, v15
    v_mfma_f32_16x16x32_bf16 v[20:23], v[68:71], a[184:187], v[20:23]
    buffer_store_dwordx4 v[24:27], v2, s[8:11], s39 offen offset:2048 sc1
    v_mfma_f32_16x16x32_bf16 v[16:19], v[72:75], a[188:191], v[16:19]
    v_mfma_f32_16x16x32_bf16 v[20:23], v[76:79], a[188:191], v[20:23]
    v_mfma_f32_16x16x32_bf16 v[8:11], v[32:35], a[192:195], 0
    v_mfma_f32_16x16x32_bf16 v[12:15], v[36:39], a[192:195], 0
    v_mfma_f32_16x16x32_bf16 v[8:11], v[40:43], a[196:199], v[8:11]
    v_mfma_f32_16x16x32_bf16 v[12:15], v[44:47], a[196:199], v[12:15]
    v_mfma_f32_16x16x32_bf16 v[8:11], v[48:51], a[200:203], v[8:11]
    v_mfma_f32_16x16x32_bf16 v[12:15], v[52:55], a[200:203], v[12:15]
    s_nop 0
    v_cvt_pk_bf16_f32 v28, v16, v17
    v_mfma_f32_16x16x32_bf16 v[8:11], v[56:59], a[204:207], v[8:11]
    v_cvt_pk_bf16_f32 v29, v18, v19
    v_mfma_f32_16x16x32_bf16 v[12:15], v[60:63], a[204:207], v[12:15]
    v_cvt_pk_bf16_f32 v30, v20, v21
    v_mfma_f32_16x16x32_bf16 v[8:11], v[64:67], a[208:211], v[8:11]
    v_cvt_pk_bf16_f32 v31, v22, v23
    v_mfma_f32_16x16x32_bf16 v[12:15], v[68:71], a[208:211], v[12:15]
    buffer_store_dwordx4 v[28:31], v2, s[8:11], s39 offen offset:3072 sc1
    v_mfma_f32_16x16x32_bf16 v[8:11], v[72:75], a[212:215], v[8:11]
    s_waitcnt vmcnt(8)
    s_cmp_lg_u32 s93, 0
    s_cbranch_scc1 Lp2w_25
    s_waitcnt vmcnt(3)
Lp2w_25:
    s_barrier
    v_add_u32 v3, s79, v2
    v_mfma_f32_16x16x32_bf16 v[12:15], v[76:79], a[212:215], v[12:15]
    v_mfma_f32_16x16x32_bf16 v[16:19], v[32:35], a[216:219], 0
    ds_read_b128 v[32:35], v3 offset:0
    v_mfma_f32_16x16x32_bf16 v[20:23], v[36:39], a[216:219], 0
    ds_read_b128 v[36:39], v3 offset:1024
    v_mfma_f32_16x16x32_bf16 v[16:19], v[40:43], a[220:223], v[16:19]
    ds_read_b128 v[40:43], v3 offset:3072
    v_mfma_f32_16x16x32_bf16 v[20:23], v[44:47], a[220:223], v[20:23]
    ds_read_b128 v[44:47], v3 offset:4096
    v_mfma_f32_16x16x32_bf16 v[16:19], v[48:51], a[224:227], v[16:19]
    ds_read_b128 v[48:51], v3 offset:6144
    v_mfma_f32_16x16x32_bf16 v[20:23], v[52:55], a[224:227], v[20:23]
    ds_read_b128 v[52:55], v3 offset:7168
    v_cvt_pk_bf16_f32 v24, v8, v9
    v_mfma_f32_16x16x32_bf16 v[16:19], v[56:59], a[228:231], v[16:19]
    ds_read_b128 v[56:59], v3 offset:9216
    v_cvt_pk_bf16_f32 v25, v10, v11
    v_mfma_f32_16x16x32_bf16 v[20:23], v[60:63], a[228:231], v[20:23]
    ds_read_b128 v[60:63], v3 offset:10240
    v_cvt_pk_bf16_f32 v26, v12, v13
    v_mfma_f32_16x16x32_bf16 v[16:19], v[64:67], a[232:235], v[16:19]
    ds_read_b64 v[64:65], v3 offset:2048
    ds_read_b64 v[66:67], v3 offset:5120
    v_cvt_pk_bf16_f32 v27, v14, v15
    v_mfma_f32_16x16x32_bf16 v[20:23], v[68:71], a[232:235], v[20:23]
    ds_read_b64 v[68:69], v3 offset:2056
    ds_read_b64 v[70:71], v3 offset:5128
    s_add_u32 s39, s72, 8192
    buffer_store_dwordx4 v[24:27], v2, s[8:11], s39 offen offset:0 sc1
    v_mfma_f32_16x16x32_bf16 v[16:19], v[72:75], a[236:239], v[16:19]
    ds_read_b64 v[72:73], v3 offset:8192
    ds_read_b64 v[74:75], v3 offset:11264
    v_mfma_f32_16x16x32_bf16 v[20:23], v[76:79], a[236:239], v[20:23]
    ds_read_b64 v[76:77], v3 offset:8200
    ds_read_b64 v[78:79], v3 offset:11272
    s_add_u32 s66, s66, 1
    s_add_u32 s79, s79, 12288
    s_cmp_eq_u32 s79, 49152
    s_cselect_b32 s79, 0, s79
    s_cmp_lt_u32 s66, s69
    s_cbranch_scc1 L_P2_loop
    v_cvt_pk_bf16_f32 v28, v16, v17
    v_cvt_pk_bf16_f32 v29, v18, v19
    v_cvt_pk_bf16_f32 v30, v20, v21
    v_cvt_pk_bf16_f32 v31, v22, v23
    buffer_store_dwordx4 v[28:31], v2, s[8:11], s39 offen offset:1024 sc1
    s_add_u32 s72, s72, s55
    s_waitcnt vmcnt(0)
    v_mov_b32 v6, s66
    s_mov_b64 exec, 1
    buffer_store_dword v6, v5, s[8:11], s73 offen sc1
    s_mov_b64 exec, -1
    s_cmp_lt_u32 s67, 32
    s_cbranch_scc0 L_P2_fin
    s_waitcnt vmcnt(0) lgkmcnt(0)
    s_branch L_F_go
L_P2_fin:
    s_waitcnt vmcnt(0)
    s_cmp_lg_u32 s36, 0
    s_cbranch_scc1 Lfin_26
    s_mov_b64 exec, 1
    v_mov_b32 v2, 1
    v_mov_b32 v3, 44
    buffer_atomic_add v2, v3, s[28:31], 0 offen
    s_mov_b64 exec, -1
Lfin_26:
    s_endpgm
L_SP:
    s_mov_b32 s3, 1
    s_sub_u32 s67, s5, 16
    s_branch L_C0
L_C:
    s_mov_b32 s3, 0
    s_sub_u32 s67, s5, 16
L_C0:
    s_lshl_b32 s66, s67, 2
    s_add_u32 s66, s66, s6
L_LN:
    s_cmp_eq_u32 s3, 1
    s_cbranch_scc1 L_C_nop
    s_lshl_b32 s68, s67, 2
    s_add_u32 s68, s68, s4
    v_mov_b32 v4, -1
    v_lshlrev_b32 v9, 2, v1
    s_lshl_b32 s38, s6, 15
    s_lshl_b32 s37, s68, 8
    s_add_u32 s38, s38, s37
    s_cmp_ge_u32 s67, 5
    s_cselect_b32 s37, 11264, 0
    s_add_u32 s38, s38, s37
    s_add_u32 s37, s38, 222298112
    buffer_store_dword v4, v9, s[8:11], s37 offen sc1
    s_add_u32 s37, s38, 222306304
    buffer_store_dword v4, v9, s[8:11], s37 offen sc1
    s_add_u32 s37, s38, 222429184
    buffer_store_dword v4, v9, s[8:11], s37 offen sc1
    s_add_u32 s37, s38, 222437376
    buffer_store_dword v4, v9, s[8:11], s37 offen sc1
    s_add_u32 s37, s38, 222560256
    buffer_store_dword v4, v9, s[8:11], s37 offen sc1
    s_add_u32 s37, s38, 222568448
    buffer_store_dword v4, v9, s[8:11], s37 offen sc1
    s_add_u32 s37, s38, 222691328
    buffer_store_dword v4, v9, s[8:11], s37 offen sc1
    s_add_u32 s37, s38, 222699520
    buffer_store_dword v4, v9, s[8:11], s37 offen sc1
    s_lshr_b32 s39, s67, 1
    s_lshl_b32 s39, s39, 14
    s_and_b32 s37, s67, 1
    s_lshl_b32 s37, s37, 12
    s_add_u32 s39, s39, s37
    s_add_u32 s37, s67, s6
    s_and_b32 s37, s37, 3
    s_lshl_b32 s37, s37, 2
    s_add_u32 s37, s37, s4
    s_lshl_b32 s37, s37, 8
    s_add_u32 s38, s39, s37
    s_waitcnt vmcnt(0)
    s_add_u32 s37, s38, 222298112
    buffer_store_dword v4, v9, s[8:11], s37 offen sc1
    s_add_u32 s37, s38, 222306304
    buffer_store_dword v4, v9, s[8:11], s37 offen sc1
    s_add_u32 s37, s38, 222380032
    buffer_store_dword v4, v9, s[8:11], s37 offen sc1
    s_add_u32 s37, s38, 222388224
    buffer_store_dword v4, v9, s[8:11], s37 offen sc1
    s_add_u32 s37, s38, 222461952
    buffer_store_dword v4, v9, s[8:11], s37 offen sc1
    s_add_u32 s37, s38, 222470144
    buffer_store_dword v4, v9, s[8:11], s37 offen sc1
    s_add_u32 s37, s38, 222543872
    buffer_store_dword v4, v9, s[8:11], s37 offen sc1
    s_add_u32 s37, s38, 222552064
    buffer_store_dword v4, v9, s[8:11], s37 offen sc1
    s_add_u32 s37, s38, 222625792
    buffer_store_dword v4, v9, s[8:11], s37 offen sc1
    s_add_u32 s37, s38, 222633984
    buffer_store_dword v4, v9, s[8:11], s37 offen sc1
    s_add_u32 s37, s38, 222707712
    buffer_store_dword v4, v9, s[8:11], s37 offen sc1
    s_add_u32 s37, s38, 222715904
    buffer_store_dword v4, v9, s[8:11], s37 offen sc1
    s_add_u32 s37, s38, 222789632
    buffer_store_dword v4, v9, s[8:11], s37 offen sc1
    s_add_u32 s37, s38, 222797824
    buffer_store_dword v4, v9, s[8:11], s37 offen sc1
    s_add_u32 s37, s38, 222871552
    buffer_store_dword v4, v9, s[8:11], s37 offen sc1
    s_add_u32 s37, s38, 222879744
    buffer_store_dword v4, v9, s[8:11], s37 offen sc1
    s_add_u32 s37, s38, 222953472
    buffer_store_dword v4, v9, s[8:11], s37 offen sc1
    s_add_u32 s37, s38, 222961664
    buffer_store_dword v4, v9, s[8:11], s37 offen sc1
    s_add_u32 s37, s38, 223035392
    buffer_store_dword v4, v9, s[8:11], s37 offen sc1
    s_add_u32 s37, s38, 223043584
    buffer_store_dword v4, v9, s[8:11], s37 offen sc1
    s_add_u32 s37, s38, 223117312
    buffer_store_dword v4, v9, s[8:11], s37 offen sc1
    s_add_u32 s37, s38, 223125504
    buffer_store_dword v4, v9, s[8:11], s37 offen sc1
    s_add_u32 s37, s38, 223199232
    buffer_store_dword v4, v9, s[8:11], s37 offen sc1
    s_add_u32 s37, s38, 223207424
    buffer_store_dword v4, v9, s[8:11], s37 offen sc1
    s_add_u32 s37, s38, 223281152
    buffer_store_dword v4, v9, s[8:11], s37 offen sc1
    s_add_u32 s37, s38, 223289344
    buffer_store_dword v4, v9, s[8:11], s37 offen sc1
    s_add_u32 s37, s38, 223363072
    buffer_store_dword v4, v9, s[8:11], s37 offen sc1
    s_add_u32 s37, s38, 223371264
    buffer_store_dword v4, v9, s[8:11], s37 offen sc1
    s_add_u32 s37, s38, 223444992
    buffer_store_dword v4, v9, s[8:11], s37 offen sc1
    s_add_u32 s37, s38, 223453184
    buffer_store_dword v4, v9, s[8:11], s37 offen sc1
    s_add_u32 s37, s38, 223526912
    buffer_store_dword v4, v9, s[8:11], s37 offen sc1
    s_add_u32 s37, s38, 223535104
    buffer_store_dword v4, v9, s[8:11], s37 offen sc1
    s_add_u32 s37, s38, 223608832
    buffer_store_dword v4, v9, s[8:11], s37 offen sc1
    s_add_u32 s37, s38, 223617024
    buffer_store_dword v4, v9, s[8:11], s37 offen sc1
    s_add_u32 s37, s38, 223690752
    buffer_store_dword v4, v9, s[8:11], s37 offen sc1
    s_add_u32 s37, s38, 223698944
    buffer_store_dword v4, v9, s[8:11], s37 offen sc1
    s_add_u32 s37, s38, 223772672
    buffer_store_dword v4, v9, s[8:11], s37 offen sc1
    s_add_u32 s37, s38, 223780864
    buffer_store_dword v4, v9, s[8:11], s37 offen sc1
    s_add_u32 s37, s38, 223854592
    buffer_store_dword v4, v9, s[8:11], s37 offen sc1
    s_add_u32 s37, s38, 223862784
    buffer_store_dword v4, v9, s[8:11], s37 offen sc1
    s_add_u32 s37, s38, 223936512
    buffer_store_dword v4, v9, s[8:11], s37 offen sc1
    s_add_u32 s37, s38, 223944704
    buffer_store_dword v4, v9, s[8:11], s37 offen sc1
    s_add_u32 s37, s38, 224018432
    buffer_store_dword v4, v9, s[8:11], s37 offen sc1
    s_add_u32 s37, s38, 224026624
    buffer_store_dword v4, v9, s[8:11], s37 offen sc1
    s_add_u32 s37, s38, 224100352
    buffer_store_dword v4, v9, s[8:11], s37 offen sc1
    s_add_u32 s37, s38, 224108544
    buffer_store_dword v4, v9, s[8:11], s37 offen sc1
    s_add_u32 s37, s38, 224182272
    buffer_store_dword v4, v9, s[8:11], s37 offen sc1
    s_add_u32 s37, s38, 224190464
    buffer_store_dword v4, v9, s[8:11], s37 offen sc1
    s_cmp_ge_u32 s68, 20
    s_cbranch_scc1 L_C_nop
    s_mul_i32 s38, s6, 5120
    s_lshl_b32 s37, s68, 8
    s_add_u32 s38, s38, s37
    s_add_u32 s37, s38, 65536
    buffer_store_dword v4, v9, s[8:11], s37 offen sc1
    s_add_u32 s37, s38, 86016
    buffer_store_dword v4, v9, s[8:11], s37 offen sc1
    s_add_u32 s37, s38, 106496
    buffer_store_dword v4, v9, s[8:11], s37 offen sc1
L_C_nop:
    s_waitcnt vmcnt(0)
    s_barrier
    s_cmp_lg_u32 s4, 0
    s_cbranch_scc1 Larr_27
    s_lshl_b32 s37, s7, 16
    s_add_u32 s37, s37, 1
    s_mov_b64 exec, 1
    v_mov_b32 v2, s37
    v_mov_b32 v3, 36
    buffer_atomic_add v2, v3, s[28:31], 0 offen
    s_mov_b64 exec, -1
Larr_27:
    s_cmp_eq_u32 s3, 0
    s_cbranch_scc1 L_C_go
    s_lshl_b32 s37, s66, 2
    s_add_u32 s37, s37, s4
    s_cmp_lg_u32 s37, 160
    s_cbranch_scc1 L_end
    s_waitcnt vmcnt(0)
    v_mov_b32 v3, 224329728
    s_mov_b32 s70, -1
    s_mov_b32 s71, -1
    s_mov_b32 s39, 8
    s_mov_b64 exec, 1
L_probe:
    s_mov_b32 s38, 0
    v_mov_b32 v2, 0
    s_memtime s[72:73]
    s_waitcnt lgkmcnt(0)
    buffer_atomic_or v2, v3, s[8:11], s38 offen sc0
    s_waitcnt vmcnt(0)
    s_memtime s[74:75]
    s_waitcnt lgkmcnt(0)
    s_sub_u32 s37, s74, s72
    s_min_u32 s70, s70, s37
    s_mov_b32 s38, 8192
    v_mov_b32 v2, 0
    s_memtime s[72:73]
    s_waitcnt lgkmcnt(0)
    buffer_atomic_or v2, v3, s[8:11], s38 offen sc0
    s_waitcnt vmcnt(0)
    s_memtime s[74:75]
    s_waitcnt lgkmcnt(0)
    s_sub_u32 s37, s74, s72
    s_min_u32 s71, s71, s37
    s_sub_u32 s39, s39, 1
    s_cbranch_scc0 L_probe
    s_cmp_lt_u32 s71, s70
    s_cselect_b32 s37, 3, 2
    s_lshl_b32 s37, s37, 24
    v_mov_b32 v2, s37
    v_mov_b32 v3, 36
    buffer_atomic_add v2, v3, s[28:31], 0 offen
    s_mov_b64 exec, -1
    s_endpgm
L_C_go:
    v_lshlrev_b32 v2, 4, v1
    v_lshlrev_b32 v6, 2, v1
    v_and_b32 v22, 2, v1
    v_cmp_eq_u32 vcc, 0, v22
    v_mov_b32 v22, 0xe4e4
    v_mov_b32 v23, 0x4e4e
    v_cndmask_b32 v3, v22, v23, vcc
    v_and_b32 v20, 15, v1
    v_lshrrev_b32 v21, 4, v1
    v_mul_u32_u24 v22, 10240, v21
    v_lshl_add_u32 v4, v20, 4, v22
    v_mul_u32_u24 v22, 2560, v21
    v_lshl_add_u32 v5, v20, 4, v22
    v_and_b32 v22, 7, v1
    s_mul_i32 s37, s68, 26
    s_lshr_b32 s37, s37, 8
    s_lshl_b32 s37, s37, 2
    s_lshl_b32 s38, s6, 10
    s_add_u32 s37, s37, s38
    s_add_u32 s37, s37, 20480
    v_lshl_add_u32 v8, v22, 7, s37
    v_lshlrev_b32 v10, 2, v22
    s_lshl_b32 s37, s6, 2
    s_add_u32 s37, s37, s4
    s_lshl_b32 s37, s37, 5
    s_add_u32 s40, s37, 34816
    v_mov_b32 v7, 0
    v_mov_b32 v9, 0
    v_mov_b32 v16, -1
    s_lshl_b32 s37, s4, 10
    v_add_u32 v11, s37, v2
    s_lshl_b32 s37, s4, 8
    s_add_u32 s37, s37, 4096
    v_add_u32 v12, s37, v6
    v_bfe_u32 v20, v1, 3, 2
    v_bfe_u32 v22, v1, 2, 1
    v_lshl_add_u32 v20, v20, 2, v22
    v_and_b32 v21, 1, v1
    v_bfe_u32 v22, v1, 1, 1
    v_lshrrev_b32 v23, 5, v1
    v_lshl_add_u32 v18, v21, 1, v20
    v_mul_u32_u24 v19, 20, v22
    v_xor_b32 v18, v18, v19
    v_lshl_add_u32 v18, v23, 5, v18
    s_lshl_b32 s38, s4, 10
    v_lshl_add_u32 v18, v18, 4, s38
    v_xor_b32 v21, v21, v22
    v_xor_b32 v21, 1, v21
    v_lshl_add_u32 v19, v21, 1, v20
    v_lshl_add_u32 v19, v19, 1, v23
    v_lshl_add_u32 v19, v19, 1, v22
    v_lshl_add_u32 v19, v19, 2, s37
    v_bfe_u32 v22, v1, 4, 1
    v_lshlrev_b32 v22, 2, v22
    v_xor_b32 v22, v22, v1
    v_lshlrev_b32 v17, 4, v22
    v_lshrrev_b32 v22, 4, v1
    v_bfe_u32 v23, v1, 2, 1
    v_lshl_add_u32 v22, v22, 1, v23
    v_mul_u32_u24 v22, 1280, v22
    v_and_b32 v23, 11, v1
    v_lshl_add_u32 v22, v23, 1, v22
    s_lshl_b32 s37, s68, 5
    buffer_load_ushort v28, v22, s[32:35], s37 offen
    buffer_load_ushort v29, v22, s[32:35], s37 offen offset:8
    v_mov_b32 v21, 36
    s_cmp_lg_u32 s4, 0
    s_cbranch_scc1 Lwik_30
Lwi_28:
    buffer_load_dword v20, v21, s[28:31], 0 offen sc1
    s_waitcnt vmcnt(0)
    v_readfirstlane_b32 s37, v20
    s_nop 0
    s_and_b32 s38, s37, 0x200ffff
    s_cmp_eq_u32 s38, 0x2000100
    s_cbranch_scc1 Lwid_29
    s_sleep 6
    s_sub_u32 s36, s36, 1
    s_cbranch_scc0 Lwi_28
    s_mov_b32 s36, 0
Lwid_29:
    v_mov_b32 v21, 163836
    ds_write_b32 v21, v20
    s_waitcnt lgkmcnt(0)
Lwik_30:
    s_waitcnt vmcnt(0)
    s_barrier
    v_mov_b32 v21, 163836
    ds_read_b32 v20, v21
    s_waitcnt lgkmcnt(0)
    v_readfirstlane_b32 s37, v20
    s_nop 0
    s_bfe_u32 s7, s37, 0x80010
    s_bfe_u32 s43, s37, 0x10018
    s_lshl_b32 s43, s43, 13
    v_and_b32 v20, 15, v1
    v_lshlrev_b32 v20, 4, v20
    v_lshrrev_b32 v21, 4, v1
    v_mov_b32 v121, 0x70000000
    s_add_u32 s38, s6, 0
    s_lshr_b32 s39, s67, 1
    s_lshl_b32 s39, s39, 14
    s_and_b32 s37, s67, 1
    s_lshl_b32 s37, s37, 12
    s_add_u32 s39, s39, s37
    s_add_u32 s37, s67, s38
    s_and_b32 s37, s37, 3
    s_lshl_b32 s37, s37, 2
    s_add_u32 s37, s37, s4
    s_lshl_b32 s37, s37, 8
    s_add_u32 s71, s39, s37
    v_mul_u32_u24 v22, 245760, v21
    v_add3_u32 v120, v22, v20, s71
    s_add_u32 s38, s6, 1
    s_lshr_b32 s39, s67, 1
    s_lshl_b32 s39, s39, 14
    s_and_b32 s37, s67, 1
    s_lshl_b32 s37, s37, 12
    s_add_u32 s39, s39, s37
    s_add_u32 s37, s67, s38
    s_and_b32 s37, s37, 3
    s_lshl_b32 s37, s37, 2
    s_add_u32 s37, s37, s4
    s_lshl_b32 s37, s37, 8
    s_add_u32 s71, s39, s37
    v_add_u32 v22, s71, v20
    v_cmp_eq_u32 vcc, 0, v21
    s_nop 1
    v_cndmask_b32 v121, v121, v22, vcc
    s_add_u32 s38, s6, 2
    s_lshr_b32 s39, s67, 1
    s_lshl_b32 s39, s39, 14
    s_and_b32 s37, s67, 1
    s_lshl_b32 s37, s37, 12
    s_add_u32 s39, s39, s37
    s_add_u32 s37, s67, s38
    s_and_b32 s37, s37, 3
    s_lshl_b32 s37, s37, 2
    s_add_u32 s37, s37, s4
    s_lshl_b32 s37, s37, 8
    s_add_u32 s71, s39, s37
    v_add_u32 v22, s71, v20
    v_cmp_eq_u32 vcc, 1, v21
    s_nop 1
    v_cndmask_b32 v121, v121, v22, vcc
    s_add_u32 s38, s6, 3
    s_lshr_b32 s39, s67, 1
    s_lshl_b32 s39, s39, 14
    s_and_b32 s37, s67, 1
    s_lshl_b32 s37, s37, 12
    s_add_u32 s39, s39, s37
    s_add_u32 s37, s67, s38
    s_and_b32 s37, s37, 3
    s_lshl_b32 s37, s37, 2
    s_add_u32 s37, s37, s4
    s_lshl_b32 s37, s37, 8
    s_add_u32 s71, s39, s37
    v_add_u32 v22, s71, v20
    v_cmp_eq_u32 vcc, 2, v21
    s_nop 1
    v_cndmask_b32 v121, v121, v22, vcc
    s_add_u32 s41, s43, 222298112
    s_add_u32 s72, s41, 81920
    s_add_u32 s73, s41, 163840
    v_bfe_u32 v22, v1, 2, 2
    v_and_b32 v23, 1, v1
    v_cmp_eq_u32 vcc, 0, v23
    v_mov_b32 v23, 0x3f80
    v_mov_b32 v20, 0x3f800000
    v_cndmask_b32 v23, v20, v23, vcc
    v_cmp_eq_u32 vcc, 0, v22
    s_nop 1
    v_cndmask_b32 v104, 0, v23, vcc
    v_mov_b32 v112, -1
    v_cmp_eq_u32 vcc, 1, v22
    s_nop 1
    v_cndmask_b32 v105, 0, v23, vcc
    v_mov_b32 v113, -1
    v_cmp_eq_u32 vcc, 2, v22
    s_nop 1
    v_cndmask_b32 v106, 0, v23, vcc
    v_mov_b32 v114, -1
    v_cmp_eq_u32 vcc, 3, v22
    s_nop 1
    v_cndmask_b32 v107, 0, v23, vcc
    v_mov_b32 v115, -1
    s_lshl_b32 s45, s6, 15
    s_lshl_b32 s37, s68, 8
    s_add_u32 s45, s45, s37
    s_cmp_ge_u32 s67, 5
    s_cselect_b32 s37, 11264, 0
    s_add_u32 s45, s45, s37
    s_xor_b32 s37, s43, 8192
    s_add_u32 s45, s45, s37
    s_add_u32 s45, s45, 222298112
    v_lshl_or_b32 v28, v29, 16, v28
    v_min_u32 v28, -2, v28
    buffer_store_dword v28, v6, s[8:11], s45 offen sc1
    s_lshl_b32 s38, s68, 8
    s_mul_i32 s74, s6, 5120
    s_add_u32 s74, s74, 65536
    s_add_u32 s75, s74, 20480
    s_add_u32 s64, s74, 40960
    s_mul_i32 s76, s6, 81920
    s_add_u32 s76, s76, s38
    s_add_u32 s76, s76, 85983232
    s_add_u32 s77, s76, 327680
    s_add_u32 s42, s76, 655360
    s_mul_i32 s44, s4, 5120
    s_mul_i32 s65, s6, 20480
    s_add_u32 s65, s65, s44
    s_add_u32 s65, s65, 163840
    s_add_u32 s78, s65, 81920
    s_add_u32 s79, s65, 163840
    s_mul_i32 s100, s6, 327680
    s_lshl_b32 s37, s68, 10
    s_add_u32 s100, s100, s37
    s_add_u32 s100, s100, 112197632
    s_mul_i32 s101, s6, 40960
    s_add_u32 s101, s101, s37
    s_add_u32 s101, s101, 89686016
    s_mov_b32 s66, 0
    s_cmp_lg_u32 s7, 0
    s_cbranch_scc1 L_C_slow
L_C_fast:
    s_add_u32 s69, s66, 1
    v_cmp_gt_u32 vcc, s69, v7
    s_cbranch_vccz Lfgd_32
Lfg_31:
    buffer_load_dword v7, v8, s[8:11], 0 offen sc1
    s_waitcnt vmcnt(0)
    v_cmp_gt_u32 vcc, s69, v7
    s_cbranch_vccz Lfgd_32
    s_sleep 1
    s_sub_u32 s36, s36, 1
    s_cbranch_scc0 Lfg_31
    s_mov_b32 s36, 0
Lfgd_32:
    s_add_u32 s37, s66, 2
    s_and_b32 s37, s37, 3
    s_lshl_b32 s37, s37, 17
    s_add_u32 s70, s45, s37
    s_add_u32 m0, s44, 8192
    s_nop 0
    buffer_load_dwordx4 v2, s[8:11], s78 offen offset:0 sc1 lds
    buffer_load_dwordx4 v2, s[8:11], s78 offen offset:1024 sc1 lds
    buffer_load_dwordx4 v2, s[8:11], s78 offen offset:2048 sc1 lds
    buffer_load_dwordx4 v2, s[8:11], s78 offen offset:3072 sc1 lds
    s_add_u32 m0, s44, 12288
    s_add_u32 s37, s78, 4096
    buffer_load_dwordx4 v2, s[8:11], s37 offen sc1 lds
    buffer_store_dword v16, v6, s[8:11], s70 offen
    s_add_u32 s38, s100, 0
    buffer_load_dwordx4 v[128:131], v2, s[8:11], s38 offen sc1 nt
    s_add_u32 s38, s100, 40960
    buffer_load_dwordx4 v[132:135], v2, s[8:11], s38 offen sc1 nt
    s_add_u32 s38, s100, 81920
    buffer_load_dwordx4 v[136:139], v2, s[8:11], s38 offen sc1 nt
    s_add_u32 s38, s100, 122880
    buffer_load_dwordx4 v[140:143], v2, s[8:11], s38 offen sc1 nt
    s_add_u32 s38, s100, 163840
    buffer_load_dwordx4 v[144:147], v2, s[8:11], s38 offen sc1 nt
    s_add_u32 s38, s100, 204800
    buffer_load_dwordx4 v[148:151], v2, s[8:11], s38 offen sc1 nt
    s_add_u32 s38, s100, 245760
    buffer_load_dwordx4 v[152:155], v2, s[8:11], s38 offen sc1 nt
    s_add_u32 s38, s100, 286720
    buffer_load_dwordx4 v[156:159], v2, s[8:11], s38 offen sc1 nt
    buffer_store_dwordx4 v[28:31], v2, s[8:11], s101 offen sc1
    s_add_u32 s101, s101, 163840
    s_add_u32 s38, s73, 0
    buffer_store_dwordx4 v[112:115], v120, s[8:11], s38 offen sc1
    s_waitcnt vmcnt(11)
    s_barrier
    ds_read_b128 v[72:75], v2 offset:8192
    ds_read_b128 v[76:79], v2 offset:9216
    ds_read_b128 v[80:83], v2 offset:10752
    ds_read_b128 v[84:87], v2 offset:11776
    ds_read_b128 v[88:91], v2 offset:13312
    ds_read_b128 v[92:95], v2 offset:14336
    s_waitcnt lgkmcnt(5)
    v_mfma_f32_16x16x32_bf16 v[44:47], a[0:3], v[72:75], 0
    ds_read_b128 v[96:99], v2 offset:15872
    v_mov_b32 v40, 0
    s_waitcnt lgkmcnt(5)
    v_mfma_f32_16x16x32_bf16 v[48:51], a[0:3], v[76:79], 0
    ds_read_b128 v[100:103], v2 offset:16896
    v_mov_b32 v41, 0
    s_waitcnt lgkmcnt(5)
    v_mfma_f32_16x16x32_bf16 v[44:47], a[4:7], v[80:83], v[44:47]
    ds_read_b128 v[72:75], v2 offset:18432
    v_mov_b32 v42, 0
    s_waitcnt lgkmcnt(5)
    v_mfma_f32_16x16x32_bf16 v[48:51], a[4:7], v[84:87], v[48:51]
    ds_read_b128 v[76:79], v2 offset:19456
    v_mov_b32 v43, 0
    s_waitcnt lgkmcnt(5)
    v_mfma_f32_16x16x32_bf16 v[44:47], a[8:11], v[88:91], v[44:47]
    ds_read_b128 v[80:83], v2 offset:20992
    s_waitcnt lgkmcnt(5)
    v_mfma_f32_16x16x32_bf16 v[48:51], a[8:11], v[92:95], v[48:51]
    ds_read_b128 v[84:87], v2 offset:22016
    s_waitcnt lgkmcnt(5)
    v_mfma_f32_16x16x32_bf16 v[44:47], a[12:15], v[96:99], v[44:47]
    ds_read_b128 v[88:91], v2 offset:23552
    s_waitcnt lgkmcnt(5)
    v_mfma_f32_16x16x32_bf16 v[48:51], a[12:15], v[100:103], v[48:51]
    ds_read_b128 v[92:95], v2 offset:24576
    s_waitcnt lgkmcnt(5)
    v_mfma_f32_16x16x32_bf16 v[44:47], a[16:19], v[72:75], v[44:47]
    ds_read_b128 v[96:99], v2 offset:26112
    s_waitcnt lgkmcnt(5)
    v_mfma_f32_16x16x32_bf16 v[48:51], a[16:19], v[76:79], v[48:51]
    ds_read_b128 v[100:103], v2 offset:27136
    s_waitcnt lgkmcnt(5)
    v_mfma_f32_16x16x32_bf16 v[44:47], a[20:23], v[80:83], v[44:47]
    ds_read_b128 v[72:75], v5 offset:10240
    s_waitcnt lgkmcnt(5)
    v_mfma_f32_16x16x32_bf16 v[48:51], a[20:23], v[84:87], v[48:51]
    ds_read_b128 v[76:79], v5 offset:10496
    s_waitcnt lgkmcnt(5)
    v_mfma_f32_16x16x32_bf16 v[44:47], a[24:27], v[88:91], v[44:47]
    ds_read_b128 v[80:83], v5 offset:20480
    s_waitcnt lgkmcnt(5)
    v_mfma_f32_16x16x32_bf16 v[48:51], a[24:27], v[92:95], v[48:51]
    ds_read_b128 v[84:87], v5 offset:20736
    s_waitcnt lgkmcnt(5)
    v_mfma_f32_16x16x32_bf16 v[44:47], a[28:31], v[96:99], v[44:47]
    s_waitcnt lgkmcnt(4)
    v_mfma_f32_16x16x32_bf16 v[48:51], a[28:31], v[100:103], v[48:51]
    s_waitcnt lgkmcnt(3)
    v_mfma_f32_16x16x32_bf16 v[44:47], a[32:35], v[72:75], v[44:47]
    s_waitcnt lgkmcnt(2)
    v_mfma_f32_16x16x32_bf16 v[48:51], a[32:35], v[76:79], v[48:51]
    s_waitcnt lgkmcnt(1)
    v_mfma_f32_16x16x32_bf16 v[44:47], a[36:39], v[80:83], v[44:47]
    s_waitcnt lgkmcnt(0)
    v_mfma_f32_16x16x32_bf16 v[48:51], a[36:39], v[84:87], v[48:51]
    s_mov_b32 s37, s78
    s_mov_b32 s78, s79
    s_mov_b32 s79, s65
    s_mov_b32 s65, s37
    s_nop 1
    v_cvt_pk_bf16_f32 v28, v44, v45
    v_cvt_pk_bf16_f32 v29, v46, v47
    v_cvt_pk_bf16_f32 v30, v48, v49
    v_cvt_pk_bf16_f32 v31, v50, v51
    s_add_u32 s37, s66, 1
    s_and_b32 s37, s37, 3
    s_lshl_b32 s37, s37, 17
    s_add_u32 s70, s45, s37
    s_add_u32 s38, s76, 40960
    v_mov_b32 v32, -1
    v_mov_b32 v33, -1
    v_mov_b32 v34, -1
    v_mov_b32 v35, -1
    v_mov_b32 v36, -1
    v_mov_b32 v160, -1
    v_mov_b32 v161, -1
    v_mov_b32 v162, -1
    v_mov_b32 v163, -1
    v_mov_b32 v164, -1
    v_mov_b32 v165, -1
    v_mov_b32 v166, -1
    v_mov_b32 v167, -1
    s_mov_b64 s[56:57], -1
    s_waitcnt vmcnt(0)
Lcb_33:
    buffer_load_dwordx4 v[32:35], v11, s[8:11], s74 offen sc1
    buffer_load_dword v36, v12, s[8:11], s74 offen sc1
    s_mov_b64 exec, s[56:57]
    buffer_load_dwordx4 v[160:163], v4, s[8:11], s76 offen sc1
    buffer_load_dwordx4 v[164:167], v4, s[8:11], s38 offen sc1
    s_mov_b64 exec, -1
    v_max3_u32 v21, v160, v161, v162
    v_max3_u32 v21, v21, v163, v164
    v_max3_u32 v21, v21, v165, v166
    v_max_u32 v21, v21, v167
    v_cmp_eq_u32 s[56:57], -1, v21
    s_sub_u32 s36, s36, 1
    s_cbranch_scc1 Lce_35
    s_waitcnt vmcnt(2)
    v_max3_u32 v20, v32, v33, v34
    v_max3_u32 v20, v20, v35, v36
    v_cmp_eq_u32 vcc, -1, v20
    ds_write_b128 v18, v[32:35] offset:0
    ds_write_b32 v19, v36 offset:0
    s_cbranch_vccnz Lcb_33
Lcd_34:
    s_waitcnt lgkmcnt(0)
    s_barrier
    ds_read_b128 v[52:55], v17 offset:0
    ds_read_b128 v[56:59], v17 offset:1024
    ds_read_b128 v[60:63], v17 offset:2048
    ds_read_b128 v[64:67], v17 offset:3072
    ds_read_b128 v[68:71], v2 offset:4096
    v_max3_u32 v20, v160, v161, v162
    v_max3_u32 v20, v20, v163, v164
    v_max3_u32 v20, v20, v165, v166
    v_max3_u32 v20, v20, v167, v167
    v_cmp_eq_u32 vcc, -1, v20
    s_cbranch_vccnz Lmp_36
Lmpd_37:
    s_waitcnt lgkmcnt(4)
    v_smfmac_f32_16x16x64_bf16 v[40:43], v[52:55], v[128:135], v3
    s_waitcnt lgkmcnt(3)
    v_smfmac_f32_16x16x64_bf16 v[40:43], v[56:59], v[136:143], v3
    s_waitcnt lgkmcnt(2)
    v_smfmac_f32_16x16x64_bf16 v[40:43], v[60:63], v[144:151], v3
    s_waitcnt lgkmcnt(1)
    v_smfmac_f32_16x16x64_bf16 v[40:43], v[64:67], v[152:159], v3
    s_waitcnt lgkmcnt(0)
    v_smfmac_f32_16x16x64_bf16 v[40:43], v[68:71], v[160:167], v3
    s_add_u32 s39, s72, 983040
    s_nop 6
    v_pk_add_f32 v[40:41], v[40:41], v[42:43]
    v_cvt_pk_bf16_f32 v108, v40, v41
    v_cvt_pk_bf16_f32 v109, v40, v41
    v_mov_b32 v42, v40
    v_mov_b32 v43, v41
    v_permlane16_swap_b32 v108, v109
    v_mov_b32 v110, v108
    v_mov_b32 v111, v109
    s_nop 0
    v_permlane32_swap_b32 v108, v110
    v_permlane32_swap_b32 v109, v111
    buffer_store_dwordx4 v[108:111], v120, s[8:11], s72 offen sc1
    v_accvgpr_write_b32 a0, v128
    v_accvgpr_write_b32 a1, v129
    v_accvgpr_write_b32 a2, v130
    v_accvgpr_write_b32 a3, v131
    v_accvgpr_write_b32 a4, v132
    v_accvgpr_write_b32 a5, v133
    v_accvgpr_write_b32 a6, v134
    v_accvgpr_write_b32 a7, v135
    v_accvgpr_write_b32 a8, v136
    v_accvgpr_write_b32 a9, v137
    v_accvgpr_write_b32 a10, v138
    v_accvgpr_write_b32 a11, v139
    v_accvgpr_write_b32 a12, v140
    v_accvgpr_write_b32 a13, v141
    v_accvgpr_write_b32 a14, v142
    v_accvgpr_write_b32 a15, v143
    v_accvgpr_write_b32 a16, v144
    v_accvgpr_write_b32 a17, v145
    v_accvgpr_write_b32 a18, v146
    v_accvgpr_write_b32 a19, v147
    v_accvgpr_write_b32 a20, v148
    v_accvgpr_write_b32 a21, v149
    v_accvgpr_write_b32 a22, v150
    v_accvgpr_write_b32 a23, v151
    v_accvgpr_write_b32 a24, v152
    v_accvgpr_write_b32 a25, v153
    v_accvgpr_write_b32 a26, v154
    v_accvgpr_write_b32 a27, v155
    v_accvgpr_write_b32 a28, v156
    v_accvgpr_write_b32 a29, v157
    v_accvgpr_write_b32 a30, v158
    v_accvgpr_write_b32 a31, v159
    v_accvgpr_write_b32 a32, v160
    v_accvgpr_write_b32 a33, v161
    v_accvgpr_write_b32 a34, v162
    v_accvgpr_write_b32 a35, v163
    v_accvgpr_write_b32 a36, v164
    v_accvgpr_write_b32 a37, v165
    v_accvgpr_write_b32 a38, v166
    v_accvgpr_write_b32 a39, v167
    s_mov_b32 s37, s74
    s_mov_b32 s74, s75
    s_mov_b32 s75, s64
    s_mov_b32 s64, s37
    s_mov_b32 s37, s76
    s_mov_b32 s76, s77
    s_mov_b32 s77, s42
    s_mov_b32 s42, s37
    s_add_u32 s100, s100, 1638400
    s_add_u32 s39, s72, 0
    buffer_load_dwordx4 v[208:211], v121, s[8:11], s39 offen sc1
    s_sleep 1
    s_sleep 1
    s_add_u32 s39, s72, 245760
    buffer_load_dwordx4 v[212:215], v121, s[8:11], s39 offen sc1
    s_sleep 1
    s_sleep 1
    s_add_u32 s39, s72, 491520
    buffer_load_dwordx4 v[216:219], v121, s[8:11], s39 offen sc1
    s_waitcnt vmcnt(2)
    v_mfma_f32_16x16x32_bf16 v[20:23], v[104:107], v[208:211], v[40:43]
    v_max3_u32 v26, v208, v209, v210
    v_max_u32 v26, v26, v211
    v_cmp_eq_u32 vcc, -1, v26
    s_cbranch_vccz Lc3j_39
    s_add_u32 s39, s72, 737280
    buffer_load_dwordx4 v[220:223], v121, s[8:11], s39 offen sc1
    s_waitcnt vmcnt(2)
    v_mfma_f32_16x16x32_bf16 v[20:23], v[104:107], v[212:215], v[40:43]
    v_max3_u32 v26, v212, v213, v214
    v_max_u32 v26, v26, v215
    v_cmp_eq_u32 vcc, -1, v26
    s_cbranch_vccz Lc3j_39
    s_waitcnt vmcnt(1)
    s_nop 0
    v_mfma_f32_16x16x32_bf16 v[20:23], v[104:107], v[216:219], v[40:43]
    v_max3_u32 v26, v216, v217, v218
    v_max_u32 v26, v26, v219
    v_cmp_eq_u32 vcc, -1, v26
    s_cbranch_vccz Lc3j_39
Lc3n_40:
    s_waitcnt vmcnt(0)
    s_nop 0
    v_mfma_f32_16x16x32_bf16 v[20:23], v[104:107], v[220:223], v[40:43]
    v_max3_u32 v26, v220, v221, v222
    v_max_u32 v26, v26, v223
    v_cmp_eq_u32 vcc, -1, v26
    s_cbranch_vccz Lc3j_39
    s_sleep 1
    s_add_u32 s39, s72, 737280
    buffer_load_dwordx4 v[220:223], v121, s[8:11], s39 offen sc1
    s_sub_u32 s36, s36, 1
    s_cbranch_scc0 Lc3n_40
    s_mov_b32 s36, 0
Lc3j_39:
    s_nop 3
    v_mov_b32_dpp v22, v21 row_shr:4 row_mask:0xf bank_mask:0xa
    v_mov_b32_dpp v23, v20 row_shl:4 row_mask:0xf bank_mask:0x5
    v_cvt_pk_bf16_f32 v40, v22, v23
    buffer_store_dword v40, v6, s[8:11], s70 offen
    s_barrier
    s_mov_b32 s37, s72
    s_mov_b32 s72, s73
    s_mov_b32 s73, s41
    s_mov_b32 s41, s37
    s_add_u32 s66, s66, 1
    s_add_u32 s69, s66, 1
    v_cmp_gt_u32 vcc, s69, v7
    s_cbranch_vccz Lfgd_46
Lfg_45:
    buffer_load_dword v7, v8, s[8:11], 0 offen sc1
    s_waitcnt vmcnt(0)
    v_cmp_gt_u32 vcc, s69, v7
    s_cbranch_vccz Lfgd_46
    s_sleep 1
    s_sub_u32 s36, s36, 1
    s_cbranch_scc0 Lfg_45
    s_mov_b32 s36, 0
Lfgd_46:
    s_add_u32 s37, s66, 2
    s_and_b32 s37, s37, 3
    s_lshl_b32 s37, s37, 17
    s_add_u32 s70, s45, s37
    s_add_u32 m0, s44, 8192
    s_nop 0
    buffer_load_dwordx4 v2, s[8:11], s78 offen offset:0 sc1 lds
    buffer_load_dwordx4 v2, s[8:11], s78 offen offset:1024 sc1 lds
    buffer_load_dwordx4 v2, s[8:11], s78 offen offset:2048 sc1 lds
    buffer_load_dwordx4 v2, s[8:11], s78 offen offset:3072 sc1 lds
    s_add_u32 m0, s44, 12288
    s_add_u32 s37, s78, 4096
    buffer_load_dwordx4 v2, s[8:11], s37 offen sc1 lds
    buffer_store_dword v16, v6, s[8:11], s70 offen
    s_add_u32 s38, s100, 0
    buffer_load_dwordx4 v[128:131], v2, s[8:11], s38 offen sc1 nt
    s_add_u32 s38, s100, 40960
    buffer_load_dwordx4 v[132:135], v2, s[8:11], s38 offen sc1 nt
    s_add_u32 s38, s100, 81920
    buffer_load_dwordx4 v[136:139], v2, s[8:11], s38 offen sc1 nt
    s_add_u32 s38, s100, 122880
    buffer_load_dwordx4 v[140:143], v2, s[8:11], s38 offen sc1 nt
    s_add_u32 s38, s100, 163840
    buffer_load_dwordx4 v[144:147], v2, s[8:11], s38 offen sc1 nt
    s_add_u32 s38, s100, 204800
    buffer_load_dwordx4 v[148:151], v2, s[8:11], s38 offen sc1 nt
    s_add_u32 s38, s100, 245760
    buffer_load_dwordx4 v[152:155], v2, s[8:11], s38 offen sc1 nt
    s_add_u32 s38, s100, 286720
    buffer_load_dwordx4 v[156:159], v2, s[8:11], s38 offen sc1 nt
    buffer_store_dwordx4 v[28:31], v2, s[8:11], s101 offen sc1
    s_add_u32 s101, s101, 163840
    s_add_u32 s38, s73, 0
    buffer_store_dwordx4 v[112:115], v120, s[8:11], s38 offen sc1
    s_waitcnt vmcnt(11)
    s_barrier
    ds_read_b128 v[72:75], v2 offset:8192
    ds_read_b128 v[76:79], v2 offset:9216
    ds_read_b128 v[80:83], v2 offset:10752
    ds_read_b128 v[84:87], v2 offset:11776
    ds_read_b128 v[88:91], v2 offset:13312
    ds_read_b128 v[92:95], v2 offset:14336
    s_waitcnt lgkmcnt(5)
    v_mfma_f32_16x16x32_bf16 v[44:47], a[40:43], v[72:75], 0
    ds_read_b128 v[96:99], v2 offset:15872
    v_mov_b32 v40, 0
    s_waitcnt lgkmcnt(5)
    v_mfma_f32_16x16x32_bf16 v[48:51], a[40:43], v[76:79], 0
    ds_read_b128 v[100:103], v2 offset:16896
    v_mov_b32 v41, 0
    s_waitcnt lgkmcnt(5)
    v_mfma_f32_16x16x32_bf16 v[44:47], a[44:47], v[80:83], v[44:47]
    ds_read_b128 v[72:75], v2 offset:18432
    v_mov_b32 v42, 0
    s_waitcnt lgkmcnt(5)
    v_mfma_f32_16x16x32_bf16 v[48:51], a[44:47], v[84:87], v[48:51]
    ds_read_b128 v[76:79], v2 offset:19456
    v_mov_b32 v43, 0
    s_waitcnt lgkmcnt(5)
    v_mfma_f32_16x16x32_bf16 v[44:47], a[48:51], v[88:91], v[44:47]
    ds_read_b128 v[80:83], v2 offset:20992
    s_waitcnt lgkmcnt(5)
    v_mfma_f32_16x16x32_bf16 v[48:51], a[48:51], v[92:95], v[48:51]
    ds_read_b128 v[84:87], v2 offset:22016
    s_waitcnt lgkmcnt(5)
    v_mfma_f32_16x16x32_bf16 v[44:47], a[52:55], v[96:99], v[44:47]
    ds_read_b128 v[88:91], v2 offset:23552
    s_waitcnt lgkmcnt(5)
    v_mfma_f32_16x16x32_bf16 v[48:51], a[52:55], v[100:103], v[48:51]
    ds_read_b128 v[92:95], v2 offset:24576
    s_waitcnt lgkmcnt(5)
    v_mfma_f32_16x16x32_bf16 v[44:47], a[56:59], v[72:75], v[44:47]
    ds_read_b128 v[96:99], v2 offset:26112
    s_waitcnt lgkmcnt(5)
    v_mfma_f32_16x16x32_bf16 v[48:51], a[56:59], v[76:79], v[48:51]
    ds_read_b128 v[100:103], v2 offset:27136
    s_waitcnt lgkmcnt(5)
    v_mfma_f32_16x16x32_bf16 v[44:47], a[60:63], v[80:83], v[44:47]
    ds_read_b128 v[72:75], v5 offset:10240
    s_waitcnt lgkmcnt(5)
    v_mfma_f32_16x16x32_bf16 v[48:51], a[60:63], v[84:87], v[48:51]
    ds_read_b128 v[76:79], v5 offset:10496
    s_waitcnt lgkmcnt(5)
    v_mfma_f32_16x16x32_bf16 v[44:47], a[64:67], v[88:91], v[44:47]
    ds_read_b128 v[80:83], v5 offset:20480
    s_waitcnt lgkmcnt(5)
    v_mfma_f32_16x16x32_bf16 v[48:51], a[64:67], v[92:95], v[48:51]
    ds_read_b128 v[84:87], v5 offset:20736
    s_waitcnt lgkmcnt(5)
    v_mfma_f32_16x16x32_bf16 v[44:47], a[68:71], v[96:99], v[44:47]
    s_waitcnt lgkmcnt(4)
    v_mfma_f32_16x16x32_bf16 v[48:51], a[68:71], v[100:103], v[48:51]
    s_waitcnt lgkmcnt(3)
    v_mfma_f32_16x16x32_bf16 v[44:47], a[72:75], v[72:75], v[44:47]
    s_waitcnt lgkmcnt(2)
    v_mfma_f32_16x16x32_bf16 v[48:51], a[72:75], v[76:79], v[48:51]
    s_waitcnt lgkmcnt(1)
    v_mfma_f32_16x16x32_bf16 v[44:47], a[76:79], v[80:83], v[44:47]
    s_waitcnt lgkmcnt(0)
    v_mfma_f32_16x16x32_bf16 v[48:51], a[76:79], v[84:87], v[48:51]
    s_mov_b32 s37, s78
    s_mov_b32 s78, s79
    s_mov_b32 s79, s65
    s_mov_b32 s65, s37
    s_nop 1
    v_cvt_pk_bf16_f32 v28, v44, v45
    v_cvt_pk_bf16_f32 v29, v46, v47
    v_cvt_pk_bf16_f32 v30, v48, v49
    v_cvt_pk_bf16_f32 v31, v50, v51
    s_add_u32 s37, s66, 1
    s_and_b32 s37, s37, 3
    s_lshl_b32 s37, s37, 17
    s_add_u32 s70, s45, s37
    s_add_u32 s38, s76, 40960
    v_mov_b32 v32, -1
    v_mov_b32 v33, -1
    v_mov_b32 v34, -1
    v_mov_b32 v35, -1
    v_mov_b32 v36, -1
    v_mov_b32 v160, -1
    v_mov_b32 v161, -1
    v_mov_b32 v162, -1
    v_mov_b32 v163, -1
    v_mov_b32 v164, -1
    v_mov_b32 v165, -1
    v_mov_b32 v166, -1
    v_mov_b32 v167, -1
    s_mov_b64 s[56:57], -1
    s_waitcnt vmcnt(0)
Lcb_47:
    buffer_load_dwordx4 v[32:35], v11, s[8:11], s74 offen sc1
    buffer_load_dword v36, v12, s[8:11], s74 offen sc1
    s_mov_b64 exec, s[56:57]
    buffer_load_dwordx4 v[160:163], v4, s[8:11], s76 offen sc1
    buffer_load_dwordx4 v[164:167], v4, s[8:11], s38 offen sc1
    s_mov_b64 exec, -1
    v_max3_u32 v21, v160, v161, v162
    v_max3_u32 v21, v21, v163, v164
    v_max3_u32 v21, v21, v165, v166
    v_max_u32 v21, v21, v167
    v_cmp_eq_u32 s[56:57], -1, v21
    s_sub_u32 s36, s36, 1
    s_cbranch_scc1 Lce_49
    s_waitcnt vmcnt(2)
    v_max3_u32 v20, v32, v33, v34
    v_max3_u32 v20, v20, v35, v36
    v_cmp_eq_u32 vcc, -1, v20
    ds_write_b128 v18, v[32:35] offset:0
    ds_write_b32 v19, v36 offset:0
    s_cbranch_vccnz Lcb_47
Lcd_48:
    s_cmp_eq_u32 s66, 63
    s_cbranch_scc1 L_C_last
    s_waitcnt lgkmcnt(0)
    s_barrier
    ds_read_b128 v[52:55], v17 offset:0
    ds_read_b128 v[56:59], v17 offset:1024
    ds_read_b128 v[60:63], v17 offset:2048
    ds_read_b128 v[64:67], v17 offset:3072
    ds_read_b128 v[68:71], v2 offset:4096
    v_max3_u32 v20, v160, v161, v162
    v_max3_u32 v20, v20, v163, v164
    v_max3_u32 v20, v20, v165, v166
    v_max3_u32 v20, v20, v167, v167
    v_cmp_eq_u32 vcc, -1, v20
    s_cbranch_vccnz Lmp_50
Lmpd_51:
    s_waitcnt lgkmcnt(4)
    v_smfmac_f32_16x16x64_bf16 v[40:43], v[52:55], v[128:135], v3
    s_waitcnt lgkmcnt(3)
    v_smfmac_f32_16x16x64_bf16 v[40:43], v[56:59], v[136:143], v3
    s_waitcnt lgkmcnt(2)
    v_smfmac_f32_16x16x64_bf16 v[40:43], v[60:63], v[144:151], v3
    s_waitcnt lgkmcnt(1)
    v_smfmac_f32_16x16x64_bf16 v[40:43], v[64:67], v[152:159], v3
    s_waitcnt lgkmcnt(0)
    v_smfmac_f32_16x16x64_bf16 v[40:43], v[68:71], v[160:167], v3
    s_add_u32 s39, s72, 983040
    s_nop 6
    v_pk_add_f32 v[40:41], v[40:41], v[42:43]
    v_cvt_pk_bf16_f32 v108, v40, v41
    v_cvt_pk_bf16_f32 v109, v40, v41
    v_mov_b32 v42, v40
    v_mov_b32 v43, v41
    v_permlane16_swap_b32 v108, v109
    v_mov_b32 v110, v108
    v_mov_b32 v111, v109
    s_nop 0
    v_permlane32_swap_b32 v108, v110
    v_permlane32_swap_b32 v109, v111
    buffer_store_dwordx4 v[108:111], v120, s[8:11], s72 offen sc1
    v_accvgpr_write_b32 a40, v128
    v_accvgpr_write_b32 a41, v129
    v_accvgpr_write_b32 a42, v130
    v_accvgpr_write_b32 a43, v131
    v_accvgpr_write_b32 a44, v132
    v_accvgpr_write_b32 a45, v133
    v_accvgpr_write_b32 a46, v134
    v_accvgpr_write_b32 a47, v135
    v_accvgpr_write_b32 a48, v136
    v_accvgpr_write_b32 a49, v137
    v_accvgpr_write_b32 a50, v138
    v_accvgpr_write_b32 a51, v139
    v_accvgpr_write_b32 a52, v140
    v_accvgpr_write_b32 a53, v141
    v_accvgpr_write_b32 a54, v142
    v_accvgpr_write_b32 a55, v143
    v_accvgpr_write_b32 a56, v144
    v_accvgpr_write_b32 a57, v145
    v_accvgpr_write_b32 a58, v146
    v_accvgpr_write_b32 a59, v147
    v_accvgpr_write_b32 a60, v148
    v_accvgpr_write_b32 a61, v149
    v_accvgpr_write_b32 a62, v150
    v_accvgpr_write_b32 a63, v151
    v_accvgpr_write_b32 a64, v152
    v_accvgpr_write_b32 a65, v153
    v_accvgpr_write_b32 a66, v154
    v_accvgpr_write_b32 a67, v155
    v_accvgpr_write_b32 a68, v156
    v_accvgpr_write_b32 a69, v157
    v_accvgpr_write_b32 a70, v158
    v_accvgpr_write_b32 a71, v159
    v_accvgpr_write_b32 a72, v160
    v_accvgpr_write_b32 a73, v161
    v_accvgpr_write_b32 a74, v162
    v_accvgpr_write_b32 a75, v163
    v_accvgpr_write_b32 a76, v164
    v_accvgpr_write_b32 a77, v165
    v_accvgpr_write_b32 a78, v166
    v_accvgpr_write_b32 a79, v167
    s_mov_b32 s37, s74
    s_mov_b32 s74, s75
    s_mov_b32 s75, s64
    s_mov_b32 s64, s37
    s_mov_b32 s37, s76
    s_mov_b32 s76, s77
    s_mov_b32 s77, s42
    s_mov_b32 s42, s37
    s_add_u32 s100, s100, 1638400
    s_add_u32 s39, s72, 0
    buffer_load_dwordx4 v[208:211], v121, s[8:11], s39 offen sc1
    s_sleep 1
    s_sleep 1
    s_add_u32 s39, s72, 245760
    buffer_load_dwordx4 v[212:215], v121, s[8:11], s39 offen sc1
    s_sleep 1
    s_sleep 1
    s_add_u32 s39, s72, 491520
    buffer_load_dwordx4 v[216:219], v121, s[8:11], s39 offen sc1
    s_waitcnt vmcnt(2)
    v_mfma_f32_16x16x32_bf16 v[20:23], v[104:107], v[208:211], v[40:43]
    v_max3_u32 v26, v208, v209, v210
    v_max_u32 v26, v26, v211
    v_cmp_eq_u32 vcc, -1, v26
    s_cbranch_vccz Lc3j_53
    s_add_u32 s39, s72, 737280
    buffer_load_dwordx4 v[220:223], v121, s[8:11], s39 offen sc1
    s_waitcnt vmcnt(2)
    v_mfma_f32_16x16x32_bf16 v[20:23], v[104:107], v[212:215], v[40:43]
    v_max3_u32 v26, v212, v213, v214
    v_max_u32 v26, v26, v215
    v_cmp_eq_u32 vcc, -1, v26
    s_cbranch_vccz Lc3j_53
    s_waitcnt vmcnt(1)
    s_nop 0
    v_mfma_f32_16x16x32_bf16 v[20:23], v[104:107], v[216:219], v[40:43]
    v_max3_u32 v26, v216, v217, v218
    v_max_u32 v26, v26, v219
    v_cmp_eq_u32 vcc, -1, v26
    s_cbranch_vccz Lc3j_53
Lc3n_54:
    s_waitcnt vmcnt(0)
    s_nop 0
    v_mfma_f32_16x16x32_bf16 v[20:23], v[104:107], v[220:223], v[40:43]
    v_max3_u32 v26, v220, v221, v222
    v_max_u32 v26, v26, v223
    v_cmp_eq_u32 vcc, -1, v26
    s_cbranch_vccz Lc3j_53
    s_sleep 1
    s_add_u32 s39, s72, 737280
    buffer_load_dwordx4 v[220:223], v121, s[8:11], s39 offen sc1
    s_sub_u32 s36, s36, 1
    s_cbranch_scc0 Lc3n_54
    s_mov_b32 s36, 0
Lc3j_53:
    s_nop 3
    v_mov_b32_dpp v22, v21 row_shr:4 row_mask:0xf bank_mask:0xa
    v_mov_b32_dpp v23, v20 row_shl:4 row_mask:0xf bank_mask:0x5
    v_cvt_pk_bf16_f32 v40, v22, v23
    buffer_store_dword v40, v6, s[8:11], s70 offen
    s_barrier
    s_mov_b32 s37, s72
    s_mov_b32 s72, s73
    s_mov_b32 s73, s41
    s_mov_b32 s41, s37
    s_add_u32 s66, s66, 1
    s_branch L_C_fast
Lmp_50:
    s_waitcnt vmcnt(0)
    v_max3_u32 v20, v160, v161, v162
    v_max3_u32 v20, v20, v163, v164
    v_max3_u32 v20, v20, v165, v166
    v_max3_u32 v20, v20, v167, v167
    v_cmp_eq_u32 vcc, -1, v20
    s_cbranch_vccz Lmpd_51
Lmpr_52:
    v_max3_u32 v20, v160, v161, v162
    v_max_u32 v20, v20, v163
    v_cmp_eq_u32 s[56:57], -1, v20
    v_max3_u32 v20, v164, v165, v166
    v_max_u32 v20, v20, v167
    v_cmp_eq_u32 s[58:59], -1, v20
    s_mov_b64 exec, s[56:57]
    buffer_load_dwordx4 v[160:163], v4, s[8:11], s76 offen sc1
    s_mov_b64 exec, s[58:59]
    buffer_load_dwordx4 v[164:167], v4, s[8:11], s38 offen sc1
    s_mov_b64 exec, -1
    s_sub_u32 s36, s36, 1
    s_cbranch_scc0 Lmp_50
    s_mov_b32 s36, 0
    s_waitcnt vmcnt(0)
    s_branch Lmpd_51
Lce_49:
    s_mov_b32 s36, 0
    s_branch Lcd_48
Lmp_36:
    s_waitcnt vmcnt(0)
    v_max3_u32 v20, v160, v161, v162
    v_max3_u32 v20, v20, v163, v164
    v_max3_u32 v20, v20, v165, v166
    v_max3_u32 v20, v20, v167, v167
    v_cmp_eq_u32 vcc, -1, v20
    s_cbranch_vccz Lmpd_37
Lmpr_38:
    v_max3_u32 v20, v160, v161, v162
    v_max_u32 v20, v20, v163
    v_cmp_eq_u32 s[56:57], -1, v20
    v_max3_u32 v20, v164, v165, v166
    v_max_u32 v20, v20, v167
    v_cmp_eq_u32 s[58:59], -1, v20
    s_mov_b64 exec, s[56:57]
    buffer_load_dwordx4 v[160:163], v4, s[8:11], s76 offen sc1
    s_mov_b64 exec, s[58:59]
    buffer_load_dwordx4 v[164:167], v4, s[8:11], s38 offen sc1
    s_mov_b64 exec, -1
    s_sub_u32 s36, s36, 1
    s_cbranch_scc0 Lmp_36
    s_mov_b32 s36, 0
    s_waitcnt vmcnt(0)
    s_branch Lmpd_37
Lce_35:
    s_mov_b32 s36, 0
    s_branch Lcd_34
L_C_slow:
    s_add_u32 s69, s66, 1
    v_cmp_gt_u32 vcc, s69, v7
    s_cbranch_vccz Lfgd_60
Lfg_59:
    buffer_load_dword v7, v8, s[8:11], 0 offen sc1
    s_waitcnt vmcnt(0)
    v_cmp_gt_u32 vcc, s69, v7
    s_cbranch_vccz Lfgd_60
    s_sleep 1
    s_sub_u32 s36, s36, 1
    s_cbranch_scc0 Lfg_59
    s_mov_b32 s36, 0
Lfgd_60:
    s_add_u32 s37, s66, 2
    s_and_b32 s37, s37, 3
    s_lshl_b32 s37, s37, 17
    s_add_u32 s70, s45, s37
    s_add_u32 m0, s44, 8192
    s_nop 0
    buffer_load_dwordx4 v2, s[8:11], s78 offen offset:0 sc1 lds
    buffer_load_dwordx4 v2, s[8:11], s78 offen offset:1024 sc1 lds
    buffer_load_dwordx4 v2, s[8:11], s78 offen offset:2048 sc1 lds
    buffer_load_dwordx4 v2, s[8:11], s78 offen offset:3072 sc1 lds
    s_add_u32 m0, s44, 12288
    s_add_u32 s37, s78, 4096
    buffer_load_dwordx4 v2, s[8:11], s37 offen sc1 lds
    buffer_store_dword v16, v6, s[8:11], s70 offen sc1
    s_add_u32 s38, s100, 0
    buffer_load_dwordx4 v[128:131], v2, s[8:11], s38 offen sc1 nt
    s_add_u32 s38, s100, 40960
    buffer_load_dwordx4 v[132:135], v2, s[8:11], s38 offen sc1 nt
    s_add_u32 s38, s100, 81920
    buffer_load_dwordx4 v[136:139], v2, s[8:11], s38 offen sc1 nt
    s_add_u32 s38, s100, 122880
    buffer_load_dwordx4 v[140:143], v2, s[8:11], s38 offen sc1 nt
    s_add_u32 s38, s100, 163840
    buffer_load_dwordx4 v[144:147], v2, s[8:11], s38 offen sc1 nt
    s_add_u32 s38, s100, 204800
    buffer_load_dwordx4 v[148:151], v2, s[8:11], s38 offen sc1 nt
    s_add_u32 s38, s100, 245760
    buffer_load_dwordx4 v[152:155], v2, s[8:11], s38 offen sc1 nt
    s_add_u32 s38, s100, 286720
    buffer_load_dwordx4 v[156:159], v2, s[8:11], s38 offen sc1 nt
    buffer_store_dwordx4 v[28:31], v2, s[8:11], s101 offen sc1
    s_add_u32 s101, s101, 163840
    s_add_u32 s38, s73, 0
    buffer_store_dwordx4 v[112:115], v120, s[8:11], s38 offen sc1
    s_waitcnt vmcnt(11)
    s_barrier
    ds_read_b128 v[72:75], v2 offset:8192
    ds_read_b128 v[76:79], v2 offset:9216
    ds_read_b128 v[80:83], v2 offset:10752
    ds_read_b128 v[84:87], v2 offset:11776
    ds_read_b128 v[88:91], v2 offset:13312
    ds_read_b128 v[92:95], v2 offset:14336
    s_waitcnt lgkmcnt(5)
    v_mfma_f32_16x16x32_bf16 v[44:47], a[0:3], v[72:75], 0
    ds_read_b128 v[96:99], v2 offset:15872
    v_mov_b32 v40, 0
    s_waitcnt lgkmcnt(5)
    v_mfma_f32_16x16x32_bf16 v[48:51], a[0:3], v[76:79], 0
    ds_read_b128 v[100:103], v2 offset:16896
    v_mov_b32 v41, 0
    s_waitcnt lgkmcnt(5)
    v_mfma_f32_16x16x32_bf16 v[44:47], a[4:7], v[80:83], v[44:47]
    ds_read_b128 v[72:75], v2 offset:18432
    v_mov_b32 v42, 0
    s_waitcnt lgkmcnt(5)
    v_mfma_f32_16x16x32_bf16 v[48:51], a[4:7], v[84:87], v[48:51]
    ds_read_b128 v[76:79], v2 offset:19456
    v_mov_b32 v43, 0
    s_waitcnt lgkmcnt(5)
    v_mfma_f32_16x16x32_bf16 v[44:47], a[8:11], v[88:91], v[44:47]
    ds_read_b128 v[80:83], v2 offset:20992
    s_waitcnt lgkmcnt(5)
    v_mfma_f32_16x16x32_bf16 v[48:51], a[8:11], v[92:95], v[48:51]
    ds_read_b128 v[84:87], v2 offset:22016
    s_waitcnt lgkmcnt(5)
    v_mfma_f32_16x16x32_bf16 v[44:47], a[12:15], v[96:99], v[44:47]
    ds_read_b128 v[88:91], v2 offset:23552
    s_waitcnt lgkmcnt(5)
    v_mfma_f32_16x16x32_bf16 v[48:51], a[12:15], v[100:103], v[48:51]
    ds_read_b128 v[92:95], v2 offset:24576
    s_waitcnt lgkmcnt(5)
    v_mfma_f32_16x16x32_bf16 v[44:47], a[16:19], v[72:75], v[44:47]
    ds_read_b128 v[96:99], v2 offset:26112
    s_waitcnt lgkmcnt(5)
    v_mfma_f32_16x16x32_bf16 v[48:51], a[16:19], v[76:79], v[48:51]
    ds_read_b128 v[100:103], v2 offset:27136
    s_waitcnt lgkmcnt(5)
    v_mfma_f32_16x16x32_bf16 v[44:47], a[20:23], v[80:83], v[44:47]
    ds_read_b128 v[72:75], v5 offset:10240
    s_waitcnt lgkmcnt(5)
    v_mfma_f32_16x16x32_bf16 v[48:51], a[20:23], v[84:87], v[48:51]
    ds_read_b128 v[76:79], v5 offset:10496
    s_waitcnt lgkmcnt(5)
    v_mfma_f32_16x16x32_bf16 v[44:47], a[24:27], v[88:91], v[44:47]
    ds_read_b128 v[80:83], v5 offset:20480
    s_waitcnt lgkmcnt(5)
    v_mfma_f32_16x16x32_bf16 v[48:51], a[24:27], v[92:95], v[48:51]
    ds_read_b128 v[84:87], v5 offset:20736
    s_waitcnt lgkmcnt(5)
    v_mfma_f32_16x16x32_bf16 v[44:47], a[28:31], v[96:99], v[44:47]
    s_waitcnt lgkmcnt(4)
    v_mfma_f32_16x16x32_bf16 v[48:51], a[28:31], v[100:103], v[48:51]
    s_waitcnt lgkmcnt(3)
    v_mfma_f32_16x16x32_bf16 v[44:47], a[32:35], v[72:75], v[44:47]
    s_waitcnt lgkmcnt(2)
    v_mfma_f32_16x16x32_bf16 v[48:51], a[32:35], v[76:79], v[48:51]
    s_waitcnt lgkmcnt(1)
    v_mfma_f32_16x16x32_bf16 v[44:47], a[36:39], v[80:83], v[44:47]
    s_waitcnt lgkmcnt(0)
    v_mfma_f32_16x16x32_bf16 v[48:51], a[36:39], v[84:87], v[48:51]
    s_mov_b32 s37, s78
    s_mov_b32 s78, s79
    s_mov_b32 s79, s65
    s_mov_b32 s65, s37
    s_nop 1
    v_cvt_pk_bf16_f32 v28, v44, v45
    v_cvt_pk_bf16_f32 v29, v46, v47
    v_cvt_pk_bf16_f32 v30, v48, v49
    v_cvt_pk_bf16_f32 v31, v50, v51
    s_add_u32 s37, s66, 1
    s_and_b32 s37, s37, 3
    s_lshl_b32 s37, s37, 17
    s_add_u32 s70, s45, s37
    s_add_u32 s38, s76, 40960
    v_mov_b32 v32, -1
    v_mov_b32 v33, -1
    v_mov_b32 v34, -1
    v_mov_b32 v35, -1
    v_mov_b32 v36, -1
    v_mov_b32 v160, -1
    v_mov_b32 v161, -1
    v_mov_b32 v162, -1
    v_mov_b32 v163, -1
    v_mov_b32 v164, -1
    v_mov_b32 v165, -1
    v_mov_b32 v166, -1
    v_mov_b32 v167, -1
    s_mov_b64 s[56:57], -1
    s_waitcnt vmcnt(0)
Lcb_61:
    buffer_load_dwordx4 v[32:35], v11, s[8:11], s74 offen sc1
    buffer_load_dword v36, v12, s[8:11], s74 offen sc1
    s_mov_b64 exec, s[56:57]
    buffer_load_dwordx4 v[160:163], v4, s[8:11], s76 offen sc1
    buffer_load_dwordx4 v[164:167], v4, s[8:11], s38 offen sc1
    s_mov_b64 exec, -1
    v_max3_u32 v21, v160, v161, v162
    v_max3_u32 v21, v21, v163, v164
    v_max3_u32 v21, v21, v165, v166
    v_max_u32 v21, v21, v167
    v_cmp_eq_u32 s[56:57], -1, v21
    s_sub_u32 s36, s36, 1
    s_cbranch_scc1 Lce_63
    s_waitcnt vmcnt(2)
    v_max3_u32 v20, v32, v33, v34
    v_max3_u32 v20, v20, v35, v36
    v_cmp_eq_u32 vcc, -1, v20
    ds_write_b128 v18, v[32:35] offset:0
    ds_write_b32 v19, v36 offset:0
    s_cbranch_vccnz Lcb_61
Lcd_62:
    s_waitcnt lgkmcnt(0)
    s_barrier
    ds_read_b128 v[52:55], v17 offset:0
    ds_read_b128 v[56:59], v17 offset:1024
    ds_read_b128 v[60:63], v17 offset:2048
    ds_read_b128 v[64:67], v17 offset:3072
    ds_read_b128 v[68:71], v2 offset:4096
    v_max3_u32 v20, v160, v161, v162
    v_max3_u32 v20, v20, v163, v164
    v_max3_u32 v20, v20, v165, v166
    v_max3_u32 v20, v20, v167, v167
    v_cmp_eq_u32 vcc, -1, v20
    s_cbranch_vccnz Lmp_64
Lmpd_65:
    s_waitcnt lgkmcnt(4)
    v_smfmac_f32_16x16x64_bf16 v[40:43], v[52:55], v[128:135], v3
    s_waitcnt lgkmcnt(3)
    v_smfmac_f32_16x16x64_bf16 v[40:43], v[56:59], v[136:143], v3
    s_waitcnt lgkmcnt(2)
    v_smfmac_f32_16x16x64_bf16 v[40:43], v[60:63], v[144:151], v3
    s_waitcnt lgkmcnt(1)
    v_smfmac_f32_16x16x64_bf16 v[40:43], v[64:67], v[152:159], v3
    s_waitcnt lgkmcnt(0)
    v_smfmac_f32_16x16x64_bf16 v[40:43], v[68:71], v[160:167], v3
    s_add_u32 s39, s72, 983040
    s_nop 6
    v_pk_add_f32 v[40:41], v[40:41], v[42:43]
    v_cvt_pk_bf16_f32 v108, v40, v41
    v_cvt_pk_bf16_f32 v109, v40, v41
    v_mov_b32 v42, v40
    v_mov_b32 v43, v41
    v_permlane16_swap_b32 v108, v109
    v_mov_b32 v110, v108
    v_mov_b32 v111, v109
    s_nop 0
    v_permlane32_swap_b32 v108, v110
    v_permlane32_swap_b32 v109, v111
    buffer_store_dwordx4 v[108:111], v120, s[8:11], s72 offen sc1
    v_accvgpr_write_b32 a0, v128
    v_accvgpr_write_b32 a1, v129
    v_accvgpr_write_b32 a2, v130
    v_accvgpr_write_b32 a3, v131
    v_accvgpr_write_b32 a4, v132
    v_accvgpr_write_b32 a5, v133
    v_accvgpr_write_b32 a6, v134
    v_accvgpr_write_b32 a7, v135
    v_accvgpr_write_b32 a8, v136
    v_accvgpr_write_b32 a9, v137
    v_accvgpr_write_b32 a10, v138
    v_accvgpr_write_b32 a11, v139
    v_accvgpr_write_b32 a12, v140
    v_accvgpr_write_b32 a13, v141
    v_accvgpr_write_b32 a14, v142
    v_accvgpr_write_b32 a15, v143
    v_accvgpr_write_b32 a16, v144
    v_accvgpr_write_b32 a17, v145
    v_accvgpr_write_b32 a18, v146
    v_accvgpr_write_b32 a19, v147
    v_accvgpr_write_b32 a20, v148
    v_accvgpr_write_b32 a21, v149
    v_accvgpr_write_b32 a22, v150
    v_accvgpr_write_b32 a23, v151
    v_accvgpr_write_b32 a24, v152
    v_accvgpr_write_b32 a25, v153
    v_accvgpr_write_b32 a26, v154
    v_accvgpr_write_b32 a27, v155
    v_accvgpr_write_b32 a28, v156
    v_accvgpr_write_b32 a29, v157
    v_accvgpr_write_b32 a30, v158
    v_accvgpr_write_b32 a31, v159
    v_accvgpr_write_b32 a32, v160
    v_accvgpr_write_b32 a33, v161
    v_accvgpr_write_b32 a34, v162
    v_accvgpr_write_b32 a35, v163
    v_accvgpr_write_b32 a36, v164
    v_accvgpr_write_b32 a37, v165
    v_accvgpr_write_b32 a38, v166
    v_accvgpr_write_b32 a39, v167
    s_mov_b32 s37, s74
    s_mov_b32 s74, s75
    s_mov_b32 s75, s64
    s_mov_b32 s64, s37
    s_mov_b32 s37, s76
    s_mov_b32 s76, s77
    s_mov_b32 s77, s42
    s_mov_b32 s42, s37
    s_add_u32 s100, s100, 1638400
    s_add_u32 s39, s72, 0
    buffer_load_dwordx4 v[208:211], v121, s[8:11], s39 offen sc1
    s_sleep 1
    s_sleep 1
    s_add_u32 s39, s72, 245760
    buffer_load_dwordx4 v[212:215], v121, s[8:11], s39 offen sc1
    s_sleep 1
    s_sleep 1
    s_add_u32 s39, s72, 491520
    buffer_load_dwordx4 v[216:219], v121, s[8:11], s39 offen sc1
    s_waitcnt vmcnt(2)
    v_mfma_f32_16x16x32_bf16 v[20:23], v[104:107], v[208:211], v[40:43]
    v_max3_u32 v26, v208, v209, v210
    v_max_u32 v26, v26, v211
    v_cmp_eq_u32 vcc, -1, v26
    s_cbranch_vccz Lc3j_67
    s_add_u32 s39, s72, 737280
    buffer_load_dwordx4 v[220:223], v121, s[8:11], s39 offen sc1
    s_waitcnt vmcnt(2)
    v_mfma_f32_16x16x32_bf16 v[20:23], v[104:107], v[212:215], v[40:43]
    v_max3_u32 v26, v212, v213, v214
    v_max_u32 v26, v26, v215
    v_cmp_eq_u32 vcc, -1, v26
    s_cbranch_vccz Lc3j_67
    s_waitcnt vmcnt(1)
    s_nop 0
    v_mfma_f32_16x16x32_bf16 v[20:23], v[104:107], v[216:219], v[40:43]
    v_max3_u32 v26, v216, v217, v218
    v_max_u32 v26, v26, v219
    v_cmp_eq_u32 vcc, -1, v26
    s_cbranch_vccz Lc3j_67
Lc3n_68:
    s_waitcnt vmcnt(0)
    s_nop 0
    v_mfma_f32_16x16x32_bf16 v[20:23], v[104:107], v[220:223], v[40:43]
    v_max3_u32 v26, v220, v221, v222
    v_max_u32 v26, v26, v223
    v_cmp_eq_u32 vcc, -1, v26
    s_cbranch_vccz Lc3j_67
    s_sleep 1
    s_add_u32 s39, s72, 737280
    buffer_load_dwordx4 v[220:223], v121, s[8:11], s39 offen sc1
    s_sub_u32 s36, s36, 1
    s_cbranch_scc0 Lc3n_68
    s_mov_b32 s36, 0
Lc3j_67:
    s_nop 3
    v_mov_b32_dpp v22, v21 row_shr:4 row_mask:0xf bank_mask:0xa
    v_mov_b32_dpp v23, v20 row_shl:4 row_mask:0xf bank_mask:0x5
    v_cvt_pk_bf16_f32 v40, v22, v23
    buffer_store_dword v40, v6, s[8:11], s70 offen sc1
    s_barrier
    s_mov_b32 s37, s72
    s_mov_b32 s72, s73
    s_mov_b32 s73, s41
    s_mov_b32 s41, s37
    s_add_u32 s66, s66, 1
    s_add_u32 s69, s66, 1
    v_cmp_gt_u32 vcc, s69, v7
    s_cbranch_vccz Lfgd_74
Lfg_73:
    buffer_load_dword v7, v8, s[8:11], 0 offen sc1
    s_waitcnt vmcnt(0)
    v_cmp_gt_u32 vcc, s69, v7
    s_cbranch_vccz Lfgd_74
    s_sleep 1
    s_sub_u32 s36, s36, 1
    s_cbranch_scc0 Lfg_73
    s_mov_b32 s36, 0
Lfgd_74:
    s_add_u32 s37, s66, 2
    s_and_b32 s37, s37, 3
    s_lshl_b32 s37, s37, 17
    s_add_u32 s70, s45, s37
    s_add_u32 m0, s44, 8192
    s_nop 0
    buffer_load_dwordx4 v2, s[8:11], s78 offen offset:0 sc1 lds
    buffer_load_dwordx4 v2, s[8:11], s78 offen offset:1024 sc1 lds
    buffer_load_dwordx4 v2, s[8:11], s78 offen offset:2048 sc1 lds
    buffer_load_dwordx4 v2, s[8:11], s78 offen offset:3072 sc1 lds
    s_add_u32 m0, s44, 12288
    s_add_u32 s37, s78, 4096
    buffer_load_dwordx4 v2, s[8:11], s37 offen sc1 lds
    buffer_store_dword v16, v6, s[8:11], s70 offen sc1
    s_add_u32 s38, s100, 0
    buffer_load_dwordx4 v[128:131], v2, s[8:11], s38 offen sc1 nt
    s_add_u32 s38, s100, 40960
    buffer_load_dwordx4 v[132:135], v2, s[8:11], s38 offen sc1 nt
    s_add_u32 s38, s100, 81920
    buffer_load_dwordx4 v[136:139], v2, s[8:11], s38 offen sc1 nt
    s_add_u32 s38, s100, 122880
    buffer_load_dwordx4 v[140:143], v2, s[8:11], s38 offen sc1 nt
    s_add_u32 s38, s100, 163840
    buffer_load_dwordx4 v[144:147], v2, s[8:11], s38 offen sc1 nt
    s_add_u32 s38, s100, 204800
    buffer_load_dwordx4 v[148:151], v2, s[8:11], s38 offen sc1 nt
    s_add_u32 s38, s100, 245760
    buffer_load_dwordx4 v[152:155], v2, s[8:11], s38 offen sc1 nt
    s_add_u32 s38, s100, 286720
    buffer_load_dwordx4 v[156:159], v2, s[8:11], s38 offen sc1 nt
    buffer_store_dwordx4 v[28:31], v2, s[8:11], s101 offen sc1
    s_add_u32 s101, s101, 163840
    s_add_u32 s38, s73, 0
    buffer_store_dwordx4 v[112:115], v120, s[8:11], s38 offen sc1
    s_waitcnt vmcnt(11)
    s_barrier
    ds_read_b128 v[72:75], v2 offset:8192
    ds_read_b128 v[76:79], v2 offset:9216
    ds_read_b128 v[80:83], v2 offset:10752
    ds_read_b128 v[84:87], v2 offset:11776
    ds_read_b128 v[88:91], v2 offset:13312
    ds_read_b128 v[92:95], v2 offset:14336
    s_waitcnt lgkmcnt(5)
    v_mfma_f32_16x16x32_bf16 v[44:47], a[40:43], v[72:75], 0
    ds_read_b128 v[96:99], v2 offset:15872
    v_mov_b32 v40, 0
    s_waitcnt lgkmcnt(5)
    v_mfma_f32_16x16x32_bf16 v[48:51], a[40:43], v[76:79], 0
    ds_read_b128 v[100:103], v2 offset:16896
    v_mov_b32 v41, 0
    s_waitcnt lgkmcnt(5)
    v_mfma_f32_16x16x32_bf16 v[44:47], a[44:47], v[80:83], v[44:47]
    ds_read_b128 v[72:75], v2 offset:18432
    v_mov_b32 v42, 0
    s_waitcnt lgkmcnt(5)
    v_mfma_f32_16x16x32_bf16 v[48:51], a[44:47], v[84:87], v[48:51]
    ds_read_b128 v[76:79], v2 offset:19456
    v_mov_b32 v43, 0
    s_waitcnt lgkmcnt(5)
    v_mfma_f32_16x16x32_bf16 v[44:47], a[48:51], v[88:91], v[44:47]
    ds_read_b128 v[80:83], v2 offset:20992
    s_waitcnt lgkmcnt(5)
    v_mfma_f32_16x16x32_bf16 v[48:51], a[48:51], v[92:95], v[48:51]
    ds_read_b128 v[84:87], v2 offset:22016
    s_waitcnt lgkmcnt(5)
    v_mfma_f32_16x16x32_bf16 v[44:47], a[52:55], v[96:99], v[44:47]
    ds_read_b128 v[88:91], v2 offset:23552
    s_waitcnt lgkmcnt(5)
    v_mfma_f32_16x16x32_bf16 v[48:51], a[52:55], v[100:103], v[48:51]
    ds_read_b128 v[92:95], v2 offset:24576
    s_waitcnt lgkmcnt(5)
    v_mfma_f32_16x16x32_bf16 v[44:47], a[56:59], v[72:75], v[44:47]
    ds_read_b128 v[96:99], v2 offset:26112
    s_waitcnt lgkmcnt(5)
    v_mfma_f32_16x16x32_bf16 v[48:51], a[56:59], v[76:79], v[48:51]
    ds_read_b128 v[100:103], v2 offset:27136
    s_waitcnt lgkmcnt(5)
    v_mfma_f32_16x16x32_bf16 v[44:47], a[60:63], v[80:83], v[44:47]
    ds_read_b128 v[72:75], v5 offset:10240
    s_waitcnt lgkmcnt(5)
    v_mfma_f32_16x16x32_bf16 v[48:51], a[60:63], v[84:87], v[48:51]
    ds_read_b128 v[76:79], v5 offset:10496
    s_waitcnt lgkmcnt(5)
    v_mfma_f32_16x16x32_bf16 v[44:47], a[64:67], v[88:91], v[44:47]
    ds_read_b128 v[80:83], v5 offset:20480
    s_waitcnt lgkmcnt(5)
    v_mfma_f32_16x16x32_bf16 v[48:51], a[64:67], v[92:95], v[48:51]
    ds_read_b128 v[84:87], v5 offset:20736
    s_waitcnt lgkmcnt(5)
    v_mfma_f32_16x16x32_bf16 v[44:47], a[68:71], v[96:99], v[44:47]
    s_waitcnt lgkmcnt(4)
    v_mfma_f32_16x16x32_bf16 v[48:51], a[68:71], v[100:103], v[48:51]
    s_waitcnt lgkmcnt(3)
    v_mfma_f32_16x16x32_bf16 v[44:47], a[72:75], v[72:75], v[44:47]
    s_waitcnt lgkmcnt(2)
    v_mfma_f32_16x16x32_bf16 v[48:51], a[72:75], v[76:79], v[48:51]
    s_waitcnt lgkmcnt(1)
    v_mfma_f32_16x16x32_bf16 v[44:47], a[76:79], v[80:83], v[44:47]
    s_waitcnt lgkmcnt(0)
    v_mfma_f32_16x16x32_bf16 v[48:51], a[76:79], v[84:87], v[48:51]
    s_mov_b32 s37, s78
    s_mov_b32 s78, s79
    s_mov_b32 s79, s65
    s_mov_b32 s65, s37
    s_nop 1
    v_cvt_pk_bf16_f32 v28, v44, v45
    v_cvt_pk_bf16_f32 v29, v46, v47
    v_cvt_pk_bf16_f32 v30, v48, v49
    v_cvt_pk_bf16_f32 v31, v50, v51
    s_add_u32 s37, s66, 1
    s_and_b32 s37, s37, 3
    s_lshl_b32 s37, s37, 17
    s_add_u32 s70, s45, s37
    s_add_u32 s38, s76, 40960
    v_mov_b32 v32, -1
    v_mov_b32 v33, -1
    v_mov_b32 v34, -1
    v_mov_b32 v35, -1
    v_mov_b32 v36, -1
    v_mov_b32 v160, -1
    v_mov_b32 v161, -1
    v_mov_b32 v162, -1
    v_mov_b32 v163, -1
    v_mov_b32 v164, -1
    v_mov_b32 v165, -1
    v_mov_b32 v166, -1
    v_mov_b32 v167, -1
    s_mov_b64 s[56:57], -1
    s_waitcnt vmcnt(0)
Lcb_75:
    buffer_load_dwordx4 v[32:35], v11, s[8:11], s74 offen sc1
    buffer_load_dword v36, v12, s[8:11], s74 offen sc1
    s_mov_b64 exec, s[56:57]
    buffer_load_dwordx4 v[160:163], v4, s[8:11], s76 offen sc1
    buffer_load_dwordx4 v[164:167], v4, s[8:11], s38 offen sc1
    s_mov_b64 exec, -1
    v_max3_u32 v21, v160, v161, v162
    v_max3_u32 v21, v21, v163, v164
    v_max3_u32 v21, v21, v165, v166
    v_max_u32 v21, v21, v167
    v_cmp_eq_u32 s[56:57], -1, v21
    s_sub_u32 s36, s36, 1
    s_cbranch_scc1 Lce_77
    s_waitcnt vmcnt(2)
    v_max3_u32 v20, v32, v33, v34
    v_max3_u32 v20, v20, v35, v36
    v_cmp_eq_u32 vcc, -1, v20
    ds_write_b128 v18, v[32:35] offset:0
    ds_write_b32 v19, v36 offset:0
    s_cbranch_vccnz Lcb_75
Lcd_76:
    s_cmp_eq_u32 s66, 63
    s_cbranch_scc1 L_C_last
    s_waitcnt lgkmcnt(0)
    s_barrier
    ds_read_b128 v[52:55], v17 offset:0
    ds_read_b128 v[56:59], v17 offset:1024
    ds_read_b128 v[60:63], v17 offset:2048
    ds_read_b128 v[64:67], v17 offset:3072
    ds_read_b128 v[68:71], v2 offset:4096
    v_max3_u32 v20, v160, v161, v162
    v_max3_u32 v20, v20, v163, v164
    v_max3_u32 v20, v20, v165, v166
    v_max3_u32 v20, v20, v167, v167
    v_cmp_eq_u32 vcc, -1, v20
    s_cbranch_vccnz Lmp_78
Lmpd_79:
    s_waitcnt lgkmcnt(4)
    v_smfmac_f32_16x16x64_bf16 v[40:43], v[52:55], v[128:135], v3
    s_waitcnt lgkmcnt(3)
    v_smfmac_f32_16x16x64_bf16 v[40:43], v[56:59], v[136:143], v3
    s_waitcnt lgkmcnt(2)
    v_smfmac_f32_16x16x64_bf16 v[40:43], v[60:63], v[144:151], v3
    s_waitcnt lgkmcnt(1)
    v_smfmac_f32_16x16x64_bf16 v[40:43], v[64:67], v[152:159], v3
    s_waitcnt lgkmcnt(0)
    v_smfmac_f32_16x16x64_bf16 v[40:43], v[68:71], v[160:167], v3
    s_add_u32 s39, s72, 983040
    s_nop 6
    v_pk_add_f32 v[40:41], v[40:41], v[42:43]
    v_cvt_pk_bf16_f32 v108, v40, v41
    v_cvt_pk_bf16_f32 v109, v40, v41
    v_mov_b32 v42, v40
    v_mov_b32 v43, v41
    v_permlane16_swap_b32 v108, v109
    v_mov_b32 v110, v108
    v_mov_b32 v111, v109
    s_nop 0
    v_permlane32_swap_b32 v108, v110
    v_permlane32_swap_b32 v109, v111
    buffer_store_dwordx4 v[108:111], v120, s[8:11], s72 offen sc1
    v_accvgpr_write_b32 a40, v128
    v_accvgpr_write_b32 a41, v129
    v_accvgpr_write_b32 a42, v130
    v_accvgpr_write_b32 a43, v131
    v_accvgpr_write_b32 a44, v132
    v_accvgpr_write_b32 a45, v133
    v_accvgpr_write_b32 a46, v134
    v_accvgpr_write_b32 a47, v135
    v_accvgpr_write_b32 a48, v136
    v_accvgpr_write_b32 a49, v137
    v_accvgpr_write_b32 a50, v138
    v_accvgpr_write_b32 a51, v139
    v_accvgpr_write_b32 a52, v140
    v_accvgpr_write_b32 a53, v141
    v_accvgpr_write_b32 a54, v142
    v_accvgpr_write_b32 a55, v143
    v_accvgpr_write_b32 a56, v144
    v_accvgpr_write_b32 a57, v145
    v_accvgpr_write_b32 a58, v146
    v_accvgpr_write_b32 a59, v147
    v_accvgpr_write_b32 a60, v148
    v_accvgpr_write_b32 a61, v149
    v_accvgpr_write_b32 a62, v150
    v_accvgpr_write_b32 a63, v151
    v_accvgpr_write_b32 a64, v152
    v_accvgpr_write_b32 a65, v153
    v_accvgpr_write_b32 a66, v154
    v_accvgpr_write_b32 a67, v155
    v_accvgpr_write_b32 a68, v156
    v_accvgpr_write_b32 a69, v157
    v_accvgpr_write_b32 a70, v158
    v_accvgpr_write_b32 a71, v159
    v_accvgpr_write_b32 a72, v160
    v_accvgpr_write_b32 a73, v161
    v_accvgpr_write_b32 a74, v162
    v_accvgpr_write_b32 a75, v163
    v_accvgpr_write_b32 a76, v164
    v_accvgpr_write_b32 a77, v165
    v_accvgpr_write_b32 a78, v166
    v_accvgpr_write_b32 a79, v167
    s_mov_b32 s37, s74
    s_mov_b32 s74, s75
    s_mov_b32 s75, s64
    s_mov_b32 s64, s37
    s_mov_b32 s37, s76
    s_mov_b32 s76, s77
    s_mov_b32 s77, s42
    s_mov_b32 s42, s37
    s_add_u32 s100, s100, 1638400
    s_add_u32 s39, s72, 0
    buffer_load_dwordx4 v[208:211], v121, s[8:11], s39 offen sc1
    s_sleep 1
    s_sleep 1
    s_add_u32 s39, s72, 245760
    buffer_load_dwordx4 v[212:215], v121, s[8:11], s39 offen sc1
    s_sleep 1
    s_sleep 1
    s_add_u32 s39, s72, 491520
    buffer_load_dwordx4 v[216:219], v121, s[8:11], s39 offen sc1
    s_waitcnt vmcnt(2)
    v_mfma_f32_16x16x32_bf16 v[20:23], v[104:107], v[208:211], v[40:43]
    v_max3_u32 v26, v208, v209, v210
    v_max_u32 v26, v26, v211
    v_cmp_eq_u32 vcc, -1, v26
    s_cbranch_vccz Lc3j_81
    s_add_u32 s39, s72, 737280
    buffer_load_dwordx4 v[220:223], v121, s[8:11], s39 offen sc1
    s_waitcnt vmcnt(2)
    v_mfma_f32_16x16x32_bf16 v[20:23], v[104:107], v[212:215], v[40:43]
    v_max3_u32 v26, v212, v213, v214
    v_max_u32 v26, v26, v215
    v_cmp_eq_u32 vcc, -1, v26
    s_cbranch_vccz Lc3j_81
    s_waitcnt vmcnt(1)
    s_nop 0
    v_mfma_f32_16x16x32_bf16 v[20:23], v[104:107], v[216:219], v[40:43]
    v_max3_u32 v26, v216, v217, v218
    v_max_u32 v26, v26, v219
    v_cmp_eq_u32 vcc, -1, v26
    s_cbranch_vccz Lc3j_81
Lc3n_82:
    s_waitcnt vmcnt(0)
    s_nop 0
    v_mfma_f32_16x16x32_bf16 v[20:23], v[104:107], v[220:223], v[40:43]
    v_max3_u32 v26, v220, v221, v222
    v_max_u32 v26, v26, v223
    v_cmp_eq_u32 vcc, -1, v26
    s_cbranch_vccz Lc3j_81
    s_sleep 1
    s_add_u32 s39, s72, 737280
    buffer_load_dwordx4 v[220:223], v121, s[8:11], s39 offen sc1
    s_sub_u32 s36, s36, 1
    s_cbranch_scc0 Lc3n_82
    s_mov_b32 s36, 0
Lc3j_81:
    s_nop 3
    v_mov_b32_dpp v22, v21 row_shr:4 row_mask:0xf bank_mask:0xa
    v_mov_b32_dpp v23, v20 row_shl:4 row_mask:0xf bank_mask:0x5
    v_cvt_pk_bf16_f32 v40, v22, v23
    buffer_store_dword v40, v6, s[8:11], s70 offen sc1
    s_barrier
    s_mov_b32 s37, s72
    s_mov_b32 s72, s73
    s_mov_b32 s73, s41
    s_mov_b32 s41, s37
    s_add_u32 s66, s66, 1
    s_branch L_C_slow
Lmp_78:
    s_waitcnt vmcnt(0)
    v_max3_u32 v20, v160, v161, v162
    v_max3_u32 v20, v20, v163, v164
    v_max3_u32 v20, v20, v165, v166
    v_max3_u32 v20, v20, v167, v167
    v_cmp_eq_u32 vcc, -1, v20
    s_cbranch_vccz Lmpd_79
Lmpr_80:
    v_max3_u32 v20, v160, v161, v162
    v_max_u32 v20, v20, v163
    v_cmp_eq_u32 s[56:57], -1, v20
    v_max3_u32 v20, v164, v165, v166
    v_max_u32 v20, v20, v167
    v_cmp_eq_u32 s[58:59], -1, v20
    s_mov_b64 exec, s[56:57]
    buffer_load_dwordx4 v[160:163], v4, s[8:11], s76 offen sc1
    s_mov_b64 exec, s[58:59]
    buffer_load_dwordx4 v[164:167], v4, s[8:11], s38 offen sc1
    s_mov_b64 exec, -1
    s_sub_u32 s36, s36, 1
    s_cbranch_scc0 Lmp_78
    s_mov_b32 s36, 0
    s_waitcnt vmcnt(0)
    s_branch Lmpd_79
Lce_77:
    s_mov_b32 s36, 0
    s_branch Lcd_76
Lmp_64:
    s_waitcnt vmcnt(0)
    v_max3_u32 v20, v160, v161, v162
    v_max3_u32 v20, v20, v163, v164
    v_max3_u32 v20, v20, v165, v166
    v_max3_u32 v20, v20, v167, v167
    v_cmp_eq_u32 vcc, -1, v20
    s_cbranch_vccz Lmpd_65
Lmpr_66:
    v_max3_u32 v20, v160, v161, v162
    v_max_u32 v20, v20, v163
    v_cmp_eq_u32 s[56:57], -1, v20
    v_max3_u32 v20, v164, v165, v166
    v_max_u32 v20, v20, v167
    v_cmp_eq_u32 s[58:59], -1, v20
    s_mov_b64 exec, s[56:57]
    buffer_load_dwordx4 v[160:163], v4, s[8:11], s76 offen sc1
    s_mov_b64 exec, s[58:59]
    buffer_load_dwordx4 v[164:167], v4, s[8:11], s38 offen sc1
    s_mov_b64 exec, -1
    s_sub_u32 s36, s36, 1
    s_cbranch_scc0 Lmp_64
    s_mov_b32 s36, 0
    s_waitcnt vmcnt(0)
    s_branch Lmpd_65
Lce_63:
    s_mov_b32 s36, 0
    s_branch Lcd_62
L_C_last:
Lmp_87:
    s_waitcnt vmcnt(0)
    v_max3_u32 v20, v160, v161, v162
    v_max3_u32 v20, v20, v163, v164
    v_max3_u32 v20, v20, v165, v166
    v_max3_u32 v20, v20, v167, v167
    v_cmp_eq_u32 vcc, -1, v20
    s_cbranch_vccnz Lmpr_89
Lmpd_88:
    v_accvgpr_write_b32 a40, v128
    v_accvgpr_write_b32 a41, v129
    v_accvgpr_write_b32 a42, v130
    v_accvgpr_write_b32 a43, v131
    v_accvgpr_write_b32 a44, v132
    v_accvgpr_write_b32 a45, v133
    v_accvgpr_write_b32 a46, v134
    v_accvgpr_write_b32 a47, v135
    v_accvgpr_write_b32 a48, v136
    v_accvgpr_write_b32 a49, v137
    v_accvgpr_write_b32 a50, v138
    v_accvgpr_write_b32 a51, v139
    v_accvgpr_write_b32 a52, v140
    v_accvgpr_write_b32 a53, v141
    v_accvgpr_write_b32 a54, v142
    v_accvgpr_write_b32 a55, v143
    v_accvgpr_write_b32 a56, v144
    v_accvgpr_write_b32 a57, v145
    v_accvgpr_write_b32 a58, v146
    v_accvgpr_write_b32 a59, v147
    v_accvgpr_write_b32 a60, v148
    v_accvgpr_write_b32 a61, v149
    v_accvgpr_write_b32 a62, v150
    v_accvgpr_write_b32 a63, v151
    v_accvgpr_write_b32 a64, v152
    v_accvgpr_write_b32 a65, v153
    v_accvgpr_write_b32 a66, v154
    v_accvgpr_write_b32 a67, v155
    v_accvgpr_write_b32 a68, v156
    v_accvgpr_write_b32 a69, v157
    v_accvgpr_write_b32 a70, v158
    v_accvgpr_write_b32 a71, v159
    v_accvgpr_write_b32 a72, v160
    v_accvgpr_write_b32 a73, v161
    v_accvgpr_write_b32 a74, v162
    v_accvgpr_write_b32 a75, v163
    v_accvgpr_write_b32 a76, v164
    v_accvgpr_write_b32 a77, v165
    v_accvgpr_write_b32 a78, v166
    v_accvgpr_write_b32 a79, v167
    s_mov_b32 s66, 64
    s_barrier
    buffer_store_dwordx4 v[28:31], v2, s[8:11], s101 offen sc1
    s_add_u32 s101, s101, 163840
    s_add_u32 m0, s44, 8192
    s_nop 0
    buffer_load_dwordx4 v2, s[8:11], s78 offen offset:0 sc1 lds
    buffer_load_dwordx4 v2, s[8:11], s78 offen offset:1024 sc1 lds
    buffer_load_dwordx4 v2, s[8:11], s78 offen offset:2048 sc1 lds
    buffer_load_dwordx4 v2, s[8:11], s78 offen offset:3072 sc1 lds
    s_add_u32 m0, s44, 12288
    s_add_u32 s37, s78, 4096
    buffer_load_dwordx4 v2, s[8:11], s37 offen sc1 lds
    s_waitcnt vmcnt(0)
    s_barrier
    ds_read_b128 v[72:75], v2 offset:8192
    ds_read_b128 v[76:79], v2 offset:9216
    ds_read_b128 v[80:83], v2 offset:10752
    ds_read_b128 v[84:87], v2 offset:11776
    ds_read_b128 v[88:91], v2 offset:13312
    ds_read_b128 v[92:95], v2 offset:14336
    s_waitcnt lgkmcnt(5)
    v_mfma_f32_16x16x32_bf16 v[44:47], a[0:3], v[72:75], 0
    ds_read_b128 v[96:99], v2 offset:15872
    s_waitcnt lgkmcnt(5)
    v_mfma_f32_16x16x32_bf16 v[48:51], a[0:3], v[76:79], 0
    ds_read_b128 v[100:103], v2 offset:16896
    s_waitcnt lgkmcnt(5)
    v_mfma_f32_16x16x32_bf16 v[44:47], a[4:7], v[80:83], v[44:47]
    ds_read_b128 v[72:75], v2 offset:18432
    s_waitcnt lgkmcnt(5)
    v_mfma_f32_16x16x32_bf16 v[48:51], a[4:7], v[84:87], v[48:51]
    ds_read_b128 v[76:79], v2 offset:19456
    s_waitcnt lgkmcnt(5)
    v_mfma_f32_16x16x32_bf16 v[44:47], a[8:11], v[88:91], v[44:47]
    ds_read_b128 v[80:83], v2 offset:20992
    s_waitcnt lgkmcnt(5)
    v_mfma_f32_16x16x32_bf16 v[48:51], a[8:11], v[92:95], v[48:51]
    ds_read_b128 v[84:87], v2 offset:22016
    s_waitcnt lgkmcnt(5)
    v_mfma_f32_16x16x32_bf16 v[44:47], a[12:15], v[96:99], v[44:47]
    ds_read_b128 v[88:91], v2 offset:23552
    s_waitcnt lgkmcnt(5)
    v_mfma_f32_16x16x32_bf16 v[48:51], a[12:15], v[100:103], v[48:51]
    ds_read_b128 v[92:95], v2 offset:24576
    s_waitcnt lgkmcnt(5)
    v_mfma_f32_16x16x32_bf16 v[44:47], a[16:19], v[72:75], v[44:47]
    ds_read_b128 v[96:99], v2 offset:26112
    s_waitcnt lgkmcnt(5)
    v_mfma_f32_16x16x32_bf16 v[48:51], a[16:19], v[76:79], v[48:51]
    ds_read_b128 v[100:103], v2 offset:27136
    s_waitcnt lgkmcnt(5)
    v_mfma_f32_16x16x32_bf16 v[44:47], a[20:23], v[80:83], v[44:47]
    ds_read_b128 v[72:75], v5 offset:10240
    s_waitcnt lgkmcnt(5)
    v_mfma_f32_16x16x32_bf16 v[48:51], a[20:23], v[84:87], v[48:51]
    ds_read_b128 v[76:79], v5 offset:10496
    s_waitcnt lgkmcnt(5)
    v_mfma_f32_16x16x32_bf16 v[44:47], a[24:27], v[88:91], v[44:47]
    ds_read_b128 v[80:83], v5 offset:20480
    s_waitcnt lgkmcnt(5)
    v_mfma_f32_16x16x32_bf16 v[48:51], a[24:27], v[92:95], v[48:51]
    ds_read_b128 v[84:87], v5 offset:20736
    s_waitcnt lgkmcnt(5)
    v_mfma_f32_16x16x32_bf16 v[44:47], a[28:31], v[96:99], v[44:47]
    s_waitcnt lgkmcnt(4)
    v_mfma_f32_16x16x32_bf16 v[48:51], a[28:31], v[100:103], v[48:51]
    s_waitcnt lgkmcnt(3)
    v_mfma_f32_16x16x32_bf16 v[44:47], a[32:35], v[72:75], v[44:47]
    s_waitcnt lgkmcnt(2)
    v_mfma_f32_16x16x32_bf16 v[48:51], a[32:35], v[76:79], v[48:51]
    s_waitcnt lgkmcnt(1)
    v_mfma_f32_16x16x32_bf16 v[44:47], a[36:39], v[80:83], v[44:47]
    s_waitcnt lgkmcnt(0)
    v_mfma_f32_16x16x32_bf16 v[48:51], a[36:39], v[84:87], v[48:51]
    s_mov_b32 s37, s78
    s_mov_b32 s78, s79
    s_mov_b32 s79, s65
    s_mov_b32 s65, s37
    s_nop 1
    v_cvt_pk_bf16_f32 v28, v44, v45
    v_cvt_pk_bf16_f32 v29, v46, v47
    v_cvt_pk_bf16_f32 v30, v48, v49
    v_cvt_pk_bf16_f32 v31, v50, v51
    buffer_store_dwordx4 v[28:31], v2, s[8:11], s101 offen sc1
    s_add_u32 s101, s101, 163840
    v_cmp_gt_u32 vcc, s66, v9
    s_cbranch_vccz Lfgd_91
Lfg_90:
    buffer_load_dword v9, v10, s[8:11], s40 offen sc1
    s_waitcnt vmcnt(0)
    v_cmp_gt_u32 vcc, s66, v9
    s_cbranch_vccz Lfgd_91
    s_sub_u32 s36, s36, 1
    s_cbranch_scc0 Lfg_90
    s_mov_b32 s36, 0
Lfgd_91:
    s_barrier
    s_add_u32 m0, s44, 8192
    s_nop 0
    buffer_load_dwordx4 v2, s[8:11], s78 offen offset:0 sc1 lds
    buffer_load_dwordx4 v2, s[8:11], s78 offen offset:1024 sc1 lds
    buffer_load_dwordx4 v2, s[8:11], s78 offen offset:2048 sc1 lds
    buffer_load_dwordx4 v2, s[8:11], s78 offen offset:3072 sc1 lds
    s_add_u32 m0, s44, 12288
    s_add_u32 s37, s78, 4096
    buffer_load_dwordx4 v2, s[8:11], s37 offen sc1 lds
    s_waitcnt vmcnt(0)
    s_barrier
    ds_read_b128 v[72:75], v2 offset:8192
    ds_read_b128 v[76:79], v2 offset:9216
    ds_read_b128 v[80:83], v2 offset:10752
    ds_read_b128 v[84:87], v2 offset:11776
    ds_read_b128 v[88:91], v2 offset:13312
    ds_read_b128 v[92:95], v2 offset:14336
    s_waitcnt lgkmcnt(5)
    v_mfma_f32_16x16x32_bf16 v[44:47], a[40:43], v[72:75], 0
    ds_read_b128 v[96:99], v2 offset:15872
    s_waitcnt lgkmcnt(5)
    v_mfma_f32_16x16x32_bf16 v[48:51], a[40:43], v[76:79], 0
    ds_read_b128 v[100:103], v2 offset:16896
    s_waitcnt lgkmcnt(5)
    v_mfma_f32_16x16x32_bf16 v[44:47], a[44:47], v[80:83], v[44:47]
    ds_read_b128 v[72:75], v2 offset:18432
    s_waitcnt lgkmcnt(5)
    v_mfma_f32_16x16x32_bf16 v[48:51], a[44:47], v[84:87], v[48:51]
    ds_read_b128 v[76:79], v2 offset:19456
    s_waitcnt lgkmcnt(5)
    v_mfma_f32_16x16x32_bf16 v[44:47], a[48:51], v[88:91], v[44:47]
    ds_read_b128 v[80:83], v2 offset:20992
    s_waitcnt lgkmcnt(5)
    v_mfma_f32_16x16x32_bf16 v[48:51], a[48:51], v[92:95], v[48:51]
    ds_read_b128 v[84:87], v2 offset:22016
    s_waitcnt lgkmcnt(5)
    v_mfma_f32_16x16x32_bf16 v[44:47], a[52:55], v[96:99], v[44:47]
    ds_read_b128 v[88:91], v2 offset:23552
    s_waitcnt lgkmcnt(5)
    v_mfma_f32_16x16x32_bf16 v[48:51], a[52:55], v[100:103], v[48:51]
    ds_read_b128 v[92:95], v2 offset:24576
    s_waitcnt lgkmcnt(5)
    v_mfma_f32_16x16x32_bf16 v[44:47], a[56:59], v[72:75], v[44:47]
    ds_read_b128 v[96:99], v2 offset:26112
    s_waitcnt lgkmcnt(5)
    v_mfma_f32_16x16x32_bf16 v[48:51], a[56:59], v[76:79], v[48:51]
    ds_read_b128 v[100:103], v2 offset:27136
    s_waitcnt lgkmcnt(5)
    v_mfma_f32_16x16x32_bf16 v[44:47], a[60:63], v[80:83], v[44:47]
    ds_read_b128 v[72:75], v5 offset:10240
    s_waitcnt lgkmcnt(5)
    v_mfma_f32_16x16x32_bf16 v[48:51], a[60:63], v[84:87], v[48:51]
    ds_read_b128 v[76:79], v5 offset:10496
    s_waitcnt lgkmcnt(5)
    v_mfma_f32_16x16x32_bf16 v[44:47], a[64:67], v[88:91], v[44:47]
    ds_read_b128 v[80:83], v5 offset:20480
    s_waitcnt lgkmcnt(5)
    v_mfma_f32_16x16x32_bf16 v[48:51], a[64:67], v[92:95], v[48:51]
    ds_read_b128 v[84:87], v5 offset:20736
    s_waitcnt lgkmcnt(5)
    v_mfma_f32_16x16x32_bf16 v[44:47], a[68:71], v[96:99], v[44:47]
    s_waitcnt lgkmcnt(4)
    v_mfma_f32_16x16x32_bf16 v[48:51], a[68:71], v[100:103], v[48:51]
    s_waitcnt lgkmcnt(3)
    v_mfma_f32_16x16x32_bf16 v[44:47], a[72:75], v[72:75], v[44:47]
    s_waitcnt lgkmcnt(2)
    v_mfma_f32_16x16x32_bf16 v[48:51], a[72:75], v[76:79], v[48:51]
    s_waitcnt lgkmcnt(1)
    v_mfma_f32_16x16x32_bf16 v[44:47], a[76:79], v[80:83], v[44:47]
    s_waitcnt lgkmcnt(0)
    v_mfma_f32_16x16x32_bf16 v[48:51], a[76:79], v[84:87], v[48:51]
    s_mov_b32 s37, s78
    s_mov_b32 s78, s79
    s_mov_b32 s79, s65
    s_mov_b32 s65, s37
    s_nop 1
    v_cvt_pk_bf16_f32 v28, v44, v45
    v_cvt_pk_bf16_f32 v29, v46, v47
    v_cvt_pk_bf16_f32 v30, v48, v49
    v_cvt_pk_bf16_f32 v31, v50, v51
    buffer_store_dwordx4 v[28:31], v2, s[8:11], s101 offen sc1
    s_add_u32 s101, s101, 163840
    s_waitcnt vmcnt(0)
    s_barrier
    s_cmp_lg_u32 s4, 0
    s_cbranch_scc1 Lrf_92
    s_mov_b64 exec, 1
    v_mov_b32 v20, 1
    v_mov_b32 v21, 48
    buffer_atomic_add v20, v21, s[28:31], 0 offen sc0
    s_waitcnt vmcnt(0)
    v_readfirstlane_b32 s37, v20
    s_mov_b64 exec, -1
    s_cmp_lg_u32 s37, 39
    s_cbranch_scc1 Lrf_92
    s_mov_b64 exec, 1
    v_mov_b32 v20, 64
    v_mov_b32 v21, 132
    buffer_atomic_umax v20, v21, s[28:31], 0 offen
    s_mov_b64 exec, -1
Lrf_92:
    s_waitcnt vmcnt(0)
    s_cmp_lg_u32 s36, 0
    s_cbranch_scc1 Lfin_93
    s_mov_b64 exec, 1
    v_mov_b32 v2, 1
    v_mov_b32 v3, 44
    buffer_atomic_add v2, v3, s[28:31], 0 offen
    s_mov_b64 exec, -1
Lfin_93:
    s_endpgm
Lmpr_89:
    v_max3_u32 v20, v160, v161, v162
    v_max_u32 v20, v20, v163
    v_cmp_eq_u32 s[56:57], -1, v20
    v_max3_u32 v20, v164, v165, v166
    v_max_u32 v20, v20, v167
    v_cmp_eq_u32 s[58:59], -1, v20
    s_mov_b64 exec, s[56:57]
    buffer_load_dwordx4 v[160:163], v4, s[8:11], s76 offen sc1
    s_mov_b64 exec, s[58:59]
    buffer_load_dwordx4 v[164:167], v4, s[8:11], s38 offen sc1
    s_mov_b64 exec, -1
    s_sub_u32 s36, s36, 1
    s_cbranch_scc0 Lmp_87
    s_mov_b32 s36, 0
    s_waitcnt vmcnt(0)
    s_branch Lmpd_88
L_F_go:
    v_lshrrev_b32 v2, 4, v1
    v_lshlrev_b32 v2, 2, v2
    v_and_b32 v3, 15, v1
    v_sub_u32 v2, v3, v2
    v_mov_b32 v12, 0
    v_mov_b32 v3, 0x3f80
    v_cmp_eq_u32 vcc, 0, v2
    s_nop 1
    v_cndmask_b32 v12, v12, v3, vcc
    v_mov_b32 v3, 0x3f800000
    v_cmp_eq_u32 vcc, 1, v2
    s_nop 1
    v_cndmask_b32 v12, v12, v3, vcc
    v_mov_b32 v13, 0
    v_mov_b32 v3, 0x3f80
    v_cmp_eq_u32 vcc, 2, v2
    s_nop 1
    v_cndmask_b32 v13, v13, v3, vcc
    v_mov_b32 v3, 0x3f800000
    v_cmp_eq_u32 vcc, 3, v2
    s_nop 1
    v_cndmask_b32 v13, v13, v3, vcc
    v_mov_b32 v14, 0
    v_mov_b32 v15, 0
    v_mov_b32 v16, v12
    v_mov_b32 v17, v13
    v_lshlrev_b32 v0, 4, v1
    s_and_b32 s76, s67, 3
    v_and_b32 v2, 7, v1
    s_lshl_b32 s37, s76, 2
    s_bfe_u32 s38, s67, 0x20002
    s_lshl_b32 s38, s38, 10
    s_add_u32 s37, s37, s38
    s_add_u32 s37, s37, 24576
    v_lshl_add_u32 v4, v2, 7, s37
    v_mov_b32 v5, 132
    v_mov_b32 v6, 0
    v_mov_b32 v7, 0
    s_mul_i32 s37, s4, 5
    s_lshr_b32 s37, s37, 1
    s_mul_i32 s75, s76, 10
    s_add_u32 s75, s75, s37
    v_lshrrev_b32 v2, 4, v1
    v_and_b32 v3, 15, v1
    v_mul_u32_u24 v8, 1280, v3
    v_lshl_add_u32 v8, v2, 3, v8
    s_lshl_b32 s37, s75, 5
    v_add_u32 v8, s37, v8
    s_lshl_b32 s75, s75, 10
    s_lshr_b32 s66, s67, 2
L_F_loop:
    s_add_u32 s73, s66, 1
    s_mul_i32 s70, s66, 1638400
    s_add_u32 s70, s70, s75
    s_add_u32 s70, s70, 113508352
    s_mul_i32 s71, s66, 163840
    s_add_u32 s71, s71, s75
    s_add_u32 s71, s71, 90177536
    s_mul_i32 s74, s66, 40960
    s_add_u32 s38, s74, 20480
    s_lshr_b32 s77, s66, 2
    s_add_u32 s77, s77, 1
    v_cmp_gt_u32 vcc, s77, v6
    s_cbranch_vccz Lfgd_95
Lfg_94:
    buffer_load_dword v6, v4, s[8:11], 0 offen sc1
    s_waitcnt vmcnt(0)
    v_cmp_gt_u32 vcc, s77, v6
    s_cbranch_vccz Lfgd_95
    s_sleep 8
    s_sub_u32 s36, s36, 1
    s_cbranch_scc0 Lfg_94
    s_mov_b32 s36, 0
Lfgd_95:
    s_add_u32 s37, s70, 0
    buffer_load_dwordx4 v[128:131], v0, s[8:11], s37 offen offset:0 sc1 nt
    buffer_load_dwordx4 v[132:135], v0, s[8:11], s37 offen offset:1024 sc1 nt
    buffer_load_dwordx4 v[136:139], v0, s[8:11], s37 offen offset:2048 sc1 nt
    s_add_u32 s37, s70, 40960
    buffer_load_dwordx4 v[140:143], v0, s[8:11], s37 offen offset:0 sc1 nt
    buffer_load_dwordx4 v[144:147], v0, s[8:11], s37 offen offset:1024 sc1 nt
    buffer_load_dwordx4 v[148:151], v0, s[8:11], s37 offen offset:2048 sc1 nt
    s_add_u32 s37, s70, 81920
    buffer_load_dwordx4 v[152:155], v0, s[8:11], s37 offen offset:0 sc1 nt
    buffer_load_dwordx4 v[156:159], v0, s[8:11], s37 offen offset:1024 sc1 nt
    buffer_load_dwordx4 v[160:163], v0, s[8:11], s37 offen offset:2048 sc1 nt
    s_add_u32 s37, s70, 122880
    buffer_load_dwordx4 v[164:167], v0, s[8:11], s37 offen offset:0 sc1 nt
    buffer_load_dwordx4 v[168:171], v0, s[8:11], s37 offen offset:1024 sc1 nt
    buffer_load_dwordx4 v[172:175], v0, s[8:11], s37 offen offset:2048 sc1 nt
    s_add_u32 s37, s70, 163840
    buffer_load_dwordx4 v[176:179], v0, s[8:11], s37 offen offset:0 sc1 nt
    buffer_load_dwordx4 v[180:183], v0, s[8:11], s37 offen offset:1024 sc1 nt
    buffer_load_dwordx4 v[184:187], v0, s[8:11], s37 offen offset:2048 sc1 nt
    s_add_u32 s37, s70, 204800
    buffer_load_dwordx4 v[188:191], v0, s[8:11], s37 offen offset:0 sc1 nt
    buffer_load_dwordx4 v[192:195], v0, s[8:11], s37 offen offset:1024 sc1 nt
    buffer_load_dwordx4 v[196:199], v0, s[8:11], s37 offen offset:2048 sc1 nt
    s_add_u32 s37, s70, 245760
    buffer_load_dwordx4 v[200:203], v0, s[8:11], s37 offen offset:0 sc1 nt
    buffer_load_dwordx4 v[204:207], v0, s[8:11], s37 offen offset:1024 sc1 nt
    buffer_load_dwordx4 v[208:211], v0, s[8:11], s37 offen offset:2048 sc1 nt
    s_add_u32 s37, s70, 286720
    buffer_load_dwordx4 v[212:215], v0, s[8:11], s37 offen offset:0 sc1 nt
    buffer_load_dwordx4 v[216:219], v0, s[8:11], s37 offen offset:1024 sc1 nt
    buffer_load_dwordx4 v[220:223], v0, s[8:11], s37 offen offset:2048 sc1 nt
    buffer_load_dwordx2 v[24:25], v8, s[12:15], s74 offen offset:0
    buffer_load_dwordx2 v[26:27], v8, s[12:15], s38 offen offset:0
    buffer_load_dwordx2 v[28:29], v8, s[12:15], s74 offen offset:32
    buffer_load_dwordx2 v[30:31], v8, s[12:15], s38 offen offset:32
    buffer_load_dwordx2 v[32:33], v8, s[12:15], s74 offen offset:64
    buffer_load_dwordx2 v[34:35], v8, s[12:15], s38 offen offset:64
    s_waitcnt vmcnt(27)
    v_mfma_f32_16x16x32_bf16 v[40:43], v[128:131], v[12:15], 0
    v_mfma_f32_16x16x32_bf16 v[44:47], v[128:131], v[14:17], 0
    v_mfma_f32_16x16x32_bf16 v[48:51], v[132:135], v[12:15], 0
    v_mfma_f32_16x16x32_bf16 v[52:55], v[132:135], v[14:17], 0
    v_mfma_f32_16x16x32_bf16 v[56:59], v[136:139], v[12:15], 0
    v_mfma_f32_16x16x32_bf16 v[60:63], v[136:139], v[14:17], 0
    s_waitcnt vmcnt(24)
    v_mfma_f32_16x16x32_bf16 v[40:43], v[140:143], v[12:15], v[40:43]
    v_mfma_f32_16x16x32_bf16 v[44:47], v[140:143], v[14:17], v[44:47]
    v_mfma_f32_16x16x32_bf16 v[48:51], v[144:147], v[12:15], v[48:51]
    v_mfma_f32_16x16x32_bf16 v[52:55], v[144:147], v[14:17], v[52:55]
    v_mfma_f32_16x16x32_bf16 v[56:59], v[148:151], v[12:15], v[56:59]
    v_mfma_f32_16x16x32_bf16 v[60:63], v[148:151], v[14:17], v[60:63]
    s_waitcnt vmcnt(21)
    v_mfma_f32_16x16x32_bf16 v[40:43], v[152:155], v[12:15], v[40:43]
    v_mfma_f32_16x16x32_bf16 v[44:47], v[152:155], v[14:17], v[44:47]
    v_mfma_f32_16x16x32_bf16 v[48:51], v[156:159], v[12:15], v[48:51]
    v_mfma_f32_16x16x32_bf16 v[52:55], v[156:159], v[14:17], v[52:55]
    v_mfma_f32_16x16x32_bf16 v[56:59], v[160:163], v[12:15], v[56:59]
    v_mfma_f32_16x16x32_bf16 v[60:63], v[160:163], v[14:17], v[60:63]
    s_waitcnt vmcnt(18)
    v_mfma_f32_16x16x32_bf16 v[40:43], v[164:167], v[12:15], v[40:43]
    v_mfma_f32_16x16x32_bf16 v[44:47], v[164:167], v[14:17], v[44:47]
    v_mfma_f32_16x16x32_bf16 v[48:51], v[168:171], v[12:15], v[48:51]
    v_mfma_f32_16x16x32_bf16 v[52:55], v[168:171], v[14:17], v[52:55]
    v_mfma_f32_16x16x32_bf16 v[56:59], v[172:175], v[12:15], v[56:59]
    v_mfma_f32_16x16x32_bf16 v[60:63], v[172:175], v[14:17], v[60:63]
    s_waitcnt vmcnt(15)
    v_mfma_f32_16x16x32_bf16 v[40:43], v[176:179], v[12:15], v[40:43]
    v_mfma_f32_16x16x32_bf16 v[44:47], v[176:179], v[14:17], v[44:47]
    v_mfma_f32_16x16x32_bf16 v[48:51], v[180:183], v[12:15], v[48:51]
    v_mfma_f32_16x16x32_bf16 v[52:55], v[180:183], v[14:17], v[52:55]
    v_mfma_f32_16x16x32_bf16 v[56:59], v[184:187], v[12:15], v[56:59]
    v_mfma_f32_16x16x32_bf16 v[60:63], v[184:187], v[14:17], v[60:63]
    s_waitcnt vmcnt(12)
    v_mfma_f32_16x16x32_bf16 v[40:43], v[188:191], v[12:15], v[40:43]
    v_mfma_f32_16x16x32_bf16 v[44:47], v[188:191], v[14:17], v[44:47]
    v_mfma_f32_16x16x32_bf16 v[48:51], v[192:195], v[12:15], v[48:51]
    v_mfma_f32_16x16x32_bf16 v[52:55], v[192:195], v[14:17], v[52:55]
    v_mfma_f32_16x16x32_bf16 v[56:59], v[196:199], v[12:15], v[56:59]
    v_mfma_f32_16x16x32_bf16 v[60:63], v[196:199], v[14:17], v[60:63]
    s_waitcnt vmcnt(9)
    v_mfma_f32_16x16x32_bf16 v[40:43], v[200:203], v[12:15], v[40:43]
    v_mfma_f32_16x16x32_bf16 v[44:47], v[200:203], v[14:17], v[44:47]
    v_mfma_f32_16x16x32_bf16 v[48:51], v[204:207], v[12:15], v[48:51]
    v_mfma_f32_16x16x32_bf16 v[52:55], v[204:207], v[14:17], v[52:55]
    v_mfma_f32_16x16x32_bf16 v[56:59], v[208:211], v[12:15], v[56:59]
    v_mfma_f32_16x16x32_bf16 v[60:63], v[208:211], v[14:17], v[60:63]
    s_waitcnt vmcnt(6)
    v_mfma_f32_16x16x32_bf16 v[40:43], v[212:215], v[12:15], v[40:43]
    v_mfma_f32_16x16x32_bf16 v[44:47], v[212:215], v[14:17], v[44:47]
    v_mfma_f32_16x16x32_bf16 v[48:51], v[216:219], v[12:15], v[48:51]
    v_mfma_f32_16x16x32_bf16 v[52:55], v[216:219], v[14:17], v[52:55]
    v_mfma_f32_16x16x32_bf16 v[56:59], v[220:223], v[12:15], v[56:59]
    v_mfma_f32_16x16x32_bf16 v[60:63], v[220:223], v[14:17], v[60:63]
    s_waitcnt vmcnt(0)
    v_mfma_f32_16x16x16_bf16 v[40:43], v[12:13], v[24:25], v[40:43]
    v_mfma_f32_16x16x16_bf16 v[44:47], v[12:13], v[26:27], v[44:47]
    v_mfma_f32_16x16x16_bf16 v[48:51], v[12:13], v[28:29], v[48:51]
    v_mfma_f32_16x16x16_bf16 v[52:55], v[12:13], v[30:31], v[52:55]
    v_mfma_f32_16x16x16_bf16 v[56:59], v[12:13], v[32:33], v[56:59]
    v_mfma_f32_16x16x16_bf16 v[60:63], v[12:13], v[34:35], v[60:63]
    s_max_u32 s37, s73, 5
    s_sub_u32 s77, s37, 5
    v_cmp_gt_u32 vcc, s77, v7
    s_cbranch_vccz Lfgd_97
Lfg_96:
    buffer_load_dword v7, v5, s[28:31], 0 offen sc1
    s_waitcnt vmcnt(0)
    v_cmp_gt_u32 vcc, s77, v7
    s_cbranch_vccz Lfgd_97
    s_sleep 64
    s_sub_u32 s36, s36, 1
    s_cbranch_scc0 Lfg_96
    s_mov_b32 s36, 0
Lfgd_97:
    v_cmp_gt_u32 vcc, s73, v7
    s_cbranch_vccz Lfgd_99
Lfg_98:
    buffer_load_dword v7, v5, s[28:31], 0 offen sc1
    s_waitcnt vmcnt(0)
    v_cmp_gt_u32 vcc, s73, v7
    s_cbranch_vccz Lfgd_99
    s_sleep 6
    s_sub_u32 s36, s36, 1
    s_cbranch_scc0 Lfg_98
    s_mov_b32 s36, 0
Lfgd_99:
    s_add_u32 s39, s71, 0
    buffer_load_dwordx4 v[64:67], v0, s[8:11], s39 offen offset:0 sc1
    buffer_load_dwordx4 v[68:71], v0, s[8:11], s39 offen offset:1024 sc1
    buffer_load_dwordx4 v[72:75], v0, s[8:11], s39 offen offset:2048 sc1
    s_add_u32 s39, s71, 40960
    buffer_load_dwordx4 v[76:79], v0, s[8:11], s39 offen offset:0 sc1
    buffer_load_dwordx4 v[80:83], v0, s[8:11], s39 offen offset:1024 sc1
    buffer_load_dwordx4 v[84:87], v0, s[8:11], s39 offen offset:2048 sc1
    s_add_u32 s39, s71, 81920
    buffer_load_dwordx4 v[88:91], v0, s[8:11], s39 offen offset:0 sc1
    buffer_load_dwordx4 v[92:95], v0, s[8:11], s39 offen offset:1024 sc1
    buffer_load_dwordx4 v[96:99], v0, s[8:11], s39 offen offset:2048 sc1
    s_add_u32 s39, s71, 122880
    buffer_load_dwordx4 v[100:103], v0, s[8:11], s39 offen offset:0 sc1
    buffer_load_dwordx4 v[104:107], v0, s[8:11], s39 offen offset:1024 sc1
    buffer_load_dwordx4 v[108:111], v0, s[8:11], s39 offen offset:2048 sc1
    s_waitcnt vmcnt(9)
    v_mfma_f32_16x16x16_bf16 v[40:43], v[12:13], v[64:65], v[40:43]
    v_mfma_f32_16x16x16_bf16 v[44:47], v[12:13], v[66:67], v[44:47]
    v_mfma_f32_16x16x16_bf16 v[48:51], v[12:13], v[68:69], v[48:51]
    v_mfma_f32_16x16x16_bf16 v[52:55], v[12:13], v[70:71], v[52:55]
    v_mfma_f32_16x16x16_bf16 v[56:59], v[12:13], v[72:73], v[56:59]
    v_mfma_f32_16x16x16_bf16 v[60:63], v[12:13], v[74:75], v[60:63]
    s_waitcnt vmcnt(6)
    v_mfma_f32_16x16x16_bf16 v[40:43], v[12:13], v[76:77], v[40:43]
    v_mfma_f32_16x16x16_bf16 v[44:47], v[12:13], v[78:79], v[44:47]
    v_mfma_f32_16x16x16_bf16 v[48:51], v[12:13], v[80:81], v[48:51]
    v_mfma_f32_16x16x16_bf16 v[52:55], v[12:13], v[82:83], v[52:55]
    v_mfma_f32_16x16x16_bf16 v[56:59], v[12:13], v[84:85], v[56:59]
    v_mfma_f32_16x16x16_bf16 v[60:63], v[12:13], v[86:87], v[60:63]
    s_waitcnt vmcnt(3)
    v_mfma_f32_16x16x16_bf16 v[40:43], v[12:13], v[88:89], v[40:43]
    v_mfma_f32_16x16x16_bf16 v[44:47], v[12:13], v[90:91], v[44:47]
    v_mfma_f32_16x16x16_bf16 v[48:51], v[12:13], v[92:93], v[48:51]
    v_mfma_f32_16x16x16_bf16 v[52:55], v[12:13], v[94:95], v[52:55]
    v_mfma_f32_16x16x16_bf16 v[56:59], v[12:13], v[96:97], v[56:59]
    v_mfma_f32_16x16x16_bf16 v[60:63], v[12:13], v[98:99], v[60:63]
    s_waitcnt vmcnt(0)
    v_mfma_f32_16x16x16_bf16 v[40:43], v[12:13], v[100:101], v[40:43]
    v_mfma_f32_16x16x16_bf16 v[44:47], v[12:13], v[102:103], v[44:47]
    v_mfma_f32_16x16x16_bf16 v[48:51], v[12:13], v[104:105], v[48:51]
    v_mfma_f32_16x16x16_bf16 v[52:55], v[12:13], v[106:107], v[52:55]
    v_mfma_f32_16x16x16_bf16 v[56:59], v[12:13], v[108:109], v[56:59]
    v_mfma_f32_16x16x16_bf16 v[60:63], v[12:13], v[110:111], v[60:63]
    s_nop 2
    v_cvt_pk_bf16_f32 v24, v40, v41
    v_cvt_pk_bf16_f32 v25, v42, v43
    buffer_store_dwordx2 v[24:25], v8, s[24:27], s74 offen offset:0
    v_cvt_pk_bf16_f32 v26, v44, v45
    v_cvt_pk_bf16_f32 v27, v46, v47
    buffer_store_dwordx2 v[26:27], v8, s[24:27], s38 offen offset:0
    v_cvt_pk_bf16_f32 v28, v48, v49
    v_cvt_pk_bf16_f32 v29, v50, v51
    buffer_store_dwordx2 v[28:29], v8, s[24:27], s74 offen offset:32
    v_cvt_pk_bf16_f32 v30, v52, v53
    v_cvt_pk_bf16_f32 v31, v54, v55
    buffer_store_dwordx2 v[30:31], v8, s[24:27], s38 offen offset:32
    v_cvt_pk_bf16_f32 v32, v56, v57
    v_cvt_pk_bf16_f32 v33, v58, v59
    buffer_store_dwordx2 v[32:33], v8, s[24:27], s74 offen offset:64
    v_cvt_pk_bf16_f32 v34, v60, v61
    v_cvt_pk_bf16_f32 v35, v62, v63
    buffer_store_dwordx2 v[34:35], v8, s[24:27], s38 offen offset:64
    s_add_u32 s66, s66, 8
    s_cmp_lt_u32 s66, 64
    s_cbranch_scc1 L_F_loop
    s_waitcnt vmcnt(0)
    s_cmp_lg_u32 s36, 0
    s_cbranch_scc1 Lfin_100
    s_mov_b64 exec, 1
    v_mov_b32 v2, 1
    v_mov_b32 v3, 44
    buffer_atomic_add v2, v3, s[28:31], 0 offen
    s_mov_b64 exec, -1
Lfin_100:
    s_endpgm
L_RQ:
    s_lshl_b32 s79, s68, 4
    s_lshl_b32 s37, s4, 2
    s_add_u32 s79, s79, s37
    s_add_u32 s79, s79, 34816
    s_mov_b64 exec, 1
    v_mov_b32 v2, 0
    buffer_store_dword v2, v2, s[8:11], s79 offen sc1
    s_mov_b64 exec, -1
    s_mov_b32 s53, s67
    s_mul_i32 s73, s6, 5120
    s_add_u32 s73, s73, 65536
    s_add_u32 s74, s73, 20480
    s_add_u32 s55, s73, 40960
    s_mov_b32 s75, 12288
    s_mul_i32 s76, s68, 384
    v_add_u32 v16, 0, v1
    v_mul_u32_u24 v17, 2731, v16
    v_lshrrev_b32 v17, 16, v17
    v_mul_u32_u24 v18, 24, v17
    v_sub_u32 v16, v16, v18
    v_and_b32 v18, 2, v17
    v_xor_b32 v16, v16, v18
    v_and_b32 v18, 8, v17
    v_lshrrev_b32 v18, 1, v18
    v_xor_b32 v16, v16, v18
    s_lshl_b32 s37, s4, 4
    v_add_u32 v17, s37, v17
    v_mul_lo_u32 v17, v17, s75
    v_lshl_add_u32 v16, v16, 4, v17
    v_add_u32 v4, s76, v16
    v_add_u32 v16, 64, v1
    v_mul_u32_u24 v17, 2731, v16
    v_lshrrev_b32 v17, 16, v17
    v_mul_u32_u24 v18, 24, v17
    v_sub_u32 v16, v16, v18
    v_and_b32 v18, 2, v17
    v_xor_b32 v16, v16, v18
    v_and_b32 v18, 8, v17
    v_lshrrev_b32 v18, 1, v18
    v_xor_b32 v16, v16, v18
    s_lshl_b32 s37, s4, 4
    v_add_u32 v17, s37, v17
    v_mul_lo_u32 v17, v17, s75
    v_lshl_add_u32 v16, v16, 4, v17
    v_add_u32 v5, s76, v16
    v_add_u32 v16, 128, v1
    v_mul_u32_u24 v17, 2731, v16
    v_lshrrev_b32 v17, 16, v17
    v_mul_u32_u24 v18, 24, v17
    v_sub_u32 v16, v16, v18
    v_and_b32 v18, 2, v17
    v_xor_b32 v16, v16, v18
    v_and_b32 v18, 8, v17
    v_lshrrev_b32 v18, 1, v18
    v_xor_b32 v16, v16, v18
    s_lshl_b32 s37, s4, 4
    v_add_u32 v17, s37, v17
    v_mul_lo_u32 v17, v17, s75
    v_lshl_add_u32 v16, v16, 4, v17
    v_add_u32 v6, s76, v16
    v_add_u32 v16, 192, v1
    v_mul_u32_u24 v17, 2731, v16
    v_lshrrev_b32 v17, 16, v17
    v_mul_u32_u24 v18, 24, v17
    v_sub_u32 v16, v16, v18
    v_and_b32 v18, 2, v17
    v_xor_b32 v16, v16, v18
    v_and_b32 v18, 8, v17
    v_lshrrev_b32 v18, 1, v18
    v_xor_b32 v16, v16, v18
    s_lshl_b32 s37, s4, 4
    v_add_u32 v17, s37, v17
    v_mul_lo_u32 v17, v17, s75
    v_lshl_add_u32 v16, v16, 4, v17
    v_add_u32 v7, s76, v16
    v_add_u32 v16, 256, v1
    v_mul_u32_u24 v17, 2731, v16
    v_lshrrev_b32 v17, 16, v17
    v_mul_u32_u24 v18, 24, v17
    v_sub_u32 v16, v16, v18
    v_and_b32 v18, 2, v17
    v_xor_b32 v16, v16, v18
    v_and_b32 v18, 8, v17
    v_lshrrev_b32 v18, 1, v18
    v_xor_b32 v16, v16, v18
    s_lshl_b32 s37, s4, 4
    v_add_u32 v17, s37, v17
    v_mul_lo_u32 v17, v17, s75
    v_lshl_add_u32 v16, v16, 4, v17
    v_add_u32 v8, s76, v16
    v_add_u32 v16, 320, v1
    v_mul_u32_u24 v17, 2731, v16
    v_lshrrev_b32 v17, 16, v17
    v_mul_u32_u24 v18, 24, v17
    v_sub_u32 v16, v16, v18
    v_and_b32 v18, 2, v17
    v_xor_b32 v16, v16, v18
    v_and_b32 v18, 8, v17
    v_lshrrev_b32 v18, 1, v18
    v_xor_b32 v16, v16, v18
    s_lshl_b32 s37, s4, 4
    v_add_u32 v17, s37, v17
    v_mul_lo_u32 v17, v17, s75
    v_lshl_add_u32 v16, v16, 4, v17
    v_add_u32 v9, s76, v16
    v_lshrrev_b32 v16, 4, v1
    v_bfe_u32 v17, v1, 2, 2
    v_lshl_add_u32 v18, v16, 3, v17
    v_lshrrev_b32 v18, 5, v1
    v_lshl_add_u32 v18, v18, 2, v17
    v_bfe_u32 v17, v1, 4, 1
    v_lshl_add_u32 v18, v18, 1, v17
    v_lshlrev_b32 v18, 1, v18
    v_mov_b32 v17, v18
    v_bfe_u32 v16, v1, 3, 1
    v_mul_u32_u24 v13, 384, v18
    v_and_b32 v14, 1, v1
    v_lshl_add_u32 v13, v14, 3, v13
    v_and_b32 v17, 2, v17
    v_and_b32 v16, 1, v16
    v_lshl_or_b32 v17, v16, 2, v17
    v_bfe_u32 v16, v1, 1, 1
    s_mul_i32 s37, s4, 6
    v_add_u32 v18, s37, v16
    v_add_u32 v18, 0, v18
    v_xor_b32 v18, v18, v17
    v_lshl_add_u32 v10, v18, 4, v13
    v_add_u32 v18, s37, v16
    v_add_u32 v18, 2, v18
    v_xor_b32 v18, v18, v17
    v_lshl_add_u32 v11, v18, 4, v13
    v_add_u32 v18, s37, v16
    v_add_u32 v18, 4, v18
    v_xor_b32 v18, v18, v17
    v_lshl_add_u32 v12, v18, 4, v13
    s_mul_i32 s90, s4, 6144
    s_lshl_b32 s92, s75, 6
    s_mul_i32 s37, s92, 9
    s_add_u32 m0, s90, 0
    s_nop 0
    buffer_load_dwordx4 v4, s[16:19], s37 offen nt lds
    s_add_u32 m0, s90, 1024
    s_nop 0
    buffer_load_dwordx4 v5, s[16:19], s37 offen nt lds
    s_add_u32 m0, s90, 2048
    s_nop 0
    buffer_load_dwordx4 v6, s[16:19], s37 offen nt lds
    s_add_u32 m0, s90, 3072
    s_nop 0
    buffer_load_dwordx4 v7, s[16:19], s37 offen nt lds
    s_add_u32 m0, s90, 4096
    s_nop 0
    buffer_load_dwordx4 v8, s[16:19], s37 offen nt lds
    s_add_u32 m0, s90, 5120
    s_nop 0
    buffer_load_dwordx4 v9, s[16:19], s37 offen nt lds
    s_mul_i32 s37, s92, 9
    s_add_u32 m0, s90, 24576
    s_nop 0
    buffer_load_dwordx4 v4, s[20:23], s37 offen nt lds
    s_add_u32 m0, s90, 25600
    s_nop 0
    buffer_load_dwordx4 v5, s[20:23], s37 offen nt lds
    s_add_u32 m0, s90, 26624
    s_nop 0
    buffer_load_dwordx4 v6, s[20:23], s37 offen nt lds
    s_add_u32 m0, s90, 27648
    s_nop 0
    buffer_load_dwordx4 v7, s[20:23], s37 offen nt lds
    s_add_u32 m0, s90, 28672
    s_nop 0
    buffer_load_dwordx4 v8, s[20:23], s37 offen nt lds
    s_add_u32 m0, s90, 29696
    s_nop 0
    buffer_load_dwordx4 v9, s[20:23], s37 offen nt lds
    s_waitcnt vmcnt(12)
    s_barrier
    s_cmp_lg_u32 s4, 0
    s_cbranch_scc1 Larr_101
    s_lshl_b32 s37, s7, 16
    s_add_u32 s37, s37, 1
    s_mov_b64 exec, 1
    v_mov_b32 v2, s37
    v_mov_b32 v3, 36
    buffer_atomic_add v2, v3, s[28:31], 0 offen
    s_mov_b64 exec, -1
Larr_101:
    s_mul_i32 s37, s92, 8
    s_add_u32 m0, s90, 49152
    s_nop 0
    buffer_load_dwordx4 v4, s[16:19], s37 offen nt lds
    s_add_u32 m0, s90, 50176
    s_nop 0
    buffer_load_dwordx4 v5, s[16:19], s37 offen nt lds
    s_add_u32 m0, s90, 51200
    s_nop 0
    buffer_load_dwordx4 v6, s[16:19], s37 offen nt lds
    s_add_u32 m0, s90, 52224
    s_nop 0
    buffer_load_dwordx4 v7, s[16:19], s37 offen nt lds
    s_add_u32 m0, s90, 53248
    s_nop 0
    buffer_load_dwordx4 v8, s[16:19], s37 offen nt lds
    s_add_u32 m0, s90, 54272
    s_nop 0
    buffer_load_dwordx4 v9, s[16:19], s37 offen nt lds
    s_mul_i32 s37, s92, 8
    s_add_u32 m0, s90, 73728
    s_nop 0
    buffer_load_dwordx4 v4, s[20:23], s37 offen nt lds
    s_add_u32 m0, s90, 74752
    s_nop 0
    buffer_load_dwordx4 v5, s[20:23], s37 offen nt lds
    s_add_u32 m0, s90, 75776
    s_nop 0
    buffer_load_dwordx4 v6, s[20:23], s37 offen nt lds
    s_add_u32 m0, s90, 76800
    s_nop 0
    buffer_load_dwordx4 v7, s[20:23], s37 offen nt lds
    s_add_u32 m0, s90, 77824
    s_nop 0
    buffer_load_dwordx4 v8, s[20:23], s37 offen nt lds
    s_add_u32 m0, s90, 78848
    s_nop 0
    buffer_load_dwordx4 v9, s[20:23], s37 offen nt lds
    s_mul_i32 s37, s92, 7
    s_add_u32 m0, s90, 98304
    s_nop 0
    buffer_load_dwordx4 v4, s[16:19], s37 offen nt lds
    s_add_u32 m0, s90, 99328
    s_nop 0
    buffer_load_dwordx4 v5, s[16:19], s37 offen nt lds
    s_add_u32 m0, s90, 100352
    s_nop 0
    buffer_load_dwordx4 v6, s[16:19], s37 offen nt lds
    s_add_u32 m0, s90, 101376
    s_nop 0
    buffer_load_dwordx4 v7, s[16:19], s37 offen nt lds
    s_add_u32 m0, s90, 102400
    s_nop 0
    buffer_load_dwordx4 v8, s[16:19], s37 offen nt lds
    s_add_u32 m0, s90, 103424
    s_nop 0
    buffer_load_dwordx4 v9, s[16:19], s37 offen nt lds
    s_mul_i32 s37, s92, 7
    s_add_u32 m0, s90, 122880
    s_nop 0
    buffer_load_dwordx4 v4, s[20:23], s37 offen nt lds
    s_add_u32 m0, s90, 123904
    s_nop 0
    buffer_load_dwordx4 v5, s[20:23], s37 offen nt lds
    s_add_u32 m0, s90, 124928
    s_nop 0
    buffer_load_dwordx4 v6, s[20:23], s37 offen nt lds
    s_add_u32 m0, s90, 125952
    s_nop 0
    buffer_load_dwordx4 v7, s[20:23], s37 offen nt lds
    s_add_u32 m0, s90, 126976
    s_nop 0
    buffer_load_dwordx4 v8, s[20:23], s37 offen nt lds
    s_add_u32 m0, s90, 128000
    s_nop 0
    buffer_load_dwordx4 v9, s[20:23], s37 offen nt lds
    s_cmp_eq_u32 s4, 1
    s_cbranch_scc1 Lpw_104
    s_cmp_eq_u32 s4, 2
    s_cbranch_scc1 Lpw_105
    s_cmp_eq_u32 s4, 3
    s_cbranch_scc1 Lpw_106
Lpw_103:
    s_waitcnt vmcnt(30)
    s_barrier
    v_add_u32 v13, 0, v10
    v_add_u32 v14, 0, v11
    v_add_u32 v15, 0, v12
    ds_read_b64_tr_b16 a[192:193], v13 offset:0
    ds_read_b64_tr_b16 v[96:97], v14 offset:0
    ds_read_b64_tr_b16 v[248:249], v15 offset:0
    ds_read_b64_tr_b16 a[194:195], v13 offset:384
    ds_read_b64_tr_b16 v[98:99], v14 offset:384
    ds_read_b64_tr_b16 v[250:251], v15 offset:384
    ds_read_b64_tr_b16 a[196:197], v13 offset:12288
    ds_read_b64_tr_b16 v[100:101], v14 offset:12288
    ds_read_b64_tr_b16 v[252:253], v15 offset:12288
    ds_read_b64_tr_b16 a[198:199], v13 offset:12672
    ds_read_b64_tr_b16 v[102:103], v14 offset:12672
    ds_read_b64_tr_b16 v[254:255], v15 offset:12672
    s_waitcnt lgkmcnt(0)
    s_barrier
    s_mul_i32 s37, s92, 6
    s_add_u32 m0, s90, 0
    s_nop 0
    buffer_load_dwordx4 v4, s[16:19], s37 offen nt lds
    s_add_u32 m0, s90, 1024
    s_nop 0
    buffer_load_dwordx4 v5, s[16:19], s37 offen nt lds
    s_add_u32 m0, s90, 2048
    s_nop 0
    buffer_load_dwordx4 v6, s[16:19], s37 offen nt lds
    s_add_u32 m0, s90, 3072
    s_nop 0
    buffer_load_dwordx4 v7, s[16:19], s37 offen nt lds
    s_add_u32 m0, s90, 4096
    s_nop 0
    buffer_load_dwordx4 v8, s[16:19], s37 offen nt lds
    s_add_u32 m0, s90, 5120
    s_nop 0
    buffer_load_dwordx4 v9, s[16:19], s37 offen nt lds
    s_waitcnt vmcnt(30)
    s_barrier
    v_add_u32 v13, 24576, v10
    v_add_u32 v14, 24576, v11
    v_add_u32 v15, 24576, v12
    ds_read_b64_tr_b16 a[200:201], v13 offset:0
    ds_read_b64_tr_b16 v[168:169], v14 offset:0
    ds_read_b64_tr_b16 v[128:129], v15 offset:0
    ds_read_b64_tr_b16 a[202:203], v13 offset:384
    ds_read_b64_tr_b16 v[170:171], v14 offset:384
    ds_read_b64_tr_b16 v[130:131], v15 offset:384
    ds_read_b64_tr_b16 a[204:205], v13 offset:12288
    ds_read_b64_tr_b16 v[172:173], v14 offset:12288
    ds_read_b64_tr_b16 v[132:133], v15 offset:12288
    ds_read_b64_tr_b16 a[206:207], v13 offset:12672
    ds_read_b64_tr_b16 v[174:175], v14 offset:12672
    ds_read_b64_tr_b16 v[134:135], v15 offset:12672
    s_waitcnt lgkmcnt(0)
    s_barrier
    s_mul_i32 s37, s92, 6
    s_add_u32 m0, s90, 24576
    s_nop 0
    buffer_load_dwordx4 v4, s[20:23], s37 offen nt lds
    s_add_u32 m0, s90, 25600
    s_nop 0
    buffer_load_dwordx4 v5, s[20:23], s37 offen nt lds
    s_add_u32 m0, s90, 26624
    s_nop 0
    buffer_load_dwordx4 v6, s[20:23], s37 offen nt lds
    s_add_u32 m0, s90, 27648
    s_nop 0
    buffer_load_dwordx4 v7, s[20:23], s37 offen nt lds
    s_add_u32 m0, s90, 28672
    s_nop 0
    buffer_load_dwordx4 v8, s[20:23], s37 offen nt lds
    s_add_u32 m0, s90, 29696
    s_nop 0
    buffer_load_dwordx4 v9, s[20:23], s37 offen nt lds
    s_waitcnt vmcnt(30)
    s_barrier
    v_add_u32 v13, 49152, v10
    v_add_u32 v14, 49152, v11
    v_add_u32 v15, 49152, v12
    ds_read_b64_tr_b16 a[184:185], v13 offset:0
    ds_read_b64_tr_b16 v[152:153], v14 offset:0
    ds_read_b64_tr_b16 v[232:233], v15 offset:0
    ds_read_b64_tr_b16 a[186:187], v13 offset:384
    ds_read_b64_tr_b16 v[154:155], v14 offset:384
    ds_read_b64_tr_b16 v[234:235], v15 offset:384
    ds_read_b64_tr_b16 a[188:189], v13 offset:12288
    ds_read_b64_tr_b16 v[156:157], v14 offset:12288
    ds_read_b64_tr_b16 v[236:237], v15 offset:12288
    ds_read_b64_tr_b16 a[190:191], v13 offset:12672
    ds_read_b64_tr_b16 v[158:159], v14 offset:12672
    ds_read_b64_tr_b16 v[238:239], v15 offset:12672
    s_waitcnt lgkmcnt(0)
    s_barrier
    s_mul_i32 s37, s92, 5
    s_add_u32 m0, s90, 49152
    s_nop 0
    buffer_load_dwordx4 v4, s[16:19], s37 offen nt lds
    s_add_u32 m0, s90, 50176
    s_nop 0
    buffer_load_dwordx4 v5, s[16:19], s37 offen nt lds
    s_add_u32 m0, s90, 51200
    s_nop 0
    buffer_load_dwordx4 v6, s[16:19], s37 offen nt lds
    s_add_u32 m0, s90, 52224
    s_nop 0
    buffer_load_dwordx4 v7, s[16:19], s37 offen nt lds
    s_add_u32 m0, s90, 53248
    s_nop 0
    buffer_load_dwordx4 v8, s[16:19], s37 offen nt lds
    s_add_u32 m0, s90, 54272
    s_nop 0
    buffer_load_dwordx4 v9, s[16:19], s37 offen nt lds
    s_waitcnt vmcnt(30)
    s_barrier
    v_add_u32 v13, 73728, v10
    v_add_u32 v14, 73728, v11
    v_add_u32 v15, 73728, v12
    ds_read_b64_tr_b16 v[64:65], v13 offset:0
    ds_read_b64_tr_b16 v[160:161], v14 offset:0
    ds_read_b64_tr_b16 v[240:241], v15 offset:0
    ds_read_b64_tr_b16 v[66:67], v13 offset:384
    ds_read_b64_tr_b16 v[162:163], v14 offset:384
    ds_read_b64_tr_b16 v[242:243], v15 offset:384
    ds_read_b64_tr_b16 v[68:69], v13 offset:12288
    ds_read_b64_tr_b16 v[164:165], v14 offset:12288
    ds_read_b64_tr_b16 v[244:245], v15 offset:12288
    ds_read_b64_tr_b16 v[70:71], v13 offset:12672
    ds_read_b64_tr_b16 v[166:167], v14 offset:12672
    ds_read_b64_tr_b16 v[246:247], v15 offset:12672
    s_waitcnt lgkmcnt(0)
    s_barrier
    s_mul_i32 s37, s92, 5
    s_add_u32 m0, s90, 73728
    s_nop 0
    buffer_load_dwordx4 v4, s[20:23], s37 offen nt lds
    s_add_u32 m0, s90, 74752
    s_nop 0
    buffer_load_dwordx4 v5, s[20:23], s37 offen nt lds
    s_add_u32 m0, s90, 75776
    s_nop 0
    buffer_load_dwordx4 v6, s[20:23], s37 offen nt lds
    s_add_u32 m0, s90, 76800
    s_nop 0
    buffer_load_dwordx4 v7, s[20:23], s37 offen nt lds
    s_add_u32 m0, s90, 77824
    s_nop 0
    buffer_load_dwordx4 v8, s[20:23], s37 offen nt lds
    s_add_u32 m0, s90, 78848
    s_nop 0
    buffer_load_dwordx4 v9, s[20:23], s37 offen nt lds
    s_waitcnt vmcnt(30)
    s_barrier
    v_add_u32 v13, 98304, v10
    v_add_u32 v14, 98304, v11
    v_add_u32 v15, 98304, v12
    ds_read_b64_tr_b16 a[168:169], v13 offset:0
    ds_read_b64_tr_b16 v[88:89], v14 offset:0
    ds_read_b64_tr_b16 v[224:225], v15 offset:0
    ds_read_b64_tr_b16 a[170:171], v13 offset:384
    ds_read_b64_tr_b16 v[90:91], v14 offset:384
    ds_read_b64_tr_b16 v[226:227], v15 offset:384
    ds_read_b64_tr_b16 a[172:173], v13 offset:12288
    ds_read_b64_tr_b16 v[92:93], v14 offset:12288
    ds_read_b64_tr_b16 v[228:229], v15 offset:12288
    ds_read_b64_tr_b16 a[174:175], v13 offset:12672
    ds_read_b64_tr_b16 v[94:95], v14 offset:12672
    ds_read_b64_tr_b16 v[230:231], v15 offset:12672
    s_waitcnt lgkmcnt(0)
    s_barrier
    s_mul_i32 s37, s92, 4
    s_add_u32 m0, s90, 98304
    s_nop 0
    buffer_load_dwordx4 v4, s[16:19], s37 offen nt lds
    s_add_u32 m0, s90, 99328
    s_nop 0
    buffer_load_dwordx4 v5, s[16:19], s37 offen nt lds
    s_add_u32 m0, s90, 100352
    s_nop 0
    buffer_load_dwordx4 v6, s[16:19], s37 offen nt lds
    s_add_u32 m0, s90, 101376
    s_nop 0
    buffer_load_dwordx4 v7, s[16:19], s37 offen nt lds
    s_add_u32 m0, s90, 102400
    s_nop 0
    buffer_load_dwordx4 v8, s[16:19], s37 offen nt lds
    s_add_u32 m0, s90, 103424
    s_nop 0
    buffer_load_dwordx4 v9, s[16:19], s37 offen nt lds
    s_waitcnt vmcnt(30)
    s_barrier
    v_add_u32 v13, 122880, v10
    v_add_u32 v14, 122880, v11
    v_add_u32 v15, 122880, v12
    ds_read_b64_tr_b16 a[176:177], v13 offset:0
    ds_read_b64_tr_b16 v[144:145], v14 offset:0
    ds_read_b64_tr_b16 v[120:121], v15 offset:0
    ds_read_b64_tr_b16 a[178:179], v13 offset:384
    ds_read_b64_tr_b16 v[146:147], v14 offset:384
    ds_read_b64_tr_b16 v[122:123], v15 offset:384
    ds_read_b64_tr_b16 a[180:181], v13 offset:12288
    ds_read_b64_tr_b16 v[148:149], v14 offset:12288
    ds_read_b64_tr_b16 v[124:125], v15 offset:12288
    ds_read_b64_tr_b16 a[182:183], v13 offset:12672
    ds_read_b64_tr_b16 v[150:151], v14 offset:12672
    ds_read_b64_tr_b16 v[126:127], v15 offset:12672
    s_waitcnt lgkmcnt(0)
    s_barrier
    s_mul_i32 s37, s92, 4
    s_add_u32 m0, s90, 122880
    s_nop 0
    buffer_load_dwordx4 v4, s[20:23], s37 offen nt lds
    s_add_u32 m0, s90, 123904
    s_nop 0
    buffer_load_dwordx4 v5, s[20:23], s37 offen nt lds
    s_add_u32 m0, s90, 124928
    s_nop 0
    buffer_load_dwordx4 v6, s[20:23], s37 offen nt lds
    s_add_u32 m0, s90, 125952
    s_nop 0
    buffer_load_dwordx4 v7, s[20:23], s37 offen nt lds
    s_add_u32 m0, s90, 126976
    s_nop 0
    buffer_load_dwordx4 v8, s[20:23], s37 offen nt lds
    s_add_u32 m0, s90, 128000
    s_nop 0
    buffer_load_dwordx4 v9, s[20:23], s37 offen nt lds
    s_waitcnt vmcnt(30)
    s_barrier
    v_add_u32 v13, 0, v10
    v_add_u32 v14, 0, v11
    v_add_u32 v15, 0, v12
    ds_read_b64_tr_b16 a[160:161], v13 offset:0
    ds_read_b64_tr_b16 a[240:241], v14 offset:0
    ds_read_b64_tr_b16 v[208:209], v15 offset:0
    ds_read_b64_tr_b16 a[162:163], v13 offset:384
    ds_read_b64_tr_b16 a[242:243], v14 offset:384
    ds_read_b64_tr_b16 v[210:211], v15 offset:384
    ds_read_b64_tr_b16 a[164:165], v13 offset:12288
    ds_read_b64_tr_b16 a[244:245], v14 offset:12288
    ds_read_b64_tr_b16 v[212:213], v15 offset:12288
    ds_read_b64_tr_b16 a[166:167], v13 offset:12672
    ds_read_b64_tr_b16 a[246:247], v14 offset:12672
    ds_read_b64_tr_b16 v[214:215], v15 offset:12672
    s_waitcnt lgkmcnt(0)
    s_barrier
    s_mul_i32 s37, s92, 3
    s_add_u32 m0, s90, 0
    s_nop 0
    buffer_load_dwordx4 v4, s[16:19], s37 offen nt lds
    s_add_u32 m0, s90, 1024
    s_nop 0
    buffer_load_dwordx4 v5, s[16:19], s37 offen nt lds
    s_add_u32 m0, s90, 2048
    s_nop 0
    buffer_load_dwordx4 v6, s[16:19], s37 offen nt lds
    s_add_u32 m0, s90, 3072
    s_nop 0
    buffer_load_dwordx4 v7, s[16:19], s37 offen nt lds
    s_add_u32 m0, s90, 4096
    s_nop 0
    buffer_load_dwordx4 v8, s[16:19], s37 offen nt lds
    s_add_u32 m0, s90, 5120
    s_nop 0
    buffer_load_dwordx4 v9, s[16:19], s37 offen nt lds
    s_waitcnt vmcnt(30)
    s_barrier
    v_add_u32 v13, 24576, v10
    v_add_u32 v14, 24576, v11
    v_add_u32 v15, 24576, v12
    ds_read_b64_tr_b16 v[56:57], v13 offset:0
    ds_read_b64_tr_b16 a[248:249], v14 offset:0
    ds_read_b64_tr_b16 v[216:217], v15 offset:0
    ds_read_b64_tr_b16 v[58:59], v13 offset:384
    ds_read_b64_tr_b16 a[250:251], v14 offset:384
    ds_read_b64_tr_b16 v[218:219], v15 offset:384
    ds_read_b64_tr_b16 v[60:61], v13 offset:12288
    ds_read_b64_tr_b16 a[252:253], v14 offset:12288
    ds_read_b64_tr_b16 v[220:221], v15 offset:12288
    ds_read_b64_tr_b16 v[62:63], v13 offset:12672
    ds_read_b64_tr_b16 a[254:255], v14 offset:12672
    ds_read_b64_tr_b16 v[222:223], v15 offset:12672
    s_waitcnt lgkmcnt(0)
    s_barrier
    s_mul_i32 s37, s92, 3
    s_add_u32 m0, s90, 24576
    s_nop 0
    buffer_load_dwordx4 v4, s[20:23], s37 offen nt lds
    s_add_u32 m0, s90, 25600
    s_nop 0
    buffer_load_dwordx4 v5, s[20:23], s37 offen nt lds
    s_add_u32 m0, s90, 26624
    s_nop 0
    buffer_load_dwordx4 v6, s[20:23], s37 offen nt lds
    s_add_u32 m0, s90, 27648
    s_nop 0
    buffer_load_dwordx4 v7, s[20:23], s37 offen nt lds
    s_add_u32 m0, s90, 28672
    s_nop 0
    buffer_load_dwordx4 v8, s[20:23], s37 offen nt lds
    s_add_u32 m0, s90, 29696
    s_nop 0
    buffer_load_dwordx4 v9, s[20:23], s37 offen nt lds
    s_waitcnt vmcnt(30)
    s_barrier
    v_add_u32 v13, 49152, v10
    v_add_u32 v14, 49152, v11
    v_add_u32 v15, 49152, v12
    ds_read_b64_tr_b16 a[144:145], v13 offset:0
    ds_read_b64_tr_b16 v[80:81], v14 offset:0
    ds_read_b64_tr_b16 v[200:201], v15 offset:0
    ds_read_b64_tr_b16 a[146:147], v13 offset:384
    ds_read_b64_tr_b16 v[82:83], v14 offset:384
    ds_read_b64_tr_b16 v[202:203], v15 offset:384
    ds_read_b64_tr_b16 a[148:149], v13 offset:12288
    ds_read_b64_tr_b16 v[84:85], v14 offset:12288
    ds_read_b64_tr_b16 v[204:205], v15 offset:12288
    ds_read_b64_tr_b16 a[150:151], v13 offset:12672
    ds_read_b64_tr_b16 v[86:87], v14 offset:12672
    ds_read_b64_tr_b16 v[206:207], v15 offset:12672
    s_waitcnt lgkmcnt(0)
    s_barrier
    s_mul_i32 s37, s92, 2
    s_add_u32 m0, s90, 49152
    s_nop 0
    buffer_load_dwordx4 v4, s[16:19], s37 offen nt lds
    s_add_u32 m0, s90, 50176
    s_nop 0
    buffer_load_dwordx4 v5, s[16:19], s37 offen nt lds
    s_add_u32 m0, s90, 51200
    s_nop 0
    buffer_load_dwordx4 v6, s[16:19], s37 offen nt lds
    s_add_u32 m0, s90, 52224
    s_nop 0
    buffer_load_dwordx4 v7, s[16:19], s37 offen nt lds
    s_add_u32 m0, s90, 53248
    s_nop 0
    buffer_load_dwordx4 v8, s[16:19], s37 offen nt lds
    s_add_u32 m0, s90, 54272
    s_nop 0
    buffer_load_dwordx4 v9, s[16:19], s37 offen nt lds
    s_waitcnt vmcnt(30)
    s_barrier
    v_add_u32 v13, 73728, v10
    v_add_u32 v14, 73728, v11
    v_add_u32 v15, 73728, v12
    ds_read_b64_tr_b16 a[152:153], v13 offset:0
    ds_read_b64_tr_b16 a[232:233], v14 offset:0
    ds_read_b64_tr_b16 v[112:113], v15 offset:0
    ds_read_b64_tr_b16 a[154:155], v13 offset:384
    ds_read_b64_tr_b16 a[234:235], v14 offset:384
    ds_read_b64_tr_b16 v[114:115], v15 offset:384
    ds_read_b64_tr_b16 a[156:157], v13 offset:12288
    ds_read_b64_tr_b16 a[236:237], v14 offset:12288
    ds_read_b64_tr_b16 v[116:117], v15 offset:12288
    ds_read_b64_tr_b16 a[158:159], v13 offset:12672
    ds_read_b64_tr_b16 a[238:239], v14 offset:12672
    ds_read_b64_tr_b16 v[118:119], v15 offset:12672
    s_waitcnt lgkmcnt(0)
    s_barrier
    s_mul_i32 s37, s92, 2
    s_add_u32 m0, s90, 73728
    s_nop 0
    buffer_load_dwordx4 v4, s[20:23], s37 offen nt lds
    s_add_u32 m0, s90, 74752
    s_nop 0
    buffer_load_dwordx4 v5, s[20:23], s37 offen nt lds
    s_add_u32 m0, s90, 75776
    s_nop 0
    buffer_load_dwordx4 v6, s[20:23], s37 offen nt lds
    s_add_u32 m0, s90, 76800
    s_nop 0
    buffer_load_dwordx4 v7, s[20:23], s37 offen nt lds
    s_add_u32 m0, s90, 77824
    s_nop 0
    buffer_load_dwordx4 v8, s[20:23], s37 offen nt lds
    s_add_u32 m0, s90, 78848
    s_nop 0
    buffer_load_dwordx4 v9, s[20:23], s37 offen nt lds
    s_waitcnt vmcnt(30)
    s_barrier
    v_add_u32 v13, 98304, v10
    v_add_u32 v14, 98304, v11
    v_add_u32 v15, 98304, v12
    ds_read_b64_tr_b16 a[136:137], v13 offset:0
    ds_read_b64_tr_b16 a[216:217], v14 offset:0
    ds_read_b64_tr_b16 v[104:105], v15 offset:0
    ds_read_b64_tr_b16 a[138:139], v13 offset:384
    ds_read_b64_tr_b16 a[218:219], v14 offset:384
    ds_read_b64_tr_b16 v[106:107], v15 offset:384
    ds_read_b64_tr_b16 a[140:141], v13 offset:12288
    ds_read_b64_tr_b16 a[220:221], v14 offset:12288
    ds_read_b64_tr_b16 v[108:109], v15 offset:12288
    ds_read_b64_tr_b16 a[142:143], v13 offset:12672
    ds_read_b64_tr_b16 a[222:223], v14 offset:12672
    ds_read_b64_tr_b16 v[110:111], v15 offset:12672
    s_waitcnt lgkmcnt(0)
    s_barrier
    s_mul_i32 s37, s92, 1
    s_add_u32 m0, s90, 98304
    s_nop 0
    buffer_load_dwordx4 v4, s[16:19], s37 offen nt lds
    s_add_u32 m0, s90, 99328
    s_nop 0
    buffer_load_dwordx4 v5, s[16:19], s37 offen nt lds
    s_add_u32 m0, s90, 100352
    s_nop 0
    buffer_load_dwordx4 v6, s[16:19], s37 offen nt lds
    s_add_u32 m0, s90, 101376
    s_nop 0
    buffer_load_dwordx4 v7, s[16:19], s37 offen nt lds
    s_add_u32 m0, s90, 102400
    s_nop 0
    buffer_load_dwordx4 v8, s[16:19], s37 offen nt lds
    s_add_u32 m0, s90, 103424
    s_nop 0
    buffer_load_dwordx4 v9, s[16:19], s37 offen nt lds
    s_waitcnt vmcnt(30)
    s_barrier
    v_add_u32 v13, 122880, v10
    v_add_u32 v14, 122880, v11
    v_add_u32 v15, 122880, v12
    ds_read_b64_tr_b16 v[48:49], v13 offset:0
    ds_read_b64_tr_b16 a[224:225], v14 offset:0
    ds_read_b64_tr_b16 v[192:193], v15 offset:0
    ds_read_b64_tr_b16 v[50:51], v13 offset:384
    ds_read_b64_tr_b16 a[226:227], v14 offset:384
    ds_read_b64_tr_b16 v[194:195], v15 offset:384
    ds_read_b64_tr_b16 v[52:53], v13 offset:12288
    ds_read_b64_tr_b16 a[228:229], v14 offset:12288
    ds_read_b64_tr_b16 v[196:197], v15 offset:12288
    ds_read_b64_tr_b16 v[54:55], v13 offset:12672
    ds_read_b64_tr_b16 a[230:231], v14 offset:12672
    ds_read_b64_tr_b16 v[198:199], v15 offset:12672
    s_waitcnt lgkmcnt(0)
    s_barrier
    s_mul_i32 s37, s92, 1
    s_add_u32 m0, s90, 122880
    s_nop 0
    buffer_load_dwordx4 v4, s[20:23], s37 offen nt lds
    s_add_u32 m0, s90, 123904
    s_nop 0
    buffer_load_dwordx4 v5, s[20:23], s37 offen nt lds
    s_add_u32 m0, s90, 124928
    s_nop 0
    buffer_load_dwordx4 v6, s[20:23], s37 offen nt lds
    s_add_u32 m0, s90, 125952
    s_nop 0
    buffer_load_dwordx4 v7, s[20:23], s37 offen nt lds
    s_add_u32 m0, s90, 126976
    s_nop 0
    buffer_load_dwordx4 v8, s[20:23], s37 offen nt lds
    s_add_u32 m0, s90, 128000
    s_nop 0
    buffer_load_dwordx4 v9, s[20:23], s37 offen nt lds
    s_waitcnt vmcnt(30)
    s_barrier
    v_add_u32 v13, 0, v10
    v_add_u32 v14, 0, v11
    v_add_u32 v15, 0, v12
    ds_read_b64_tr_b16 v[40:41], v13 offset:0
    ds_read_b64_tr_b16 a[208:209], v14 offset:0
    ds_read_b64_tr_b16 v[176:177], v15 offset:0
    ds_read_b64_tr_b16 v[42:43], v13 offset:384
    ds_read_b64_tr_b16 a[210:211], v14 offset:384
    ds_read_b64_tr_b16 v[178:179], v15 offset:384
    ds_read_b64_tr_b16 v[44:45], v13 offset:12288
    ds_read_b64_tr_b16 a[212:213], v14 offset:12288
    ds_read_b64_tr_b16 v[180:181], v15 offset:12288
    ds_read_b64_tr_b16 v[46:47], v13 offset:12672
    ds_read_b64_tr_b16 a[214:215], v14 offset:12672
    ds_read_b64_tr_b16 v[182:183], v15 offset:12672
    s_waitcnt lgkmcnt(0)
    s_barrier
    s_mul_i32 s37, s92, 0
    s_add_u32 m0, s90, 0
    s_nop 0
    buffer_load_dwordx4 v4, s[16:19], s37 offen nt lds
    s_add_u32 m0, s90, 1024
    s_nop 0
    buffer_load_dwordx4 v5, s[16:19], s37 offen nt lds
    s_add_u32 m0, s90, 2048
    s_nop 0
    buffer_load_dwordx4 v6, s[16:19], s37 offen nt lds
    s_add_u32 m0, s90, 3072
    s_nop 0
    buffer_load_dwordx4 v7, s[16:19], s37 offen nt lds
    s_add_u32 m0, s90, 4096
    s_nop 0
    buffer_load_dwordx4 v8, s[16:19], s37 offen nt lds
    s_add_u32 m0, s90, 5120
    s_nop 0
    buffer_load_dwordx4 v9, s[16:19], s37 offen nt lds
    s_waitcnt vmcnt(30)
    s_barrier
    v_add_u32 v13, 24576, v10
    v_add_u32 v14, 24576, v11
    v_add_u32 v15, 24576, v12
    ds_read_b64_tr_b16 a[128:129], v13 offset:0
    ds_read_b64_tr_b16 v[72:73], v14 offset:0
    ds_read_b64_tr_b16 v[184:185], v15 offset:0
    ds_read_b64_tr_b16 a[130:131], v13 offset:384
    ds_read_b64_tr_b16 v[74:75], v14 offset:384
    ds_read_b64_tr_b16 v[186:187], v15 offset:384
    ds_read_b64_tr_b16 a[132:133], v13 offset:12288
    ds_read_b64_tr_b16 v[76:77], v14 offset:12288
    ds_read_b64_tr_b16 v[188:189], v15 offset:12288
    ds_read_b64_tr_b16 a[134:135], v13 offset:12672
    ds_read_b64_tr_b16 v[78:79], v14 offset:12672
    ds_read_b64_tr_b16 v[190:191], v15 offset:12672
    s_waitcnt lgkmcnt(0)
    s_barrier
    s_mul_i32 s37, s92, 0
    s_add_u32 m0, s90, 24576
    s_nop 0
    buffer_load_dwordx4 v4, s[20:23], s37 offen nt lds
    s_add_u32 m0, s90, 25600
    s_nop 0
    buffer_load_dwordx4 v5, s[20:23], s37 offen nt lds
    s_add_u32 m0, s90, 26624
    s_nop 0
    buffer_load_dwordx4 v6, s[20:23], s37 offen nt lds
    s_add_u32 m0, s90, 27648
    s_nop 0
    buffer_load_dwordx4 v7, s[20:23], s37 offen nt lds
    s_add_u32 m0, s90, 28672
    s_nop 0
    buffer_load_dwordx4 v8, s[20:23], s37 offen nt lds
    s_add_u32 m0, s90, 29696
    s_nop 0
    buffer_load_dwordx4 v9, s[20:23], s37 offen nt lds
    s_waitcnt vmcnt(30)
    s_barrier
    v_add_u32 v13, 49152, v10
    v_add_u32 v14, 49152, v11
    v_add_u32 v15, 49152, v12
    ds_read_b64_tr_b16 a[88:89], v13 offset:0
    ds_read_b64_tr_b16 a[96:97], v14 offset:0
    ds_read_b64_tr_b16 v[32:33], v15 offset:0
    ds_read_b64_tr_b16 a[90:91], v13 offset:384
    ds_read_b64_tr_b16 a[98:99], v14 offset:384
    ds_read_b64_tr_b16 v[34:35], v15 offset:384
    ds_read_b64_tr_b16 a[92:93], v13 offset:12288
    ds_read_b64_tr_b16 a[100:101], v14 offset:12288
    ds_read_b64_tr_b16 v[36:37], v15 offset:12288
    ds_read_b64_tr_b16 a[94:95], v13 offset:12672
    ds_read_b64_tr_b16 a[102:103], v14 offset:12672
    ds_read_b64_tr_b16 v[38:39], v15 offset:12672
    s_waitcnt lgkmcnt(0)
    s_waitcnt vmcnt(24)
    s_barrier
    v_add_u32 v13, 73728, v10
    v_add_u32 v14, 73728, v11
    v_add_u32 v15, 73728, v12
    ds_read_b64_tr_b16 a[104:105], v13 offset:0
    ds_read_b64_tr_b16 a[112:113], v14 offset:0
    ds_read_b64_tr_b16 a[120:121], v15 offset:0
    ds_read_b64_tr_b16 a[106:107], v13 offset:384
    ds_read_b64_tr_b16 a[114:115], v14 offset:384
    ds_read_b64_tr_b16 a[122:123], v15 offset:384
    ds_read_b64_tr_b16 a[108:109], v13 offset:12288
    ds_read_b64_tr_b16 a[116:117], v14 offset:12288
    ds_read_b64_tr_b16 a[124:125], v15 offset:12288
    ds_read_b64_tr_b16 a[110:111], v13 offset:12672
    ds_read_b64_tr_b16 a[118:119], v14 offset:12672
    ds_read_b64_tr_b16 a[126:127], v15 offset:12672
    s_waitcnt lgkmcnt(0)
    s_waitcnt vmcnt(18)
    s_barrier
    v_add_u32 v13, 98304, v10
    v_add_u32 v14, 98304, v11
    v_add_u32 v15, 98304, v12
    ds_read_b64_tr_b16 a[48:49], v13 offset:0
    ds_read_b64_tr_b16 a[56:57], v14 offset:0
    ds_read_b64_tr_b16 a[64:65], v15 offset:0
    ds_read_b64_tr_b16 a[50:51], v13 offset:384
    ds_read_b64_tr_b16 a[58:59], v14 offset:384
    ds_read_b64_tr_b16 a[66:67], v15 offset:384
    ds_read_b64_tr_b16 a[52:53], v13 offset:12288
    ds_read_b64_tr_b16 a[60:61], v14 offset:12288
    ds_read_b64_tr_b16 a[68:69], v15 offset:12288
    ds_read_b64_tr_b16 a[54:55], v13 offset:12672
    ds_read_b64_tr_b16 a[62:63], v14 offset:12672
    ds_read_b64_tr_b16 a[70:71], v15 offset:12672
    s_waitcnt lgkmcnt(0)
    s_waitcnt vmcnt(12)
    s_barrier
    v_add_u32 v13, 122880, v10
    v_add_u32 v14, 122880, v11
    v_add_u32 v15, 122880, v12
    ds_read_b64_tr_b16 a[72:73], v13 offset:0
    ds_read_b64_tr_b16 v[24:25], v14 offset:0
    ds_read_b64_tr_b16 a[80:81], v15 offset:0
    ds_read_b64_tr_b16 a[74:75], v13 offset:384
    ds_read_b64_tr_b16 v[26:27], v14 offset:384
    ds_read_b64_tr_b16 a[82:83], v15 offset:384
    ds_read_b64_tr_b16 a[76:77], v13 offset:12288
    ds_read_b64_tr_b16 v[28:29], v14 offset:12288
    ds_read_b64_tr_b16 a[84:85], v15 offset:12288
    ds_read_b64_tr_b16 a[78:79], v13 offset:12672
    ds_read_b64_tr_b16 v[30:31], v14 offset:12672
    ds_read_b64_tr_b16 a[86:87], v15 offset:12672
    s_waitcnt lgkmcnt(0)
    s_waitcnt vmcnt(6)
    s_barrier
    v_add_u32 v13, 0, v10
    v_add_u32 v14, 0, v11
    v_add_u32 v15, 0, v12
    ds_read_b64_tr_b16 a[0:1], v13 offset:0
    ds_read_b64_tr_b16 a[8:9], v14 offset:0
    ds_read_b64_tr_b16 a[16:17], v15 offset:0
    ds_read_b64_tr_b16 a[2:3], v13 offset:384
    ds_read_b64_tr_b16 a[10:11], v14 offset:384
    ds_read_b64_tr_b16 a[18:19], v15 offset:384
    ds_read_b64_tr_b16 a[4:5], v13 offset:12288
    ds_read_b64_tr_b16 a[12:13], v14 offset:12288
    ds_read_b64_tr_b16 a[20:21], v15 offset:12288
    ds_read_b64_tr_b16 a[6:7], v13 offset:12672
    ds_read_b64_tr_b16 a[14:15], v14 offset:12672
    ds_read_b64_tr_b16 a[22:23], v15 offset:12672
    s_waitcnt lgkmcnt(0)
    s_waitcnt vmcnt(0)
    s_barrier
    v_add_u32 v13, 24576, v10
    v_add_u32 v14, 24576, v11
    v_add_u32 v15, 24576, v12
    ds_read_b64_tr_b16 a[24:25], v13 offset:0
    ds_read_b64_tr_b16 a[32:33], v14 offset:0
    ds_read_b64_tr_b16 a[40:41], v15 offset:0
    ds_read_b64_tr_b16 a[26:27], v13 offset:384
    ds_read_b64_tr_b16 a[34:35], v14 offset:384
    ds_read_b64_tr_b16 a[42:43], v15 offset:384
    ds_read_b64_tr_b16 a[28:29], v13 offset:12288
    ds_read_b64_tr_b16 a[36:37], v14 offset:12288
    ds_read_b64_tr_b16 a[44:45], v15 offset:12288
    ds_read_b64_tr_b16 a[30:31], v13 offset:12672
    ds_read_b64_tr_b16 a[38:39], v14 offset:12672
    ds_read_b64_tr_b16 a[46:47], v15 offset:12672
    s_waitcnt lgkmcnt(0)
    s_branch Lpw_102
Lpw_104:
    s_waitcnt vmcnt(30)
    s_barrier
    v_add_u32 v13, 0, v10
    v_add_u32 v14, 0, v11
    v_add_u32 v15, 0, v12
    ds_read_b64_tr_b16 a[168:169], v13 offset:0
    ds_read_b64_tr_b16 v[88:89], v14 offset:0
    ds_read_b64_tr_b16 v[224:225], v15 offset:0
    ds_read_b64_tr_b16 a[170:171], v13 offset:384
    ds_read_b64_tr_b16 v[90:91], v14 offset:384
    ds_read_b64_tr_b16 v[226:227], v15 offset:384
    ds_read_b64_tr_b16 a[172:173], v13 offset:12288
    ds_read_b64_tr_b16 v[92:93], v14 offset:12288
    ds_read_b64_tr_b16 v[228:229], v15 offset:12288
    ds_read_b64_tr_b16 a[174:175], v13 offset:12672
    ds_read_b64_tr_b16 v[94:95], v14 offset:12672
    ds_read_b64_tr_b16 v[230:231], v15 offset:12672
    s_waitcnt lgkmcnt(0)
    s_barrier
    s_mul_i32 s37, s92, 6
    s_add_u32 m0, s90, 0
    s_nop 0
    buffer_load_dwordx4 v4, s[16:19], s37 offen nt lds
    s_add_u32 m0, s90, 1024
    s_nop 0
    buffer_load_dwordx4 v5, s[16:19], s37 offen nt lds
    s_add_u32 m0, s90, 2048
    s_nop 0
    buffer_load_dwordx4 v6, s[16:19], s37 offen nt lds
    s_add_u32 m0, s90, 3072
    s_nop 0
    buffer_load_dwordx4 v7, s[16:19], s37 offen nt lds
    s_add_u32 m0, s90, 4096
    s_nop 0
    buffer_load_dwordx4 v8, s[16:19], s37 offen nt lds
    s_add_u32 m0, s90, 5120
    s_nop 0
    buffer_load_dwordx4 v9, s[16:19], s37 offen nt lds
    s_waitcnt vmcnt(30)
    s_barrier
    v_add_u32 v13, 24576, v10
    v_add_u32 v14, 24576, v11
    v_add_u32 v15, 24576, v12
    ds_read_b64_tr_b16 a[176:177], v13 offset:0
    ds_read_b64_tr_b16 v[144:145], v14 offset:0
    ds_read_b64_tr_b16 v[120:121], v15 offset:0
    ds_read_b64_tr_b16 a[178:179], v13 offset:384
    ds_read_b64_tr_b16 v[146:147], v14 offset:384
    ds_read_b64_tr_b16 v[122:123], v15 offset:384
    ds_read_b64_tr_b16 a[180:181], v13 offset:12288
    ds_read_b64_tr_b16 v[148:149], v14 offset:12288
    ds_read_b64_tr_b16 v[124:125], v15 offset:12288
    ds_read_b64_tr_b16 a[182:183], v13 offset:12672
    ds_read_b64_tr_b16 v[150:151], v14 offset:12672
    ds_read_b64_tr_b16 v[126:127], v15 offset:12672
    s_waitcnt lgkmcnt(0)
    s_barrier
    s_mul_i32 s37, s92, 6
    s_add_u32 m0, s90, 24576
    s_nop 0
    buffer_load_dwordx4 v4, s[20:23], s37 offen nt lds
    s_add_u32 m0, s90, 25600
    s_nop 0
    buffer_load_dwordx4 v5, s[20:23], s37 offen nt lds
    s_add_u32 m0, s90, 26624
    s_nop 0
    buffer_load_dwordx4 v6, s[20:23], s37 offen nt lds
    s_add_u32 m0, s90, 27648
    s_nop 0
    buffer_load_dwordx4 v7, s[20:23], s37 offen nt lds
    s_add_u32 m0, s90, 28672
    s_nop 0
    buffer_load_dwordx4 v8, s[20:23], s37 offen nt lds
    s_add_u32 m0, s90, 29696
    s_nop 0
    buffer_load_dwordx4 v9, s[20:23], s37 offen nt lds
    s_waitcnt vmcnt(30)
    s_barrier
    v_add_u32 v13, 49152, v10
    v_add_u32 v14, 49152, v11
    v_add_u32 v15, 49152, v12
    ds_read_b64_tr_b16 a[160:161], v13 offset:0
    ds_read_b64_tr_b16 a[240:241], v14 offset:0
    ds_read_b64_tr_b16 v[208:209], v15 offset:0
    ds_read_b64_tr_b16 a[162:163], v13 offset:384
    ds_read_b64_tr_b16 a[242:243], v14 offset:384
    ds_read_b64_tr_b16 v[210:211], v15 offset:384
    ds_read_b64_tr_b16 a[164:165], v13 offset:12288
    ds_read_b64_tr_b16 a[244:245], v14 offset:12288
    ds_read_b64_tr_b16 v[212:213], v15 offset:12288
    ds_read_b64_tr_b16 a[166:167], v13 offset:12672
    ds_read_b64_tr_b16 a[246:247], v14 offset:12672
    ds_read_b64_tr_b16 v[214:215], v15 offset:12672
    s_waitcnt lgkmcnt(0)
    s_barrier
    s_mul_i32 s37, s92, 5
    s_add_u32 m0, s90, 49152
    s_nop 0
    buffer_load_dwordx4 v4, s[16:19], s37 offen nt lds
    s_add_u32 m0, s90, 50176
    s_nop 0
    buffer_load_dwordx4 v5, s[16:19], s37 offen nt lds
    s_add_u32 m0, s90, 51200
    s_nop 0
    buffer_load_dwordx4 v6, s[16:19], s37 offen nt lds
    s_add_u32 m0, s90, 52224
    s_nop 0
    buffer_load_dwordx4 v7, s[16:19], s37 offen nt lds
    s_add_u32 m0, s90, 53248
    s_nop 0
    buffer_load_dwordx4 v8, s[16:19], s37 offen nt lds
    s_add_u32 m0, s90, 54272
    s_nop 0
    buffer_load_dwordx4 v9, s[16:19], s37 offen nt lds
    s_waitcnt vmcnt(30)
    s_barrier
    v_add_u32 v13, 73728, v10
    v_add_u32 v14, 73728, v11
    v_add_u32 v15, 73728, v12
    ds_read_b64_tr_b16 v[56:57], v13 offset:0
    ds_read_b64_tr_b16 a[248:249], v14 offset:0
    ds_read_b64_tr_b16 v[216:217], v15 offset:0
    ds_read_b64_tr_b16 v[58:59], v13 offset:384
    ds_read_b64_tr_b16 a[250:251], v14 offset:384
    ds_read_b64_tr_b16 v[218:219], v15 offset:384
    ds_read_b64_tr_b16 v[60:61], v13 offset:12288
    ds_read_b64_tr_b16 a[252:253], v14 offset:12288
    ds_read_b64_tr_b16 v[220:221], v15 offset:12288
    ds_read_b64_tr_b16 v[62:63], v13 offset:12672
    ds_read_b64_tr_b16 a[254:255], v14 offset:12672
    ds_read_b64_tr_b16 v[222:223], v15 offset:12672
    s_waitcnt lgkmcnt(0)
    s_barrier
    s_mul_i32 s37, s92, 5
    s_add_u32 m0, s90, 73728
    s_nop 0
    buffer_load_dwordx4 v4, s[20:23], s37 offen nt lds
    s_add_u32 m0, s90, 74752
    s_nop 0
    buffer_load_dwordx4 v5, s[20:23], s37 offen nt lds
    s_add_u32 m0, s90, 75776
    s_nop 0
    buffer_load_dwordx4 v6, s[20:23], s37 offen nt lds
    s_add_u32 m0, s90, 76800
    s_nop 0
    buffer_load_dwordx4 v7, s[20:23], s37 offen nt lds
    s_add_u32 m0, s90, 77824
    s_nop 0
    buffer_load_dwordx4 v8, s[20:23], s37 offen nt lds
    s_add_u32 m0, s90, 78848
    s_nop 0
    buffer_load_dwordx4 v9, s[20:23], s37 offen nt lds
    s_waitcnt vmcnt(30)
    s_barrier
    v_add_u32 v13, 98304, v10
    v_add_u32 v14, 98304, v11
    v_add_u32 v15, 98304, v12
    ds_read_b64_tr_b16 a[144:145], v13 offset:0
    ds_read_b64_tr_b16 v[80:81], v14 offset:0
    ds_read_b64_tr_b16 v[200:201], v15 offset:0
    ds_read_b64_tr_b16 a[146:147], v13 offset:384
    ds_read_b64_tr_b16 v[82:83], v14 offset:384
    ds_read_b64_tr_b16 v[202:203], v15 offset:384
    ds_read_b64_tr_b16 a[148:149], v13 offset:12288
    ds_read_b64_tr_b16 v[84:85], v14 offset:12288
    ds_read_b64_tr_b16 v[204:205], v15 offset:12288
    ds_read_b64_tr_b16 a[150:151], v13 offset:12672
    ds_read_b64_tr_b16 v[86:87], v14 offset:12672
    ds_read_b64_tr_b16 v[206:207], v15 offset:12672
    s_waitcnt lgkmcnt(0)
    s_barrier
    s_mul_i32 s37, s92, 4
    s_add_u32 m0, s90, 98304
    s_nop 0
    buffer_load_dwordx4 v4, s[16:19], s37 offen nt lds
    s_add_u32 m0, s90, 99328
    s_nop 0
    buffer_load_dwordx4 v5, s[16:19], s37 offen nt lds
    s_add_u32 m0, s90, 100352
    s_nop 0
    buffer_load_dwordx4 v6, s[16:19], s37 offen nt lds
    s_add_u32 m0, s90, 101376
    s_nop 0
    buffer_load_dwordx4 v7, s[16:19], s37 offen nt lds
    s_add_u32 m0, s90, 102400
    s_nop 0
    buffer_load_dwordx4 v8, s[16:19], s37 offen nt lds
    s_add_u32 m0, s90, 103424
    s_nop 0
    buffer_load_dwordx4 v9, s[16:19], s37 offen nt lds
    s_waitcnt vmcnt(30)
    s_barrier
    v_add_u32 v13, 122880, v10
    v_add_u32 v14, 122880, v11
    v_add_u32 v15, 122880, v12
    ds_read_b64_tr_b16 a[152:153], v13 offset:0
    ds_read_b64_tr_b16 a[232:233], v14 offset:0
    ds_read_b64_tr_b16 v[112:113], v15 offset:0
    ds_read_b64_tr_b16 a[154:155], v13 offset:384
    ds_read_b64_tr_b16 a[234:235], v14 offset:384
    ds_read_b64_tr_b16 v[114:115], v15 offset:384
    ds_read_b64_tr_b16 a[156:157], v13 offset:12288
    ds_read_b64_tr_b16 a[236:237], v14 offset:12288
    ds_read_b64_tr_b16 v[116:117], v15 offset:12288
    ds_read_b64_tr_b16 a[158:159], v13 offset:12672
    ds_read_b64_tr_b16 a[238:239], v14 offset:12672
    ds_read_b64_tr_b16 v[118:119], v15 offset:12672
    s_waitcnt lgkmcnt(0)
    s_barrier
    s_mul_i32 s37, s92, 4
    s_add_u32 m0, s90, 122880
    s_nop 0
    buffer_load_dwordx4 v4, s[20:23], s37 offen nt lds
    s_add_u32 m0, s90, 123904
    s_nop 0
    buffer_load_dwordx4 v5, s[20:23], s37 offen nt lds
    s_add_u32 m0, s90, 124928
    s_nop 0
    buffer_load_dwordx4 v6, s[20:23], s37 offen nt lds
    s_add_u32 m0, s90, 125952
    s_nop 0
    buffer_load_dwordx4 v7, s[20:23], s37 offen nt lds
    s_add_u32 m0, s90, 126976
    s_nop 0
    buffer_load_dwordx4 v8, s[20:23], s37 offen nt lds
    s_add_u32 m0, s90, 128000
    s_nop 0
    buffer_load_dwordx4 v9, s[20:23], s37 offen nt lds
    s_waitcnt vmcnt(30)
    s_barrier
    v_add_u32 v13, 0, v10
    v_add_u32 v14, 0, v11
    v_add_u32 v15, 0, v12
    ds_read_b64_tr_b16 a[136:137], v13 offset:0
    ds_read_b64_tr_b16 a[216:217], v14 offset:0
    ds_read_b64_tr_b16 v[104:105], v15 offset:0
    ds_read_b64_tr_b16 a[138:139], v13 offset:384
    ds_read_b64_tr_b16 a[218:219], v14 offset:384
    ds_read_b64_tr_b16 v[106:107], v15 offset:384
    ds_read_b64_tr_b16 a[140:141], v13 offset:12288
    ds_read_b64_tr_b16 a[220:221], v14 offset:12288
    ds_read_b64_tr_b16 v[108:109], v15 offset:12288
    ds_read_b64_tr_b16 a[142:143], v13 offset:12672
    ds_read_b64_tr_b16 a[222:223], v14 offset:12672
    ds_read_b64_tr_b16 v[110:111], v15 offset:12672
    s_waitcnt lgkmcnt(0)
    s_barrier
    s_mul_i32 s37, s92, 3
    s_add_u32 m0, s90, 0
    s_nop 0
    buffer_load_dwordx4 v4, s[16:19], s37 offen nt lds
    s_add_u32 m0, s90, 1024
    s_nop 0
    buffer_load_dwordx4 v5, s[16:19], s37 offen nt lds
    s_add_u32 m0, s90, 2048
    s_nop 0
    buffer_load_dwordx4 v6, s[16:19], s37 offen nt lds
    s_add_u32 m0, s90, 3072
    s_nop 0
    buffer_load_dwordx4 v7, s[16:19], s37 offen nt lds
    s_add_u32 m0, s90, 4096
    s_nop 0
    buffer_load_dwordx4 v8, s[16:19], s37 offen nt lds
    s_add_u32 m0, s90, 5120
    s_nop 0
    buffer_load_dwordx4 v9, s[16:19], s37 offen nt lds
    s_waitcnt vmcnt(30)
    s_barrier
    v_add_u32 v13, 24576, v10
    v_add_u32 v14, 24576, v11
    v_add_u32 v15, 24576, v12
    ds_read_b64_tr_b16 v[48:49], v13 offset:0
    ds_read_b64_tr_b16 a[224:225], v14 offset:0
    ds_read_b64_tr_b16 v[192:193], v15 offset:0
    ds_read_b64_tr_b16 v[50:51], v13 offset:384
    ds_read_b64_tr_b16 a[226:227], v14 offset:384
    ds_read_b64_tr_b16 v[194:195], v15 offset:384
    ds_read_b64_tr_b16 v[52:53], v13 offset:12288
    ds_read_b64_tr_b16 a[228:229], v14 offset:12288
    ds_read_b64_tr_b16 v[196:197], v15 offset:12288
    ds_read_b64_tr_b16 v[54:55], v13 offset:12672
    ds_read_b64_tr_b16 a[230:231], v14 offset:12672
    ds_read_b64_tr_b16 v[198:199], v15 offset:12672
    s_waitcnt lgkmcnt(0)
    s_barrier
    s_mul_i32 s37, s92, 3
    s_add_u32 m0, s90, 24576
    s_nop 0
    buffer_load_dwordx4 v4, s[20:23], s37 offen nt lds
    s_add_u32 m0, s90, 25600
    s_nop 0
    buffer_load_dwordx4 v5, s[20:23], s37 offen nt lds
    s_add_u32 m0, s90, 26624
    s_nop 0
    buffer_load_dwordx4 v6, s[20:23], s37 offen nt lds
    s_add_u32 m0, s90, 27648
    s_nop 0
    buffer_load_dwordx4 v7, s[20:23], s37 offen nt lds
    s_add_u32 m0, s90, 28672
    s_nop 0
    buffer_load_dwordx4 v8, s[20:23], s37 offen nt lds
    s_add_u32 m0, s90, 29696
    s_nop 0
    buffer_load_dwordx4 v9, s[20:23], s37 offen nt lds
    s_waitcnt vmcnt(30)
    s_barrier
    v_add_u32 v13, 49152, v10
    v_add_u32 v14, 49152, v11
    v_add_u32 v15, 49152, v12
    ds_read_b64_tr_b16 v[40:41], v13 offset:0
    ds_read_b64_tr_b16 a[208:209], v14 offset:0
    ds_read_b64_tr_b16 v[176:177], v15 offset:0
    ds_read_b64_tr_b16 v[42:43], v13 offset:384
    ds_read_b64_tr_b16 a[210:211], v14 offset:384
    ds_read_b64_tr_b16 v[178:179], v15 offset:384
    ds_read_b64_tr_b16 v[44:45], v13 offset:12288
    ds_read_b64_tr_b16 a[212:213], v14 offset:12288
    ds_read_b64_tr_b16 v[180:181], v15 offset:12288
    ds_read_b64_tr_b16 v[46:47], v13 offset:12672
    ds_read_b64_tr_b16 a[214:215], v14 offset:12672
    ds_read_b64_tr_b16 v[182:183], v15 offset:12672
    s_waitcnt lgkmcnt(0)
    s_barrier
    s_mul_i32 s37, s92, 2
    s_add_u32 m0, s90, 49152
    s_nop 0
    buffer_load_dwordx4 v4, s[16:19], s37 offen nt lds
    s_add_u32 m0, s90, 50176
    s_nop 0
    buffer_load_dwordx4 v5, s[16:19], s37 offen nt lds
    s_add_u32 m0, s90, 51200
    s_nop 0
    buffer_load_dwordx4 v6, s[16:19], s37 offen nt lds
    s_add_u32 m0, s90, 52224
    s_nop 0
    buffer_load_dwordx4 v7, s[16:19], s37 offen nt lds
    s_add_u32 m0, s90, 53248
    s_nop 0
    buffer_load_dwordx4 v8, s[16:19], s37 offen nt lds
    s_add_u32 m0, s90, 54272
    s_nop 0
    buffer_load_dwordx4 v9, s[16:19], s37 offen nt lds
    s_waitcnt vmcnt(30)
    s_barrier
    v_add_u32 v13, 73728, v10
    v_add_u32 v14, 73728, v11
    v_add_u32 v15, 73728, v12
    ds_read_b64_tr_b16 a[128:129], v13 offset:0
    ds_read_b64_tr_b16 v[72:73], v14 offset:0
    ds_read_b64_tr_b16 v[184:185], v15 offset:0
    ds_read_b64_tr_b16 a[130:131], v13 offset:384
    ds_read_b64_tr_b16 v[74:75], v14 offset:384
    ds_read_b64_tr_b16 v[186:187], v15 offset:384
    ds_read_b64_tr_b16 a[132:133], v13 offset:12288
    ds_read_b64_tr_b16 v[76:77], v14 offset:12288
    ds_read_b64_tr_b16 v[188:189], v15 offset:12288
    ds_read_b64_tr_b16 a[134:135], v13 offset:12672
    ds_read_b64_tr_b16 v[78:79], v14 offset:12672
    ds_read_b64_tr_b16 v[190:191], v15 offset:12672
    s_waitcnt lgkmcnt(0)
    s_barrier
    s_mul_i32 s37, s92, 2
    s_add_u32 m0, s90, 73728
    s_nop 0
    buffer_load_dwordx4 v4, s[20:23], s37 offen nt lds
    s_add_u32 m0, s90, 74752
    s_nop 0
    buffer_load_dwordx4 v5, s[20:23], s37 offen nt lds
    s_add_u32 m0, s90, 75776
    s_nop 0
    buffer_load_dwordx4 v6, s[20:23], s37 offen nt lds
    s_add_u32 m0, s90, 76800
    s_nop 0
    buffer_load_dwordx4 v7, s[20:23], s37 offen nt lds
    s_add_u32 m0, s90, 77824
    s_nop 0
    buffer_load_dwordx4 v8, s[20:23], s37 offen nt lds
    s_add_u32 m0, s90, 78848
    s_nop 0
    buffer_load_dwordx4 v9, s[20:23], s37 offen nt lds
    s_waitcnt vmcnt(30)
    s_barrier
    v_add_u32 v13, 98304, v10
    v_add_u32 v14, 98304, v11
    v_add_u32 v15, 98304, v12
    ds_read_b64_tr_b16 a[88:89], v13 offset:0
    ds_read_b64_tr_b16 a[96:97], v14 offset:0
    ds_read_b64_tr_b16 v[32:33], v15 offset:0
    ds_read_b64_tr_b16 a[90:91], v13 offset:384
    ds_read_b64_tr_b16 a[98:99], v14 offset:384
    ds_read_b64_tr_b16 v[34:35], v15 offset:384
    ds_read_b64_tr_b16 a[92:93], v13 offset:12288
    ds_read_b64_tr_b16 a[100:101], v14 offset:12288
    ds_read_b64_tr_b16 v[36:37], v15 offset:12288
    ds_read_b64_tr_b16 a[94:95], v13 offset:12672
    ds_read_b64_tr_b16 a[102:103], v14 offset:12672
    ds_read_b64_tr_b16 v[38:39], v15 offset:12672
    s_waitcnt lgkmcnt(0)
    s_barrier
    s_mul_i32 s37, s92, 1
    s_add_u32 m0, s90, 98304
    s_nop 0
    buffer_load_dwordx4 v4, s[16:19], s37 offen nt lds
    s_add_u32 m0, s90, 99328
    s_nop 0
    buffer_load_dwordx4 v5, s[16:19], s37 offen nt lds
    s_add_u32 m0, s90, 100352
    s_nop 0
    buffer_load_dwordx4 v6, s[16:19], s37 offen nt lds
    s_add_u32 m0, s90, 101376
    s_nop 0
    buffer_load_dwordx4 v7, s[16:19], s37 offen nt lds
    s_add_u32 m0, s90, 102400
    s_nop 0
    buffer_load_dwordx4 v8, s[16:19], s37 offen nt lds
    s_add_u32 m0, s90, 103424
    s_nop 0
    buffer_load_dwordx4 v9, s[16:19], s37 offen nt lds
    s_waitcnt vmcnt(30)
    s_barrier
    v_add_u32 v13, 122880, v10
    v_add_u32 v14, 122880, v11
    v_add_u32 v15, 122880, v12
    ds_read_b64_tr_b16 a[104:105], v13 offset:0
    ds_read_b64_tr_b16 a[112:113], v14 offset:0
    ds_read_b64_tr_b16 a[120:121], v15 offset:0
    ds_read_b64_tr_b16 a[106:107], v13 offset:384
    ds_read_b64_tr_b16 a[114:115], v14 offset:384
    ds_read_b64_tr_b16 a[122:123], v15 offset:384
    ds_read_b64_tr_b16 a[108:109], v13 offset:12288
    ds_read_b64_tr_b16 a[116:117], v14 offset:12288
    ds_read_b64_tr_b16 a[124:125], v15 offset:12288
    ds_read_b64_tr_b16 a[110:111], v13 offset:12672
    ds_read_b64_tr_b16 a[118:119], v14 offset:12672
    ds_read_b64_tr_b16 a[126:127], v15 offset:12672
    s_waitcnt lgkmcnt(0)
    s_barrier
    s_mul_i32 s37, s92, 1
    s_add_u32 m0, s90, 122880
    s_nop 0
    buffer_load_dwordx4 v4, s[20:23], s37 offen nt lds
    s_add_u32 m0, s90, 123904
    s_nop 0
    buffer_load_dwordx4 v5, s[20:23], s37 offen nt lds
    s_add_u32 m0, s90, 124928
    s_nop 0
    buffer_load_dwordx4 v6, s[20:23], s37 offen nt lds
    s_add_u32 m0, s90, 125952
    s_nop 0
    buffer_load_dwordx4 v7, s[20:23], s37 offen nt lds
    s_add_u32 m0, s90, 126976
    s_nop 0
    buffer_load_dwordx4 v8, s[20:23], s37 offen nt lds
    s_add_u32 m0, s90, 128000
    s_nop 0
    buffer_load_dwordx4 v9, s[20:23], s37 offen nt lds
    s_waitcnt vmcnt(30)
    s_barrier
    v_add_u32 v13, 0, v10
    v_add_u32 v14, 0, v11
    v_add_u32 v15, 0, v12
    ds_read_b64_tr_b16 a[48:49], v13 offset:0
    ds_read_b64_tr_b16 a[56:57], v14 offset:0
    ds_read_b64_tr_b16 a[64:65], v15 offset:0
    ds_read_b64_tr_b16 a[50:51], v13 offset:384
    ds_read_b64_tr_b16 a[58:59], v14 offset:384
    ds_read_b64_tr_b16 a[66:67], v15 offset:384
    ds_read_b64_tr_b16 a[52:53], v13 offset:12288
    ds_read_b64_tr_b16 a[60:61], v14 offset:12288
    ds_read_b64_tr_b16 a[68:69], v15 offset:12288
    ds_read_b64_tr_b16 a[54:55], v13 offset:12672
    ds_read_b64_tr_b16 a[62:63], v14 offset:12672
    ds_read_b64_tr_b16 a[70:71], v15 offset:12672
    s_waitcnt lgkmcnt(0)
    s_barrier
    s_mul_i32 s37, s92, 0
    s_add_u32 m0, s90, 0
    s_nop 0
    buffer_load_dwordx4 v4, s[16:19], s37 offen nt lds
    s_add_u32 m0, s90, 1024
    s_nop 0
    buffer_load_dwordx4 v5, s[16:19], s37 offen nt lds
    s_add_u32 m0, s90, 2048
    s_nop 0
    buffer_load_dwordx4 v6, s[16:19], s37 offen nt lds
    s_add_u32 m0, s90, 3072
    s_nop 0
    buffer_load_dwordx4 v7, s[16:19], s37 offen nt lds
    s_add_u32 m0, s90, 4096
    s_nop 0
    buffer_load_dwordx4 v8, s[16:19], s37 offen nt lds
    s_add_u32 m0, s90, 5120
    s_nop 0
    buffer_load_dwordx4 v9, s[16:19], s37 offen nt lds
    s_waitcnt vmcnt(30)
    s_barrier
    v_add_u32 v13, 24576, v10
    v_add_u32 v14, 24576, v11
    v_add_u32 v15, 24576, v12
    ds_read_b64_tr_b16 a[72:73], v13 offset:0
    ds_read_b64_tr_b16 v[24:25], v14 offset:0
    ds_read_b64_tr_b16 a[80:81], v15 offset:0
    ds_read_b64_tr_b16 a[74:75], v13 offset:384
    ds_read_b64_tr_b16 v[26:27], v14 offset:384
    ds_read_b64_tr_b16 a[82:83], v15 offset:384
    ds_read_b64_tr_b16 a[76:77], v13 offset:12288
    ds_read_b64_tr_b16 v[28:29], v14 offset:12288
    ds_read_b64_tr_b16 a[84:85], v15 offset:12288
    ds_read_b64_tr_b16 a[78:79], v13 offset:12672
    ds_read_b64_tr_b16 v[30:31], v14 offset:12672
    ds_read_b64_tr_b16 a[86:87], v15 offset:12672
    s_waitcnt lgkmcnt(0)
    s_barrier
    s_mul_i32 s37, s92, 0
    s_add_u32 m0, s90, 24576
    s_nop 0
    buffer_load_dwordx4 v4, s[20:23], s37 offen nt lds
    s_add_u32 m0, s90, 25600
    s_nop 0
    buffer_load_dwordx4 v5, s[20:23], s37 offen nt lds
    s_add_u32 m0, s90, 26624
    s_nop 0
    buffer_load_dwordx4 v6, s[20:23], s37 offen nt lds
    s_add_u32 m0, s90, 27648
    s_nop 0
    buffer_load_dwordx4 v7, s[20:23], s37 offen nt lds
    s_add_u32 m0, s90, 28672
    s_nop 0
    buffer_load_dwordx4 v8, s[20:23], s37 offen nt lds
    s_add_u32 m0, s90, 29696
    s_nop 0
    buffer_load_dwordx4 v9, s[20:23], s37 offen nt lds
    s_waitcnt vmcnt(30)
    s_barrier
    v_add_u32 v13, 49152, v10
    v_add_u32 v14, 49152, v11
    v_add_u32 v15, 49152, v12
    ds_read_b64_tr_b16 a[0:1], v13 offset:0
    ds_read_b64_tr_b16 a[8:9], v14 offset:0
    ds_read_b64_tr_b16 a[16:17], v15 offset:0
    ds_read_b64_tr_b16 a[2:3], v13 offset:384
    ds_read_b64_tr_b16 a[10:11], v14 offset:384
    ds_read_b64_tr_b16 a[18:19], v15 offset:384
    ds_read_b64_tr_b16 a[4:5], v13 offset:12288
    ds_read_b64_tr_b16 a[12:13], v14 offset:12288
    ds_read_b64_tr_b16 a[20:21], v15 offset:12288
    ds_read_b64_tr_b16 a[6:7], v13 offset:12672
    ds_read_b64_tr_b16 a[14:15], v14 offset:12672
    ds_read_b64_tr_b16 a[22:23], v15 offset:12672
    s_waitcnt lgkmcnt(0)
    s_waitcnt vmcnt(24)
    s_barrier
    v_add_u32 v13, 73728, v10
    v_add_u32 v14, 73728, v11
    v_add_u32 v15, 73728, v12
    ds_read_b64_tr_b16 a[24:25], v13 offset:0
    ds_read_b64_tr_b16 a[32:33], v14 offset:0
    ds_read_b64_tr_b16 a[40:41], v15 offset:0
    ds_read_b64_tr_b16 a[26:27], v13 offset:384
    ds_read_b64_tr_b16 a[34:35], v14 offset:384
    ds_read_b64_tr_b16 a[42:43], v15 offset:384
    ds_read_b64_tr_b16 a[28:29], v13 offset:12288
    ds_read_b64_tr_b16 a[36:37], v14 offset:12288
    ds_read_b64_tr_b16 a[44:45], v15 offset:12288
    ds_read_b64_tr_b16 a[30:31], v13 offset:12672
    ds_read_b64_tr_b16 a[38:39], v14 offset:12672
    ds_read_b64_tr_b16 a[46:47], v15 offset:12672
    s_waitcnt lgkmcnt(0)
    s_waitcnt vmcnt(18)
    s_barrier
    v_add_u32 v13, 98304, v10
    v_add_u32 v14, 98304, v11
    v_add_u32 v15, 98304, v12
    ds_read_b64_tr_b16 a[192:193], v13 offset:0
    ds_read_b64_tr_b16 v[96:97], v14 offset:0
    ds_read_b64_tr_b16 v[248:249], v15 offset:0
    ds_read_b64_tr_b16 a[194:195], v13 offset:384
    ds_read_b64_tr_b16 v[98:99], v14 offset:384
    ds_read_b64_tr_b16 v[250:251], v15 offset:384
    ds_read_b64_tr_b16 a[196:197], v13 offset:12288
    ds_read_b64_tr_b16 v[100:101], v14 offset:12288
    ds_read_b64_tr_b16 v[252:253], v15 offset:12288
    ds_read_b64_tr_b16 a[198:199], v13 offset:12672
    ds_read_b64_tr_b16 v[102:103], v14 offset:12672
    ds_read_b64_tr_b16 v[254:255], v15 offset:12672
    s_waitcnt lgkmcnt(0)
    s_waitcnt vmcnt(12)
    s_barrier
    v_add_u32 v13, 122880, v10
    v_add_u32 v14, 122880, v11
    v_add_u32 v15, 122880, v12
    ds_read_b64_tr_b16 a[200:201], v13 offset:0
    ds_read_b64_tr_b16 v[168:169], v14 offset:0
    ds_read_b64_tr_b16 v[128:129], v15 offset:0
    ds_read_b64_tr_b16 a[202:203], v13 offset:384
    ds_read_b64_tr_b16 v[170:171], v14 offset:384
    ds_read_b64_tr_b16 v[130:131], v15 offset:384
    ds_read_b64_tr_b16 a[204:205], v13 offset:12288
    ds_read_b64_tr_b16 v[172:173], v14 offset:12288
    ds_read_b64_tr_b16 v[132:133], v15 offset:12288
    ds_read_b64_tr_b16 a[206:207], v13 offset:12672
    ds_read_b64_tr_b16 v[174:175], v14 offset:12672
    ds_read_b64_tr_b16 v[134:135], v15 offset:12672
    s_waitcnt lgkmcnt(0)
    s_waitcnt vmcnt(6)
    s_barrier
    v_add_u32 v13, 0, v10
    v_add_u32 v14, 0, v11
    v_add_u32 v15, 0, v12
    ds_read_b64_tr_b16 a[184:185], v13 offset:0
    ds_read_b64_tr_b16 v[152:153], v14 offset:0
    ds_read_b64_tr_b16 v[232:233], v15 offset:0
    ds_read_b64_tr_b16 a[186:187], v13 offset:384
    ds_read_b64_tr_b16 v[154:155], v14 offset:384
    ds_read_b64_tr_b16 v[234:235], v15 offset:384
    ds_read_b64_tr_b16 a[188:189], v13 offset:12288
    ds_read_b64_tr_b16 v[156:157], v14 offset:12288
    ds_read_b64_tr_b16 v[236:237], v15 offset:12288
    ds_read_b64_tr_b16 a[190:191], v13 offset:12672
    ds_read_b64_tr_b16 v[158:159], v14 offset:12672
    ds_read_b64_tr_b16 v[238:239], v15 offset:12672
    s_waitcnt lgkmcnt(0)
    s_waitcnt vmcnt(0)
    s_barrier
    v_add_u32 v13, 24576, v10
    v_add_u32 v14, 24576, v11
    v_add_u32 v15, 24576, v12
    ds_read_b64_tr_b16 v[64:65], v13 offset:0
    ds_read_b64_tr_b16 v[160:161], v14 offset:0
    ds_read_b64_tr_b16 v[240:241], v15 offset:0
    ds_read_b64_tr_b16 v[66:67], v13 offset:384
    ds_read_b64_tr_b16 v[162:163], v14 offset:384
    ds_read_b64_tr_b16 v[242:243], v15 offset:384
    ds_read_b64_tr_b16 v[68:69], v13 offset:12288
    ds_read_b64_tr_b16 v[164:165], v14 offset:12288
    ds_read_b64_tr_b16 v[244:245], v15 offset:12288
    ds_read_b64_tr_b16 v[70:71], v13 offset:12672
    ds_read_b64_tr_b16 v[166:167], v14 offset:12672
    ds_read_b64_tr_b16 v[246:247], v15 offset:12672
    s_waitcnt lgkmcnt(0)
    s_branch Lpw_102
Lpw_105:
    s_waitcnt vmcnt(30)
    s_barrier
    v_add_u32 v13, 0, v10
    v_add_u32 v14, 0, v11
    v_add_u32 v15, 0, v12
    ds_read_b64_tr_b16 a[136:137], v13 offset:0
    ds_read_b64_tr_b16 a[216:217], v14 offset:0
    ds_read_b64_tr_b16 v[104:105], v15 offset:0
    ds_read_b64_tr_b16 a[138:139], v13 offset:384
    ds_read_b64_tr_b16 a[218:219], v14 offset:384
    ds_read_b64_tr_b16 v[106:107], v15 offset:384
    ds_read_b64_tr_b16 a[140:141], v13 offset:12288
    ds_read_b64_tr_b16 a[220:221], v14 offset:12288
    ds_read_b64_tr_b16 v[108:109], v15 offset:12288
    ds_read_b64_tr_b16 a[142:143], v13 offset:12672
    ds_read_b64_tr_b16 a[222:223], v14 offset:12672
    ds_read_b64_tr_b16 v[110:111], v15 offset:12672
    s_waitcnt lgkmcnt(0)
    s_barrier
    s_mul_i32 s37, s92, 6
    s_add_u32 m0, s90, 0
    s_nop 0
    buffer_load_dwordx4 v4, s[16:19], s37 offen nt lds
    s_add_u32 m0, s90, 1024
    s_nop 0
    buffer_load_dwordx4 v5, s[16:19], s37 offen nt lds
    s_add_u32 m0, s90, 2048
    s_nop 0
    buffer_load_dwordx4 v6, s[16:19], s37 offen nt lds
    s_add_u32 m0, s90, 3072
    s_nop 0
    buffer_load_dwordx4 v7, s[16:19], s37 offen nt lds
    s_add_u32 m0, s90, 4096
    s_nop 0
    buffer_load_dwordx4 v8, s[16:19], s37 offen nt lds
    s_add_u32 m0, s90, 5120
    s_nop 0
    buffer_load_dwordx4 v9, s[16:19], s37 offen nt lds
    s_waitcnt vmcnt(30)
    s_barrier
    v_add_u32 v13, 24576, v10
    v_add_u32 v14, 24576, v11
    v_add_u32 v15, 24576, v12
    ds_read_b64_tr_b16 v[48:49], v13 offset:0
    ds_read_b64_tr_b16 a[224:225], v14 offset:0
    ds_read_b64_tr_b16 v[192:193], v15 offset:0
    ds_read_b64_tr_b16 v[50:51], v13 offset:384
    ds_read_b64_tr_b16 a[226:227], v14 offset:384
    ds_read_b64_tr_b16 v[194:195], v15 offset:384
    ds_read_b64_tr_b16 v[52:53], v13 offset:12288
    ds_read_b64_tr_b16 a[228:229], v14 offset:12288
    ds_read_b64_tr_b16 v[196:197], v15 offset:12288
    ds_read_b64_tr_b16 v[54:55], v13 offset:12672
    ds_read_b64_tr_b16 a[230:231], v14 offset:12672
    ds_read_b64_tr_b16 v[198:199], v15 offset:12672
    s_waitcnt lgkmcnt(0)
    s_barrier
    s_mul_i32 s37, s92, 6
    s_add_u32 m0, s90, 24576
    s_nop 0
    buffer_load_dwordx4 v4, s[20:23], s37 offen nt lds
    s_add_u32 m0, s90, 25600
    s_nop 0
    buffer_load_dwordx4 v5, s[20:23], s37 offen nt lds
    s_add_u32 m0, s90, 26624
    s_nop 0
    buffer_load_dwordx4 v6, s[20:23], s37 offen nt lds
    s_add_u32 m0, s90, 27648
    s_nop 0
    buffer_load_dwordx4 v7, s[20:23], s37 offen nt lds
    s_add_u32 m0, s90, 28672
    s_nop 0
    buffer_load_dwordx4 v8, s[20:23], s37 offen nt lds
    s_add_u32 m0, s90, 29696
    s_nop 0
    buffer_load_dwordx4 v9, s[20:23], s37 offen nt lds
    s_waitcnt vmcnt(30)
    s_barrier
    v_add_u32 v13, 49152, v10
    v_add_u32 v14, 49152, v11
    v_add_u32 v15, 49152, v12
    ds_read_b64_tr_b16 v[40:41], v13 offset:0
    ds_read_b64_tr_b16 a[208:209], v14 offset:0
    ds_read_b64_tr_b16 v[176:177], v15 offset:0
    ds_read_b64_tr_b16 v[42:43], v13 offset:384
    ds_read_b64_tr_b16 a[210:211], v14 offset:384
    ds_read_b64_tr_b16 v[178:179], v15 offset:384
    ds_read_b64_tr_b16 v[44:45], v13 offset:12288
    ds_read_b64_tr_b16 a[212:213], v14 offset:12288
    ds_read_b64_tr_b16 v[180:181], v15 offset:12288
    ds_read_b64_tr_b16 v[46:47], v13 offset:12672
    ds_read_b64_tr_b16 a[214:215], v14 offset:12672
    ds_read_b64_tr_b16 v[182:183], v15 offset:12672
    s_waitcnt lgkmcnt(0)
    s_barrier
    s_mul_i32 s37, s92, 5
    s_add_u32 m0, s90, 49152
    s_nop 0
    buffer_load_dwordx4 v4, s[16:19], s37 offen nt lds
    s_add_u32 m0, s90, 50176
    s_nop 0
    buffer_load_dwordx4 v5, s[16:19], s37 offen nt lds
    s_add_u32 m0, s90, 51200
    s_nop 0
    buffer_load_dwordx4 v6, s[16:19], s37 offen nt lds
    s_add_u32 m0, s90, 52224
    s_nop 0
    buffer_load_dwordx4 v7, s[16:19], s37 offen nt lds
    s_add_u32 m0, s90, 53248
    s_nop 0
    buffer_load_dwordx4 v8, s[16:19], s37 offen nt lds
    s_add_u32 m0, s90, 54272
    s_nop 0
    buffer_load_dwordx4 v9, s[16:19], s37 offen nt lds
    s_waitcnt vmcnt(30)
    s_barrier
    v_add_u32 v13, 73728, v10
    v_add_u32 v14, 73728, v11
    v_add_u32 v15, 73728, v12
    ds_read_b64_tr_b16 a[128:129], v13 offset:0
    ds_read_b64_tr_b16 v[72:73], v14 offset:0
    ds_read_b64_tr_b16 v[184:185], v15 offset:0
    ds_read_b64_tr_b16 a[130:131], v13 offset:384
    ds_read_b64_tr_b16 v[74:75], v14 offset:384
    ds_read_b64_tr_b16 v[186:187], v15 offset:384
    ds_read_b64_tr_b16 a[132:133], v13 offset:12288
    ds_read_b64_tr_b16 v[76:77], v14 offset:12288
    ds_read_b64_tr_b16 v[188:189], v15 offset:12288
    ds_read_b64_tr_b16 a[134:135], v13 offset:12672
    ds_read_b64_tr_b16 v[78:79], v14 offset:12672
    ds_read_b64_tr_b16 v[190:191], v15 offset:12672
    s_waitcnt lgkmcnt(0)
    s_barrier
    s_mul_i32 s37, s92, 5
    s_add_u32 m0, s90, 73728
    s_nop 0
    buffer_load_dwordx4 v4, s[20:23], s37 offen nt lds
    s_add_u32 m0, s90, 74752
    s_nop 0
    buffer_load_dwordx4 v5, s[20:23], s37 offen nt lds
    s_add_u32 m0, s90, 75776
    s_nop 0
    buffer_load_dwordx4 v6, s[20:23], s37 offen nt lds
    s_add_u32 m0, s90, 76800
    s_nop 0
    buffer_load_dwordx4 v7, s[20:23], s37 offen nt lds
    s_add_u32 m0, s90, 77824
    s_nop 0
    buffer_load_dwordx4 v8, s[20:23], s37 offen nt lds
    s_add_u32 m0, s90, 78848
    s_nop 0
    buffer_load_dwordx4 v9, s[20:23], s37 offen nt lds
    s_waitcnt vmcnt(30)
    s_barrier
    v_add_u32 v13, 98304, v10
    v_add_u32 v14, 98304, v11
    v_add_u32 v15, 98304, v12
    ds_read_b64_tr_b16 a[88:89], v13 offset:0
    ds_read_b64_tr_b16 a[96:97], v14 offset:0
    ds_read_b64_tr_b16 v[32:33], v15 offset:0
    ds_read_b64_tr_b16 a[90:91], v13 offset:384
    ds_read_b64_tr_b16 a[98:99], v14 offset:384
    ds_read_b64_tr_b16 v[34:35], v15 offset:384
    ds_read_b64_tr_b16 a[92:93], v13 offset:12288
    ds_read_b64_tr_b16 a[100:101], v14 offset:12288
    ds_read_b64_tr_b16 v[36:37], v15 offset:12288
    ds_read_b64_tr_b16 a[94:95], v13 offset:12672
    ds_read_b64_tr_b16 a[102:103], v14 offset:12672
    ds_read_b64_tr_b16 v[38:39], v15 offset:12672
    s_waitcnt lgkmcnt(0)
    s_barrier
    s_mul_i32 s37, s92, 4
    s_add_u32 m0, s90, 98304
    s_nop 0
    buffer_load_dwordx4 v4, s[16:19], s37 offen nt lds
    s_add_u32 m0, s90, 99328
    s_nop 0
    buffer_load_dwordx4 v5, s[16:19], s37 offen nt lds
    s_add_u32 m0, s90, 100352
    s_nop 0
    buffer_load_dwordx4 v6, s[16:19], s37 offen nt lds
    s_add_u32 m0, s90, 101376
    s_nop 0
    buffer_load_dwordx4 v7, s[16:19], s37 offen nt lds
    s_add_u32 m0, s90, 102400
    s_nop 0
    buffer_load_dwordx4 v8, s[16:19], s37 offen nt lds
    s_add_u32 m0, s90, 103424
    s_nop 0
    buffer_load_dwordx4 v9, s[16:19], s37 offen nt lds
    s_waitcnt vmcnt(30)
    s_barrier
    v_add_u32 v13, 122880, v10
    v_add_u32 v14, 122880, v11
    v_add_u32 v15, 122880, v12
    ds_read_b64_tr_b16 a[104:105], v13 offset:0
    ds_read_b64_tr_b16 a[112:113], v14 offset:0
    ds_read_b64_tr_b16 a[120:121], v15 offset:0
    ds_read_b64_tr_b16 a[106:107], v13 offset:384
    ds_read_b64_tr_b16 a[114:115], v14 offset:384
    ds_read_b64_tr_b16 a[122:123], v15 offset:384
    ds_read_b64_tr_b16 a[108:109], v13 offset:12288
    ds_read_b64_tr_b16 a[116:117], v14 offset:12288
    ds_read_b64_tr_b16 a[124:125], v15 offset:12288
    ds_read_b64_tr_b16 a[110:111], v13 offset:12672
    ds_read_b64_tr_b16 a[118:119], v14 offset:12672
    ds_read_b64_tr_b16 a[126:127], v15 offset:12672
    s_waitcnt lgkmcnt(0)
    s_barrier
    s_mul_i32 s37, s92, 4
    s_add_u32 m0, s90, 122880
    s_nop 0
    buffer_load_dwordx4 v4, s[20:23], s37 offen nt lds
    s_add_u32 m0, s90, 123904
    s_nop 0
    buffer_load_dwordx4 v5, s[20:23], s37 offen nt lds
    s_add_u32 m0, s90, 124928
    s_nop 0
    buffer_load_dwordx4 v6, s[20:23], s37 offen nt lds
    s_add_u32 m0, s90, 125952
    s_nop 0
    buffer_load_dwordx4 v7, s[20:23], s37 offen nt lds
    s_add_u32 m0, s90, 126976
    s_nop 0
    buffer_load_dwordx4 v8, s[20:23], s37 offen nt lds
    s_add_u32 m0, s90, 128000
    s_nop 0
    buffer_load_dwordx4 v9, s[20:23], s37 offen nt lds
    s_waitcnt vmcnt(30)
    s_barrier
    v_add_u32 v13, 0, v10
    v_add_u32 v14, 0, v11
    v_add_u32 v15, 0, v12
    ds_read_b64_tr_b16 a[48:49], v13 offset:0
    ds_read_b64_tr_b16 a[56:57], v14 offset:0
    ds_read_b64_tr_b16 a[64:65], v15 offset:0
    ds_read_b64_tr_b16 a[50:51], v13 offset:384
    ds_read_b64_tr_b16 a[58:59], v14 offset:384
    ds_read_b64_tr_b16 a[66:67], v15 offset:384
    ds_read_b64_tr_b16 a[52:53], v13 offset:12288
    ds_read_b64_tr_b16 a[60:61], v14 offset:12288
    ds_read_b64_tr_b16 a[68:69], v15 offset:12288
    ds_read_b64_tr_b16 a[54:55], v13 offset:12672
    ds_read_b64_tr_b16 a[62:63], v14 offset:12672
    ds_read_b64_tr_b16 a[70:71], v15 offset:12672
    s_waitcnt lgkmcnt(0)
    s_barrier
    s_mul_i32 s37, s92, 3
    s_add_u32 m0, s90, 0
    s_nop 0
    buffer_load_dwordx4 v4, s[16:19], s37 offen nt lds
    s_add_u32 m0, s90, 1024
    s_nop 0
    buffer_load_dwordx4 v5, s[16:19], s37 offen nt lds
    s_add_u32 m0, s90, 2048
    s_nop 0
    buffer_load_dwordx4 v6, s[16:19], s37 offen nt lds
    s_add_u32 m0, s90, 3072
    s_nop 0
    buffer_load_dwordx4 v7, s[16:19], s37 offen nt lds
    s_add_u32 m0, s90, 4096
    s_nop 0
    buffer_load_dwordx4 v8, s[16:19], s37 offen nt lds
    s_add_u32 m0, s90, 5120
    s_nop 0
    buffer_load_dwordx4 v9, s[16:19], s37 offen nt lds
    s_waitcnt vmcnt(30)
    s_barrier
    v_add_u32 v13, 24576, v10
    v_add_u32 v14, 24576, v11
    v_add_u32 v15, 24576, v12
    ds_read_b64_tr_b16 a[72:73], v13 offset:0
    ds_read_b64_tr_b16 v[24:25], v14 offset:0
    ds_read_b64_tr_b16 a[80:81], v15 offset:0
    ds_read_b64_tr_b16 a[74:75], v13 offset:384
    ds_read_b64_tr_b16 v[26:27], v14 offset:384
    ds_read_b64_tr_b16 a[82:83], v15 offset:384
    ds_read_b64_tr_b16 a[76:77], v13 offset:12288
    ds_read_b64_tr_b16 v[28:29], v14 offset:12288
    ds_read_b64_tr_b16 a[84:85], v15 offset:12288
    ds_read_b64_tr_b16 a[78:79], v13 offset:12672
    ds_read_b64_tr_b16 v[30:31], v14 offset:12672
    ds_read_b64_tr_b16 a[86:87], v15 offset:12672
    s_waitcnt lgkmcnt(0)
    s_barrier
    s_mul_i32 s37, s92, 3
    s_add_u32 m0, s90, 24576
    s_nop 0
    buffer_load_dwordx4 v4, s[20:23], s37 offen nt lds
    s_add_u32 m0, s90, 25600
    s_nop 0
    buffer_load_dwordx4 v5, s[20:23], s37 offen nt lds
    s_add_u32 m0, s90, 26624
    s_nop 0
    buffer_load_dwordx4 v6, s[20:23], s37 offen nt lds
    s_add_u32 m0, s90, 27648
    s_nop 0
    buffer_load_dwordx4 v7, s[20:23], s37 offen nt lds
    s_add_u32 m0, s90, 28672
    s_nop 0
    buffer_load_dwordx4 v8, s[20:23], s37 offen nt lds
    s_add_u32 m0, s90, 29696
    s_nop 0
    buffer_load_dwordx4 v9, s[20:23], s37 offen nt lds
    s_waitcnt vmcnt(30)
    s_barrier
    v_add_u32 v13, 49152, v10
    v_add_u32 v14, 49152, v11
    v_add_u32 v15, 49152, v12
    ds_read_b64_tr_b16 a[0:1], v13 offset:0
    ds_read_b64_tr_b16 a[8:9], v14 offset:0
    ds_read_b64_tr_b16 a[16:17], v15 offset:0
    ds_read_b64_tr_b16 a[2:3], v13 offset:384
    ds_read_b64_tr_b16 a[10:11], v14 offset:384
    ds_read_b64_tr_b16 a[18:19], v15 offset:384
    ds_read_b64_tr_b16 a[4:5], v13 offset:12288
    ds_read_b64_tr_b16 a[12:13], v14 offset:12288
    ds_read_b64_tr_b16 a[20:21], v15 offset:12288
    ds_read_b64_tr_b16 a[6:7], v13 offset:12672
    ds_read_b64_tr_b16 a[14:15], v14 offset:12672
    ds_read_b64_tr_b16 a[22:23], v15 offset:12672
    s_waitcnt lgkmcnt(0)
    s_barrier
    s_mul_i32 s37, s92, 2
    s_add_u32 m0, s90, 49152
    s_nop 0
    buffer_load_dwordx4 v4, s[16:19], s37 offen nt lds
    s_add_u32 m0, s90, 50176
    s_nop 0
    buffer_load_dwordx4 v5, s[16:19], s37 offen nt lds
    s_add_u32 m0, s90, 51200
    s_nop 0
    buffer_load_dwordx4 v6, s[16:19], s37 offen nt lds
    s_add_u32 m0, s90, 52224
    s_nop 0
    buffer_load_dwordx4 v7, s[16:19], s37 offen nt lds
    s_add_u32 m0, s90, 53248
    s_nop 0
    buffer_load_dwordx4 v8, s[16:19], s37 offen nt lds
    s_add_u32 m0, s90, 54272
    s_nop 0
    buffer_load_dwordx4 v9, s[16:19], s37 offen nt lds
    s_waitcnt vmcnt(30)
    s_barrier
    v_add_u32 v13, 73728, v10
    v_add_u32 v14, 73728, v11
    v_add_u32 v15, 73728, v12
    ds_read_b64_tr_b16 a[24:25], v13 offset:0
    ds_read_b64_tr_b16 a[32:33], v14 offset:0
    ds_read_b64_tr_b16 a[40:41], v15 offset:0
    ds_read_b64_tr_b16 a[26:27], v13 offset:384
    ds_read_b64_tr_b16 a[34:35], v14 offset:384
    ds_read_b64_tr_b16 a[42:43], v15 offset:384
    ds_read_b64_tr_b16 a[28:29], v13 offset:12288
    ds_read_b64_tr_b16 a[36:37], v14 offset:12288
    ds_read_b64_tr_b16 a[44:45], v15 offset:12288
    ds_read_b64_tr_b16 a[30:31], v13 offset:12672
    ds_read_b64_tr_b16 a[38:39], v14 offset:12672
    ds_read_b64_tr_b16 a[46:47], v15 offset:12672
    s_waitcnt lgkmcnt(0)
    s_barrier
    s_mul_i32 s37, s92, 2
    s_add_u32 m0, s90, 73728
    s_nop 0
    buffer_load_dwordx4 v4, s[20:23], s37 offen nt lds
    s_add_u32 m0, s90, 74752
    s_nop 0
    buffer_load_dwordx4 v5, s[20:23], s37 offen nt lds
    s_add_u32 m0, s90, 75776
    s_nop 0
    buffer_load_dwordx4 v6, s[20:23], s37 offen nt lds
    s_add_u32 m0, s90, 76800
    s_nop 0
    buffer_load_dwordx4 v7, s[20:23], s37 offen nt lds
    s_add_u32 m0, s90, 77824
    s_nop 0
    buffer_load_dwordx4 v8, s[20:23], s37 offen nt lds
    s_add_u32 m0, s90, 78848
    s_nop 0
    buffer_load_dwordx4 v9, s[20:23], s37 offen nt lds
    s_waitcnt vmcnt(30)
    s_barrier
    v_add_u32 v13, 98304, v10
    v_add_u32 v14, 98304, v11
    v_add_u32 v15, 98304, v12
    ds_read_b64_tr_b16 a[192:193], v13 offset:0
    ds_read_b64_tr_b16 v[96:97], v14 offset:0
    ds_read_b64_tr_b16 v[248:249], v15 offset:0
    ds_read_b64_tr_b16 a[194:195], v13 offset:384
    ds_read_b64_tr_b16 v[98:99], v14 offset:384
    ds_read_b64_tr_b16 v[250:251], v15 offset:384
    ds_read_b64_tr_b16 a[196:197], v13 offset:12288
    ds_read_b64_tr_b16 v[100:101], v14 offset:12288
    ds_read_b64_tr_b16 v[252:253], v15 offset:12288
    ds_read_b64_tr_b16 a[198:199], v13 offset:12672
    ds_read_b64_tr_b16 v[102:103], v14 offset:12672
    ds_read_b64_tr_b16 v[254:255], v15 offset:12672
    s_waitcnt lgkmcnt(0)
    s_barrier
    s_mul_i32 s37, s92, 1
    s_add_u32 m0, s90, 98304
    s_nop 0
    buffer_load_dwordx4 v4, s[16:19], s37 offen nt lds
    s_add_u32 m0, s90, 99328
    s_nop 0
    buffer_load_dwordx4 v5, s[16:19], s37 offen nt lds
    s_add_u32 m0, s90, 100352
    s_nop 0
    buffer_load_dwordx4 v6, s[16:19], s37 offen nt lds
    s_add_u32 m0, s90, 101376
    s_nop 0
    buffer_load_dwordx4 v7, s[16:19], s37 offen nt lds
    s_add_u32 m0, s90, 102400
    s_nop 0
    buffer_load_dwordx4 v8, s[16:19], s37 offen nt lds
    s_add_u32 m0, s90, 103424
    s_nop 0
    buffer_load_dwordx4 v9, s[16:19], s37 offen nt lds
    s_waitcnt vmcnt(30)
    s_barrier
    v_add_u32 v13, 122880, v10
    v_add_u32 v14, 122880, v11
    v_add_u32 v15, 122880, v12
    ds_read_b64_tr_b16 a[200:201], v13 offset:0
    ds_read_b64_tr_b16 v[168:169], v14 offset:0
    ds_read_b64_tr_b16 v[128:129], v15 offset:0
    ds_read_b64_tr_b16 a[202:203], v13 offset:384
    ds_read_b64_tr_b16 v[170:171], v14 offset:384
    ds_read_b64_tr_b16 v[130:131], v15 offset:384
    ds_read_b64_tr_b16 a[204:205], v13 offset:12288
    ds_read_b64_tr_b16 v[172:173], v14 offset:12288
    ds_read_b64_tr_b16 v[132:133], v15 offset:12288
    ds_read_b64_tr_b16 a[206:207], v13 offset:12672
    ds_read_b64_tr_b16 v[174:175], v14 offset:12672
    ds_read_b64_tr_b16 v[134:135], v15 offset:12672
    s_waitcnt lgkmcnt(0)
    s_barrier
    s_mul_i32 s37, s92, 1
    s_add_u32 m0, s90, 122880
    s_nop 0
    buffer_load_dwordx4 v4, s[20:23], s37 offen nt lds
    s_add_u32 m0, s90, 123904
    s_nop 0
    buffer_load_dwordx4 v5, s[20:23], s37 offen nt lds
    s_add_u32 m0, s90, 124928
    s_nop 0
    buffer_load_dwordx4 v6, s[20:23], s37 offen nt lds
    s_add_u32 m0, s90, 125952
    s_nop 0
    buffer_load_dwordx4 v7, s[20:23], s37 offen nt lds
    s_add_u32 m0, s90, 126976
    s_nop 0
    buffer_load_dwordx4 v8, s[20:23], s37 offen nt lds
    s_add_u32 m0, s90, 128000
    s_nop 0
    buffer_load_dwordx4 v9, s[20:23], s37 offen nt lds
    s_waitcnt vmcnt(30)
    s_barrier
    v_add_u32 v13, 0, v10
    v_add_u32 v14, 0, v11
    v_add_u32 v15, 0, v12
    ds_read_b64_tr_b16 a[184:185], v13 offset:0
    ds_read_b64_tr_b16 v[152:153], v14 offset:0
    ds_read_b64_tr_b16 v[232:233], v15 offset:0
    ds_read_b64_tr_b16 a[186:187], v13 offset:384
    ds_read_b64_tr_b16 v[154:155], v14 offset:384
    ds_read_b64_tr_b16 v[234:235], v15 offset:384
    ds_read_b64_tr_b16 a[188:189], v13 offset:12288
    ds_read_b64_tr_b16 v[156:157], v14 offset:12288
    ds_read_b64_tr_b16 v[236:237], v15 offset:12288
    ds_read_b64_tr_b16 a[190:191], v13 offset:12672
    ds_read_b64_tr_b16 v[158:159], v14 offset:12672
    ds_read_b64_tr_b16 v[238:239], v15 offset:12672
    s_waitcnt lgkmcnt(0)
    s_barrier
    s_mul_i32 s37, s92, 0
    s_add_u32 m0, s90, 0
    s_nop 0
    buffer_load_dwordx4 v4, s[16:19], s37 offen nt lds
    s_add_u32 m0, s90, 1024
    s_nop 0
    buffer_load_dwordx4 v5, s[16:19], s37 offen nt lds
    s_add_u32 m0, s90, 2048
    s_nop 0
    buffer_load_dwordx4 v6, s[16:19], s37 offen nt lds
    s_add_u32 m0, s90, 3072
    s_nop 0
    buffer_load_dwordx4 v7, s[16:19], s37 offen nt lds
    s_add_u32 m0, s90, 4096
    s_nop 0
    buffer_load_dwordx4 v8, s[16:19], s37 offen nt lds
    s_add_u32 m0, s90, 5120
    s_nop 0
    buffer_load_dwordx4 v9, s[16:19], s37 offen nt lds
    s_waitcnt vmcnt(30)
    s_barrier
    v_add_u32 v13, 24576, v10
    v_add_u32 v14, 24576, v11
    v_add_u32 v15, 24576, v12
    ds_read_b64_tr_b16 v[64:65], v13 offset:0
    ds_read_b64_tr_b16 v[160:161], v14 offset:0
    ds_read_b64_tr_b16 v[240:241], v15 offset:0
    ds_read_b64_tr_b16 v[66:67], v13 offset:384
    ds_read_b64_tr_b16 v[162:163], v14 offset:384
    ds_read_b64_tr_b16 v[242:243], v15 offset:384
    ds_read_b64_tr_b16 v[68:69], v13 offset:12288
    ds_read_b64_tr_b16 v[164:165], v14 offset:12288
    ds_read_b64_tr_b16 v[244:245], v15 offset:12288
    ds_read_b64_tr_b16 v[70:71], v13 offset:12672
    ds_read_b64_tr_b16 v[166:167], v14 offset:12672
    ds_read_b64_tr_b16 v[246:247], v15 offset:12672
    s_waitcnt lgkmcnt(0)
    s_barrier
    s_mul_i32 s37, s92, 0
    s_add_u32 m0, s90, 24576
    s_nop 0
    buffer_load_dwordx4 v4, s[20:23], s37 offen nt lds
    s_add_u32 m0, s90, 25600
    s_nop 0
    buffer_load_dwordx4 v5, s[20:23], s37 offen nt lds
    s_add_u32 m0, s90, 26624
    s_nop 0
    buffer_load_dwordx4 v6, s[20:23], s37 offen nt lds
    s_add_u32 m0, s90, 27648
    s_nop 0
    buffer_load_dwordx4 v7, s[20:23], s37 offen nt lds
    s_add_u32 m0, s90, 28672
    s_nop 0
    buffer_load_dwordx4 v8, s[20:23], s37 offen nt lds
    s_add_u32 m0, s90, 29696
    s_nop 0
    buffer_load_dwordx4 v9, s[20:23], s37 offen nt lds
    s_waitcnt vmcnt(30)
    s_barrier
    v_add_u32 v13, 49152, v10
    v_add_u32 v14, 49152, v11
    v_add_u32 v15, 49152, v12
    ds_read_b64_tr_b16 a[168:169], v13 offset:0
    ds_read_b64_tr_b16 v[88:89], v14 offset:0
    ds_read_b64_tr_b16 v[224:225], v15 offset:0
    ds_read_b64_tr_b16 a[170:171], v13 offset:384
    ds_read_b64_tr_b16 v[90:91], v14 offset:384
    ds_read_b64_tr_b16 v[226:227], v15 offset:384
    ds_read_b64_tr_b16 a[172:173], v13 offset:12288
    ds_read_b64_tr_b16 v[92:93], v14 offset:12288
    ds_read_b64_tr_b16 v[228:229], v15 offset:12288
    ds_read_b64_tr_b16 a[174:175], v13 offset:12672
    ds_read_b64_tr_b16 v[94:95], v14 offset:12672
    ds_read_b64_tr_b16 v[230:231], v15 offset:12672
    s_waitcnt lgkmcnt(0)
    s_waitcnt vmcnt(24)
    s_barrier
    v_add_u32 v13, 73728, v10
    v_add_u32 v14, 73728, v11
    v_add_u32 v15, 73728, v12
    ds_read_b64_tr_b16 a[176:177], v13 offset:0
    ds_read_b64_tr_b16 v[144:145], v14 offset:0
    ds_read_b64_tr_b16 v[120:121], v15 offset:0
    ds_read_b64_tr_b16 a[178:179], v13 offset:384
    ds_read_b64_tr_b16 v[146:147], v14 offset:384
    ds_read_b64_tr_b16 v[122:123], v15 offset:384
    ds_read_b64_tr_b16 a[180:181], v13 offset:12288
    ds_read_b64_tr_b16 v[148:149], v14 offset:12288
    ds_read_b64_tr_b16 v[124:125], v15 offset:12288
    ds_read_b64_tr_b16 a[182:183], v13 offset:12672
    ds_read_b64_tr_b16 v[150:151], v14 offset:12672
    ds_read_b64_tr_b16 v[126:127], v15 offset:12672
    s_waitcnt lgkmcnt(0)
    s_waitcnt vmcnt(18)
    s_barrier
    v_add_u32 v13, 98304, v10
    v_add_u32 v14, 98304, v11
    v_add_u32 v15, 98304, v12
    ds_read_b64_tr_b16 a[160:161], v13 offset:0
    ds_read_b64_tr_b16 a[240:241], v14 offset:0
    ds_read_b64_tr_b16 v[208:209], v15 offset:0
    ds_read_b64_tr_b16 a[162:163], v13 offset:384
    ds_read_b64_tr_b16 a[242:243], v14 offset:384
    ds_read_b64_tr_b16 v[210:211], v15 offset:384
    ds_read_b64_tr_b16 a[164:165], v13 offset:12288
    ds_read_b64_tr_b16 a[244:245], v14 offset:12288
    ds_read_b64_tr_b16 v[212:213], v15 offset:12288
    ds_read_b64_tr_b16 a[166:167], v13 offset:12672
    ds_read_b64_tr_b16 a[246:247], v14 offset:12672
    ds_read_b64_tr_b16 v[214:215], v15 offset:12672
    s_waitcnt lgkmcnt(0)
    s_waitcnt vmcnt(12)
    s_barrier
    v_add_u32 v13, 122880, v10
    v_add_u32 v14, 122880, v11
    v_add_u32 v15, 122880, v12
    ds_read_b64_tr_b16 v[56:57], v13 offset:0
    ds_read_b64_tr_b16 a[248:249], v14 offset:0
    ds_read_b64_tr_b16 v[216:217], v15 offset:0
    ds_read_b64_tr_b16 v[58:59], v13 offset:384
    ds_read_b64_tr_b16 a[250:251], v14 offset:384
    ds_read_b64_tr_b16 v[218:219], v15 offset:384
    ds_read_b64_tr_b16 v[60:61], v13 offset:12288
    ds_read_b64_tr_b16 a[252:253], v14 offset:12288
    ds_read_b64_tr_b16 v[220:221], v15 offset:12288
    ds_read_b64_tr_b16 v[62:63], v13 offset:12672
    ds_read_b64_tr_b16 a[254:255], v14 offset:12672
    ds_read_b64_tr_b16 v[222:223], v15 offset:12672
    s_waitcnt lgkmcnt(0)
    s_waitcnt vmcnt(6)
    s_barrier
    v_add_u32 v13, 0, v10
    v_add_u32 v14, 0, v11
    v_add_u32 v15, 0, v12
    ds_read_b64_tr_b16 a[144:145], v13 offset:0
    ds_read_b64_tr_b16 v[80:81], v14 offset:0
    ds_read_b64_tr_b16 v[200:201], v15 offset:0
    ds_read_b64_tr_b16 a[146:147], v13 offset:384
    ds_read_b64_tr_b16 v[82:83], v14 offset:384
    ds_read_b64_tr_b16 v[202:203], v15 offset:384
    ds_read_b64_tr_b16 a[148:149], v13 offset:12288
    ds_read_b64_tr_b16 v[84:85], v14 offset:12288
    ds_read_b64_tr_b16 v[204:205], v15 offset:12288
    ds_read_b64_tr_b16 a[150:151], v13 offset:12672
    ds_read_b64_tr_b16 v[86:87], v14 offset:12672
    ds_read_b64_tr_b16 v[206:207], v15 offset:12672
    s_waitcnt lgkmcnt(0)
    s_waitcnt vmcnt(0)
    s_barrier
    v_add_u32 v13, 24576, v10
    v_add_u32 v14, 24576, v11
    v_add_u32 v15, 24576, v12
    ds_read_b64_tr_b16 a[152:153], v13 offset:0
    ds_read_b64_tr_b16 a[232:233], v14 offset:0
    ds_read_b64_tr_b16 v[112:113], v15 offset:0
    ds_read_b64_tr_b16 a[154:155], v13 offset:384
    ds_read_b64_tr_b16 a[234:235], v14 offset:384
    ds_read_b64_tr_b16 v[114:115], v15 offset:384
    ds_read_b64_tr_b16 a[156:157], v13 offset:12288
    ds_read_b64_tr_b16 a[236:237], v14 offset:12288
    ds_read_b64_tr_b16 v[116:117], v15 offset:12288
    ds_read_b64_tr_b16 a[158:159], v13 offset:12672
    ds_read_b64_tr_b16 a[238:239], v14 offset:12672
    ds_read_b64_tr_b16 v[118:119], v15 offset:12672
    s_waitcnt lgkmcnt(0)
    s_branch Lpw_102
Lpw_106:
    s_waitcnt vmcnt(30)
    s_barrier
    v_add_u32 v13, 0, v10
    v_add_u32 v14, 0, v11
    v_add_u32 v15, 0, v12
    ds_read_b64_tr_b16 a[88:89], v13 offset:0
    ds_read_b64_tr_b16 a[96:97], v14 offset:0
    ds_read_b64_tr_b16 v[32:33], v15 offset:0
    ds_read_b64_tr_b16 a[90:91], v13 offset:384
    ds_read_b64_tr_b16 a[98:99], v14 offset:384
    ds_read_b64_tr_b16 v[34:35], v15 offset:384
    ds_read_b64_tr_b16 a[92:93], v13 offset:12288
    ds_read_b64_tr_b16 a[100:101], v14 offset:12288
    ds_read_b64_tr_b16 v[36:37], v15 offset:12288
    ds_read_b64_tr_b16 a[94:95], v13 offset:12672
    ds_read_b64_tr_b16 a[102:103], v14 offset:12672
    ds_read_b64_tr_b16 v[38:39], v15 offset:12672
    s_waitcnt lgkmcnt(0)
    s_barrier
    s_mul_i32 s37, s92, 6
    s_add_u32 m0, s90, 0
    s_nop 0
    buffer_load_dwordx4 v4, s[16:19], s37 offen nt lds
    s_add_u32 m0, s90, 1024
    s_nop 0
    buffer_load_dwordx4 v5, s[16:19], s37 offen nt lds
    s_add_u32 m0, s90, 2048
    s_nop 0
    buffer_load_dwordx4 v6, s[16:19], s37 offen nt lds
    s_add_u32 m0, s90, 3072
    s_nop 0
    buffer_load_dwordx4 v7, s[16:19], s37 offen nt lds
    s_add_u32 m0, s90, 4096
    s_nop 0
    buffer_load_dwordx4 v8, s[16:19], s37 offen nt lds
    s_add_u32 m0, s90, 5120
    s_nop 0
    buffer_load_dwordx4 v9, s[16:19], s37 offen nt lds
    s_waitcnt vmcnt(30)
    s_barrier
    v_add_u32 v13, 24576, v10
    v_add_u32 v14, 24576, v11
    v_add_u32 v15, 24576, v12
    ds_read_b64_tr_b16 a[104:105], v13 offset:0
    ds_read_b64_tr_b16 a[112:113], v14 offset:0
    ds_read_b64_tr_b16 a[120:121], v15 offset:0
    ds_read_b64_tr_b16 a[106:107], v13 offset:384
    ds_read_b64_tr_b16 a[114:115], v14 offset:384
    ds_read_b64_tr_b16 a[122:123], v15 offset:384
    ds_read_b64_tr_b16 a[108:109], v13 offset:12288
    ds_read_b64_tr_b16 a[116:117], v14 offset:12288
    ds_read_b64_tr_b16 a[124:125], v15 offset:12288
    ds_read_b64_tr_b16 a[110:111], v13 offset:12672
    ds_read_b64_tr_b16 a[118:119], v14 offset:12672
    ds_read_b64_tr_b16 a[126:127], v15 offset:12672
    s_waitcnt lgkmcnt(0)
    s_barrier
    s_mul_i32 s37, s92, 6
    s_add_u32 m0, s90, 24576
    s_nop 0
    buffer_load_dwordx4 v4, s[20:23], s37 offen nt lds
    s_add_u32 m0, s90, 25600
    s_nop 0
    buffer_load_dwordx4 v5, s[20:23], s37 offen nt lds
    s_add_u32 m0, s90, 26624
    s_nop 0
    buffer_load_dwordx4 v6, s[20:23], s37 offen nt lds
    s_add_u32 m0, s90, 27648
    s_nop 0
    buffer_load_dwordx4 v7, s[20:23], s37 offen nt lds
    s_add_u32 m0, s90, 28672
    s_nop 0
    buffer_load_dwordx4 v8, s[20:23], s37 offen nt lds
    s_add_u32 m0, s90, 29696
    s_nop 0
    buffer_load_dwordx4 v9, s[20:23], s37 offen nt lds
    s_waitcnt vmcnt(30)
    s_barrier
    v_add_u32 v13, 49152, v10
    v_add_u32 v14, 49152, v11
    v_add_u32 v15, 49152, v12
    ds_read_b64_tr_b16 a[48:49], v13 offset:0
    ds_read_b64_tr_b16 a[56:57], v14 offset:0
    ds_read_b64_tr_b16 a[64:65], v15 offset:0
    ds_read_b64_tr_b16 a[50:51], v13 offset:384
    ds_read_b64_tr_b16 a[58:59], v14 offset:384
    ds_read_b64_tr_b16 a[66:67], v15 offset:384
    ds_read_b64_tr_b16 a[52:53], v13 offset:12288
    ds_read_b64_tr_b16 a[60:61], v14 offset:12288
    ds_read_b64_tr_b16 a[68:69], v15 offset:12288
    ds_read_b64_tr_b16 a[54:55], v13 offset:12672
    ds_read_b64_tr_b16 a[62:63], v14 offset:12672
    ds_read_b64_tr_b16 a[70:71], v15 offset:12672
    s_waitcnt lgkmcnt(0)
    s_barrier
    s_mul_i32 s37, s92, 5
    s_add_u32 m0, s90, 49152
    s_nop 0
    buffer_load_dwordx4 v4, s[16:19], s37 offen nt lds
    s_add_u32 m0, s90, 50176
    s_nop 0
    buffer_load_dwordx4 v5, s[16:19], s37 offen nt lds
    s_add_u32 m0, s90, 51200
    s_nop 0
    buffer_load_dwordx4 v6, s[16:19], s37 offen nt lds
    s_add_u32 m0, s90, 52224
    s_nop 0
    buffer_load_dwordx4 v7, s[16:19], s37 offen nt lds
    s_add_u32 m0, s90, 53248
    s_nop 0
    buffer_load_dwordx4 v8, s[16:19], s37 offen nt lds
    s_add_u32 m0, s90, 54272
    s_nop 0
    buffer_load_dwordx4 v9, s[16:19], s37 offen nt lds
    s_waitcnt vmcnt(30)
    s_barrier
    v_add_u32 v13, 73728, v10
    v_add_u32 v14, 73728, v11
    v_add_u32 v15, 73728, v12
    ds_read_b64_tr_b16 a[72:73], v13 offset:0
    ds_read_b64_tr_b16 v[24:25], v14 offset:0
    ds_read_b64_tr_b16 a[80:81], v15 offset:0
    ds_read_b64_tr_b16 a[74:75], v13 offset:384
    ds_read_b64_tr_b16 v[26:27], v14 offset:384
    ds_read_b64_tr_b16 a[82:83], v15 offset:384
    ds_read_b64_tr_b16 a[76:77], v13 offset:12288
    ds_read_b64_tr_b16 v[28:29], v14 offset:12288
    ds_read_b64_tr_b16 a[84:85], v15 offset:12288
    ds_read_b64_tr_b16 a[78:79], v13 offset:12672
    ds_read_b64_tr_b16 v[30:31], v14 offset:12672
    ds_read_b64_tr_b16 a[86:87], v15 offset:12672
    s_waitcnt lgkmcnt(0)
    s_barrier
    s_mul_i32 s37, s92, 5
    s_add_u32 m0, s90, 73728
    s_nop 0
    buffer_load_dwordx4 v4, s[20:23], s37 offen nt lds
    s_add_u32 m0, s90, 74752
    s_nop 0
    buffer_load_dwordx4 v5, s[20:23], s37 offen nt lds
    s_add_u32 m0, s90, 75776
    s_nop 0
    buffer_load_dwordx4 v6, s[20:23], s37 offen nt lds
    s_add_u32 m0, s90, 76800
    s_nop 0
    buffer_load_dwordx4 v7, s[20:23], s37 offen nt lds
    s_add_u32 m0, s90, 77824
    s_nop 0
    buffer_load_dwordx4 v8, s[20:23], s37 offen nt lds
    s_add_u32 m0, s90, 78848
    s_nop 0
    buffer_load_dwordx4 v9, s[20:23], s37 offen nt lds
    s_waitcnt vmcnt(30)
    s_barrier
    v_add_u32 v13, 98304, v10
    v_add_u32 v14, 98304, v11
    v_add_u32 v15, 98304, v12
    ds_read_b64_tr_b16 a[0:1], v13 offset:0
    ds_read_b64_tr_b16 a[8:9], v14 offset:0
    ds_read_b64_tr_b16 a[16:17], v15 offset:0
    ds_read_b64_tr_b16 a[2:3], v13 offset:384
    ds_read_b64_tr_b16 a[10:11], v14 offset:384
    ds_read_b64_tr_b16 a[18:19], v15 offset:384
    ds_read_b64_tr_b16 a[4:5], v13 offset:12288
    ds_read_b64_tr_b16 a[12:13], v14 offset:12288
    ds_read_b64_tr_b16 a[20:21], v15 offset:12288
    ds_read_b64_tr_b16 a[6:7], v13 offset:12672
    ds_read_b64_tr_b16 a[14:15], v14 offset:12672
    ds_read_b64_tr_b16 a[22:23], v15 offset:12672
    s_waitcnt lgkmcnt(0)
    s_barrier
    s_mul_i32 s37, s92, 4
    s_add_u32 m0, s90, 98304
    s_nop 0
    buffer_load_dwordx4 v4, s[16:19], s37 offen nt lds
    s_add_u32 m0, s90, 99328
    s_nop 0
    buffer_load_dwordx4 v5, s[16:19], s37 offen nt lds
    s_add_u32 m0, s90, 100352
    s_nop 0
    buffer_load_dwordx4 v6, s[16:19], s37 offen nt lds
    s_add_u32 m0, s90, 101376
    s_nop 0
    buffer_load_dwordx4 v7, s[16:19], s37 offen nt lds
    s_add_u32 m0, s90, 102400
    s_nop 0
    buffer_load_dwordx4 v8, s[16:19], s37 offen nt lds
    s_add_u32 m0, s90, 103424
    s_nop 0
    buffer_load_dwordx4 v9, s[16:19], s37 offen nt lds
    s_waitcnt vmcnt(30)
    s_barrier
    v_add_u32 v13, 122880, v10
    v_add_u32 v14, 122880, v11
    v_add_u32 v15, 122880, v12
    ds_read_b64_tr_b16 a[24:25], v13 offset:0
    ds_read_b64_tr_b16 a[32:33], v14 offset:0
    ds_read_b64_tr_b16 a[40:41], v15 offset:0
    ds_read_b64_tr_b16 a[26:27], v13 offset:384
    ds_read_b64_tr_b16 a[34:35], v14 offset:384
    ds_read_b64_tr_b16 a[42:43], v15 offset:384
    ds_read_b64_tr_b16 a[28:29], v13 offset:12288
    ds_read_b64_tr_b16 a[36:37], v14 offset:12288
    ds_read_b64_tr_b16 a[44:45], v15 offset:12288
    ds_read_b64_tr_b16 a[30:31], v13 offset:12672
    ds_read_b64_tr_b16 a[38:39], v14 offset:12672
    ds_read_b64_tr_b16 a[46:47], v15 offset:12672
    s_waitcnt lgkmcnt(0)
    s_barrier
    s_mul_i32 s37, s92, 4
    s_add_u32 m0, s90, 122880
    s_nop 0
    buffer_load_dwordx4 v4, s[20:23], s37 offen nt lds
    s_add_u32 m0, s90, 123904
    s_nop 0
    buffer_load_dwordx4 v5, s[20:23], s37 offen nt lds
    s_add_u32 m0, s90, 124928
    s_nop 0
    buffer_load_dwordx4 v6, s[20:23], s37 offen nt lds
    s_add_u32 m0, s90, 125952
    s_nop 0
    buffer_load_dwordx4 v7, s[20:23], s37 offen nt lds
    s_add_u32 m0, s90, 126976
    s_nop 0
    buffer_load_dwordx4 v8, s[20:23], s37 offen nt lds
    s_add_u32 m0, s90, 128000
    s_nop 0
    buffer_load_dwordx4 v9, s[20:23], s37 offen nt lds
    s_waitcnt vmcnt(30)
    s_barrier
    v_add_u32 v13, 0, v10
    v_add_u32 v14, 0, v11
    v_add_u32 v15, 0, v12
    ds_read_b64_tr_b16 a[192:193], v13 offset:0
    ds_read_b64_tr_b16 v[96:97], v14 offset:0
    ds_read_b64_tr_b16 v[248:249], v15 offset:0
    ds_read_b64_tr_b16 a[194:195], v13 offset:384
    ds_read_b64_tr_b16 v[98:99], v14 offset:384
    ds_read_b64_tr_b16 v[250:251], v15 offset:384
    ds_read_b64_tr_b16 a[196:197], v13 offset:12288
    ds_read_b64_tr_b16 v[100:101], v14 offset:12288
    ds_read_b64_tr_b16 v[252:253], v15 offset:12288
    ds_read_b64_tr_b16 a[198:199], v13 offset:12672
    ds_read_b64_tr_b16 v[102:103], v14 offset:12672
    ds_read_b64_tr_b16 v[254:255], v15 offset:12672
    s_waitcnt lgkmcnt(0)
    s_barrier
    s_mul_i32 s37, s92, 3
    s_add_u32 m0, s90, 0
    s_nop 0
    buffer_load_dwordx4 v4, s[16:19], s37 offen nt lds
    s_add_u32 m0, s90, 1024
    s_nop 0
    buffer_load_dwordx4 v5, s[16:19], s37 offen nt lds
    s_add_u32 m0, s90, 2048
    s_nop 0
    buffer_load_dwordx4 v6, s[16:19], s37 offen nt lds
    s_add_u32 m0, s90, 3072
    s_nop 0
    buffer_load_dwordx4 v7, s[16:19], s37 offen nt lds
    s_add_u32 m0, s90, 4096
    s_nop 0
    buffer_load_dwordx4 v8, s[16:19], s37 offen nt lds
    s_add_u32 m0, s90, 5120
    s_nop 0
    buffer_load_dwordx4 v9, s[16:19], s37 offen nt lds
    s_waitcnt vmcnt(30)
    s_barrier
    v_add_u32 v13, 24576, v10
    v_add_u32 v14, 24576, v11
    v_add_u32 v15, 24576, v12
    ds_read_b64_tr_b16 a[200:201], v13 offset:0
    ds_read_b64_tr_b16 v[168:169], v14 offset:0
    ds_read_b64_tr_b16 v[128:129], v15 offset:0
    ds_read_b64_tr_b16 a[202:203], v13 offset:384
    ds_read_b64_tr_b16 v[170:171], v14 offset:384
    ds_read_b64_tr_b16 v[130:131], v15 offset:384
    ds_read_b64_tr_b16 a[204:205], v13 offset:12288
    ds_read_b64_tr_b16 v[172:173], v14 offset:12288
    ds_read_b64_tr_b16 v[132:133], v15 offset:12288
    ds_read_b64_tr_b16 a[206:207], v13 offset:12672
    ds_read_b64_tr_b16 v[174:175], v14 offset:12672
    ds_read_b64_tr_b16 v[134:135], v15 offset:12672
    s_waitcnt lgkmcnt(0)
    s_barrier
    s_mul_i32 s37, s92, 3
    s_add_u32 m0, s90, 24576
    s_nop 0
    buffer_load_dwordx4 v4, s[20:23], s37 offen nt lds
    s_add_u32 m0, s90, 25600
    s_nop 0
    buffer_load_dwordx4 v5, s[20:23], s37 offen nt lds
    s_add_u32 m0, s90, 26624
    s_nop 0
    buffer_load_dwordx4 v6, s[20:23], s37 offen nt lds
    s_add_u32 m0, s90, 27648
    s_nop 0
    buffer_load_dwordx4 v7, s[20:23], s37 offen nt lds
    s_add_u32 m0, s90, 28672
    s_nop 0
    buffer_load_dwordx4 v8, s[20:23], s37 offen nt lds
    s_add_u32 m0, s90, 29696
    s_nop 0
    buffer_load_dwordx4 v9, s[20:23], s37 offen nt lds
    s_waitcnt vmcnt(30)
    s_barrier
    v_add_u32 v13, 49152, v10
    v_add_u32 v14, 49152, v11
    v_add_u32 v15, 49152, v12
    ds_read_b64_tr_b16 a[184:185], v13 offset:0
    ds_read_b64_tr_b16 v[152:153], v14 offset:0
    ds_read_b64_tr_b16 v[232:233], v15 offset:0
    ds_read_b64_tr_b16 a[186:187], v13 offset:384
    ds_read_b64_tr_b16 v[154:155], v14 offset:384
    ds_read_b64_tr_b16 v[234:235], v15 offset:384
    ds_read_b64_tr_b16 a[188:189], v13 offset:12288
    ds_read_b64_tr_b16 v[156:157], v14 offset:12288
    ds_read_b64_tr_b16 v[236:237], v15 offset:12288
    ds_read_b64_tr_b16 a[190:191], v13 offset:12672
    ds_read_b64_tr_b16 v[158:159], v14 offset:12672
    ds_read_b64_tr_b16 v[238:239], v15 offset:12672
    s_waitcnt lgkmcnt(0)
    s_barrier
    s_mul_i32 s37, s92, 2
    s_add_u32 m0, s90, 49152
    s_nop 0
    buffer_load_dwordx4 v4, s[16:19], s37 offen nt lds
    s_add_u32 m0, s90, 50176
    s_nop 0
    buffer_load_dwordx4 v5, s[16:19], s37 offen nt lds
    s_add_u32 m0, s90, 51200
    s_nop 0
    buffer_load_dwordx4 v6, s[16:19], s37 offen nt lds
    s_add_u32 m0, s90, 52224
    s_nop 0
    buffer_load_dwordx4 v7, s[16:19], s37 offen nt lds
    s_add_u32 m0, s90, 53248
    s_nop 0
    buffer_load_dwordx4 v8, s[16:19], s37 offen nt lds
    s_add_u32 m0, s90, 54272
    s_nop 0
    buffer_load_dwordx4 v9, s[16:19], s37 offen nt lds
    s_waitcnt vmcnt(30)
    s_barrier
    v_add_u32 v13, 73728, v10
    v_add_u32 v14, 73728, v11
    v_add_u32 v15, 73728, v12
    ds_read_b64_tr_b16 v[64:65], v13 offset:0
    ds_read_b64_tr_b16 v[160:161], v14 offset:0
    ds_read_b64_tr_b16 v[240:241], v15 offset:0
    ds_read_b64_tr_b16 v[66:67], v13 offset:384
    ds_read_b64_tr_b16 v[162:163], v14 offset:384
    ds_read_b64_tr_b16 v[242:243], v15 offset:384
    ds_read_b64_tr_b16 v[68:69], v13 offset:12288
    ds_read_b64_tr_b16 v[164:165], v14 offset:12288
    ds_read_b64_tr_b16 v[244:245], v15 offset:12288
    ds_read_b64_tr_b16 v[70:71], v13 offset:12672
    ds_read_b64_tr_b16 v[166:167], v14 offset:12672
    ds_read_b64_tr_b16 v[246:247], v15 offset:12672
    s_waitcnt lgkmcnt(0)
    s_barrier
    s_mul_i32 s37, s92, 2
    s_add_u32 m0, s90, 73728
    s_nop 0
    buffer_load_dwordx4 v4, s[20:23], s37 offen nt lds
    s_add_u32 m0, s90, 74752
    s_nop 0
    buffer_load_dwordx4 v5, s[20:23], s37 offen nt lds
    s_add_u32 m0, s90, 75776
    s_nop 0
    buffer_load_dwordx4 v6, s[20:23], s37 offen nt lds
    s_add_u32 m0, s90, 76800
    s_nop 0
    buffer_load_dwordx4 v7, s[20:23], s37 offen nt lds
    s_add_u32 m0, s90, 77824
    s_nop 0
    buffer_load_dwordx4 v8, s[20:23], s37 offen nt lds
    s_add_u32 m0, s90, 78848
    s_nop 0
    buffer_load_dwordx4 v9, s[20:23], s37 offen nt lds
    s_waitcnt vmcnt(30)
    s_barrier
    v_add_u32 v13, 98304, v10
    v_add_u32 v14, 98304, v11
    v_add_u32 v15, 98304, v12
    ds_read_b64_tr_b16 a[168:169], v13 offset:0
    ds_read_b64_tr_b16 v[88:89], v14 offset:0
    ds_read_b64_tr_b16 v[224:225], v15 offset:0
    ds_read_b64_tr_b16 a[170:171], v13 offset:384
    ds_read_b64_tr_b16 v[90:91], v14 offset:384
    ds_read_b64_tr_b16 v[226:227], v15 offset:384
    ds_read_b64_tr_b16 a[172:173], v13 offset:12288
    ds_read_b64_tr_b16 v[92:93], v14 offset:12288
    ds_read_b64_tr_b16 v[228:229], v15 offset:12288
    ds_read_b64_tr_b16 a[174:175], v13 offset:12672
    ds_read_b64_tr_b16 v[94:95], v14 offset:12672
    ds_read_b64_tr_b16 v[230:231], v15 offset:12672
    s_waitcnt lgkmcnt(0)
    s_barrier
    s_mul_i32 s37, s92, 1
    s_add_u32 m0, s90, 98304
    s_nop 0
    buffer_load_dwordx4 v4, s[16:19], s37 offen nt lds
    s_add_u32 m0, s90, 99328
    s_nop 0
    buffer_load_dwordx4 v5, s[16:19], s37 offen nt lds
    s_add_u32 m0, s90, 100352
    s_nop 0
    buffer_load_dwordx4 v6, s[16:19], s37 offen nt lds
    s_add_u32 m0, s90, 101376
    s_nop 0
    buffer_load_dwordx4 v7, s[16:19], s37 offen nt lds
    s_add_u32 m0, s90, 102400
    s_nop 0
    buffer_load_dwordx4 v8, s[16:19], s37 offen nt lds
    s_add_u32 m0, s90, 103424
    s_nop 0
    buffer_load_dwordx4 v9, s[16:19], s37 offen nt lds
    s_waitcnt vmcnt(30)
    s_barrier
    v_add_u32 v13, 122880, v10
    v_add_u32 v14, 122880, v11
    v_add_u32 v15, 122880, v12
    ds_read_b64_tr_b16 a[176:177], v13 offset:0
    ds_read_b64_tr_b16 v[144:145], v14 offset:0
    ds_read_b64_tr_b16 v[120:121], v15 offset:0
    ds_read_b64_tr_b16 a[178:179], v13 offset:384
    ds_read_b64_tr_b16 v[146:147], v14 offset:384
    ds_read_b64_tr_b16 v[122:123], v15 offset:384
    ds_read_b64_tr_b16 a[180:181], v13 offset:12288
    ds_read_b64_tr_b16 v[148:149], v14 offset:12288
    ds_read_b64_tr_b16 v[124:125], v15 offset:12288
    ds_read_b64_tr_b16 a[182:183], v13 offset:12672
    ds_read_b64_tr_b16 v[150:151], v14 offset:12672
    ds_read_b64_tr_b16 v[126:127], v15 offset:12672
    s_waitcnt lgkmcnt(0)
    s_barrier
    s_mul_i32 s37, s92, 1
    s_add_u32 m0, s90, 122880
    s_nop 0
    buffer_load_dwordx4 v4, s[20:23], s37 offen nt lds
    s_add_u32 m0, s90, 123904
    s_nop 0
    buffer_load_dwordx4 v5, s[20:23], s37 offen nt lds
    s_add_u32 m0, s90, 124928
    s_nop 0
    buffer_load_dwordx4 v6, s[20:23], s37 offen nt lds
    s_add_u32 m0, s90, 125952
    s_nop 0
    buffer_load_dwordx4 v7, s[20:23], s37 offen nt lds
    s_add_u32 m0, s90, 126976
    s_nop 0
    buffer_load_dwordx4 v8, s[20:23], s37 offen nt lds
    s_add_u32 m0, s90, 128000
    s_nop 0
    buffer_load_dwordx4 v9, s[20:23], s37 offen nt lds
    s_waitcnt vmcnt(30)
    s_barrier
    v_add_u32 v13, 0, v10
    v_add_u32 v14, 0, v11
    v_add_u32 v15, 0, v12
    ds_read_b64_tr_b16 a[160:161], v13 offset:0
    ds_read_b64_tr_b16 a[240:241], v14 offset:0
    ds_read_b64_tr_b16 v[208:209], v15 offset:0
    ds_read_b64_tr_b16 a[162:163], v13 offset:384
    ds_read_b64_tr_b16 a[242:243], v14 offset:384
    ds_read_b64_tr_b16 v[210:211], v15 offset:384
    ds_read_b64_tr_b16 a[164:165], v13 offset:12288
    ds_read_b64_tr_b16 a[244:245], v14 offset:12288
    ds_read_b64_tr_b16 v[212:213], v15 offset:12288
    ds_read_b64_tr_b16 a[166:167], v13 offset:12672
    ds_read_b64_tr_b16 a[246:247], v14 offset:12672
    ds_read_b64_tr_b16 v[214:215], v15 offset:12672
    s_waitcnt lgkmcnt(0)
    s_barrier
    s_mul_i32 s37, s92, 0
    s_add_u32 m0, s90, 0
    s_nop 0
    buffer_load_dwordx4 v4, s[16:19], s37 offen nt lds
    s_add_u32 m0, s90, 1024
    s_nop 0
    buffer_load_dwordx4 v5, s[16:19], s37 offen nt lds
    s_add_u32 m0, s90, 2048
    s_nop 0
    buffer_load_dwordx4 v6, s[16:19], s37 offen nt lds
    s_add_u32 m0, s90, 3072
    s_nop 0
    buffer_load_dwordx4 v7, s[16:19], s37 offen nt lds
    s_add_u32 m0, s90, 4096
    s_nop 0
    buffer_load_dwordx4 v8, s[16:19], s37 offen nt lds
    s_add_u32 m0, s90, 5120
    s_nop 0
    buffer_load_dwordx4 v9, s[16:19], s37 offen nt lds
    s_waitcnt vmcnt(30)
    s_barrier
    v_add_u32 v13, 24576, v10
    v_add_u32 v14, 24576, v11
    v_add_u32 v15, 24576, v12
    ds_read_b64_tr_b16 v[56:57], v13 offset:0
    ds_read_b64_tr_b16 a[248:249], v14 offset:0
    ds_read_b64_tr_b16 v[216:217], v15 offset:0
    ds_read_b64_tr_b16 v[58:59], v13 offset:384
    ds_read_b64_tr_b16 a[250:251], v14 offset:384
    ds_read_b64_tr_b16 v[218:219], v15 offset:384
    ds_read_b64_tr_b16 v[60:61], v13 offset:12288
    ds_read_b64_tr_b16 a[252:253], v14 offset:12288
    ds_read_b64_tr_b16 v[220:221], v15 offset:12288
    ds_read_b64_tr_b16 v[62:63], v13 offset:12672
    ds_read_b64_tr_b16 a[254:255], v14 offset:12672
    ds_read_b64_tr_b16 v[222:223], v15 offset:12672
    s_waitcnt lgkmcnt(0)
    s_barrier
    s_mul_i32 s37, s92, 0
    s_add_u32 m0, s90, 24576
    s_nop 0
    buffer_load_dwordx4 v4, s[20:23], s37 offen nt lds
    s_add_u32 m0, s90, 25600
    s_nop 0
    buffer_load_dwordx4 v5, s[20:23], s37 offen nt lds
    s_add_u32 m0, s90, 26624
    s_nop 0
    buffer_load_dwordx4 v6, s[20:23], s37 offen nt lds
    s_add_u32 m0, s90, 27648
    s_nop 0
    buffer_load_dwordx4 v7, s[20:23], s37 offen nt lds
    s_add_u32 m0, s90, 28672
    s_nop 0
    buffer_load_dwordx4 v8, s[20:23], s37 offen nt lds
    s_add_u32 m0, s90, 29696
    s_nop 0
    buffer_load_dwordx4 v9, s[20:23], s37 offen nt lds
    s_waitcnt vmcnt(30)
    s_barrier
    v_add_u32 v13, 49152, v10
    v_add_u32 v14, 49152, v11
    v_add_u32 v15, 49152, v12
    ds_read_b64_tr_b16 a[144:145], v13 offset:0
    ds_read_b64_tr_b16 v[80:81], v14 offset:0
    ds_read_b64_tr_b16 v[200:201], v15 offset:0
    ds_read_b64_tr_b16 a[146:147], v13 offset:384
    ds_read_b64_tr_b16 v[82:83], v14 offset:384
    ds_read_b64_tr_b16 v[202:203], v15 offset:384
    ds_read_b64_tr_b16 a[148:149], v13 offset:12288
    ds_read_b64_tr_b16 v[84:85], v14 offset:12288
    ds_read_b64_tr_b16 v[204:205], v15 offset:12288
    ds_read_b64_tr_b16 a[150:151], v13 offset:12672
    ds_read_b64_tr_b16 v[86:87], v14 offset:12672
    ds_read_b64_tr_b16 v[206:207], v15 offset:12672
    s_waitcnt lgkmcnt(0)
    s_waitcnt vmcnt(24)
    s_barrier
    v_add_u32 v13, 73728, v10
    v_add_u32 v14, 73728, v11
    v_add_u32 v15, 73728, v12
    ds_read_b64_tr_b16 a[152:153], v13 offset:0
    ds_read_b64_tr_b16 a[232:233], v14 offset:0
    ds_read_b64_tr_b16 v[112:113], v15 offset:0
    ds_read_b64_tr_b16 a[154:155], v13 offset:384
    ds_read_b64_tr_b16 a[234:235], v14 offset:384
    ds_read_b64_tr_b16 v[114:115], v15 offset:384
    ds_read_b64_tr_b16 a[156:157], v13 offset:12288
    ds_read_b64_tr_b16 a[236:237], v14 offset:12288
    ds_read_b64_tr_b16 v[116:117], v15 offset:12288
    ds_read_b64_tr_b16 a[158:159], v13 offset:12672
    ds_read_b64_tr_b16 a[238:239], v14 offset:12672
    ds_read_b64_tr_b16 v[118:119], v15 offset:12672
    s_waitcnt lgkmcnt(0)
    s_waitcnt vmcnt(18)
    s_barrier
    v_add_u32 v13, 98304, v10
    v_add_u32 v14, 98304, v11
    v_add_u32 v15, 98304, v12
    ds_read_b64_tr_b16 a[136:137], v13 offset:0
    ds_read_b64_tr_b16 a[216:217], v14 offset:0
    ds_read_b64_tr_b16 v[104:105], v15 offset:0
    ds_read_b64_tr_b16 a[138:139], v13 offset:384
    ds_read_b64_tr_b16 a[218:219], v14 offset:384
    ds_read_b64_tr_b16 v[106:107], v15 offset:384
    ds_read_b64_tr_b16 a[140:141], v13 offset:12288
    ds_read_b64_tr_b16 a[220:221], v14 offset:12288
    ds_read_b64_tr_b16 v[108:109], v15 offset:12288
    ds_read_b64_tr_b16 a[142:143], v13 offset:12672
    ds_read_b64_tr_b16 a[222:223], v14 offset:12672
    ds_read_b64_tr_b16 v[110:111], v15 offset:12672
    s_waitcnt lgkmcnt(0)
    s_waitcnt vmcnt(12)
    s_barrier
    v_add_u32 v13, 122880, v10
    v_add_u32 v14, 122880, v11
    v_add_u32 v15, 122880, v12
    ds_read_b64_tr_b16 v[48:49], v13 offset:0
    ds_read_b64_tr_b16 a[224:225], v14 offset:0
    ds_read_b64_tr_b16 v[192:193], v15 offset:0
    ds_read_b64_tr_b16 v[50:51], v13 offset:384
    ds_read_b64_tr_b16 a[226:227], v14 offset:384
    ds_read_b64_tr_b16 v[194:195], v15 offset:384
    ds_read_b64_tr_b16 v[52:53], v13 offset:12288
    ds_read_b64_tr_b16 a[228:229], v14 offset:12288
    ds_read_b64_tr_b16 v[196:197], v15 offset:12288
    ds_read_b64_tr_b16 v[54:55], v13 offset:12672
    ds_read_b64_tr_b16 a[230:231], v14 offset:12672
    ds_read_b64_tr_b16 v[198:199], v15 offset:12672
    s_waitcnt lgkmcnt(0)
    s_waitcnt vmcnt(6)
    s_barrier
    v_add_u32 v13, 0, v10
    v_add_u32 v14, 0, v11
    v_add_u32 v15, 0, v12
    ds_read_b64_tr_b16 v[40:41], v13 offset:0
    ds_read_b64_tr_b16 a[208:209], v14 offset:0
    ds_read_b64_tr_b16 v[176:177], v15 offset:0
    ds_read_b64_tr_b16 v[42:43], v13 offset:384
    ds_read_b64_tr_b16 a[210:211], v14 offset:384
    ds_read_b64_tr_b16 v[178:179], v15 offset:384
    ds_read_b64_tr_b16 v[44:45], v13 offset:12288
    ds_read_b64_tr_b16 a[212:213], v14 offset:12288
    ds_read_b64_tr_b16 v[180:181], v15 offset:12288
    ds_read_b64_tr_b16 v[46:47], v13 offset:12672
    ds_read_b64_tr_b16 a[214:215], v14 offset:12672
    ds_read_b64_tr_b16 v[182:183], v15 offset:12672
    s_waitcnt lgkmcnt(0)
    s_waitcnt vmcnt(0)
    s_barrier
    v_add_u32 v13, 24576, v10
    v_add_u32 v14, 24576, v11
    v_add_u32 v15, 24576, v12
    ds_read_b64_tr_b16 a[128:129], v13 offset:0
    ds_read_b64_tr_b16 v[72:73], v14 offset:0
    ds_read_b64_tr_b16 v[184:185], v15 offset:0
    ds_read_b64_tr_b16 a[130:131], v13 offset:384
    ds_read_b64_tr_b16 v[74:75], v14 offset:384
    ds_read_b64_tr_b16 v[186:187], v15 offset:384
    ds_read_b64_tr_b16 a[132:133], v13 offset:12288
    ds_read_b64_tr_b16 v[76:77], v14 offset:12288
    ds_read_b64_tr_b16 v[188:189], v15 offset:12288
    ds_read_b64_tr_b16 a[134:135], v13 offset:12672
    ds_read_b64_tr_b16 v[78:79], v14 offset:12672
    ds_read_b64_tr_b16 v[190:191], v15 offset:12672
    s_waitcnt lgkmcnt(0)
Lpw_102:
    s_mul_i32 s37, s4, 28672
    v_lshlrev_b32 v9, 4, v1
    s_add_u32 s37, s37, 40960
    v_add_u32 v9, s37, v9
    s_barrier
    ds_write_b128 v9, v[24:27] offset:0
    ds_write_b128 v9, v[28:31] offset:1024
    ds_write_b128 v9, v[32:35] offset:2048
    ds_write_b128 v9, v[36:39] offset:3072
    ds_write_b128 v9, v[40:43] offset:4096
    ds_write_b128 v9, v[44:47] offset:5120
    ds_write_b128 v9, v[48:51] offset:6144
    ds_write_b128 v9, v[52:55] offset:7168
    ds_write_b128 v9, v[56:59] offset:8192
    ds_write_b128 v9, v[60:63] offset:9216
    ds_write_b128 v9, v[64:67] offset:10240
    ds_write_b128 v9, v[68:71] offset:11264
    ds_write_b128 v9, v[72:75] offset:12288
    ds_write_b128 v9, v[76:79] offset:13312
    ds_write_b128 v9, v[80:83] offset:14336
    ds_write_b128 v9, v[84:87] offset:15360
    ds_write_b128 v9, v[88:91] offset:16384
    ds_write_b128 v9, v[92:95] offset:17408
    ds_write_b128 v9, v[96:99] offset:18432
    ds_write_b128 v9, v[100:103] offset:19456
    ds_write_b128 v9, v[104:107] offset:20480
    ds_write_b128 v9, v[108:111] offset:21504
    ds_write_b128 v9, v[112:115] offset:22528
    ds_write_b128 v9, v[116:119] offset:23552
    ds_write_b128 v9, v[120:123] offset:24576
    ds_write_b128 v9, v[124:127] offset:25600
    ds_write_b128 v9, v[128:131] offset:26624
    ds_write_b128 v9, v[132:135] offset:27648
    s_waitcnt lgkmcnt(0)
    s_mul_i32 s37, s4, 5
    s_lshr_b32 s37, s37, 1
    v_lshlrev_b32 v8, 4, v1
    s_lshl_b32 s38, s37, 10
    v_add_u32 v0, s38, v8
    s_add_u32 s38, s37, 3
    s_cmp_ge_u32 s38, 10
    s_cselect_b32 s39, 10, 0
    s_sub_u32 s38, s38, s39
    s_lshl_b32 s38, s38, 10
    v_add_u32 v4, s38, v8
    s_add_u32 s38, s37, 5
    s_cmp_ge_u32 s38, 10
    s_cselect_b32 s39, 10, 0
    s_sub_u32 s38, s38, s39
    s_lshl_b32 s38, s38, 10
    v_add_u32 v5, s38, v8
    s_add_u32 s38, s37, 8
    s_cmp_ge_u32 s38, 10
    s_cselect_b32 s39, 10, 0
    s_sub_u32 s38, s38, s39
    s_lshl_b32 s38, s38, 10
    v_add_u32 v6, s38, v8
    v_and_b32 v7, 2, v1
    v_cmp_eq_u32 vcc, 0, v7
    v_mov_b32 v7, 0xeeee
    v_mov_b32 v84, 0x4444
    v_cndmask_b32 v7, v7, v84, vcc
    v_lshrrev_b32 v84, 4, v1
    v_lshlrev_b32 v84, 1, v84
    v_and_b32 v85, 15, v1
    v_sub_u32 v84, v85, v84
    v_mov_b32 v18, 0
    v_mov_b32 v85, 0x3f80
    v_cmp_eq_u32 vcc, 0, v84
    s_nop 1
    v_cndmask_b32 v18, v18, v85, vcc
    v_mov_b32 v85, 0x3f800000
    v_cmp_eq_u32 vcc, 1, v84
    s_nop 1
    v_cndmask_b32 v18, v18, v85, vcc
    v_mov_b32 v19, 0
    v_mov_b32 v85, 0x3f80
    v_cmp_eq_u32 vcc, 8, v84
    s_nop 1
    v_cndmask_b32 v19, v19, v85, vcc
    v_mov_b32 v85, 0x3f800000
    v_cmp_eq_u32 vcc, 9, v84
    s_nop 1
    v_cndmask_b32 v19, v19, v85, vcc
    v_mov_b32 v84, 0x70000000
    v_lshlrev_b32 v2, 2, v1
    v_and_b32 v85, 7, v1
    v_bfe_u32 v86, v1, 3, 1
    v_lshrrev_b32 v87, 4, v1
    v_and_b32 v88, 2, v87
    v_add_u32 v88, v88, v87
    v_lshl_add_u32 v88, v86, 1, v88
    v_add_u32 v88, v88, v85
    v_and_b32 v88, 7, v88
    v_lshl_add_u32 v88, v85, 3, v88
    s_lshl_b32 s37, s4, 10
    s_add_u32 s37, s37, 10240
    v_lshl_add_u32 v15, v88, 4, s37
    v_and_b32 v88, 1, v87
    v_lshl_add_u32 v88, v88, 1, v86
    v_lshl_add_u32 v88, v85, 2, v88
    v_lshlrev_b32 v88, 3, v88
    v_lshrrev_b32 v89, 1, v87
    v_xor_b32 v89, 1, v89
    v_lshl_add_u32 v88, v89, 8, v88
    s_lshl_b32 s37, s4, 9
    s_add_u32 s37, s37, 14336
    v_add_u32 v17, s37, v88
    v_lshrrev_b32 v85, 3, v1
    v_and_b32 v86, 1, v1
    v_bfe_u32 v87, v1, 1, 2
    v_add_u32 v88, v1, v85
    v_and_b32 v88, 7, v88
    v_lshl_add_u32 v88, v85, 3, v88
    v_lshlrev_b32 v16, 4, v88
    s_lshl_b32 s37, s53, 9
    v_lshl_add_u32 v10, v1, 3, s37
    v_lshlrev_b32 v88, 4, v85
    v_lshl_add_u32 v88, v87, 2, v88
    v_cmp_eq_u32 vcc, 0, v86
    s_nop 1
    v_cndmask_b32 v88, v84, v88, vcc
    s_lshl_b32 s37, s4, 7
    s_add_u32 s37, s37, 2048
    v_add_u32 v14, s37, v88
    s_lshl_b32 s37, s53, 7
    s_add_u32 s37, s37, 4096
    v_add_u32 v11, s37, v88
    s_cmp_eq_u32 s4, 0
    s_cselect_b64 vcc, -1, 0
    v_cndmask_b32 v10, v84, v10, vcc
    v_cndmask_b32 v11, v84, v11, vcc
    s_lshl_b32 s37, s4, 3
    v_add_u32 v88, s37, v85
    v_lshlrev_b32 v89, 4, v86
    v_lshl_add_u32 v89, v87, 2, v89
    v_sub_u32 v88, v88, v89
    v_cmp_le_i32 s[40:41], 0, v88
    v_cmp_le_i32 s[42:43], 1, v88
    v_cmp_le_i32 s[44:45], 2, v88
    v_cmp_le_i32 s[46:47], 3, v88
    s_lshl_b32 s37, s68, 7
    s_lshl_b32 s38, s4, 2
    s_add_u32 s37, s37, s38
    s_add_u32 s37, s37, 4096
    v_lshl_add_u32 v13, v86, 12, s37
    v_mov_b32 v12, 0
    v_lshl_add_u32 v88, v87, 4, v85
    v_lshlrev_b32 v88, 4, v88
    v_lshl_add_u32 v88, v86, 3, v88
    s_lshr_b32 s37, s4, 1
    s_lshl_b32 s37, s37, 10
    s_and_b32 s38, s4, 1
    s_lshl_b32 s38, s38, 7
    s_add_u32 s37, s37, s38
    v_add_u32 v1, s37, v88
    s_mov_b32 s100, 0x3dd53b95
    s_mov_b32 s101, s100
    v_mov_b32 v85, 36
    s_cmp_lg_u32 s4, 0
    s_cbranch_scc1 Lwik_109
Lwi_107:
    buffer_load_dword v84, v85, s[28:31], 0 offen sc1
    s_waitcnt vmcnt(0)
    v_readfirstlane_b32 s37, v84
    s_nop 0
    s_and_b32 s38, s37, 0x200ffff
    s_cmp_eq_u32 s38, 0x2000100
    s_cbranch_scc1 Lwid_108
    s_sleep 6
    s_sub_u32 s36, s36, 1
    s_cbranch_scc0 Lwi_107
    s_mov_b32 s36, 0
Lwid_108:
    v_mov_b32 v85, 163836
    ds_write_b32 v85, v84
    s_waitcnt lgkmcnt(0)
Lwik_109:
    s_waitcnt vmcnt(0)
    s_barrier
    v_mov_b32 v85, 163836
    ds_read_b32 v84, v85
    s_waitcnt lgkmcnt(0)
    v_readfirstlane_b32 s37, v84
    s_nop 0
    s_bfe_u32 s7, s37, 0x80010
    s_bfe_u32 s37, s37, 0x10018
    s_xor_b32 s37, s37, 1
    s_lshl_b32 s37, s37, 13
    s_lshl_b32 s70, s6, 15
    s_add_u32 s70, s70, s37
    s_cmp_ge_u32 s4, 2
    s_cselect_b32 s37, 11264, 0
    s_add_u32 s70, s70, s37
    s_add_u32 s70, s70, 222298112
    s_mul_i32 s76, s68, 786432
    s_mul_i32 s37, s4, 3072
    s_add_u32 s76, s76, s37
    s_add_u32 s75, s76, 29360128
    s_add_u32 s76, s76, 4194304
    s_mul_i32 s77, s68, 2560
    s_add_u32 s77, s77, 163840
    s_add_u32 s78, s77, 81920
    s_add_u32 s54, s77, 163840
    s_mov_b32 s66, 0
    s_mov_b32 s69, 1
    v_cmp_gt_u32 vcc, s69, v12
    s_cbranch_vccz Lfgd_111
Lfg_110:
    buffer_load_dword v12, v13, s[8:11], 0 offen sc1
    s_waitcnt vmcnt(0)
    v_cmp_gt_u32 vcc, s69, v12
    s_cbranch_vccz Lfgd_111
    s_sleep 1
    s_sub_u32 s36, s36, 1
    s_cbranch_scc0 Lfg_110
    s_mov_b32 s36, 0
Lfgd_111:
    buffer_load_dwordx4 v[120:123], v8, s[8:11], s75 offen offset:0 sc1 nt
    buffer_load_dwordx4 v[124:127], v8, s[8:11], s75 offen offset:1024 sc1 nt
    buffer_load_dwordx4 v[128:131], v8, s[8:11], s75 offen offset:2048 sc1 nt
    buffer_load_dwordx4 v[132:135], v8, s[8:11], s76 offen offset:0 sc1 nt
    buffer_load_dwordx4 v[136:139], v8, s[8:11], s76 offen offset:1024 sc1 nt
    buffer_load_dwordx4 v[140:143], v8, s[8:11], s76 offen offset:2048 sc1 nt
    s_add_u32 s75, s75, 12288
    s_add_u32 s76, s76, 12288
    s_cmp_lg_u32 s7, 0
    s_cbranch_scc1 L_RQ_slow
L_RQ_fast:
    ds_read_b128 v[92:95], v9 offset:0
    ds_read_b128 v[96:99], v9 offset:1024
    ds_read_b128 v[100:103], v9 offset:2048
    ds_read_b128 v[104:107], v9 offset:3072
    ds_read_b128 v[108:111], v9 offset:4096
    ds_read_b128 v[112:115], v9 offset:5120
    v_mov_b32 v28, 0
    v_mov_b32 v29, 0
    v_mov_b32 v30, 0
    v_mov_b32 v31, 0
    v_mov_b32 v32, 0
    v_mov_b32 v33, 0
    v_mov_b32 v34, 0
    v_mov_b32 v35, 0
    v_mov_b32 v36, 0
    v_mov_b32 v37, 0
    v_mov_b32 v38, 0
    v_mov_b32 v39, 0
    v_mov_b32 v40, 0
    v_mov_b32 v41, 0
    v_mov_b32 v42, 0
    v_mov_b32 v43, 0
    v_mov_b32 v44, 0
    v_mov_b32 v45, 0
    v_mov_b32 v46, 0
    v_mov_b32 v47, 0
    v_mov_b32 v48, 0
    v_mov_b32 v49, 0
    v_mov_b32 v50, 0
    v_mov_b32 v51, 0
    s_add_u32 s37, s66, 0
    s_and_b32 s37, s37, 3
    s_lshl_b32 s37, s37, 17
    s_add_u32 s71, s70, s37
    v_mov_b32 v52, -1
    v_mov_b32 v53, -1
    v_mov_b32 v54, -1
    v_mov_b32 v55, -1
    v_mov_b32 v56, -1
    v_mov_b32 v57, -1
    v_mov_b32 v58, -1
    v_mov_b32 v59, -1
    v_mov_b32 v60, -1
    v_mov_b32 v61, -1
    v_mov_b32 v62, -1
    v_mov_b32 v63, -1
    s_waitcnt vmcnt(0)
    buffer_load_dwordx4 v[52:55], v0, s[8:11], s71 offen offset:0 sc1
    buffer_load_dwordx4 v[56:59], v0, s[8:11], s71 offen offset:1024 sc1
    buffer_load_dwordx4 v[60:63], v0, s[8:11], s71 offen offset:2048 sc1
    s_sleep 2
    buffer_load_dwordx4 v[52:55], v0, s[8:11], s71 offen offset:0 sc1
    buffer_load_dwordx4 v[56:59], v0, s[8:11], s71 offen offset:1024 sc1
    buffer_load_dwordx4 v[60:63], v0, s[8:11], s71 offen offset:2048 sc1
Lmp_112:
    s_waitcnt vmcnt(3)
    v_max3_u32 v88, v52, v53, v54
    v_max3_u32 v88, v88, v55, v56
    v_max3_u32 v88, v88, v57, v58
    v_max3_u32 v88, v88, v59, v60
    v_max3_u32 v88, v88, v61, v62
    v_max3_u32 v88, v88, v63, v63
    v_cmp_eq_u32 vcc, -1, v88
    ds_write_b128 v0, v[52:55] offset:0
    s_cbranch_vccnz Lmpr_114
Lmpd_113:
    v_smfmac_f32_16x16x64_bf16 v[28:31], v[52:55], a[0:7], v7
    ds_write_b128 v0, v[56:59] offset:1024
    v_smfmac_f32_16x16x64_bf16 v[36:39], v[52:55], a[8:15], v7
    ds_write_b128 v0, v[60:63] offset:2048
    v_smfmac_f32_16x16x64_bf16 v[44:47], v[52:55], a[16:23], v7
    v_smfmac_f32_16x16x64_bf16 v[32:35], v[52:55], a[24:31], v7
    v_smfmac_f32_16x16x64_bf16 v[40:43], v[52:55], a[32:39], v7
    v_smfmac_f32_16x16x64_bf16 v[48:51], v[52:55], a[40:47], v7
    v_smfmac_f32_16x16x64_bf16 v[28:31], v[56:59], a[48:55], v7
    v_smfmac_f32_16x16x64_bf16 v[36:39], v[56:59], a[56:63], v7
    v_smfmac_f32_16x16x64_bf16 v[44:47], v[56:59], a[64:71], v7
    s_waitcnt lgkmcnt(0)
    s_barrier
    v_smfmac_f32_16x16x64_bf16 v[32:35], v[56:59], a[72:79], v7
    ds_read_b128 v[64:67], v4 offset:0
    v_smfmac_f32_16x16x64_bf16 v[40:43], v[56:59], v[92:99], v7
    ds_read_b128 v[68:71], v4 offset:1024
    v_smfmac_f32_16x16x64_bf16 v[48:51], v[56:59], a[80:87], v7
    ds_read_b128 v[72:75], v5 offset:0
    v_smfmac_f32_16x16x64_bf16 v[28:31], v[60:63], a[88:95], v7
    ds_read_b128 v[76:79], v5 offset:1024
    v_smfmac_f32_16x16x64_bf16 v[36:39], v[60:63], a[96:103], v7
    ds_read_b128 v[80:83], v5 offset:2048
    v_smfmac_f32_16x16x64_bf16 v[44:47], v[60:63], v[100:107], v7
    ds_read_b128 v[92:95], v9 offset:6144
    ds_read_b128 v[84:87], v6 offset:0
    v_smfmac_f32_16x16x64_bf16 v[32:35], v[60:63], a[104:111], v7
    ds_read_b128 v[96:99], v9 offset:7168
    ds_read_b128 v[88:91], v6 offset:1024
    v_smfmac_f32_16x16x64_bf16 v[40:43], v[60:63], a[112:119], v7
    ds_read_b128 v[100:103], v9 offset:8192
    v_smfmac_f32_16x16x64_bf16 v[48:51], v[60:63], a[120:127], v7
    s_waitcnt lgkmcnt(9)
    ds_read_b128 v[104:107], v9 offset:9216
    v_smfmac_f32_16x16x64_bf16 v[28:31], v[64:67], v[108:115], v7
    ds_read_b128 v[108:111], v9 offset:10240
    v_smfmac_f32_16x16x64_bf16 v[32:35], v[64:67], a[128:135], v7
    s_waitcnt lgkmcnt(10)
    ds_read_b128 v[112:115], v9 offset:11264
    v_smfmac_f32_16x16x64_bf16 v[28:31], v[68:71], a[136:143], v7
    s_waitcnt lgkmcnt(5)
    v_smfmac_f32_16x16x64_bf16 v[32:35], v[68:71], v[92:99], v7
    ds_read_b128 v[92:95], v9 offset:12288
    v_smfmac_f32_16x16x64_bf16 v[28:31], v[72:75], a[144:151], v7
    ds_read_b128 v[96:99], v9 offset:13312
    v_smfmac_f32_16x16x64_bf16 v[32:35], v[72:75], a[152:159], v7
    v_smfmac_f32_16x16x64_bf16 v[28:31], v[76:79], a[160:167], v7
    s_waitcnt lgkmcnt(4)
    v_smfmac_f32_16x16x64_bf16 v[32:35], v[76:79], v[100:107], v7
    ds_read_b128 v[100:103], v9 offset:14336
    v_smfmac_f32_16x16x64_bf16 v[28:31], v[80:83], a[168:175], v7
    ds_read_b128 v[104:107], v9 offset:15360
    v_smfmac_f32_16x16x64_bf16 v[32:35], v[80:83], a[176:183], v7
    v_smfmac_f32_16x16x64_bf16 v[28:31], v[84:87], a[184:191], v7
    s_waitcnt lgkmcnt(4)
    v_smfmac_f32_16x16x64_bf16 v[32:35], v[84:87], v[108:115], v7
    ds_read_b128 v[108:111], v9 offset:16384
    v_smfmac_f32_16x16x64_bf16 v[28:31], v[88:91], a[192:199], v7
    ds_read_b128 v[112:115], v9 offset:17408
    v_smfmac_f32_16x16x64_bf16 v[32:35], v[88:91], a[200:207], v7
    v_smfmac_f32_16x16x64_bf16 v[36:39], v[64:67], a[208:215], v7
    s_waitcnt lgkmcnt(4)
    v_smfmac_f32_16x16x64_bf16 v[40:43], v[64:67], v[92:99], v7
    ds_read_b128 v[92:95], v9 offset:18432
    v_smfmac_f32_16x16x64_bf16 v[36:39], v[68:71], a[216:223], v7
    ds_read_b128 v[96:99], v9 offset:19456
    v_smfmac_f32_16x16x64_bf16 v[40:43], v[68:71], a[224:231], v7
    s_waitcnt lgkmcnt(4)
    v_smfmac_f32_16x16x64_bf16 v[36:39], v[72:75], v[100:107], v7
    ds_read_b128 v[100:103], v9 offset:20480
    v_smfmac_f32_16x16x64_bf16 v[40:43], v[72:75], a[232:239], v7
    ds_read_b128 v[104:107], v9 offset:21504
    v_smfmac_f32_16x16x64_bf16 v[36:39], v[76:79], a[240:247], v7
    v_add_f32 v28, v28, v30
    v_smfmac_f32_16x16x64_bf16 v[40:43], v[76:79], a[248:255], v7
    s_waitcnt lgkmcnt(4)
    v_add_f32 v29, v29, v31
    v_smfmac_f32_16x16x64_bf16 v[36:39], v[80:83], v[108:115], v7
    ds_read_b128 v[108:111], v9 offset:22528
    v_add_f32 v32, v32, v34
    v_smfmac_f32_16x16x64_bf16 v[40:43], v[80:83], v[144:151], v7
    ds_read_b128 v[112:115], v9 offset:23552
    v_add_f32 v33, v33, v35
    v_smfmac_f32_16x16x64_bf16 v[36:39], v[84:87], v[152:159], v7
    v_cvt_pk_bf16_f32 v28, v28, v29
    v_smfmac_f32_16x16x64_bf16 v[40:43], v[84:87], v[160:167], v7
    s_waitcnt lgkmcnt(4)
    v_cvt_pk_bf16_f32 v29, v32, v33
    v_smfmac_f32_16x16x64_bf16 v[36:39], v[88:91], v[92:99], v7
    ds_read_b128 v[92:95], v9 offset:24576
    v_smfmac_f32_16x16x64_bf16 v[40:43], v[88:91], v[168:175], v7
    ds_read_b128 v[96:99], v9 offset:25600
    v_smfmac_f32_16x16x64_bf16 v[44:47], v[64:67], v[176:183], v7
    v_smfmac_f32_16x16x64_bf16 v[48:51], v[64:67], v[184:191], v7
    s_waitcnt lgkmcnt(4)
    v_smfmac_f32_16x16x64_bf16 v[44:47], v[68:71], v[100:107], v7
    ds_read_b128 v[100:103], v9 offset:26624
    v_smfmac_f32_16x16x64_bf16 v[48:51], v[68:71], v[192:199], v7
    ds_read_b128 v[104:107], v9 offset:27648
    v_smfmac_f32_16x16x64_bf16 v[44:47], v[72:75], v[200:207], v7
    s_waitcnt lgkmcnt(4)
    s_waitcnt vmcnt(0)
    v_smfmac_f32_16x16x64_bf16 v[48:51], v[72:75], v[108:115], v7
    v_smfmac_f32_16x16x64_bf16 v[44:47], v[76:79], v[208:215], v7
    v_add_f32 v36, v36, v38
    v_smfmac_f32_16x16x64_bf16 v[48:51], v[76:79], v[216:223], v7
    v_add_f32 v37, v37, v39
    v_smfmac_f32_16x16x64_bf16 v[44:47], v[80:83], v[224:231], v7
    s_waitcnt lgkmcnt(2)
    v_add_f32 v40, v40, v42
    v_smfmac_f32_16x16x64_bf16 v[48:51], v[80:83], v[92:99], v7
    v_add_f32 v41, v41, v43
    v_smfmac_f32_16x16x64_bf16 v[44:47], v[84:87], v[232:239], v7
    v_cvt_pk_bf16_f32 v36, v36, v37
    v_smfmac_f32_16x16x64_bf16 v[48:51], v[84:87], v[240:247], v7
    v_cvt_pk_bf16_f32 v37, v40, v41
    v_smfmac_f32_16x16x64_bf16 v[44:47], v[88:91], v[248:255], v7
    s_waitcnt lgkmcnt(0)
    v_smfmac_f32_16x16x64_bf16 v[48:51], v[88:91], v[100:107], v7
    s_nop 1
    v_mfma_f32_16x16x16_bf16 v[32:35], v[28:29], v[18:19], 0
    v_mfma_f32_16x16x16_bf16 v[40:43], v[36:37], v[18:19], 0
    s_nop 1
    v_pk_add_f32 v[44:45], v[44:45], v[46:47]
    s_nop 0
    v_pk_add_f32 v[48:49], v[48:49], v[50:51]
    v_cvt_pk_bf16_f32 v44, v44, v45
    v_cvt_pk_bf16_f32 v45, v48, v49
    v_cvt_pk_bf16_f32 v22, v32, v33
    v_cvt_pk_bf16_f32 v23, v34, v35
    v_mfma_f32_16x16x16_bf16 v[48:51], v[44:45], v[18:19], 0
    v_cvt_pk_bf16_f32 v24, v40, v41
    v_cvt_pk_bf16_f32 v25, v42, v43
    s_nop 1
    v_mfma_f32_16x16x32_bf16 v[52:55], v[22:25], v[22:25], 0
    v_mfma_f32_16x16x32_bf16 v[56:59], v[120:123], v[22:25], 0
    v_mfma_f32_16x16x32_bf16 v[60:63], v[124:127], v[22:25], 0
    s_nop 0
    v_cvt_pk_bf16_f32 v26, v48, v49
    v_cvt_pk_bf16_f32 v27, v50, v51
    s_nop 1
    v_mfma_f32_16x16x16_bf16 v[56:59], v[128:129], v[26:27], v[56:59]
    v_mfma_f32_16x16x16_bf16 v[60:63], v[130:131], v[26:27], v[60:63]
    v_mfma_f32_16x16x16_bf16 v[52:55], v[26:27], v[26:27], v[52:55]
    s_nop 5
    v_mov_b32_dpp v58, v56 row_ror:8 row_mask:0xf bank_mask:0xc
    v_mov_b32_dpp v59, v57 row_ror:8 row_mask:0xf bank_mask:0xc
    v_mov_b32_dpp v60, v62 row_ror:8 row_mask:0xf bank_mask:0xc
    v_mov_b32_dpp v61, v63 row_ror:8 row_mask:0xf bank_mask:0xc
    ds_write_b128 v15, v[58:61]
    v_mov_b32_dpp v52, v54 row_ror:8 row_mask:0xf bank_mask:0xc
    v_mov_b32_dpp v53, v55 row_ror:8 row_mask:0xf bank_mask:0xc
    ds_write_b64 v17, v[52:53]
    s_cmp_lg_u32 s4, 0
    s_waitcnt lgkmcnt(0)
    s_barrier
    s_cbranch_scc1 Lqs_115
    ds_read_b128 v[28:31], v16 offset:10240
    ds_read_b128 v[32:35], v16 offset:11264
    ds_read_b128 v[36:39], v16 offset:12288
    ds_read_b128 v[40:43], v16 offset:13312
    ds_read2st64_b32 v[44:45], v2 offset0:56 offset1:58
    ds_read2st64_b32 v[46:47], v2 offset0:60 offset1:62
    s_waitcnt lgkmcnt(4)
    v_pk_add_f32 v[28:29], v[28:29], v[32:33]
    v_pk_add_f32 v[30:31], v[30:31], v[34:35]
    s_waitcnt lgkmcnt(2)
    v_pk_add_f32 v[36:37], v[36:37], v[40:41]
    v_pk_add_f32 v[38:39], v[38:39], v[42:43]
    s_waitcnt lgkmcnt(0)
    v_pk_add_f32 v[44:45], v[44:45], v[46:47]
    v_pk_add_f32 v[28:29], v[28:29], v[36:37]
    v_pk_add_f32 v[30:31], v[30:31], v[38:39]
    v_add_f32 v44, v44, v45
    v_max3_f32 v46, v28, v29, v44
    v_max3_f32 v46, v30, v31, v46
    v_pk_mul_f32 v[28:29], v[28:29], s[100:101]
    v_pk_mul_f32 v[30:31], v[30:31], s[100:101]
    v_max_f32_dpp v46, v46, v46 quad_perm:[1,0,3,2] row_mask:0xf bank_mask:0xf
    v_mul_f32 v44, s100, v44
    s_nop 0
    v_max_f32_dpp v46, v46, v46 quad_perm:[2,3,0,1] row_mask:0xf bank_mask:0xf
    s_nop 1
    v_max_f32_dpp v46, v46, v46 row_half_mirror row_mask:0xf bank_mask:0xf
    v_pk_fma_f32 v[28:29], v[46:47], s[100:101], v[28:29] op_sel_hi:[0,1,1] neg_lo:[1,0,0] neg_hi:[1,0,0]
    v_pk_fma_f32 v[30:31], v[46:47], s[100:101], v[30:31] op_sel_hi:[0,1,1] neg_lo:[1,0,0] neg_hi:[1,0,0]
    v_fma_f32 v44, -v46, s100, v44
    v_exp_f32 v28, v28
    v_exp_f32 v29, v29
    v_exp_f32 v30, v30
    v_exp_f32 v31, v31
    v_exp_f32 v44, v44
    v_pk_add_f32 v[46:47], v[28:29], v[30:31]
    v_add_f32 v46, v46, v44
    v_add_f32 v46, v46, v47
    v_mov_b32_dpp v45, v44 quad_perm:[1,0,3,2] row_mask:0xf bank_mask:0xf
    s_nop 0
    v_add_f32_dpp v46, v46, v46 quad_perm:[1,0,3,2] row_mask:0xf bank_mask:0xf
    s_nop 1
    v_add_f32_dpp v46, v46, v46 quad_perm:[2,3,0,1] row_mask:0xf bank_mask:0xf
    s_nop 1
    v_add_f32_dpp v46, v46, v46 row_half_mirror row_mask:0xf bank_mask:0xf
    v_rcp_f32 v46, v46
    s_nop 0
    v_pk_mul_f32 v[28:29], v[28:29], v[46:47] op_sel_hi:[1,0]
    v_pk_mul_f32 v[30:31], v[30:31], v[46:47] op_sel_hi:[1,0]
    v_cvt_pk_bf16_f32 v28, v28, v29
    v_cvt_pk_bf16_f32 v29, v30, v31
    buffer_store_dwordx2 v[28:29], v10, s[8:11], s73 offen
    v_pk_mul_f32 v[44:45], v[44:45], v[46:47] op_sel_hi:[1,0]
    v_cvt_pk_bf16_f32 v44, v44, v45
    buffer_store_dword v44, v11, s[8:11], s73 offen
    v_mov_b32 v30, -1
    v_mov_b32 v31, -1
    buffer_store_dwordx2 v[30:31], v10, s[8:11], s55 offen
    buffer_store_dword v30, v11, s[8:11], s55 offen
Lqs_115:
    v_mfma_f32_16x16x32_bf16 v[64:67], v[22:25], v[132:135], 0
    v_mfma_f32_16x16x32_bf16 v[68:71], v[22:25], v[136:139], 0
    v_mfma_f32_16x16x32_bf16 v[72:75], v[120:123], v[132:135], 0
    v_mfma_f32_16x16x32_bf16 v[76:79], v[120:123], v[136:139], 0
    v_mfma_f32_16x16x32_bf16 v[80:83], v[124:127], v[136:139], 0
    s_mul_i32 s37, s4, 6144
    v_bfe_u32 v84, v8, 4, 4
    v_lshrrev_b32 v85, 8, v8
    v_lshl_add_u32 v86, v85, 1, v84
    v_add_u32 v87, 1, v86
    v_mfma_f32_16x16x16_bf16 v[64:67], v[26:27], v[140:141], v[64:67]
    v_mfma_f32_16x16x16_bf16 v[68:71], v[26:27], v[142:143], v[68:71]
    v_mfma_f32_16x16x16_bf16 v[72:75], v[128:129], v[140:141], v[72:75]
    v_mfma_f32_16x16x16_bf16 v[76:79], v[128:129], v[142:143], v[76:79]
    v_mfma_f32_16x16x16_bf16 v[80:83], v[130:131], v[142:143], v[80:83]
    v_and_b32 v86, 7, v86
    v_lshl_add_u32 v86, v84, 3, v86
    v_lshl_add_u32 v86, v86, 4, s37
    v_and_b32 v87, 7, v87
    v_lshl_add_u32 v87, v84, 3, v87
    v_lshl_add_u32 v87, v87, 4, s37
    v_and_b32 v88, 1, v85
    v_lshl_add_u32 v88, v84, 1, v88
    v_lshl_add_u32 v88, v88, 4, s37
    v_lshrrev_b32 v85, 1, v85
    v_xor_b32 v85, 1, v85
    v_lshl_add_u32 v88, v85, 9, v88
    ds_write_b128 v88, v[64:67] offset:18432
    ds_write_b128 v88, v[68:71] offset:21504
    ds_write_b128 v86, v[72:75] offset:16384
    ds_write_b128 v86, v[76:79] offset:19456
    ds_write_b128 v87, v[80:83] offset:19456
    s_lshr_b32 s37, s4, 1
    s_mul_i32 s37, s37, 3072
    s_and_b32 s38, s4, 1
    s_lshl_b32 s38, s38, 8
    s_add_u32 s39, s37, s38
    v_add_u32 v84, s39, v2
    s_lshl_b32 s38, s38, 2
    s_add_u32 s39, s37, s38
    v_add_u32 v85, s39, v16
    v_mov_b32 v89, 0xd04e79ff
    s_waitcnt lgkmcnt(0)
    s_barrier
    s_add_u32 s69, s66, 2
    s_min_u32 s69, s69, 64
    v_cmp_gt_u32 vcc, s69, v12
    s_cbranch_vccz Lfgd_117
Lfg_116:
    buffer_load_dword v12, v13, s[8:11], 0 offen sc1
    s_waitcnt vmcnt(0)
    v_cmp_gt_u32 vcc, s69, v12
    s_cbranch_vccz Lfgd_117
    s_sleep 1
    s_sub_u32 s36, s36, 1
    s_cbranch_scc0 Lfg_116
    s_mov_b32 s36, 0
Lfgd_117:
    buffer_load_dwordx4 v[120:123], v8, s[8:11], s75 offen offset:0 sc1 nt
    buffer_load_dwordx4 v[124:127], v8, s[8:11], s75 offen offset:1024 sc1 nt
    buffer_load_dwordx4 v[128:131], v8, s[8:11], s75 offen offset:2048 sc1 nt
    buffer_load_dwordx4 v[132:135], v8, s[8:11], s76 offen offset:0 sc1 nt
    buffer_load_dwordx4 v[136:139], v8, s[8:11], s76 offen offset:1024 sc1 nt
    buffer_load_dwordx4 v[140:143], v8, s[8:11], s76 offen offset:2048 sc1 nt
    s_add_u32 s75, s75, 12288
    s_add_u32 s76, s76, 12288
    ds_read_b128 v[28:31], v85 offset:16384
    ds_read_b128 v[32:35], v85 offset:22528
    ds_read_b128 v[36:39], v85 offset:28672
    ds_read_b128 v[40:43], v85 offset:34816
    ds_read2st64_b32 v[44:45], v84 offset0:72 offset1:96
    ds_read2st64_b32 v[46:47], v84 offset0:120 offset1:144
    s_waitcnt lgkmcnt(4)
    v_pk_add_f32 v[28:29], v[28:29], v[32:33]
    v_pk_add_f32 v[30:31], v[30:31], v[34:35]
    s_waitcnt lgkmcnt(2)
    v_pk_add_f32 v[36:37], v[36:37], v[40:41]
    v_pk_add_f32 v[38:39], v[38:39], v[42:43]
    s_waitcnt lgkmcnt(0)
    v_pk_add_f32 v[44:45], v[44:45], v[46:47]
    v_pk_add_f32 v[28:29], v[28:29], v[36:37]
    v_pk_add_f32 v[30:31], v[30:31], v[38:39]
    v_add_f32 v44, v44, v45
    v_cndmask_b32 v28, v89, v28, s[40:41]
    v_cndmask_b32 v29, v89, v29, s[42:43]
    v_cndmask_b32 v30, v89, v30, s[44:45]
    v_cndmask_b32 v31, v89, v31, s[46:47]
    v_max3_f32 v46, v28, v29, v44
    v_max3_f32 v46, v30, v31, v46
    v_pk_mul_f32 v[28:29], v[28:29], s[100:101]
    v_pk_mul_f32 v[30:31], v[30:31], s[100:101]
    v_max_f32_dpp v46, v46, v46 quad_perm:[1,0,3,2] row_mask:0xf bank_mask:0xf
    v_mul_f32 v44, s100, v44
    s_nop 0
    v_max_f32_dpp v46, v46, v46 quad_perm:[2,3,0,1] row_mask:0xf bank_mask:0xf
    s_nop 1
    v_max_f32_dpp v46, v46, v46 row_half_mirror row_mask:0xf bank_mask:0xf
    v_pk_fma_f32 v[28:29], v[46:47], s[100:101], v[28:29] op_sel_hi:[0,1,1] neg_lo:[1,0,0] neg_hi:[1,0,0]
    v_pk_fma_f32 v[30:31], v[46:47], s[100:101], v[30:31] op_sel_hi:[0,1,1] neg_lo:[1,0,0] neg_hi:[1,0,0]
    v_fma_f32 v44, -v46, s100, v44
    v_exp_f32 v28, v28
    v_exp_f32 v29, v29
    v_exp_f32 v30, v30
    v_exp_f32 v31, v31
    v_exp_f32 v44, v44
    v_pk_add_f32 v[46:47], v[28:29], v[30:31]
    v_add_f32 v46, v46, v44
    v_add_f32 v46, v46, v47
    v_mov_b32_dpp v45, v44 quad_perm:[1,0,3,2] row_mask:0xf bank_mask:0xf
    s_nop 0
    v_add_f32_dpp v46, v46, v46 quad_perm:[1,0,3,2] row_mask:0xf bank_mask:0xf
    s_nop 1
    v_add_f32_dpp v46, v46, v46 quad_perm:[2,3,0,1] row_mask:0xf bank_mask:0xf
    s_nop 1
    v_add_f32_dpp v46, v46, v46 row_half_mirror row_mask:0xf bank_mask:0xf
    v_rcp_f32 v46, v46
    s_nop 0
    v_pk_mul_f32 v[28:29], v[28:29], v[46:47] op_sel_hi:[1,0]
    v_pk_mul_f32 v[30:31], v[30:31], v[46:47] op_sel_hi:[1,0]
    v_cvt_pk_bf16_f32 v28, v28, v29
    v_cvt_pk_bf16_f32 v29, v30, v31
    buffer_store_dwordx2 v[28:29], v1, s[8:11], s77 offen
    v_pk_mul_f32 v[44:45], v[44:45], v[46:47] op_sel_hi:[1,0]
    v_cvt_pk_bf16_f32 v44, v44, v45
    buffer_store_dword v44, v14, s[8:11], s77 offen
    s_mov_b32 s37, s73
    s_mov_b32 s73, s74
    s_mov_b32 s74, s55
    s_mov_b32 s55, s37
    s_mov_b32 s37, s77
    s_mov_b32 s77, s78
    s_mov_b32 s78, s54
    s_mov_b32 s54, s37
    s_add_u32 s66, s66, 1
    s_cmp_lt_u32 s66, 64
    s_cbranch_scc1 L_RQ_fast
    s_waitcnt vmcnt(0)
    v_mov_b32 v3, s66
    s_mov_b64 exec, 1
    buffer_store_dword v3, off, s[8:11], s79
    s_mov_b64 exec, -1
    s_branch L_RQ_fin
Lmpr_114:
    v_max3_u32 v88, v52, v53, v54
    v_max_u32 v88, v88, v55
    v_cmp_eq_u32 s[56:57], -1, v88
    v_max3_u32 v88, v56, v57, v58
    v_max_u32 v88, v88, v59
    v_cmp_eq_u32 s[58:59], -1, v88
    v_max3_u32 v88, v60, v61, v62
    v_max_u32 v88, v88, v63
    v_cmp_eq_u32 s[60:61], -1, v88
    s_mov_b64 exec, s[56:57]
    buffer_load_dwordx4 v[52:55], v0, s[8:11], s71 offen offset:0 sc1
    s_mov_b64 exec, s[58:59]
    buffer_load_dwordx4 v[56:59], v0, s[8:11], s71 offen offset:1024 sc1
    s_mov_b64 exec, s[60:61]
    buffer_load_dwordx4 v[60:63], v0, s[8:11], s71 offen offset:2048 sc1
    s_mov_b64 exec, -1
    s_sub_u32 s36, s36, 1
    s_cbranch_scc0 Lmp_112
    s_mov_b32 s36, 0
    s_waitcnt vmcnt(0)
    s_branch Lmpd_113
L_RQ_slow:
    ds_read_b128 v[92:95], v9 offset:0
    ds_read_b128 v[96:99], v9 offset:1024
    ds_read_b128 v[100:103], v9 offset:2048
    ds_read_b128 v[104:107], v9 offset:3072
    ds_read_b128 v[108:111], v9 offset:4096
    ds_read_b128 v[112:115], v9 offset:5120
    v_mov_b32 v28, 0
    v_mov_b32 v29, 0
    v_mov_b32 v30, 0
    v_mov_b32 v31, 0
    v_mov_b32 v32, 0
    v_mov_b32 v33, 0
    v_mov_b32 v34, 0
    v_mov_b32 v35, 0
    v_mov_b32 v36, 0
    v_mov_b32 v37, 0
    v_mov_b32 v38, 0
    v_mov_b32 v39, 0
    v_mov_b32 v40, 0
    v_mov_b32 v41, 0
    v_mov_b32 v42, 0
    v_mov_b32 v43, 0
    v_mov_b32 v44, 0
    v_mov_b32 v45, 0
    v_mov_b32 v46, 0
    v_mov_b32 v47, 0
    v_mov_b32 v48, 0
    v_mov_b32 v49, 0
    v_mov_b32 v50, 0
    v_mov_b32 v51, 0
    s_add_u32 s37, s66, 0
    s_and_b32 s37, s37, 3
    s_lshl_b32 s37, s37, 17
    s_add_u32 s71, s70, s37
    v_mov_b32 v52, -1
    v_mov_b32 v53, -1
    v_mov_b32 v54, -1
    v_mov_b32 v55, -1
    v_mov_b32 v56, -1
    v_mov_b32 v57, -1
    v_mov_b32 v58, -1
    v_mov_b32 v59, -1
    v_mov_b32 v60, -1
    v_mov_b32 v61, -1
    v_mov_b32 v62, -1
    v_mov_b32 v63, -1
    s_waitcnt vmcnt(0)
    buffer_load_dwordx4 v[52:55], v0, s[8:11], s71 offen offset:0 sc1
    buffer_load_dwordx4 v[56:59], v0, s[8:11], s71 offen offset:1024 sc1
    buffer_load_dwordx4 v[60:63], v0, s[8:11], s71 offen offset:2048 sc1
    s_sleep 2
    buffer_load_dwordx4 v[52:55], v0, s[8:11], s71 offen offset:0 sc1
    buffer_load_dwordx4 v[56:59], v0, s[8:11], s71 offen offset:1024 sc1
    buffer_load_dwordx4 v[60:63], v0, s[8:11], s71 offen offset:2048 sc1
Lmp_118:
    s_waitcnt vmcnt(3)
    v_max3_u32 v88, v52, v53, v54
    v_max3_u32 v88, v88, v55, v56
    v_max3_u32 v88, v88, v57, v58
    v_max3_u32 v88, v88, v59, v60
    v_max3_u32 v88, v88, v61, v62
    v_max3_u32 v88, v88, v63, v63
    v_cmp_eq_u32 vcc, -1, v88
    ds_write_b128 v0, v[52:55] offset:0
    s_cbranch_vccnz Lmpr_120
Lmpd_119:
    v_smfmac_f32_16x16x64_bf16 v[28:31], v[52:55], a[0:7], v7
    ds_write_b128 v0, v[56:59] offset:1024
    v_smfmac_f32_16x16x64_bf16 v[36:39], v[52:55], a[8:15], v7
    ds_write_b128 v0, v[60:63] offset:2048
    v_smfmac_f32_16x16x64_bf16 v[44:47], v[52:55], a[16:23], v7
    v_smfmac_f32_16x16x64_bf16 v[32:35], v[52:55], a[24:31], v7
    v_smfmac_f32_16x16x64_bf16 v[40:43], v[52:55], a[32:39], v7
    v_smfmac_f32_16x16x64_bf16 v[48:51], v[52:55], a[40:47], v7
    v_smfmac_f32_16x16x64_bf16 v[28:31], v[56:59], a[48:55], v7
    v_smfmac_f32_16x16x64_bf16 v[36:39], v[56:59], a[56:63], v7
    v_smfmac_f32_16x16x64_bf16 v[44:47], v[56:59], a[64:71], v7
    s_waitcnt lgkmcnt(0)
    s_barrier
    v_smfmac_f32_16x16x64_bf16 v[32:35], v[56:59], a[72:79], v7
    ds_read_b128 v[64:67], v4 offset:0
    v_smfmac_f32_16x16x64_bf16 v[40:43], v[56:59], v[92:99], v7
    ds_read_b128 v[68:71], v4 offset:1024
    v_smfmac_f32_16x16x64_bf16 v[48:51], v[56:59], a[80:87], v7
    ds_read_b128 v[72:75], v5 offset:0
    v_smfmac_f32_16x16x64_bf16 v[28:31], v[60:63], a[88:95], v7
    ds_read_b128 v[76:79], v5 offset:1024
    v_smfmac_f32_16x16x64_bf16 v[36:39], v[60:63], a[96:103], v7
    ds_read_b128 v[80:83], v5 offset:2048
    v_smfmac_f32_16x16x64_bf16 v[44:47], v[60:63], v[100:107], v7
    ds_read_b128 v[92:95], v9 offset:6144
    ds_read_b128 v[84:87], v6 offset:0
    v_smfmac_f32_16x16x64_bf16 v[32:35], v[60:63], a[104:111], v7
    ds_read_b128 v[96:99], v9 offset:7168
    ds_read_b128 v[88:91], v6 offset:1024
    v_smfmac_f32_16x16x64_bf16 v[40:43], v[60:63], a[112:119], v7
    ds_read_b128 v[100:103], v9 offset:8192
    v_smfmac_f32_16x16x64_bf16 v[48:51], v[60:63], a[120:127], v7
    s_waitcnt lgkmcnt(9)
    ds_read_b128 v[104:107], v9 offset:9216
    v_smfmac_f32_16x16x64_bf16 v[28:31], v[64:67], v[108:115], v7
    ds_read_b128 v[108:111], v9 offset:10240
    v_smfmac_f32_16x16x64_bf16 v[32:35], v[64:67], a[128:135], v7
    s_waitcnt lgkmcnt(10)
    ds_read_b128 v[112:115], v9 offset:11264
    v_smfmac_f32_16x16x64_bf16 v[28:31], v[68:71], a[136:143], v7
    s_waitcnt lgkmcnt(5)
    v_smfmac_f32_16x16x64_bf16 v[32:35], v[68:71], v[92:99], v7
    ds_read_b128 v[92:95], v9 offset:12288
    v_smfmac_f32_16x16x64_bf16 v[28:31], v[72:75], a[144:151], v7
    ds_read_b128 v[96:99], v9 offset:13312
    v_smfmac_f32_16x16x64_bf16 v[32:35], v[72:75], a[152:159], v7
    v_smfmac_f32_16x16x64_bf16 v[28:31], v[76:79], a[160:167], v7
    s_waitcnt lgkmcnt(4)
    v_smfmac_f32_16x16x64_bf16 v[32:35], v[76:79], v[100:107], v7
    ds_read_b128 v[100:103], v9 offset:14336
    v_smfmac_f32_16x16x64_bf16 v[28:31], v[80:83], a[168:175], v7
    ds_read_b128 v[104:107], v9 offset:15360
    v_smfmac_f32_16x16x64_bf16 v[32:35], v[80:83], a[176:183], v7
    v_smfmac_f32_16x16x64_bf16 v[28:31], v[84:87], a[184:191], v7
    s_waitcnt lgkmcnt(4)
    v_smfmac_f32_16x16x64_bf16 v[32:35], v[84:87], v[108:115], v7
    ds_read_b128 v[108:111], v9 offset:16384
    v_smfmac_f32_16x16x64_bf16 v[28:31], v[88:91], a[192:199], v7
    ds_read_b128 v[112:115], v9 offset:17408
    v_smfmac_f32_16x16x64_bf16 v[32:35], v[88:91], a[200:207], v7
    v_smfmac_f32_16x16x64_bf16 v[36:39], v[64:67], a[208:215], v7
    s_waitcnt lgkmcnt(4)
    v_smfmac_f32_16x16x64_bf16 v[40:43], v[64:67], v[92:99], v7
    ds_read_b128 v[92:95], v9 offset:18432
    v_smfmac_f32_16x16x64_bf16 v[36:39], v[68:71], a[216:223], v7
    ds_read_b128 v[96:99], v9 offset:19456
    v_smfmac_f32_16x16x64_bf16 v[40:43], v[68:71], a[224:231], v7
    s_waitcnt lgkmcnt(4)
    v_smfmac_f32_16x16x64_bf16 v[36:39], v[72:75], v[100:107], v7
    ds_read_b128 v[100:103], v9 offset:20480
    v_smfmac_f32_16x16x64_bf16 v[40:43], v[72:75], a[232:239], v7
    ds_read_b128 v[104:107], v9 offset:21504
    v_smfmac_f32_16x16x64_bf16 v[36:39], v[76:79], a[240:247], v7
    v_add_f32 v28, v28, v30
    v_smfmac_f32_16x16x64_bf16 v[40:43], v[76:79], a[248:255], v7
    s_waitcnt lgkmcnt(4)
    v_add_f32 v29, v29, v31
    v_smfmac_f32_16x16x64_bf16 v[36:39], v[80:83], v[108:115], v7
    ds_read_b128 v[108:111], v9 offset:22528
    v_add_f32 v32, v32, v34
    v_smfmac_f32_16x16x64_bf16 v[40:43], v[80:83], v[144:151], v7
    ds_read_b128 v[112:115], v9 offset:23552
    v_add_f32 v33, v33, v35
    v_smfmac_f32_16x16x64_bf16 v[36:39], v[84:87], v[152:159], v7
    v_cvt_pk_bf16_f32 v28, v28, v29
    v_smfmac_f32_16x16x64_bf16 v[40:43], v[84:87], v[160:167], v7
    s_waitcnt lgkmcnt(4)
    v_cvt_pk_bf16_f32 v29, v32, v33
    v_smfmac_f32_16x16x64_bf16 v[36:39], v[88:91], v[92:99], v7
    ds_read_b128 v[92:95], v9 offset:24576
    v_smfmac_f32_16x16x64_bf16 v[40:43], v[88:91], v[168:175], v7
    ds_read_b128 v[96:99], v9 offset:25600
    v_smfmac_f32_16x16x64_bf16 v[44:47], v[64:67], v[176:183], v7
    v_smfmac_f32_16x16x64_bf16 v[48:51], v[64:67], v[184:191], v7
    s_waitcnt lgkmcnt(4)
    v_smfmac_f32_16x16x64_bf16 v[44:47], v[68:71], v[100:107], v7
    ds_read_b128 v[100:103], v9 offset:26624
    v_smfmac_f32_16x16x64_bf16 v[48:51], v[68:71], v[192:199], v7
    ds_read_b128 v[104:107], v9 offset:27648
    v_smfmac_f32_16x16x64_bf16 v[44:47], v[72:75], v[200:207], v7
    s_waitcnt lgkmcnt(4)
    s_waitcnt vmcnt(0)
    v_smfmac_f32_16x16x64_bf16 v[48:51], v[72:75], v[108:115], v7
    v_smfmac_f32_16x16x64_bf16 v[44:47], v[76:79], v[208:215], v7
    v_add_f32 v36, v36, v38
    v_smfmac_f32_16x16x64_bf16 v[48:51], v[76:79], v[216:223], v7
    v_add_f32 v37, v37, v39
    v_smfmac_f32_16x16x64_bf16 v[44:47], v[80:83], v[224:231], v7
    s_waitcnt lgkmcnt(2)
    v_add_f32 v40, v40, v42
    v_smfmac_f32_16x16x64_bf16 v[48:51], v[80:83], v[92:99], v7
    v_add_f32 v41, v41, v43
    v_smfmac_f32_16x16x64_bf16 v[44:47], v[84:87], v[232:239], v7
    v_cvt_pk_bf16_f32 v36, v36, v37
    v_smfmac_f32_16x16x64_bf16 v[48:51], v[84:87], v[240:247], v7
    v_cvt_pk_bf16_f32 v37, v40, v41
    v_smfmac_f32_16x16x64_bf16 v[44:47], v[88:91], v[248:255], v7
    s_waitcnt lgkmcnt(0)
    v_smfmac_f32_16x16x64_bf16 v[48:51], v[88:91], v[100:107], v7
    s_nop 1
    v_mfma_f32_16x16x16_bf16 v[32:35], v[28:29], v[18:19], 0
    v_mfma_f32_16x16x16_bf16 v[40:43], v[36:37], v[18:19], 0
    s_nop 1
    v_pk_add_f32 v[44:45], v[44:45], v[46:47]
    s_nop 0
    v_pk_add_f32 v[48:49], v[48:49], v[50:51]
    v_cvt_pk_bf16_f32 v44, v44, v45
    v_cvt_pk_bf16_f32 v45, v48, v49
    v_cvt_pk_bf16_f32 v22, v32, v33
    v_cvt_pk_bf16_f32 v23, v34, v35
    v_mfma_f32_16x16x16_bf16 v[48:51], v[44:45], v[18:19], 0
    v_cvt_pk_bf16_f32 v24, v40, v41
    v_cvt_pk_bf16_f32 v25, v42, v43
    s_nop 1
    v_mfma_f32_16x16x32_bf16 v[52:55], v[22:25], v[22:25], 0
    v_mfma_f32_16x16x32_bf16 v[56:59], v[120:123], v[22:25], 0
    v_mfma_f32_16x16x32_bf16 v[60:63], v[124:127], v[22:25], 0
    s_nop 0
    v_cvt_pk_bf16_f32 v26, v48, v49
    v_cvt_pk_bf16_f32 v27, v50, v51
    s_nop 1
    v_mfma_f32_16x16x16_bf16 v[56:59], v[128:129], v[26:27], v[56:59]
    v_mfma_f32_16x16x16_bf16 v[60:63], v[130:131], v[26:27], v[60:63]
    v_mfma_f32_16x16x16_bf16 v[52:55], v[26:27], v[26:27], v[52:55]
    s_nop 5
    v_mov_b32_dpp v58, v56 row_ror:8 row_mask:0xf bank_mask:0xc
    v_mov_b32_dpp v59, v57 row_ror:8 row_mask:0xf bank_mask:0xc
    v_mov_b32_dpp v60, v62 row_ror:8 row_mask:0xf bank_mask:0xc
    v_mov_b32_dpp v61, v63 row_ror:8 row_mask:0xf bank_mask:0xc
    ds_write_b128 v15, v[58:61]
    v_mov_b32_dpp v52, v54 row_ror:8 row_mask:0xf bank_mask:0xc
    v_mov_b32_dpp v53, v55 row_ror:8 row_mask:0xf bank_mask:0xc
    ds_write_b64 v17, v[52:53]
    s_cmp_lg_u32 s4, 0
    s_waitcnt lgkmcnt(0)
    s_barrier
    s_cbranch_scc1 Lqs_121
    ds_read_b128 v[28:31], v16 offset:10240
    ds_read_b128 v[32:35], v16 offset:11264
    ds_read_b128 v[36:39], v16 offset:12288
    ds_read_b128 v[40:43], v16 offset:13312
    ds_read2st64_b32 v[44:45], v2 offset0:56 offset1:58
    ds_read2st64_b32 v[46:47], v2 offset0:60 offset1:62
    s_waitcnt lgkmcnt(4)
    v_pk_add_f32 v[28:29], v[28:29], v[32:33]
    v_pk_add_f32 v[30:31], v[30:31], v[34:35]
    s_waitcnt lgkmcnt(2)
    v_pk_add_f32 v[36:37], v[36:37], v[40:41]
    v_pk_add_f32 v[38:39], v[38:39], v[42:43]
    s_waitcnt lgkmcnt(0)
    v_pk_add_f32 v[44:45], v[44:45], v[46:47]
    v_pk_add_f32 v[28:29], v[28:29], v[36:37]
    v_pk_add_f32 v[30:31], v[30:31], v[38:39]
    v_add_f32 v44, v44, v45
    v_max3_f32 v46, v28, v29, v44
    v_max3_f32 v46, v30, v31, v46
    v_pk_mul_f32 v[28:29], v[28:29], s[100:101]
    v_pk_mul_f32 v[30:31], v[30:31], s[100:101]
    v_max_f32_dpp v46, v46, v46 quad_perm:[1,0,3,2] row_mask:0xf bank_mask:0xf
    v_mul_f32 v44, s100, v44
    s_nop 0
    v_max_f32_dpp v46, v46, v46 quad_perm:[2,3,0,1] row_mask:0xf bank_mask:0xf
    s_nop 1
    v_max_f32_dpp v46, v46, v46 row_half_mirror row_mask:0xf bank_mask:0xf
    v_pk_fma_f32 v[28:29], v[46:47], s[100:101], v[28:29] op_sel_hi:[0,1,1] neg_lo:[1,0,0] neg_hi:[1,0,0]
    v_pk_fma_f32 v[30:31], v[46:47], s[100:101], v[30:31] op_sel_hi:[0,1,1] neg_lo:[1,0,0] neg_hi:[1,0,0]
    v_fma_f32 v44, -v46, s100, v44
    v_exp_f32 v28, v28
    v_exp_f32 v29, v29
    v_exp_f32 v30, v30
    v_exp_f32 v31, v31
    v_exp_f32 v44, v44
    v_pk_add_f32 v[46:47], v[28:29], v[30:31]
    v_add_f32 v46, v46, v44
    v_add_f32 v46, v46, v47
    v_mov_b32_dpp v45, v44 quad_perm:[1,0,3,2] row_mask:0xf bank_mask:0xf
    s_nop 0
    v_add_f32_dpp v46, v46, v46 quad_perm:[1,0,3,2] row_mask:0xf bank_mask:0xf
    s_nop 1
    v_add_f32_dpp v46, v46, v46 quad_perm:[2,3,0,1] row_mask:0xf bank_mask:0xf
    s_nop 1
    v_add_f32_dpp v46, v46, v46 row_half_mirror row_mask:0xf bank_mask:0xf
    v_rcp_f32 v46, v46
    s_nop 0
    v_pk_mul_f32 v[28:29], v[28:29], v[46:47] op_sel_hi:[1,0]
    v_pk_mul_f32 v[30:31], v[30:31], v[46:47] op_sel_hi:[1,0]
    v_cvt_pk_bf16_f32 v28, v28, v29
    v_cvt_pk_bf16_f32 v29, v30, v31
    buffer_store_dwordx2 v[28:29], v10, s[8:11], s73 offen sc1
    v_pk_mul_f32 v[44:45], v[44:45], v[46:47] op_sel_hi:[1,0]
    v_cvt_pk_bf16_f32 v44, v44, v45
    buffer_store_dword v44, v11, s[8:11], s73 offen sc1
    v_mov_b32 v30, -1
    v_mov_b32 v31, -1
    buffer_store_dwordx2 v[30:31], v10, s[8:11], s55 offen sc1
    buffer_store_dword v30, v11, s[8:11], s55 offen sc1
Lqs_121:
    v_mfma_f32_16x16x32_bf16 v[64:67], v[22:25], v[132:135], 0
    v_mfma_f32_16x16x32_bf16 v[68:71], v[22:25], v[136:139], 0
    v_mfma_f32_16x16x32_bf16 v[72:75], v[120:123], v[132:135], 0
    v_mfma_f32_16x16x32_bf16 v[76:79], v[120:123], v[136:139], 0
    v_mfma_f32_16x16x32_bf16 v[80:83], v[124:127], v[136:139], 0
    s_mul_i32 s37, s4, 6144
    v_bfe_u32 v84, v8, 4, 4
    v_lshrrev_b32 v85, 8, v8
    v_lshl_add_u32 v86, v85, 1, v84
    v_add_u32 v87, 1, v86
    v_mfma_f32_16x16x16_bf16 v[64:67], v[26:27], v[140:141], v[64:67]
    v_mfma_f32_16x16x16_bf16 v[68:71], v[26:27], v[142:143], v[68:71]
    v_mfma_f32_16x16x16_bf16 v[72:75], v[128:129], v[140:141], v[72:75]
    v_mfma_f32_16x16x16_bf16 v[76:79], v[128:129], v[142:143], v[76:79]
    v_mfma_f32_16x16x16_bf16 v[80:83], v[130:131], v[142:143], v[80:83]
    v_and_b32 v86, 7, v86
    v_lshl_add_u32 v86, v84, 3, v86
    v_lshl_add_u32 v86, v86, 4, s37
    v_and_b32 v87, 7, v87
    v_lshl_add_u32 v87, v84, 3, v87
    v_lshl_add_u32 v87, v87, 4, s37
    v_and_b32 v88, 1, v85
    v_lshl_add_u32 v88, v84, 1, v88
    v_lshl_add_u32 v88, v88, 4, s37
    v_lshrrev_b32 v85, 1, v85
    v_xor_b32 v85, 1, v85
    v_lshl_add_u32 v88, v85, 9, v88
    ds_write_b128 v88, v[64:67] offset:18432
    ds_write_b128 v88, v[68:71] offset:21504
    ds_write_b128 v86, v[72:75] offset:16384
    ds_write_b128 v86, v[76:79] offset:19456
    ds_write_b128 v87, v[80:83] offset:19456
    s_lshr_b32 s37, s4, 1
    s_mul_i32 s37, s37, 3072
    s_and_b32 s38, s4, 1
    s_lshl_b32 s38, s38, 8
    s_add_u32 s39, s37, s38
    v_add_u32 v84, s39, v2
    s_lshl_b32 s38, s38, 2
    s_add_u32 s39, s37, s38
    v_add_u32 v85, s39, v16
    v_mov_b32 v89, 0xd04e79ff
    s_waitcnt lgkmcnt(0)
    s_barrier
    s_add_u32 s69, s66, 2
    s_min_u32 s69, s69, 64
    v_cmp_gt_u32 vcc, s69, v12
    s_cbranch_vccz Lfgd_123
Lfg_122:
    buffer_load_dword v12, v13, s[8:11], 0 offen sc1
    s_waitcnt vmcnt(0)
    v_cmp_gt_u32 vcc, s69, v12
    s_cbranch_vccz Lfgd_123
    s_sleep 1
    s_sub_u32 s36, s36, 1
    s_cbranch_scc0 Lfg_122
    s_mov_b32 s36, 0
Lfgd_123:
    buffer_load_dwordx4 v[120:123], v8, s[8:11], s75 offen offset:0 sc1 nt
    buffer_load_dwordx4 v[124:127], v8, s[8:11], s75 offen offset:1024 sc1 nt
    buffer_load_dwordx4 v[128:131], v8, s[8:11], s75 offen offset:2048 sc1 nt
    buffer_load_dwordx4 v[132:135], v8, s[8:11], s76 offen offset:0 sc1 nt
    buffer_load_dwordx4 v[136:139], v8, s[8:11], s76 offen offset:1024 sc1 nt
    buffer_load_dwordx4 v[140:143], v8, s[8:11], s76 offen offset:2048 sc1 nt
    s_add_u32 s75, s75, 12288
    s_add_u32 s76, s76, 12288
    ds_read_b128 v[28:31], v85 offset:16384
    ds_read_b128 v[32:35], v85 offset:22528
    ds_read_b128 v[36:39], v85 offset:28672
    ds_read_b128 v[40:43], v85 offset:34816
    ds_read2st64_b32 v[44:45], v84 offset0:72 offset1:96
    ds_read2st64_b32 v[46:47], v84 offset0:120 offset1:144
    s_waitcnt lgkmcnt(4)
    v_pk_add_f32 v[28:29], v[28:29], v[32:33]
    v_pk_add_f32 v[30:31], v[30:31], v[34:35]
    s_waitcnt lgkmcnt(2)
    v_pk_add_f32 v[36:37], v[36:37], v[40:41]
    v_pk_add_f32 v[38:39], v[38:39], v[42:43]
    s_waitcnt lgkmcnt(0)
    v_pk_add_f32 v[44:45], v[44:45], v[46:47]
    v_pk_add_f32 v[28:29], v[28:29], v[36:37]
    v_pk_add_f32 v[30:31], v[30:31], v[38:39]
    v_add_f32 v44, v44, v45
    v_cndmask_b32 v28, v89, v28, s[40:41]
    v_cndmask_b32 v29, v89, v29, s[42:43]
    v_cndmask_b32 v30, v89, v30, s[44:45]
    v_cndmask_b32 v31, v89, v31, s[46:47]
    v_max3_f32 v46, v28, v29, v44
    v_max3_f32 v46, v30, v31, v46
    v_pk_mul_f32 v[28:29], v[28:29], s[100:101]
    v_pk_mul_f32 v[30:31], v[30:31], s[100:101]
    v_max_f32_dpp v46, v46, v46 quad_perm:[1,0,3,2] row_mask:0xf bank_mask:0xf
    v_mul_f32 v44, s100, v44
    s_nop 0
    v_max_f32_dpp v46, v46, v46 quad_perm:[2,3,0,1] row_mask:0xf bank_mask:0xf
    s_nop 1
    v_max_f32_dpp v46, v46, v46 row_half_mirror row_mask:0xf bank_mask:0xf
    v_pk_fma_f32 v[28:29], v[46:47], s[100:101], v[28:29] op_sel_hi:[0,1,1] neg_lo:[1,0,0] neg_hi:[1,0,0]
    v_pk_fma_f32 v[30:31], v[46:47], s[100:101], v[30:31] op_sel_hi:[0,1,1] neg_lo:[1,0,0] neg_hi:[1,0,0]
    v_fma_f32 v44, -v46, s100, v44
    v_exp_f32 v28, v28
    v_exp_f32 v29, v29
    v_exp_f32 v30, v30
    v_exp_f32 v31, v31
    v_exp_f32 v44, v44
    v_pk_add_f32 v[46:47], v[28:29], v[30:31]
    v_add_f32 v46, v46, v44
    v_add_f32 v46, v46, v47
    v_mov_b32_dpp v45, v44 quad_perm:[1,0,3,2] row_mask:0xf bank_mask:0xf
    s_nop 0
    v_add_f32_dpp v46, v46, v46 quad_perm:[1,0,3,2] row_mask:0xf bank_mask:0xf
    s_nop 1
    v_add_f32_dpp v46, v46, v46 quad_perm:[2,3,0,1] row_mask:0xf bank_mask:0xf
    s_nop 1
    v_add_f32_dpp v46, v46, v46 row_half_mirror row_mask:0xf bank_mask:0xf
    v_rcp_f32 v46, v46
    s_nop 0
    v_pk_mul_f32 v[28:29], v[28:29], v[46:47] op_sel_hi:[1,0]
    v_pk_mul_f32 v[30:31], v[30:31], v[46:47] op_sel_hi:[1,0]
    v_cvt_pk_bf16_f32 v28, v28, v29
    v_cvt_pk_bf16_f32 v29, v30, v31
    buffer_store_dwordx2 v[28:29], v1, s[8:11], s77 offen sc1
    v_pk_mul_f32 v[44:45], v[44:45], v[46:47] op_sel_hi:[1,0]
    v_cvt_pk_bf16_f32 v44, v44, v45
    buffer_store_dword v44, v14, s[8:11], s77 offen sc1
    s_mov_b32 s37, s73
    s_mov_b32 s73, s74
    s_mov_b32 s74, s55
    s_mov_b32 s55, s37
    s_mov_b32 s37, s77
    s_mov_b32 s77, s78
    s_mov_b32 s78, s54
    s_mov_b32 s54, s37
    s_add_u32 s66, s66, 1
    s_cmp_lt_u32 s66, 64
    s_cbranch_scc1 L_RQ_slow
    s_waitcnt vmcnt(0)
    v_mov_b32 v3, s66
    s_mov_b64 exec, 1
    buffer_store_dword v3, off, s[8:11], s79 sc1
    s_mov_b64 exec, -1
    s_branch L_RQ_fin
Lmpr_120:
    v_max3_u32 v88, v52, v53, v54
    v_max_u32 v88, v88, v55
    v_cmp_eq_u32 s[56:57], -1, v88
    v_max3_u32 v88, v56, v57, v58
    v_max_u32 v88, v88, v59
    v_cmp_eq_u32 s[58:59], -1, v88
    v_max3_u32 v88, v60, v61, v62
    v_max_u32 v88, v88, v63
    v_cmp_eq_u32 s[60:61], -1, v88
    s_mov_b64 exec, s[56:57]
    buffer_load_dwordx4 v[52:55], v0, s[8:11], s71 offen offset:0 sc1
    s_mov_b64 exec, s[58:59]
    buffer_load_dwordx4 v[56:59], v0, s[8:11], s71 offen offset:1024 sc1
    s_mov_b64 exec, s[60:61]
    buffer_load_dwordx4 v[60:63], v0, s[8:11], s71 offen offset:2048 sc1
    s_mov_b64 exec, -1
    s_sub_u32 s36, s36, 1
    s_cbranch_scc0 Lmp_118
    s_mov_b32 s36, 0
    s_waitcnt vmcnt(0)
    s_branch Lmpd_119
L_RQ_fin:
    s_waitcnt vmcnt(0)
    s_cmp_lg_u32 s36, 0
    s_cbranch_scc1 Lfin_124
    s_mov_b64 exec, 1
    v_mov_b32 v2, 1
    v_mov_b32 v3, 44
    buffer_atomic_add v2, v3, s[28:31], 0 offen
    s_mov_b64 exec, -1
Lfin_124:
    s_endpgm
L_RV:
    s_mov_b32 s16, s48
    s_and_b32 s17, s49, 0xffff
    s_mov_b32 s18, 0x780000
    s_mov_b32 s19, 0x20000
    s_mov_b32 s20, s50
    s_and_b32 s21, s51, 0xffff
    s_mov_b32 s22, 0x780000
    s_mov_b32 s23, 0x20000
    s_lshl_b32 s37, s68, 2
    s_add_u32 s37, s37, s4
    s_cmp_eq_u32 s37, 3
    s_cselect_b32 s76, 1879048060, 0
    s_sub_u32 s76, 0x70000000, s76
    s_mul_i32 s73, s68, 10240
    s_add_u32 s73, s73, 85983232
    s_add_u32 s74, s73, 327680
    s_add_u32 s78, s73, 655360
    v_mov_b32 v4, -1
    v_mov_b32 v5, -1
    v_mov_b32 v6, -1
    v_mov_b32 v7, -1
    v_lshlrev_b32 v8, 4, v1
    s_mul_i32 s75, s4, 2560
    s_add_u32 s37, s75, s73
    buffer_store_dwordx4 v[4:7], v8, s[8:11], s37 offen offset:0 sc1
    buffer_store_dwordx4 v[4:7], v8, s[8:11], s37 offen offset:1024 sc1
    buffer_store_dwordx4 v[4:7], v8, s[8:11], s37 offen offset:1536 sc1
    s_add_u32 s37, s75, s74
    buffer_store_dwordx4 v[4:7], v8, s[8:11], s37 offen offset:0 sc1
    buffer_store_dwordx4 v[4:7], v8, s[8:11], s37 offen offset:1024 sc1
    buffer_store_dwordx4 v[4:7], v8, s[8:11], s37 offen offset:1536 sc1
    s_mov_b32 s70, 12288
    s_mul_i32 s71, s68, 384
    s_mul_i32 s72, s68, 245760
    v_add_u32 v16, 0, v1
    v_mul_u32_u24 v17, 2731, v16
    v_lshrrev_b32 v17, 16, v17
    v_mul_u32_u24 v18, 24, v17
    v_sub_u32 v16, v16, v18
    v_and_b32 v18, 2, v17
    v_xor_b32 v16, v16, v18
    v_and_b32 v18, 8, v17
    v_lshrrev_b32 v18, 1, v18
    v_xor_b32 v16, v16, v18
    s_lshl_b32 s37, s4, 4
    v_add_u32 v17, s37, v17
    v_mul_lo_u32 v17, v17, s70
    v_lshl_add_u32 v16, v16, 4, v17
    v_add_u32 v4, s71, v16
    v_add_u32 v16, 64, v1
    v_mul_u32_u24 v17, 2731, v16
    v_lshrrev_b32 v17, 16, v17
    v_mul_u32_u24 v18, 24, v17
    v_sub_u32 v16, v16, v18
    v_and_b32 v18, 2, v17
    v_xor_b32 v16, v16, v18
    v_and_b32 v18, 8, v17
    v_lshrrev_b32 v18, 1, v18
    v_xor_b32 v16, v16, v18
    s_lshl_b32 s37, s4, 4
    v_add_u32 v17, s37, v17
    v_mul_lo_u32 v17, v17, s70
    v_lshl_add_u32 v16, v16, 4, v17
    v_add_u32 v5, s71, v16
    v_add_u32 v16, 128, v1
    v_mul_u32_u24 v17, 2731, v16
    v_lshrrev_b32 v17, 16, v17
    v_mul_u32_u24 v18, 24, v17
    v_sub_u32 v16, v16, v18
    v_and_b32 v18, 2, v17
    v_xor_b32 v16, v16, v18
    v_and_b32 v18, 8, v17
    v_lshrrev_b32 v18, 1, v18
    v_xor_b32 v16, v16, v18
    s_lshl_b32 s37, s4, 4
    v_add_u32 v17, s37, v17
    v_mul_lo_u32 v17, v17, s70
    v_lshl_add_u32 v16, v16, 4, v17
    v_add_u32 v6, s71, v16
    v_add_u32 v16, 192, v1
    v_mul_u32_u24 v17, 2731, v16
    v_lshrrev_b32 v17, 16, v17
    v_mul_u32_u24 v18, 24, v17
    v_sub_u32 v16, v16, v18
    v_and_b32 v18, 2, v17
    v_xor_b32 v16, v16, v18
    v_and_b32 v18, 8, v17
    v_lshrrev_b32 v18, 1, v18
    v_xor_b32 v16, v16, v18
    s_lshl_b32 s37, s4, 4
    v_add_u32 v17, s37, v17
    v_mul_lo_u32 v17, v17, s70
    v_lshl_add_u32 v16, v16, 4, v17
    v_add_u32 v7, s71, v16
    v_add_u32 v16, 256, v1
    v_mul_u32_u24 v17, 2731, v16
    v_lshrrev_b32 v17, 16, v17
    v_mul_u32_u24 v18, 24, v17
    v_sub_u32 v16, v16, v18
    v_and_b32 v18, 2, v17
    v_xor_b32 v16, v16, v18
    v_and_b32 v18, 8, v17
    v_lshrrev_b32 v18, 1, v18
    v_xor_b32 v16, v16, v18
    s_lshl_b32 s37, s4, 4
    v_add_u32 v17, s37, v17
    v_mul_lo_u32 v17, v17, s70
    v_lshl_add_u32 v16, v16, 4, v17
    v_add_u32 v8, s71, v16
    v_add_u32 v16, 320, v1
    v_mul_u32_u24 v17, 2731, v16
    v_lshrrev_b32 v17, 16, v17
    v_mul_u32_u24 v18, 24, v17
    v_sub_u32 v16, v16, v18
    v_and_b32 v18, 2, v17
    v_xor_b32 v16, v16, v18
    v_and_b32 v18, 8, v17
    v_lshrrev_b32 v18, 1, v18
    v_xor_b32 v16, v16, v18
    s_lshl_b32 s37, s4, 4
    v_add_u32 v17, s37, v17
    v_mul_lo_u32 v17, v17, s70
    v_lshl_add_u32 v16, v16, 4, v17
    v_add_u32 v9, s71, v16
    v_lshrrev_b32 v16, 4, v1
    v_bfe_u32 v17, v1, 2, 2
    v_lshl_add_u32 v18, v16, 3, v17
    v_lshrrev_b32 v18, 5, v1
    v_lshl_add_u32 v18, v18, 2, v17
    v_bfe_u32 v17, v1, 4, 1
    v_lshl_add_u32 v18, v18, 1, v17
    v_lshlrev_b32 v18, 1, v18
    v_mov_b32 v17, v18
    v_bfe_u32 v16, v1, 3, 1
    v_mul_u32_u24 v13, 384, v18
    v_and_b32 v14, 1, v1
    v_lshl_add_u32 v13, v14, 3, v13
    v_and_b32 v17, 2, v17
    v_and_b32 v16, 1, v16
    v_lshl_or_b32 v17, v16, 2, v17
    v_bfe_u32 v16, v1, 1, 1
    s_mul_i32 s37, s4, 6
    v_add_u32 v18, s37, v16
    v_add_u32 v18, 0, v18
    v_xor_b32 v18, v18, v17
    v_lshl_add_u32 v10, v18, 4, v13
    v_add_u32 v18, s37, v16
    v_add_u32 v18, 2, v18
    v_xor_b32 v18, v18, v17
    v_lshl_add_u32 v11, v18, 4, v13
    v_add_u32 v18, s37, v16
    v_add_u32 v18, 4, v18
    v_xor_b32 v18, v18, v17
    v_lshl_add_u32 v12, v18, 4, v13
    s_mul_i32 s90, s4, 6144
    s_lshl_b32 s92, s70, 6
    s_lshl_b32 s37, s4, 2
    v_add_u32 v2, 0, v1
    v_mul_u32_u24 v3, 820, v2
    v_lshrrev_b32 v3, 16, v3
    v_mul_u32_u24 v16, 80, v3
    v_sub_u32 v2, v2, v16
    v_add_u32 v3, s37, v3
    v_and_b32 v16, 7, v3
    v_lshlrev_b32 v16, 1, v16
    v_xor_b32 v2, v2, v16
    v_mul_u32_u24 v3, 1280, v3
    v_lshl_add_u32 v19, v2, 4, v3
    v_add_u32 v2, 64, v1
    v_mul_u32_u24 v3, 820, v2
    v_lshrrev_b32 v3, 16, v3
    v_mul_u32_u24 v16, 80, v3
    v_sub_u32 v2, v2, v16
    v_add_u32 v3, s37, v3
    v_and_b32 v16, 7, v3
    v_lshlrev_b32 v16, 1, v16
    v_xor_b32 v2, v2, v16
    v_mul_u32_u24 v3, 1280, v3
    v_lshl_add_u32 v20, v2, 4, v3
    v_add_u32 v2, 128, v1
    v_mul_u32_u24 v3, 820, v2
    v_lshrrev_b32 v3, 16, v3
    v_mul_u32_u24 v16, 80, v3
    v_sub_u32 v2, v2, v16
    v_add_u32 v3, s37, v3
    v_and_b32 v16, 7, v3
    v_lshlrev_b32 v16, 1, v16
    v_xor_b32 v2, v2, v16
    v_mul_u32_u24 v3, 1280, v3
    v_lshl_add_u32 v21, v2, 4, v3
    v_add_u32 v2, 192, v1
    v_mul_u32_u24 v3, 820, v2
    v_lshrrev_b32 v3, 16, v3
    v_mul_u32_u24 v16, 80, v3
    v_sub_u32 v2, v2, v16
    v_add_u32 v3, s37, v3
    v_and_b32 v16, 7, v3
    v_lshlrev_b32 v16, 1, v16
    v_xor_b32 v2, v2, v16
    v_mul_u32_u24 v3, 1280, v3
    v_lshl_add_u32 v22, v2, 4, v3
    v_add_u32 v2, 256, v1
    v_mul_u32_u24 v3, 820, v2
    v_lshrrev_b32 v3, 16, v3
    v_mul_u32_u24 v16, 80, v3
    v_sub_u32 v2, v2, v16
    v_add_u32 v3, s37, v3
    v_and_b32 v16, 7, v3
    v_lshlrev_b32 v16, 1, v16
    v_xor_b32 v2, v2, v16
    v_mul_u32_u24 v3, 1280, v3
    v_lshl_add_u32 v23, v2, 4, v3
    s_mul_i32 s91, s4, 5120
    s_mul_i32 s37, s92, 9
    s_add_u32 m0, s90, 0
    s_nop 0
    buffer_load_dwordx4 v4, s[16:19], s37 offen nt lds
    s_add_u32 m0, s90, 1024
    s_nop 0
    buffer_load_dwordx4 v5, s[16:19], s37 offen nt lds
    s_add_u32 m0, s90, 2048
    s_nop 0
    buffer_load_dwordx4 v6, s[16:19], s37 offen nt lds
    s_add_u32 m0, s90, 3072
    s_nop 0
    buffer_load_dwordx4 v7, s[16:19], s37 offen nt lds
    s_add_u32 m0, s90, 4096
    s_nop 0
    buffer_load_dwordx4 v8, s[16:19], s37 offen nt lds
    s_add_u32 m0, s90, 5120
    s_nop 0
    buffer_load_dwordx4 v9, s[16:19], s37 offen nt lds
    s_mul_i32 s37, s92, 8
    s_add_u32 m0, s90, 24576
    s_nop 0
    buffer_load_dwordx4 v4, s[16:19], s37 offen nt lds
    s_add_u32 m0, s90, 25600
    s_nop 0
    buffer_load_dwordx4 v5, s[16:19], s37 offen nt lds
    s_add_u32 m0, s90, 26624
    s_nop 0
    buffer_load_dwordx4 v6, s[16:19], s37 offen nt lds
    s_add_u32 m0, s90, 27648
    s_nop 0
    buffer_load_dwordx4 v7, s[16:19], s37 offen nt lds
    s_add_u32 m0, s90, 28672
    s_nop 0
    buffer_load_dwordx4 v8, s[16:19], s37 offen nt lds
    s_add_u32 m0, s90, 29696
    s_nop 0
    buffer_load_dwordx4 v9, s[16:19], s37 offen nt lds
    s_waitcnt vmcnt(12)
    s_barrier
    s_cmp_lg_u32 s4, 0
    s_cbranch_scc1 Larr_125
    s_lshl_b32 s37, s7, 16
    s_add_u32 s37, s37, 1
    s_mov_b64 exec, 1
    v_mov_b32 v2, s37
    v_mov_b32 v3, 36
    buffer_atomic_add v2, v3, s[28:31], 0 offen
    s_mov_b64 exec, -1
Larr_125:
    s_mul_i32 s37, s92, 7
    s_add_u32 m0, s90, 49152
    s_nop 0
    buffer_load_dwordx4 v4, s[16:19], s37 offen nt lds
    s_add_u32 m0, s90, 50176
    s_nop 0
    buffer_load_dwordx4 v5, s[16:19], s37 offen nt lds
    s_add_u32 m0, s90, 51200
    s_nop 0
    buffer_load_dwordx4 v6, s[16:19], s37 offen nt lds
    s_add_u32 m0, s90, 52224
    s_nop 0
    buffer_load_dwordx4 v7, s[16:19], s37 offen nt lds
    s_add_u32 m0, s90, 53248
    s_nop 0
    buffer_load_dwordx4 v8, s[16:19], s37 offen nt lds
    s_add_u32 m0, s90, 54272
    s_nop 0
    buffer_load_dwordx4 v9, s[16:19], s37 offen nt lds
    s_mul_i32 s37, s92, 6
    s_add_u32 m0, s90, 73728
    s_nop 0
    buffer_load_dwordx4 v4, s[16:19], s37 offen nt lds
    s_add_u32 m0, s90, 74752
    s_nop 0
    buffer_load_dwordx4 v5, s[16:19], s37 offen nt lds
    s_add_u32 m0, s90, 75776
    s_nop 0
    buffer_load_dwordx4 v6, s[16:19], s37 offen nt lds
    s_add_u32 m0, s90, 76800
    s_nop 0
    buffer_load_dwordx4 v7, s[16:19], s37 offen nt lds
    s_add_u32 m0, s90, 77824
    s_nop 0
    buffer_load_dwordx4 v8, s[16:19], s37 offen nt lds
    s_add_u32 m0, s90, 78848
    s_nop 0
    buffer_load_dwordx4 v9, s[16:19], s37 offen nt lds
    s_mul_i32 s37, s92, 5
    s_add_u32 m0, s90, 98304
    s_nop 0
    buffer_load_dwordx4 v4, s[16:19], s37 offen nt lds
    s_add_u32 m0, s90, 99328
    s_nop 0
    buffer_load_dwordx4 v5, s[16:19], s37 offen nt lds
    s_add_u32 m0, s90, 100352
    s_nop 0
    buffer_load_dwordx4 v6, s[16:19], s37 offen nt lds
    s_add_u32 m0, s90, 101376
    s_nop 0
    buffer_load_dwordx4 v7, s[16:19], s37 offen nt lds
    s_add_u32 m0, s90, 102400
    s_nop 0
    buffer_load_dwordx4 v8, s[16:19], s37 offen nt lds
    s_add_u32 m0, s90, 103424
    s_nop 0
    buffer_load_dwordx4 v9, s[16:19], s37 offen nt lds
    s_mul_i32 s37, s92, 4
    s_add_u32 m0, s90, 122880
    s_nop 0
    buffer_load_dwordx4 v4, s[16:19], s37 offen nt lds
    s_add_u32 m0, s90, 123904
    s_nop 0
    buffer_load_dwordx4 v5, s[16:19], s37 offen nt lds
    s_add_u32 m0, s90, 124928
    s_nop 0
    buffer_load_dwordx4 v6, s[16:19], s37 offen nt lds
    s_add_u32 m0, s90, 125952
    s_nop 0
    buffer_load_dwordx4 v7, s[16:19], s37 offen nt lds
    s_add_u32 m0, s90, 126976
    s_nop 0
    buffer_load_dwordx4 v8, s[16:19], s37 offen nt lds
    s_add_u32 m0, s90, 128000
    s_nop 0
    buffer_load_dwordx4 v9, s[16:19], s37 offen nt lds
    s_cmp_eq_u32 s4, 1
    s_cbranch_scc1 Lpw_128
    s_cmp_eq_u32 s4, 2
    s_cbranch_scc1 Lpw_129
    s_cmp_eq_u32 s4, 3
    s_cbranch_scc1 Lpw_130
Lpw_127:
    s_waitcnt vmcnt(30)
    s_barrier
    v_add_u32 v13, 0, v10
    v_add_u32 v14, 0, v11
    v_add_u32 v15, 0, v12
    ds_read_b64_tr_b16 a[104:105], v13 offset:0
    ds_read_b64_tr_b16 a[144:145], v14 offset:0
    ds_read_b64_tr_b16 a[184:185], v15 offset:0
    ds_read_b64_tr_b16 a[106:107], v13 offset:384
    ds_read_b64_tr_b16 a[146:147], v14 offset:384
    ds_read_b64_tr_b16 a[186:187], v15 offset:384
    ds_read_b64_tr_b16 a[108:109], v13 offset:12288
    ds_read_b64_tr_b16 a[148:149], v14 offset:12288
    ds_read_b64_tr_b16 a[188:189], v15 offset:12288
    ds_read_b64_tr_b16 a[110:111], v13 offset:12672
    ds_read_b64_tr_b16 a[150:151], v14 offset:12672
    ds_read_b64_tr_b16 a[190:191], v15 offset:12672
    s_waitcnt lgkmcnt(0)
    s_barrier
    s_mul_i32 s37, s92, 3
    s_add_u32 m0, s90, 0
    s_nop 0
    buffer_load_dwordx4 v4, s[16:19], s37 offen nt lds
    s_add_u32 m0, s90, 1024
    s_nop 0
    buffer_load_dwordx4 v5, s[16:19], s37 offen nt lds
    s_add_u32 m0, s90, 2048
    s_nop 0
    buffer_load_dwordx4 v6, s[16:19], s37 offen nt lds
    s_add_u32 m0, s90, 3072
    s_nop 0
    buffer_load_dwordx4 v7, s[16:19], s37 offen nt lds
    s_add_u32 m0, s90, 4096
    s_nop 0
    buffer_load_dwordx4 v8, s[16:19], s37 offen nt lds
    s_add_u32 m0, s90, 5120
    s_nop 0
    buffer_load_dwordx4 v9, s[16:19], s37 offen nt lds
    s_waitcnt vmcnt(30)
    s_barrier
    v_add_u32 v13, 24576, v10
    v_add_u32 v14, 24576, v11
    v_add_u32 v15, 24576, v12
    ds_read_b64_tr_b16 v[32:33], v13 offset:0
    ds_read_b64_tr_b16 v[48:49], v14 offset:0
    ds_read_b64_tr_b16 v[64:65], v15 offset:0
    ds_read_b64_tr_b16 v[34:35], v13 offset:384
    ds_read_b64_tr_b16 v[50:51], v14 offset:384
    ds_read_b64_tr_b16 v[66:67], v15 offset:384
    ds_read_b64_tr_b16 v[36:37], v13 offset:12288
    ds_read_b64_tr_b16 v[52:53], v14 offset:12288
    ds_read_b64_tr_b16 v[68:69], v15 offset:12288
    ds_read_b64_tr_b16 v[38:39], v13 offset:12672
    ds_read_b64_tr_b16 v[54:55], v14 offset:12672
    ds_read_b64_tr_b16 v[70:71], v15 offset:12672
    s_waitcnt lgkmcnt(0)
    s_barrier
    s_mul_i32 s37, s92, 2
    s_add_u32 m0, s90, 24576
    s_nop 0
    buffer_load_dwordx4 v4, s[16:19], s37 offen nt lds
    s_add_u32 m0, s90, 25600
    s_nop 0
    buffer_load_dwordx4 v5, s[16:19], s37 offen nt lds
    s_add_u32 m0, s90, 26624
    s_nop 0
    buffer_load_dwordx4 v6, s[16:19], s37 offen nt lds
    s_add_u32 m0, s90, 27648
    s_nop 0
    buffer_load_dwordx4 v7, s[16:19], s37 offen nt lds
    s_add_u32 m0, s90, 28672
    s_nop 0
    buffer_load_dwordx4 v8, s[16:19], s37 offen nt lds
    s_add_u32 m0, s90, 29696
    s_nop 0
    buffer_load_dwordx4 v9, s[16:19], s37 offen nt lds
    s_waitcnt vmcnt(30)
    s_barrier
    v_add_u32 v13, 49152, v10
    v_add_u32 v14, 49152, v11
    v_add_u32 v15, 49152, v12
    ds_read_b64_tr_b16 a[96:97], v13 offset:0
    ds_read_b64_tr_b16 a[136:137], v14 offset:0
    ds_read_b64_tr_b16 a[176:177], v15 offset:0
    ds_read_b64_tr_b16 a[98:99], v13 offset:384
    ds_read_b64_tr_b16 a[138:139], v14 offset:384
    ds_read_b64_tr_b16 a[178:179], v15 offset:384
    ds_read_b64_tr_b16 a[100:101], v13 offset:12288
    ds_read_b64_tr_b16 a[140:141], v14 offset:12288
    ds_read_b64_tr_b16 a[180:181], v15 offset:12288
    ds_read_b64_tr_b16 a[102:103], v13 offset:12672
    ds_read_b64_tr_b16 a[142:143], v14 offset:12672
    ds_read_b64_tr_b16 a[182:183], v15 offset:12672
    s_waitcnt lgkmcnt(0)
    s_barrier
    s_mul_i32 s37, s92, 1
    s_add_u32 m0, s90, 49152
    s_nop 0
    buffer_load_dwordx4 v4, s[16:19], s37 offen nt lds
    s_add_u32 m0, s90, 50176
    s_nop 0
    buffer_load_dwordx4 v5, s[16:19], s37 offen nt lds
    s_add_u32 m0, s90, 51200
    s_nop 0
    buffer_load_dwordx4 v6, s[16:19], s37 offen nt lds
    s_add_u32 m0, s90, 52224
    s_nop 0
    buffer_load_dwordx4 v7, s[16:19], s37 offen nt lds
    s_add_u32 m0, s90, 53248
    s_nop 0
    buffer_load_dwordx4 v8, s[16:19], s37 offen nt lds
    s_add_u32 m0, s90, 54272
    s_nop 0
    buffer_load_dwordx4 v9, s[16:19], s37 offen nt lds
    s_waitcnt vmcnt(30)
    s_barrier
    v_add_u32 v13, 73728, v10
    v_add_u32 v14, 73728, v11
    v_add_u32 v15, 73728, v12
    ds_read_b64_tr_b16 a[88:89], v13 offset:0
    ds_read_b64_tr_b16 a[128:129], v14 offset:0
    ds_read_b64_tr_b16 a[168:169], v15 offset:0
    ds_read_b64_tr_b16 a[90:91], v13 offset:384
    ds_read_b64_tr_b16 a[130:131], v14 offset:384
    ds_read_b64_tr_b16 a[170:171], v15 offset:384
    ds_read_b64_tr_b16 a[92:93], v13 offset:12288
    ds_read_b64_tr_b16 a[132:133], v14 offset:12288
    ds_read_b64_tr_b16 a[172:173], v15 offset:12288
    ds_read_b64_tr_b16 a[94:95], v13 offset:12672
    ds_read_b64_tr_b16 a[134:135], v14 offset:12672
    ds_read_b64_tr_b16 a[174:175], v15 offset:12672
    s_waitcnt lgkmcnt(0)
    s_barrier
    s_mul_i32 s37, s92, 0
    s_add_u32 m0, s90, 73728
    s_nop 0
    buffer_load_dwordx4 v4, s[16:19], s37 offen nt lds
    s_add_u32 m0, s90, 74752
    s_nop 0
    buffer_load_dwordx4 v5, s[16:19], s37 offen nt lds
    s_add_u32 m0, s90, 75776
    s_nop 0
    buffer_load_dwordx4 v6, s[16:19], s37 offen nt lds
    s_add_u32 m0, s90, 76800
    s_nop 0
    buffer_load_dwordx4 v7, s[16:19], s37 offen nt lds
    s_add_u32 m0, s90, 77824
    s_nop 0
    buffer_load_dwordx4 v8, s[16:19], s37 offen nt lds
    s_add_u32 m0, s90, 78848
    s_nop 0
    buffer_load_dwordx4 v9, s[16:19], s37 offen nt lds
    s_waitcnt vmcnt(30)
    s_barrier
    v_add_u32 v13, 98304, v10
    v_add_u32 v14, 98304, v11
    v_add_u32 v15, 98304, v12
    ds_read_b64_tr_b16 a[80:81], v13 offset:0
    ds_read_b64_tr_b16 a[120:121], v14 offset:0
    ds_read_b64_tr_b16 a[160:161], v15 offset:0
    ds_read_b64_tr_b16 a[82:83], v13 offset:384
    ds_read_b64_tr_b16 a[122:123], v14 offset:384
    ds_read_b64_tr_b16 a[162:163], v15 offset:384
    ds_read_b64_tr_b16 a[84:85], v13 offset:12288
    ds_read_b64_tr_b16 a[124:125], v14 offset:12288
    ds_read_b64_tr_b16 a[164:165], v15 offset:12288
    ds_read_b64_tr_b16 a[86:87], v13 offset:12672
    ds_read_b64_tr_b16 a[126:127], v14 offset:12672
    ds_read_b64_tr_b16 a[166:167], v15 offset:12672
    s_waitcnt lgkmcnt(0)
    s_barrier
    s_add_u32 s37, s72, 0
    s_add_u32 m0, s91, 98304
    s_nop 0
    buffer_load_dwordx4 v19, s[20:23], s37 offen nt lds
    s_add_u32 m0, s91, 99328
    s_nop 0
    buffer_load_dwordx4 v20, s[20:23], s37 offen nt lds
    s_add_u32 m0, s91, 100352
    s_nop 0
    buffer_load_dwordx4 v21, s[20:23], s37 offen nt lds
    s_add_u32 m0, s91, 101376
    s_nop 0
    buffer_load_dwordx4 v22, s[20:23], s37 offen nt lds
    s_add_u32 m0, s91, 102400
    s_nop 0
    buffer_load_dwordx4 v23, s[20:23], s37 offen nt lds
    s_waitcnt vmcnt(29)
    s_barrier
    v_add_u32 v13, 122880, v10
    v_add_u32 v14, 122880, v11
    v_add_u32 v15, 122880, v12
    ds_read_b64_tr_b16 v[24:25], v13 offset:0
    ds_read_b64_tr_b16 v[40:41], v14 offset:0
    ds_read_b64_tr_b16 v[56:57], v15 offset:0
    ds_read_b64_tr_b16 v[26:27], v13 offset:384
    ds_read_b64_tr_b16 v[42:43], v14 offset:384
    ds_read_b64_tr_b16 v[58:59], v15 offset:384
    ds_read_b64_tr_b16 v[28:29], v13 offset:12288
    ds_read_b64_tr_b16 v[44:45], v14 offset:12288
    ds_read_b64_tr_b16 v[60:61], v15 offset:12288
    ds_read_b64_tr_b16 v[30:31], v13 offset:12672
    ds_read_b64_tr_b16 v[46:47], v14 offset:12672
    ds_read_b64_tr_b16 v[62:63], v15 offset:12672
    s_waitcnt lgkmcnt(0)
    s_barrier
    s_add_u32 s37, s72, 20480
    s_add_u32 m0, s91, 122880
    s_nop 0
    buffer_load_dwordx4 v19, s[20:23], s37 offen nt lds
    s_add_u32 m0, s91, 123904
    s_nop 0
    buffer_load_dwordx4 v20, s[20:23], s37 offen nt lds
    s_add_u32 m0, s91, 124928
    s_nop 0
    buffer_load_dwordx4 v21, s[20:23], s37 offen nt lds
    s_add_u32 m0, s91, 125952
    s_nop 0
    buffer_load_dwordx4 v22, s[20:23], s37 offen nt lds
    s_add_u32 m0, s91, 126976
    s_nop 0
    buffer_load_dwordx4 v23, s[20:23], s37 offen nt lds
    s_waitcnt vmcnt(28)
    s_barrier
    v_add_u32 v13, 0, v10
    v_add_u32 v14, 0, v11
    v_add_u32 v15, 0, v12
    ds_read_b64_tr_b16 a[72:73], v13 offset:0
    ds_read_b64_tr_b16 a[112:113], v14 offset:0
    ds_read_b64_tr_b16 a[152:153], v15 offset:0
    ds_read_b64_tr_b16 a[74:75], v13 offset:384
    ds_read_b64_tr_b16 a[114:115], v14 offset:384
    ds_read_b64_tr_b16 a[154:155], v15 offset:384
    ds_read_b64_tr_b16 a[76:77], v13 offset:12288
    ds_read_b64_tr_b16 a[116:117], v14 offset:12288
    ds_read_b64_tr_b16 a[156:157], v15 offset:12288
    ds_read_b64_tr_b16 a[78:79], v13 offset:12672
    ds_read_b64_tr_b16 a[118:119], v14 offset:12672
    ds_read_b64_tr_b16 a[158:159], v15 offset:12672
    s_waitcnt lgkmcnt(0)
    s_barrier
    s_add_u32 s37, s72, 40960
    s_add_u32 m0, s91, 0
    s_nop 0
    buffer_load_dwordx4 v19, s[20:23], s37 offen nt lds
    s_add_u32 m0, s91, 1024
    s_nop 0
    buffer_load_dwordx4 v20, s[20:23], s37 offen nt lds
    s_add_u32 m0, s91, 2048
    s_nop 0
    buffer_load_dwordx4 v21, s[20:23], s37 offen nt lds
    s_add_u32 m0, s91, 3072
    s_nop 0
    buffer_load_dwordx4 v22, s[20:23], s37 offen nt lds
    s_add_u32 m0, s91, 4096
    s_nop 0
    buffer_load_dwordx4 v23, s[20:23], s37 offen nt lds
    s_waitcnt vmcnt(27)
    s_barrier
    v_add_u32 v13, 24576, v10
    v_add_u32 v14, 24576, v11
    v_add_u32 v15, 24576, v12
    ds_read_b64_tr_b16 a[48:49], v13 offset:0
    ds_read_b64_tr_b16 a[56:57], v14 offset:0
    ds_read_b64_tr_b16 a[64:65], v15 offset:0
    ds_read_b64_tr_b16 a[50:51], v13 offset:384
    ds_read_b64_tr_b16 a[58:59], v14 offset:384
    ds_read_b64_tr_b16 a[66:67], v15 offset:384
    ds_read_b64_tr_b16 a[52:53], v13 offset:12288
    ds_read_b64_tr_b16 a[60:61], v14 offset:12288
    ds_read_b64_tr_b16 a[68:69], v15 offset:12288
    ds_read_b64_tr_b16 a[54:55], v13 offset:12672
    ds_read_b64_tr_b16 a[62:63], v14 offset:12672
    ds_read_b64_tr_b16 a[70:71], v15 offset:12672
    s_waitcnt lgkmcnt(0)
    s_barrier
    s_add_u32 s37, s72, 61440
    s_add_u32 m0, s91, 24576
    s_nop 0
    buffer_load_dwordx4 v19, s[20:23], s37 offen nt lds
    s_add_u32 m0, s91, 25600
    s_nop 0
    buffer_load_dwordx4 v20, s[20:23], s37 offen nt lds
    s_add_u32 m0, s91, 26624
    s_nop 0
    buffer_load_dwordx4 v21, s[20:23], s37 offen nt lds
    s_add_u32 m0, s91, 27648
    s_nop 0
    buffer_load_dwordx4 v22, s[20:23], s37 offen nt lds
    s_add_u32 m0, s91, 28672
    s_nop 0
    buffer_load_dwordx4 v23, s[20:23], s37 offen nt lds
    s_waitcnt vmcnt(26)
    s_barrier
    v_add_u32 v13, 49152, v10
    v_add_u32 v14, 49152, v11
    v_add_u32 v15, 49152, v12
    ds_read_b64_tr_b16 a[24:25], v13 offset:0
    ds_read_b64_tr_b16 a[32:33], v14 offset:0
    ds_read_b64_tr_b16 a[40:41], v15 offset:0
    ds_read_b64_tr_b16 a[26:27], v13 offset:384
    ds_read_b64_tr_b16 a[34:35], v14 offset:384
    ds_read_b64_tr_b16 a[42:43], v15 offset:384
    ds_read_b64_tr_b16 a[28:29], v13 offset:12288
    ds_read_b64_tr_b16 a[36:37], v14 offset:12288
    ds_read_b64_tr_b16 a[44:45], v15 offset:12288
    ds_read_b64_tr_b16 a[30:31], v13 offset:12672
    ds_read_b64_tr_b16 a[38:39], v14 offset:12672
    ds_read_b64_tr_b16 a[46:47], v15 offset:12672
    s_waitcnt lgkmcnt(0)
    s_barrier
    s_add_u32 s37, s72, 81920
    s_add_u32 m0, s91, 49152
    s_nop 0
    buffer_load_dwordx4 v19, s[20:23], s37 offen nt lds
    s_add_u32 m0, s91, 50176
    s_nop 0
    buffer_load_dwordx4 v20, s[20:23], s37 offen nt lds
    s_add_u32 m0, s91, 51200
    s_nop 0
    buffer_load_dwordx4 v21, s[20:23], s37 offen nt lds
    s_add_u32 m0, s91, 52224
    s_nop 0
    buffer_load_dwordx4 v22, s[20:23], s37 offen nt lds
    s_add_u32 m0, s91, 53248
    s_nop 0
    buffer_load_dwordx4 v23, s[20:23], s37 offen nt lds
    s_waitcnt vmcnt(25)
    s_barrier
    v_add_u32 v13, 73728, v10
    v_add_u32 v14, 73728, v11
    v_add_u32 v15, 73728, v12
    ds_read_b64_tr_b16 a[0:1], v13 offset:0
    ds_read_b64_tr_b16 a[8:9], v14 offset:0
    ds_read_b64_tr_b16 a[16:17], v15 offset:0
    ds_read_b64_tr_b16 a[2:3], v13 offset:384
    ds_read_b64_tr_b16 a[10:11], v14 offset:384
    ds_read_b64_tr_b16 a[18:19], v15 offset:384
    ds_read_b64_tr_b16 a[4:5], v13 offset:12288
    ds_read_b64_tr_b16 a[12:13], v14 offset:12288
    ds_read_b64_tr_b16 a[20:21], v15 offset:12288
    ds_read_b64_tr_b16 a[6:7], v13 offset:12672
    ds_read_b64_tr_b16 a[14:15], v14 offset:12672
    ds_read_b64_tr_b16 a[22:23], v15 offset:12672
    s_waitcnt lgkmcnt(0)
    s_barrier
    s_add_u32 s37, s72, 102400
    s_add_u32 m0, s91, 73728
    s_nop 0
    buffer_load_dwordx4 v19, s[20:23], s37 offen nt lds
    s_add_u32 m0, s91, 74752
    s_nop 0
    buffer_load_dwordx4 v20, s[20:23], s37 offen nt lds
    s_add_u32 m0, s91, 75776
    s_nop 0
    buffer_load_dwordx4 v21, s[20:23], s37 offen nt lds
    s_add_u32 m0, s91, 76800
    s_nop 0
    buffer_load_dwordx4 v22, s[20:23], s37 offen nt lds
    s_add_u32 m0, s91, 77824
    s_nop 0
    buffer_load_dwordx4 v23, s[20:23], s37 offen nt lds
    s_waitcnt vmcnt(25)
    s_barrier
    v_lshrrev_b32 v14, 2, v1
    v_mul_u32_u24 v17, 1280, v14
    v_and_b32 v15, 1, v1
    v_lshl_add_u32 v17, v15, 3, v17
    v_and_b32 v14, 7, v14
    v_lshlrev_b32 v14, 1, v14
    v_bfe_u32 v15, v1, 1, 1
    s_mul_i32 s37, s4, 20
    v_add_u32 v15, s37, v15
    v_add_u32 v16, 0, v15
    v_xor_b32 v16, v16, v14
    v_lshl_add_u32 v4, v16, 4, v17
    v_add_u32 v16, 2, v15
    v_xor_b32 v16, v16, v14
    v_lshl_add_u32 v5, v16, 4, v17
    v_add_u32 v16, 4, v15
    v_xor_b32 v16, v16, v14
    v_lshl_add_u32 v6, v16, 4, v17
    v_add_u32 v16, 6, v15
    v_xor_b32 v16, v16, v14
    v_lshl_add_u32 v7, v16, 4, v17
    v_add_u32 v16, 8, v15
    v_xor_b32 v16, v16, v14
    v_lshl_add_u32 v8, v16, 4, v17
    v_add_u32 v16, 10, v15
    v_xor_b32 v16, v16, v14
    v_lshl_add_u32 v9, v16, 4, v17
    v_add_u32 v16, 12, v15
    v_xor_b32 v16, v16, v14
    v_lshl_add_u32 v10, v16, 4, v17
    v_add_u32 v16, 14, v15
    v_xor_b32 v16, v16, v14
    v_lshl_add_u32 v11, v16, 4, v17
    v_add_u32 v16, 16, v15
    v_xor_b32 v16, v16, v14
    v_lshl_add_u32 v12, v16, 4, v17
    v_add_u32 v16, 18, v15
    v_xor_b32 v16, v16, v14
    v_lshl_add_u32 v13, v16, 4, v17
    v_add_u32 v4, 98304, v4
    v_add_u32 v5, 98304, v5
    v_add_u32 v6, 98304, v6
    v_add_u32 v7, 98304, v7
    v_add_u32 v8, 98304, v8
    v_add_u32 v9, 98304, v9
    v_add_u32 v10, 98304, v10
    v_add_u32 v11, 98304, v11
    v_add_u32 v12, 98304, v12
    v_add_u32 v13, 98304, v13
    ds_read_b64_tr_b16 a[192:193], v4 offset:0
    ds_read_b64_tr_b16 v[72:73], v5 offset:0
    ds_read_b64_tr_b16 a[200:201], v6 offset:0
    ds_read_b64_tr_b16 a[208:209], v7 offset:0
    ds_read_b64_tr_b16 a[216:217], v8 offset:0
    ds_read_b64_tr_b16 v[80:81], v9 offset:0
    ds_read_b64_tr_b16 a[224:225], v10 offset:0
    ds_read_b64_tr_b16 a[232:233], v11 offset:0
    ds_read_b64_tr_b16 v[88:89], v12 offset:0
    ds_read_b64_tr_b16 a[240:241], v13 offset:0
    s_waitcnt lgkmcnt(0)
    s_barrier
    s_add_u32 s37, s72, 122880
    s_add_u32 m0, s91, 98304
    s_nop 0
    buffer_load_dwordx4 v19, s[20:23], s37 offen nt lds
    s_add_u32 m0, s91, 99328
    s_nop 0
    buffer_load_dwordx4 v20, s[20:23], s37 offen nt lds
    s_add_u32 m0, s91, 100352
    s_nop 0
    buffer_load_dwordx4 v21, s[20:23], s37 offen nt lds
    s_add_u32 m0, s91, 101376
    s_nop 0
    buffer_load_dwordx4 v22, s[20:23], s37 offen nt lds
    s_add_u32 m0, s91, 102400
    s_nop 0
    buffer_load_dwordx4 v23, s[20:23], s37 offen nt lds
    s_waitcnt vmcnt(25)
    s_barrier
    ds_read_b64_tr_b16 a[248:249], v4 offset:24576
    ds_read_b64_tr_b16 v[152:153], v5 offset:24576
    ds_read_b64_tr_b16 v[96:97], v6 offset:24576
    ds_read_b64_tr_b16 v[160:161], v7 offset:24576
    ds_read_b64_tr_b16 v[168:169], v8 offset:24576
    ds_read_b64_tr_b16 v[104:105], v9 offset:24576
    ds_read_b64_tr_b16 v[176:177], v10 offset:24576
    ds_read_b64_tr_b16 v[184:185], v11 offset:24576
    ds_read_b64_tr_b16 v[192:193], v12 offset:24576
    ds_read_b64_tr_b16 v[112:113], v13 offset:24576
    s_waitcnt lgkmcnt(0)
    s_barrier
    s_add_u32 s37, s72, 143360
    s_add_u32 m0, s91, 122880
    s_nop 0
    buffer_load_dwordx4 v19, s[20:23], s37 offen nt lds
    s_add_u32 m0, s91, 123904
    s_nop 0
    buffer_load_dwordx4 v20, s[20:23], s37 offen nt lds
    s_add_u32 m0, s91, 124928
    s_nop 0
    buffer_load_dwordx4 v21, s[20:23], s37 offen nt lds
    s_add_u32 m0, s91, 125952
    s_nop 0
    buffer_load_dwordx4 v22, s[20:23], s37 offen nt lds
    s_add_u32 m0, s91, 126976
    s_nop 0
    buffer_load_dwordx4 v23, s[20:23], s37 offen nt lds
    s_waitcnt vmcnt(25)
    s_barrier
    v_add_u32 v4, -98304, v4
    v_add_u32 v5, -98304, v5
    v_add_u32 v6, -98304, v6
    v_add_u32 v7, -98304, v7
    v_add_u32 v8, -98304, v8
    v_add_u32 v9, -98304, v9
    v_add_u32 v10, -98304, v10
    v_add_u32 v11, -98304, v11
    v_add_u32 v12, -98304, v12
    v_add_u32 v13, -98304, v13
    ds_read_b64_tr_b16 v[200:201], v4 offset:0
    ds_read_b64_tr_b16 v[208:209], v5 offset:0
    ds_read_b64_tr_b16 v[120:121], v6 offset:0
    ds_read_b64_tr_b16 v[216:217], v7 offset:0
    ds_read_b64_tr_b16 v[224:225], v8 offset:0
    ds_read_b64_tr_b16 v[232:233], v9 offset:0
    ds_read_b64_tr_b16 v[128:129], v10 offset:0
    ds_read_b64_tr_b16 v[240:241], v11 offset:0
    ds_read_b64_tr_b16 v[248:249], v12 offset:0
    ds_read_b64_tr_b16 v[136:137], v13 offset:0
    s_waitcnt lgkmcnt(0)
    s_barrier
    s_add_u32 s37, s72, 163840
    s_add_u32 m0, s91, 0
    s_nop 0
    buffer_load_dwordx4 v19, s[20:23], s37 offen nt lds
    s_add_u32 m0, s91, 1024
    s_nop 0
    buffer_load_dwordx4 v20, s[20:23], s37 offen nt lds
    s_add_u32 m0, s91, 2048
    s_nop 0
    buffer_load_dwordx4 v21, s[20:23], s37 offen nt lds
    s_add_u32 m0, s91, 3072
    s_nop 0
    buffer_load_dwordx4 v22, s[20:23], s37 offen nt lds
    s_add_u32 m0, s91, 4096
    s_nop 0
    buffer_load_dwordx4 v23, s[20:23], s37 offen nt lds
    s_waitcnt vmcnt(25)
    s_barrier
    ds_read_b64_tr_b16 a[194:195], v4 offset:24576
    ds_read_b64_tr_b16 v[74:75], v5 offset:24576
    ds_read_b64_tr_b16 a[202:203], v6 offset:24576
    ds_read_b64_tr_b16 a[210:211], v7 offset:24576
    ds_read_b64_tr_b16 a[218:219], v8 offset:24576
    ds_read_b64_tr_b16 v[82:83], v9 offset:24576
    ds_read_b64_tr_b16 a[226:227], v10 offset:24576
    ds_read_b64_tr_b16 a[234:235], v11 offset:24576
    ds_read_b64_tr_b16 v[90:91], v12 offset:24576
    ds_read_b64_tr_b16 a[242:243], v13 offset:24576
    s_waitcnt lgkmcnt(0)
    s_barrier
    s_add_u32 s37, s72, 184320
    s_add_u32 m0, s91, 24576
    s_nop 0
    buffer_load_dwordx4 v19, s[20:23], s37 offen nt lds
    s_add_u32 m0, s91, 25600
    s_nop 0
    buffer_load_dwordx4 v20, s[20:23], s37 offen nt lds
    s_add_u32 m0, s91, 26624
    s_nop 0
    buffer_load_dwordx4 v21, s[20:23], s37 offen nt lds
    s_add_u32 m0, s91, 27648
    s_nop 0
    buffer_load_dwordx4 v22, s[20:23], s37 offen nt lds
    s_add_u32 m0, s91, 28672
    s_nop 0
    buffer_load_dwordx4 v23, s[20:23], s37 offen nt lds
    s_waitcnt vmcnt(25)
    s_barrier
    v_add_u32 v4, 49152, v4
    v_add_u32 v5, 49152, v5
    v_add_u32 v6, 49152, v6
    v_add_u32 v7, 49152, v7
    v_add_u32 v8, 49152, v8
    v_add_u32 v9, 49152, v9
    v_add_u32 v10, 49152, v10
    v_add_u32 v11, 49152, v11
    v_add_u32 v12, 49152, v12
    v_add_u32 v13, 49152, v13
    ds_read_b64_tr_b16 a[250:251], v4 offset:0
    ds_read_b64_tr_b16 v[154:155], v5 offset:0
    ds_read_b64_tr_b16 v[98:99], v6 offset:0
    ds_read_b64_tr_b16 v[162:163], v7 offset:0
    ds_read_b64_tr_b16 v[170:171], v8 offset:0
    ds_read_b64_tr_b16 v[106:107], v9 offset:0
    ds_read_b64_tr_b16 v[178:179], v10 offset:0
    ds_read_b64_tr_b16 v[186:187], v11 offset:0
    ds_read_b64_tr_b16 v[194:195], v12 offset:0
    ds_read_b64_tr_b16 v[114:115], v13 offset:0
    s_waitcnt lgkmcnt(0)
    s_barrier
    s_add_u32 s37, s72, 204800
    s_add_u32 m0, s91, 49152
    s_nop 0
    buffer_load_dwordx4 v19, s[20:23], s37 offen nt lds
    s_add_u32 m0, s91, 50176
    s_nop 0
    buffer_load_dwordx4 v20, s[20:23], s37 offen nt lds
    s_add_u32 m0, s91, 51200
    s_nop 0
    buffer_load_dwordx4 v21, s[20:23], s37 offen nt lds
    s_add_u32 m0, s91, 52224
    s_nop 0
    buffer_load_dwordx4 v22, s[20:23], s37 offen nt lds
    s_add_u32 m0, s91, 53248
    s_nop 0
    buffer_load_dwordx4 v23, s[20:23], s37 offen nt lds
    s_waitcnt vmcnt(25)
    s_barrier
    ds_read_b64_tr_b16 v[202:203], v4 offset:24576
    ds_read_b64_tr_b16 v[210:211], v5 offset:24576
    ds_read_b64_tr_b16 v[122:123], v6 offset:24576
    ds_read_b64_tr_b16 v[218:219], v7 offset:24576
    ds_read_b64_tr_b16 v[226:227], v8 offset:24576
    ds_read_b64_tr_b16 v[234:235], v9 offset:24576
    ds_read_b64_tr_b16 v[130:131], v10 offset:24576
    ds_read_b64_tr_b16 v[242:243], v11 offset:24576
    ds_read_b64_tr_b16 v[250:251], v12 offset:24576
    ds_read_b64_tr_b16 v[138:139], v13 offset:24576
    s_waitcnt lgkmcnt(0)
    s_barrier
    s_add_u32 s37, s72, 225280
    s_add_u32 m0, s91, 73728
    s_nop 0
    buffer_load_dwordx4 v19, s[20:23], s37 offen nt lds
    s_add_u32 m0, s91, 74752
    s_nop 0
    buffer_load_dwordx4 v20, s[20:23], s37 offen nt lds
    s_add_u32 m0, s91, 75776
    s_nop 0
    buffer_load_dwordx4 v21, s[20:23], s37 offen nt lds
    s_add_u32 m0, s91, 76800
    s_nop 0
    buffer_load_dwordx4 v22, s[20:23], s37 offen nt lds
    s_add_u32 m0, s91, 77824
    s_nop 0
    buffer_load_dwordx4 v23, s[20:23], s37 offen nt lds
    s_waitcnt vmcnt(25)
    s_barrier
    v_add_u32 v4, 49152, v4
    v_add_u32 v5, 49152, v5
    v_add_u32 v6, 49152, v6
    v_add_u32 v7, 49152, v7
    v_add_u32 v8, 49152, v8
    v_add_u32 v9, 49152, v9
    v_add_u32 v10, 49152, v10
    v_add_u32 v11, 49152, v11
    v_add_u32 v12, 49152, v12
    v_add_u32 v13, 49152, v13
    ds_read_b64_tr_b16 a[196:197], v4 offset:0
    ds_read_b64_tr_b16 v[76:77], v5 offset:0
    ds_read_b64_tr_b16 a[204:205], v6 offset:0
    ds_read_b64_tr_b16 a[212:213], v7 offset:0
    ds_read_b64_tr_b16 a[220:221], v8 offset:0
    ds_read_b64_tr_b16 v[84:85], v9 offset:0
    ds_read_b64_tr_b16 a[228:229], v10 offset:0
    ds_read_b64_tr_b16 a[236:237], v11 offset:0
    ds_read_b64_tr_b16 v[92:93], v12 offset:0
    ds_read_b64_tr_b16 a[244:245], v13 offset:0
    s_waitcnt lgkmcnt(0)
    s_waitcnt vmcnt(20)
    s_barrier
    ds_read_b64_tr_b16 a[252:253], v4 offset:24576
    ds_read_b64_tr_b16 v[156:157], v5 offset:24576
    ds_read_b64_tr_b16 v[100:101], v6 offset:24576
    ds_read_b64_tr_b16 v[164:165], v7 offset:24576
    ds_read_b64_tr_b16 v[172:173], v8 offset:24576
    ds_read_b64_tr_b16 v[108:109], v9 offset:24576
    ds_read_b64_tr_b16 v[180:181], v10 offset:24576
    ds_read_b64_tr_b16 v[188:189], v11 offset:24576
    ds_read_b64_tr_b16 v[196:197], v12 offset:24576
    ds_read_b64_tr_b16 v[116:117], v13 offset:24576
    s_waitcnt lgkmcnt(0)
    s_waitcnt vmcnt(15)
    s_barrier
    v_add_u32 v4, -98304, v4
    v_add_u32 v5, -98304, v5
    v_add_u32 v6, -98304, v6
    v_add_u32 v7, -98304, v7
    v_add_u32 v8, -98304, v8
    v_add_u32 v9, -98304, v9
    v_add_u32 v10, -98304, v10
    v_add_u32 v11, -98304, v11
    v_add_u32 v12, -98304, v12
    v_add_u32 v13, -98304, v13
    ds_read_b64_tr_b16 v[204:205], v4 offset:0
    ds_read_b64_tr_b16 v[212:213], v5 offset:0
    ds_read_b64_tr_b16 v[124:125], v6 offset:0
    ds_read_b64_tr_b16 v[220:221], v7 offset:0
    ds_read_b64_tr_b16 v[228:229], v8 offset:0
    ds_read_b64_tr_b16 v[236:237], v9 offset:0
    ds_read_b64_tr_b16 v[132:133], v10 offset:0
    ds_read_b64_tr_b16 v[244:245], v11 offset:0
    ds_read_b64_tr_b16 v[252:253], v12 offset:0
    ds_read_b64_tr_b16 v[140:141], v13 offset:0
    s_waitcnt lgkmcnt(0)
    s_waitcnt vmcnt(10)
    s_barrier
    ds_read_b64_tr_b16 a[198:199], v4 offset:24576
    ds_read_b64_tr_b16 v[78:79], v5 offset:24576
    ds_read_b64_tr_b16 a[206:207], v6 offset:24576
    ds_read_b64_tr_b16 a[214:215], v7 offset:24576
    ds_read_b64_tr_b16 a[222:223], v8 offset:24576
    ds_read_b64_tr_b16 v[86:87], v9 offset:24576
    ds_read_b64_tr_b16 a[230:231], v10 offset:24576
    ds_read_b64_tr_b16 a[238:239], v11 offset:24576
    ds_read_b64_tr_b16 v[94:95], v12 offset:24576
    ds_read_b64_tr_b16 a[246:247], v13 offset:24576
    s_waitcnt lgkmcnt(0)
    s_waitcnt vmcnt(5)
    s_barrier
    v_add_u32 v4, 49152, v4
    v_add_u32 v5, 49152, v5
    v_add_u32 v6, 49152, v6
    v_add_u32 v7, 49152, v7
    v_add_u32 v8, 49152, v8
    v_add_u32 v9, 49152, v9
    v_add_u32 v10, 49152, v10
    v_add_u32 v11, 49152, v11
    v_add_u32 v12, 49152, v12
    v_add_u32 v13, 49152, v13
    ds_read_b64_tr_b16 a[254:255], v4 offset:0
    ds_read_b64_tr_b16 v[158:159], v5 offset:0
    ds_read_b64_tr_b16 v[102:103], v6 offset:0
    ds_read_b64_tr_b16 v[166:167], v7 offset:0
    ds_read_b64_tr_b16 v[174:175], v8 offset:0
    ds_read_b64_tr_b16 v[110:111], v9 offset:0
    ds_read_b64_tr_b16 v[182:183], v10 offset:0
    ds_read_b64_tr_b16 v[190:191], v11 offset:0
    ds_read_b64_tr_b16 v[198:199], v12 offset:0
    ds_read_b64_tr_b16 v[118:119], v13 offset:0
    s_waitcnt lgkmcnt(0)
    s_waitcnt vmcnt(0)
    s_barrier
    ds_read_b64_tr_b16 v[206:207], v4 offset:24576
    ds_read_b64_tr_b16 v[214:215], v5 offset:24576
    ds_read_b64_tr_b16 v[126:127], v6 offset:24576
    ds_read_b64_tr_b16 v[222:223], v7 offset:24576
    ds_read_b64_tr_b16 v[230:231], v8 offset:24576
    ds_read_b64_tr_b16 v[238:239], v9 offset:24576
    ds_read_b64_tr_b16 v[134:135], v10 offset:24576
    ds_read_b64_tr_b16 v[246:247], v11 offset:24576
    ds_read_b64_tr_b16 v[254:255], v12 offset:24576
    ds_read_b64_tr_b16 v[142:143], v13 offset:24576
    s_waitcnt lgkmcnt(0)
    s_branch Lpw_126
Lpw_128:
    s_waitcnt vmcnt(30)
    s_barrier
    v_add_u32 v13, 0, v10
    v_add_u32 v14, 0, v11
    v_add_u32 v15, 0, v12
    ds_read_b64_tr_b16 a[96:97], v13 offset:0
    ds_read_b64_tr_b16 a[136:137], v14 offset:0
    ds_read_b64_tr_b16 a[176:177], v15 offset:0
    ds_read_b64_tr_b16 a[98:99], v13 offset:384
    ds_read_b64_tr_b16 a[138:139], v14 offset:384
    ds_read_b64_tr_b16 a[178:179], v15 offset:384
    ds_read_b64_tr_b16 a[100:101], v13 offset:12288
    ds_read_b64_tr_b16 a[140:141], v14 offset:12288
    ds_read_b64_tr_b16 a[180:181], v15 offset:12288
    ds_read_b64_tr_b16 a[102:103], v13 offset:12672
    ds_read_b64_tr_b16 a[142:143], v14 offset:12672
    ds_read_b64_tr_b16 a[182:183], v15 offset:12672
    s_waitcnt lgkmcnt(0)
    s_barrier
    s_mul_i32 s37, s92, 3
    s_add_u32 m0, s90, 0
    s_nop 0
    buffer_load_dwordx4 v4, s[16:19], s37 offen nt lds
    s_add_u32 m0, s90, 1024
    s_nop 0
    buffer_load_dwordx4 v5, s[16:19], s37 offen nt lds
    s_add_u32 m0, s90, 2048
    s_nop 0
    buffer_load_dwordx4 v6, s[16:19], s37 offen nt lds
    s_add_u32 m0, s90, 3072
    s_nop 0
    buffer_load_dwordx4 v7, s[16:19], s37 offen nt lds
    s_add_u32 m0, s90, 4096
    s_nop 0
    buffer_load_dwordx4 v8, s[16:19], s37 offen nt lds
    s_add_u32 m0, s90, 5120
    s_nop 0
    buffer_load_dwordx4 v9, s[16:19], s37 offen nt lds
    s_waitcnt vmcnt(30)
    s_barrier
    v_add_u32 v13, 24576, v10
    v_add_u32 v14, 24576, v11
    v_add_u32 v15, 24576, v12
    ds_read_b64_tr_b16 a[88:89], v13 offset:0
    ds_read_b64_tr_b16 a[128:129], v14 offset:0
    ds_read_b64_tr_b16 a[168:169], v15 offset:0
    ds_read_b64_tr_b16 a[90:91], v13 offset:384
    ds_read_b64_tr_b16 a[130:131], v14 offset:384
    ds_read_b64_tr_b16 a[170:171], v15 offset:384
    ds_read_b64_tr_b16 a[92:93], v13 offset:12288
    ds_read_b64_tr_b16 a[132:133], v14 offset:12288
    ds_read_b64_tr_b16 a[172:173], v15 offset:12288
    ds_read_b64_tr_b16 a[94:95], v13 offset:12672
    ds_read_b64_tr_b16 a[134:135], v14 offset:12672
    ds_read_b64_tr_b16 a[174:175], v15 offset:12672
    s_waitcnt lgkmcnt(0)
    s_barrier
    s_mul_i32 s37, s92, 2
    s_add_u32 m0, s90, 24576
    s_nop 0
    buffer_load_dwordx4 v4, s[16:19], s37 offen nt lds
    s_add_u32 m0, s90, 25600
    s_nop 0
    buffer_load_dwordx4 v5, s[16:19], s37 offen nt lds
    s_add_u32 m0, s90, 26624
    s_nop 0
    buffer_load_dwordx4 v6, s[16:19], s37 offen nt lds
    s_add_u32 m0, s90, 27648
    s_nop 0
    buffer_load_dwordx4 v7, s[16:19], s37 offen nt lds
    s_add_u32 m0, s90, 28672
    s_nop 0
    buffer_load_dwordx4 v8, s[16:19], s37 offen nt lds
    s_add_u32 m0, s90, 29696
    s_nop 0
    buffer_load_dwordx4 v9, s[16:19], s37 offen nt lds
    s_waitcnt vmcnt(30)
    s_barrier
    v_add_u32 v13, 49152, v10
    v_add_u32 v14, 49152, v11
    v_add_u32 v15, 49152, v12
    ds_read_b64_tr_b16 a[80:81], v13 offset:0
    ds_read_b64_tr_b16 a[120:121], v14 offset:0
    ds_read_b64_tr_b16 a[160:161], v15 offset:0
    ds_read_b64_tr_b16 a[82:83], v13 offset:384
    ds_read_b64_tr_b16 a[122:123], v14 offset:384
    ds_read_b64_tr_b16 a[162:163], v15 offset:384
    ds_read_b64_tr_b16 a[84:85], v13 offset:12288
    ds_read_b64_tr_b16 a[124:125], v14 offset:12288
    ds_read_b64_tr_b16 a[164:165], v15 offset:12288
    ds_read_b64_tr_b16 a[86:87], v13 offset:12672
    ds_read_b64_tr_b16 a[126:127], v14 offset:12672
    ds_read_b64_tr_b16 a[166:167], v15 offset:12672
    s_waitcnt lgkmcnt(0)
    s_barrier
    s_mul_i32 s37, s92, 1
    s_add_u32 m0, s90, 49152
    s_nop 0
    buffer_load_dwordx4 v4, s[16:19], s37 offen nt lds
    s_add_u32 m0, s90, 50176
    s_nop 0
    buffer_load_dwordx4 v5, s[16:19], s37 offen nt lds
    s_add_u32 m0, s90, 51200
    s_nop 0
    buffer_load_dwordx4 v6, s[16:19], s37 offen nt lds
    s_add_u32 m0, s90, 52224
    s_nop 0
    buffer_load_dwordx4 v7, s[16:19], s37 offen nt lds
    s_add_u32 m0, s90, 53248
    s_nop 0
    buffer_load_dwordx4 v8, s[16:19], s37 offen nt lds
    s_add_u32 m0, s90, 54272
    s_nop 0
    buffer_load_dwordx4 v9, s[16:19], s37 offen nt lds
    s_waitcnt vmcnt(30)
    s_barrier
    v_add_u32 v13, 73728, v10
    v_add_u32 v14, 73728, v11
    v_add_u32 v15, 73728, v12
    ds_read_b64_tr_b16 v[24:25], v13 offset:0
    ds_read_b64_tr_b16 v[40:41], v14 offset:0
    ds_read_b64_tr_b16 v[56:57], v15 offset:0
    ds_read_b64_tr_b16 v[26:27], v13 offset:384
    ds_read_b64_tr_b16 v[42:43], v14 offset:384
    ds_read_b64_tr_b16 v[58:59], v15 offset:384
    ds_read_b64_tr_b16 v[28:29], v13 offset:12288
    ds_read_b64_tr_b16 v[44:45], v14 offset:12288
    ds_read_b64_tr_b16 v[60:61], v15 offset:12288
    ds_read_b64_tr_b16 v[30:31], v13 offset:12672
    ds_read_b64_tr_b16 v[46:47], v14 offset:12672
    ds_read_b64_tr_b16 v[62:63], v15 offset:12672
    s_waitcnt lgkmcnt(0)
    s_barrier
    s_mul_i32 s37, s92, 0
    s_add_u32 m0, s90, 73728
    s_nop 0
    buffer_load_dwordx4 v4, s[16:19], s37 offen nt lds
    s_add_u32 m0, s90, 74752
    s_nop 0
    buffer_load_dwordx4 v5, s[16:19], s37 offen nt lds
    s_add_u32 m0, s90, 75776
    s_nop 0
    buffer_load_dwordx4 v6, s[16:19], s37 offen nt lds
    s_add_u32 m0, s90, 76800
    s_nop 0
    buffer_load_dwordx4 v7, s[16:19], s37 offen nt lds
    s_add_u32 m0, s90, 77824
    s_nop 0
    buffer_load_dwordx4 v8, s[16:19], s37 offen nt lds
    s_add_u32 m0, s90, 78848
    s_nop 0
    buffer_load_dwordx4 v9, s[16:19], s37 offen nt lds
    s_waitcnt vmcnt(30)
    s_barrier
    v_add_u32 v13, 98304, v10
    v_add_u32 v14, 98304, v11
    v_add_u32 v15, 98304, v12
    ds_read_b64_tr_b16 a[72:73], v13 offset:0
    ds_read_b64_tr_b16 a[112:113], v14 offset:0
    ds_read_b64_tr_b16 a[152:153], v15 offset:0
    ds_read_b64_tr_b16 a[74:75], v13 offset:384
    ds_read_b64_tr_b16 a[114:115], v14 offset:384
    ds_read_b64_tr_b16 a[154:155], v15 offset:384
    ds_read_b64_tr_b16 a[76:77], v13 offset:12288
    ds_read_b64_tr_b16 a[116:117], v14 offset:12288
    ds_read_b64_tr_b16 a[156:157], v15 offset:12288
    ds_read_b64_tr_b16 a[78:79], v13 offset:12672
    ds_read_b64_tr_b16 a[118:119], v14 offset:12672
    ds_read_b64_tr_b16 a[158:159], v15 offset:12672
    s_waitcnt lgkmcnt(0)
    s_barrier
    s_add_u32 s37, s72, 0
    s_add_u32 m0, s91, 98304
    s_nop 0
    buffer_load_dwordx4 v19, s[20:23], s37 offen nt lds
    s_add_u32 m0, s91, 99328
    s_nop 0
    buffer_load_dwordx4 v20, s[20:23], s37 offen nt lds
    s_add_u32 m0, s91, 100352
    s_nop 0
    buffer_load_dwordx4 v21, s[20:23], s37 offen nt lds
    s_add_u32 m0, s91, 101376
    s_nop 0
    buffer_load_dwordx4 v22, s[20:23], s37 offen nt lds
    s_add_u32 m0, s91, 102400
    s_nop 0
    buffer_load_dwordx4 v23, s[20:23], s37 offen nt lds
    s_waitcnt vmcnt(29)
    s_barrier
    v_add_u32 v13, 122880, v10
    v_add_u32 v14, 122880, v11
    v_add_u32 v15, 122880, v12
    ds_read_b64_tr_b16 a[48:49], v13 offset:0
    ds_read_b64_tr_b16 a[56:57], v14 offset:0
    ds_read_b64_tr_b16 a[64:65], v15 offset:0
    ds_read_b64_tr_b16 a[50:51], v13 offset:384
    ds_read_b64_tr_b16 a[58:59], v14 offset:384
    ds_read_b64_tr_b16 a[66:67], v15 offset:384
    ds_read_b64_tr_b16 a[52:53], v13 offset:12288
    ds_read_b64_tr_b16 a[60:61], v14 offset:12288
    ds_read_b64_tr_b16 a[68:69], v15 offset:12288
    ds_read_b64_tr_b16 a[54:55], v13 offset:12672
    ds_read_b64_tr_b16 a[62:63], v14 offset:12672
    ds_read_b64_tr_b16 a[70:71], v15 offset:12672
    s_waitcnt lgkmcnt(0)
    s_barrier
    s_add_u32 s37, s72, 20480
    s_add_u32 m0, s91, 122880
    s_nop 0
    buffer_load_dwordx4 v19, s[20:23], s37 offen nt lds
    s_add_u32 m0, s91, 123904
    s_nop 0
    buffer_load_dwordx4 v20, s[20:23], s37 offen nt lds
    s_add_u32 m0, s91, 124928
    s_nop 0
    buffer_load_dwordx4 v21, s[20:23], s37 offen nt lds
    s_add_u32 m0, s91, 125952
    s_nop 0
    buffer_load_dwordx4 v22, s[20:23], s37 offen nt lds
    s_add_u32 m0, s91, 126976
    s_nop 0
    buffer_load_dwordx4 v23, s[20:23], s37 offen nt lds
    s_waitcnt vmcnt(28)
    s_barrier
    v_add_u32 v13, 0, v10
    v_add_u32 v14, 0, v11
    v_add_u32 v15, 0, v12
    ds_read_b64_tr_b16 a[24:25], v13 offset:0
    ds_read_b64_tr_b16 a[32:33], v14 offset:0
    ds_read_b64_tr_b16 a[40:41], v15 offset:0
    ds_read_b64_tr_b16 a[26:27], v13 offset:384
    ds_read_b64_tr_b16 a[34:35], v14 offset:384
    ds_read_b64_tr_b16 a[42:43], v15 offset:384
    ds_read_b64_tr_b16 a[28:29], v13 offset:12288
    ds_read_b64_tr_b16 a[36:37], v14 offset:12288
    ds_read_b64_tr_b16 a[44:45], v15 offset:12288
    ds_read_b64_tr_b16 a[30:31], v13 offset:12672
    ds_read_b64_tr_b16 a[38:39], v14 offset:12672
    ds_read_b64_tr_b16 a[46:47], v15 offset:12672
    s_waitcnt lgkmcnt(0)
    s_barrier
    s_add_u32 s37, s72, 40960
    s_add_u32 m0, s91, 0
    s_nop 0
    buffer_load_dwordx4 v19, s[20:23], s37 offen nt lds
    s_add_u32 m0, s91, 1024
    s_nop 0
    buffer_load_dwordx4 v20, s[20:23], s37 offen nt lds
    s_add_u32 m0, s91, 2048
    s_nop 0
    buffer_load_dwordx4 v21, s[20:23], s37 offen nt lds
    s_add_u32 m0, s91, 3072
    s_nop 0
    buffer_load_dwordx4 v22, s[20:23], s37 offen nt lds
    s_add_u32 m0, s91, 4096
    s_nop 0
    buffer_load_dwordx4 v23, s[20:23], s37 offen nt lds
    s_waitcnt vmcnt(27)
    s_barrier
    v_add_u32 v13, 24576, v10
    v_add_u32 v14, 24576, v11
    v_add_u32 v15, 24576, v12
    ds_read_b64_tr_b16 a[0:1], v13 offset:0
    ds_read_b64_tr_b16 a[8:9], v14 offset:0
    ds_read_b64_tr_b16 a[16:17], v15 offset:0
    ds_read_b64_tr_b16 a[2:3], v13 offset:384
    ds_read_b64_tr_b16 a[10:11], v14 offset:384
    ds_read_b64_tr_b16 a[18:19], v15 offset:384
    ds_read_b64_tr_b16 a[4:5], v13 offset:12288
    ds_read_b64_tr_b16 a[12:13], v14 offset:12288
    ds_read_b64_tr_b16 a[20:21], v15 offset:12288
    ds_read_b64_tr_b16 a[6:7], v13 offset:12672
    ds_read_b64_tr_b16 a[14:15], v14 offset:12672
    ds_read_b64_tr_b16 a[22:23], v15 offset:12672
    s_waitcnt lgkmcnt(0)
    s_barrier
    s_add_u32 s37, s72, 61440
    s_add_u32 m0, s91, 24576
    s_nop 0
    buffer_load_dwordx4 v19, s[20:23], s37 offen nt lds
    s_add_u32 m0, s91, 25600
    s_nop 0
    buffer_load_dwordx4 v20, s[20:23], s37 offen nt lds
    s_add_u32 m0, s91, 26624
    s_nop 0
    buffer_load_dwordx4 v21, s[20:23], s37 offen nt lds
    s_add_u32 m0, s91, 27648
    s_nop 0
    buffer_load_dwordx4 v22, s[20:23], s37 offen nt lds
    s_add_u32 m0, s91, 28672
    s_nop 0
    buffer_load_dwordx4 v23, s[20:23], s37 offen nt lds
    s_waitcnt vmcnt(26)
    s_barrier
    v_add_u32 v13, 49152, v10
    v_add_u32 v14, 49152, v11
    v_add_u32 v15, 49152, v12
    ds_read_b64_tr_b16 a[104:105], v13 offset:0
    ds_read_b64_tr_b16 a[144:145], v14 offset:0
    ds_read_b64_tr_b16 a[184:185], v15 offset:0
    ds_read_b64_tr_b16 a[106:107], v13 offset:384
    ds_read_b64_tr_b16 a[146:147], v14 offset:384
    ds_read_b64_tr_b16 a[186:187], v15 offset:384
    ds_read_b64_tr_b16 a[108:109], v13 offset:12288
    ds_read_b64_tr_b16 a[148:149], v14 offset:12288
    ds_read_b64_tr_b16 a[188:189], v15 offset:12288
    ds_read_b64_tr_b16 a[110:111], v13 offset:12672
    ds_read_b64_tr_b16 a[150:151], v14 offset:12672
    ds_read_b64_tr_b16 a[190:191], v15 offset:12672
    s_waitcnt lgkmcnt(0)
    s_barrier
    s_add_u32 s37, s72, 81920
    s_add_u32 m0, s91, 49152
    s_nop 0
    buffer_load_dwordx4 v19, s[20:23], s37 offen nt lds
    s_add_u32 m0, s91, 50176
    s_nop 0
    buffer_load_dwordx4 v20, s[20:23], s37 offen nt lds
    s_add_u32 m0, s91, 51200
    s_nop 0
    buffer_load_dwordx4 v21, s[20:23], s37 offen nt lds
    s_add_u32 m0, s91, 52224
    s_nop 0
    buffer_load_dwordx4 v22, s[20:23], s37 offen nt lds
    s_add_u32 m0, s91, 53248
    s_nop 0
    buffer_load_dwordx4 v23, s[20:23], s37 offen nt lds
    s_waitcnt vmcnt(25)
    s_barrier
    v_add_u32 v13, 73728, v10
    v_add_u32 v14, 73728, v11
    v_add_u32 v15, 73728, v12
    ds_read_b64_tr_b16 v[32:33], v13 offset:0
    ds_read_b64_tr_b16 v[48:49], v14 offset:0
    ds_read_b64_tr_b16 v[64:65], v15 offset:0
    ds_read_b64_tr_b16 v[34:35], v13 offset:384
    ds_read_b64_tr_b16 v[50:51], v14 offset:384
    ds_read_b64_tr_b16 v[66:67], v15 offset:384
    ds_read_b64_tr_b16 v[36:37], v13 offset:12288
    ds_read_b64_tr_b16 v[52:53], v14 offset:12288
    ds_read_b64_tr_b16 v[68:69], v15 offset:12288
    ds_read_b64_tr_b16 v[38:39], v13 offset:12672
    ds_read_b64_tr_b16 v[54:55], v14 offset:12672
    ds_read_b64_tr_b16 v[70:71], v15 offset:12672
    s_waitcnt lgkmcnt(0)
    s_barrier
    s_add_u32 s37, s72, 102400
    s_add_u32 m0, s91, 73728
    s_nop 0
    buffer_load_dwordx4 v19, s[20:23], s37 offen nt lds
    s_add_u32 m0, s91, 74752
    s_nop 0
    buffer_load_dwordx4 v20, s[20:23], s37 offen nt lds
    s_add_u32 m0, s91, 75776
    s_nop 0
    buffer_load_dwordx4 v21, s[20:23], s37 offen nt lds
    s_add_u32 m0, s91, 76800
    s_nop 0
    buffer_load_dwordx4 v22, s[20:23], s37 offen nt lds
    s_add_u32 m0, s91, 77824
    s_nop 0
    buffer_load_dwordx4 v23, s[20:23], s37 offen nt lds
    s_waitcnt vmcnt(25)
    s_barrier
    v_lshrrev_b32 v14, 2, v1
    v_mul_u32_u24 v17, 1280, v14
    v_and_b32 v15, 1, v1
    v_lshl_add_u32 v17, v15, 3, v17
    v_and_b32 v14, 7, v14
    v_lshlrev_b32 v14, 1, v14
    v_bfe_u32 v15, v1, 1, 1
    s_mul_i32 s37, s4, 20
    v_add_u32 v15, s37, v15
    v_add_u32 v16, 0, v15
    v_xor_b32 v16, v16, v14
    v_lshl_add_u32 v4, v16, 4, v17
    v_add_u32 v16, 2, v15
    v_xor_b32 v16, v16, v14
    v_lshl_add_u32 v5, v16, 4, v17
    v_add_u32 v16, 4, v15
    v_xor_b32 v16, v16, v14
    v_lshl_add_u32 v6, v16, 4, v17
    v_add_u32 v16, 6, v15
    v_xor_b32 v16, v16, v14
    v_lshl_add_u32 v7, v16, 4, v17
    v_add_u32 v16, 8, v15
    v_xor_b32 v16, v16, v14
    v_lshl_add_u32 v8, v16, 4, v17
    v_add_u32 v16, 10, v15
    v_xor_b32 v16, v16, v14
    v_lshl_add_u32 v9, v16, 4, v17
    v_add_u32 v16, 12, v15
    v_xor_b32 v16, v16, v14
    v_lshl_add_u32 v10, v16, 4, v17
    v_add_u32 v16, 14, v15
    v_xor_b32 v16, v16, v14
    v_lshl_add_u32 v11, v16, 4, v17
    v_add_u32 v16, 16, v15
    v_xor_b32 v16, v16, v14
    v_lshl_add_u32 v12, v16, 4, v17
    v_add_u32 v16, 18, v15
    v_xor_b32 v16, v16, v14
    v_lshl_add_u32 v13, v16, 4, v17
    v_add_u32 v4, 98304, v4
    v_add_u32 v5, 98304, v5
    v_add_u32 v6, 98304, v6
    v_add_u32 v7, 98304, v7
    v_add_u32 v8, 98304, v8
    v_add_u32 v9, 98304, v9
    v_add_u32 v10, 98304, v10
    v_add_u32 v11, 98304, v11
    v_add_u32 v12, 98304, v12
    v_add_u32 v13, 98304, v13
    ds_read_b64_tr_b16 a[192:193], v4 offset:0
    ds_read_b64_tr_b16 v[72:73], v5 offset:0
    ds_read_b64_tr_b16 a[200:201], v6 offset:0
    ds_read_b64_tr_b16 a[208:209], v7 offset:0
    ds_read_b64_tr_b16 a[216:217], v8 offset:0
    ds_read_b64_tr_b16 v[80:81], v9 offset:0
    ds_read_b64_tr_b16 a[224:225], v10 offset:0
    ds_read_b64_tr_b16 a[232:233], v11 offset:0
    ds_read_b64_tr_b16 v[88:89], v12 offset:0
    ds_read_b64_tr_b16 a[240:241], v13 offset:0
    s_waitcnt lgkmcnt(0)
    s_barrier
    s_add_u32 s37, s72, 122880
    s_add_u32 m0, s91, 98304
    s_nop 0
    buffer_load_dwordx4 v19, s[20:23], s37 offen nt lds
    s_add_u32 m0, s91, 99328
    s_nop 0
    buffer_load_dwordx4 v20, s[20:23], s37 offen nt lds
    s_add_u32 m0, s91, 100352
    s_nop 0
    buffer_load_dwordx4 v21, s[20:23], s37 offen nt lds
    s_add_u32 m0, s91, 101376
    s_nop 0
    buffer_load_dwordx4 v22, s[20:23], s37 offen nt lds
    s_add_u32 m0, s91, 102400
    s_nop 0
    buffer_load_dwordx4 v23, s[20:23], s37 offen nt lds
    s_waitcnt vmcnt(25)
    s_barrier
    ds_read_b64_tr_b16 a[248:249], v4 offset:24576
    ds_read_b64_tr_b16 v[152:153], v5 offset:24576
    ds_read_b64_tr_b16 v[96:97], v6 offset:24576
    ds_read_b64_tr_b16 v[160:161], v7 offset:24576
    ds_read_b64_tr_b16 v[168:169], v8 offset:24576
    ds_read_b64_tr_b16 v[104:105], v9 offset:24576
    ds_read_b64_tr_b16 v[176:177], v10 offset:24576
    ds_read_b64_tr_b16 v[184:185], v11 offset:24576
    ds_read_b64_tr_b16 v[192:193], v12 offset:24576
    ds_read_b64_tr_b16 v[112:113], v13 offset:24576
    s_waitcnt lgkmcnt(0)
    s_barrier
    s_add_u32 s37, s72, 143360
    s_add_u32 m0, s91, 122880
    s_nop 0
    buffer_load_dwordx4 v19, s[20:23], s37 offen nt lds
    s_add_u32 m0, s91, 123904
    s_nop 0
    buffer_load_dwordx4 v20, s[20:23], s37 offen nt lds
    s_add_u32 m0, s91, 124928
    s_nop 0
    buffer_load_dwordx4 v21, s[20:23], s37 offen nt lds
    s_add_u32 m0, s91, 125952
    s_nop 0
    buffer_load_dwordx4 v22, s[20:23], s37 offen nt lds
    s_add_u32 m0, s91, 126976
    s_nop 0
    buffer_load_dwordx4 v23, s[20:23], s37 offen nt lds
    s_waitcnt vmcnt(25)
    s_barrier
    v_add_u32 v4, -98304, v4
    v_add_u32 v5, -98304, v5
    v_add_u32 v6, -98304, v6
    v_add_u32 v7, -98304, v7
    v_add_u32 v8, -98304, v8
    v_add_u32 v9, -98304, v9
    v_add_u32 v10, -98304, v10
    v_add_u32 v11, -98304, v11
    v_add_u32 v12, -98304, v12
    v_add_u32 v13, -98304, v13
    ds_read_b64_tr_b16 v[200:201], v4 offset:0
    ds_read_b64_tr_b16 v[208:209], v5 offset:0
    ds_read_b64_tr_b16 v[120:121], v6 offset:0
    ds_read_b64_tr_b16 v[216:217], v7 offset:0
    ds_read_b64_tr_b16 v[224:225], v8 offset:0
    ds_read_b64_tr_b16 v[232:233], v9 offset:0
    ds_read_b64_tr_b16 v[128:129], v10 offset:0
    ds_read_b64_tr_b16 v[240:241], v11 offset:0
    ds_read_b64_tr_b16 v[248:249], v12 offset:0
    ds_read_b64_tr_b16 v[136:137], v13 offset:0
    s_waitcnt lgkmcnt(0)
    s_barrier
    s_add_u32 s37, s72, 163840
    s_add_u32 m0, s91, 0
    s_nop 0
    buffer_load_dwordx4 v19, s[20:23], s37 offen nt lds
    s_add_u32 m0, s91, 1024
    s_nop 0
    buffer_load_dwordx4 v20, s[20:23], s37 offen nt lds
    s_add_u32 m0, s91, 2048
    s_nop 0
    buffer_load_dwordx4 v21, s[20:23], s37 offen nt lds
    s_add_u32 m0, s91, 3072
    s_nop 0
    buffer_load_dwordx4 v22, s[20:23], s37 offen nt lds
    s_add_u32 m0, s91, 4096
    s_nop 0
    buffer_load_dwordx4 v23, s[20:23], s37 offen nt lds
    s_waitcnt vmcnt(25)
    s_barrier
    ds_read_b64_tr_b16 a[194:195], v4 offset:24576
    ds_read_b64_tr_b16 v[74:75], v5 offset:24576
    ds_read_b64_tr_b16 a[202:203], v6 offset:24576
    ds_read_b64_tr_b16 a[210:211], v7 offset:24576
    ds_read_b64_tr_b16 a[218:219], v8 offset:24576
    ds_read_b64_tr_b16 v[82:83], v9 offset:24576
    ds_read_b64_tr_b16 a[226:227], v10 offset:24576
    ds_read_b64_tr_b16 a[234:235], v11 offset:24576
    ds_read_b64_tr_b16 v[90:91], v12 offset:24576
    ds_read_b64_tr_b16 a[242:243], v13 offset:24576
    s_waitcnt lgkmcnt(0)
    s_barrier
    s_add_u32 s37, s72, 184320
    s_add_u32 m0, s91, 24576
    s_nop 0
    buffer_load_dwordx4 v19, s[20:23], s37 offen nt lds
    s_add_u32 m0, s91, 25600
    s_nop 0
    buffer_load_dwordx4 v20, s[20:23], s37 offen nt lds
    s_add_u32 m0, s91, 26624
    s_nop 0
    buffer_load_dwordx4 v21, s[20:23], s37 offen nt lds
    s_add_u32 m0, s91, 27648
    s_nop 0
    buffer_load_dwordx4 v22, s[20:23], s37 offen nt lds
    s_add_u32 m0, s91, 28672
    s_nop 0
    buffer_load_dwordx4 v23, s[20:23], s37 offen nt lds
    s_waitcnt vmcnt(25)
    s_barrier
    v_add_u32 v4, 49152, v4
    v_add_u32 v5, 49152, v5
    v_add_u32 v6, 49152, v6
    v_add_u32 v7, 49152, v7
    v_add_u32 v8, 49152, v8
    v_add_u32 v9, 49152, v9
    v_add_u32 v10, 49152, v10
    v_add_u32 v11, 49152, v11
    v_add_u32 v12, 49152, v12
    v_add_u32 v13, 49152, v13
    ds_read_b64_tr_b16 a[250:251], v4 offset:0
    ds_read_b64_tr_b16 v[154:155], v5 offset:0
    ds_read_b64_tr_b16 v[98:99], v6 offset:0
    ds_read_b64_tr_b16 v[162:163], v7 offset:0
    ds_read_b64_tr_b16 v[170:171], v8 offset:0
    ds_read_b64_tr_b16 v[106:107], v9 offset:0
    ds_read_b64_tr_b16 v[178:179], v10 offset:0
    ds_read_b64_tr_b16 v[186:187], v11 offset:0
    ds_read_b64_tr_b16 v[194:195], v12 offset:0
    ds_read_b64_tr_b16 v[114:115], v13 offset:0
    s_waitcnt lgkmcnt(0)
    s_barrier
    s_add_u32 s37, s72, 204800
    s_add_u32 m0, s91, 49152
    s_nop 0
    buffer_load_dwordx4 v19, s[20:23], s37 offen nt lds
    s_add_u32 m0, s91, 50176
    s_nop 0
    buffer_load_dwordx4 v20, s[20:23], s37 offen nt lds
    s_add_u32 m0, s91, 51200
    s_nop 0
    buffer_load_dwordx4 v21, s[20:23], s37 offen nt lds
    s_add_u32 m0, s91, 52224
    s_nop 0
    buffer_load_dwordx4 v22, s[20:23], s37 offen nt lds
    s_add_u32 m0, s91, 53248
    s_nop 0
    buffer_load_dwordx4 v23, s[20:23], s37 offen nt lds
    s_waitcnt vmcnt(25)
    s_barrier
    ds_read_b64_tr_b16 v[202:203], v4 offset:24576
    ds_read_b64_tr_b16 v[210:211], v5 offset:24576
    ds_read_b64_tr_b16 v[122:123], v6 offset:24576
    ds_read_b64_tr_b16 v[218:219], v7 offset:24576
    ds_read_b64_tr_b16 v[226:227], v8 offset:24576
    ds_read_b64_tr_b16 v[234:235], v9 offset:24576
    ds_read_b64_tr_b16 v[130:131], v10 offset:24576
    ds_read_b64_tr_b16 v[242:243], v11 offset:24576
    ds_read_b64_tr_b16 v[250:251], v12 offset:24576
    ds_read_b64_tr_b16 v[138:139], v13 offset:24576
    s_waitcnt lgkmcnt(0)
    s_barrier
    s_add_u32 s37, s72, 225280
    s_add_u32 m0, s91, 73728
    s_nop 0
    buffer_load_dwordx4 v19, s[20:23], s37 offen nt lds
    s_add_u32 m0, s91, 74752
    s_nop 0
    buffer_load_dwordx4 v20, s[20:23], s37 offen nt lds
    s_add_u32 m0, s91, 75776
    s_nop 0
    buffer_load_dwordx4 v21, s[20:23], s37 offen nt lds
    s_add_u32 m0, s91, 76800
    s_nop 0
    buffer_load_dwordx4 v22, s[20:23], s37 offen nt lds
    s_add_u32 m0, s91, 77824
    s_nop 0
    buffer_load_dwordx4 v23, s[20:23], s37 offen nt lds
    s_waitcnt vmcnt(25)
    s_barrier
    v_add_u32 v4, 49152, v4
    v_add_u32 v5, 49152, v5
    v_add_u32 v6, 49152, v6
    v_add_u32 v7, 49152, v7
    v_add_u32 v8, 49152, v8
    v_add_u32 v9, 49152, v9
    v_add_u32 v10, 49152, v10
    v_add_u32 v11, 49152, v11
    v_add_u32 v12, 49152, v12
    v_add_u32 v13, 49152, v13
    ds_read_b64_tr_b16 a[196:197], v4 offset:0
    ds_read_b64_tr_b16 v[76:77], v5 offset:0
    ds_read_b64_tr_b16 a[204:205], v6 offset:0
    ds_read_b64_tr_b16 a[212:213], v7 offset:0
    ds_read_b64_tr_b16 a[220:221], v8 offset:0
    ds_read_b64_tr_b16 v[84:85], v9 offset:0
    ds_read_b64_tr_b16 a[228:229], v10 offset:0
    ds_read_b64_tr_b16 a[236:237], v11 offset:0
    ds_read_b64_tr_b16 v[92:93], v12 offset:0
    ds_read_b64_tr_b16 a[244:245], v13 offset:0
    s_waitcnt lgkmcnt(0)
    s_waitcnt vmcnt(20)
    s_barrier
    ds_read_b64_tr_b16 a[252:253], v4 offset:24576
    ds_read_b64_tr_b16 v[156:157], v5 offset:24576
    ds_read_b64_tr_b16 v[100:101], v6 offset:24576
    ds_read_b64_tr_b16 v[164:165], v7 offset:24576
    ds_read_b64_tr_b16 v[172:173], v8 offset:24576
    ds_read_b64_tr_b16 v[108:109], v9 offset:24576
    ds_read_b64_tr_b16 v[180:181], v10 offset:24576
    ds_read_b64_tr_b16 v[188:189], v11 offset:24576
    ds_read_b64_tr_b16 v[196:197], v12 offset:24576
    ds_read_b64_tr_b16 v[116:117], v13 offset:24576
    s_waitcnt lgkmcnt(0)
    s_waitcnt vmcnt(15)
    s_barrier
    v_add_u32 v4, -98304, v4
    v_add_u32 v5, -98304, v5
    v_add_u32 v6, -98304, v6
    v_add_u32 v7, -98304, v7
    v_add_u32 v8, -98304, v8
    v_add_u32 v9, -98304, v9
    v_add_u32 v10, -98304, v10
    v_add_u32 v11, -98304, v11
    v_add_u32 v12, -98304, v12
    v_add_u32 v13, -98304, v13
    ds_read_b64_tr_b16 v[204:205], v4 offset:0
    ds_read_b64_tr_b16 v[212:213], v5 offset:0
    ds_read_b64_tr_b16 v[124:125], v6 offset:0
    ds_read_b64_tr_b16 v[220:221], v7 offset:0
    ds_read_b64_tr_b16 v[228:229], v8 offset:0
    ds_read_b64_tr_b16 v[236:237], v9 offset:0
    ds_read_b64_tr_b16 v[132:133], v10 offset:0
    ds_read_b64_tr_b16 v[244:245], v11 offset:0
    ds_read_b64_tr_b16 v[252:253], v12 offset:0
    ds_read_b64_tr_b16 v[140:141], v13 offset:0
    s_waitcnt lgkmcnt(0)
    s_waitcnt vmcnt(10)
    s_barrier
    ds_read_b64_tr_b16 a[198:199], v4 offset:24576
    ds_read_b64_tr_b16 v[78:79], v5 offset:24576
    ds_read_b64_tr_b16 a[206:207], v6 offset:24576
    ds_read_b64_tr_b16 a[214:215], v7 offset:24576
    ds_read_b64_tr_b16 a[222:223], v8 offset:24576
    ds_read_b64_tr_b16 v[86:87], v9 offset:24576
    ds_read_b64_tr_b16 a[230:231], v10 offset:24576
    ds_read_b64_tr_b16 a[238:239], v11 offset:24576
    ds_read_b64_tr_b16 v[94:95], v12 offset:24576
    ds_read_b64_tr_b16 a[246:247], v13 offset:24576
    s_waitcnt lgkmcnt(0)
    s_waitcnt vmcnt(5)
    s_barrier
    v_add_u32 v4, 49152, v4
    v_add_u32 v5, 49152, v5
    v_add_u32 v6, 49152, v6
    v_add_u32 v7, 49152, v7
    v_add_u32 v8, 49152, v8
    v_add_u32 v9, 49152, v9
    v_add_u32 v10, 49152, v10
    v_add_u32 v11, 49152, v11
    v_add_u32 v12, 49152, v12
    v_add_u32 v13, 49152, v13
    ds_read_b64_tr_b16 a[254:255], v4 offset:0
    ds_read_b64_tr_b16 v[158:159], v5 offset:0
    ds_read_b64_tr_b16 v[102:103], v6 offset:0
    ds_read_b64_tr_b16 v[166:167], v7 offset:0
    ds_read_b64_tr_b16 v[174:175], v8 offset:0
    ds_read_b64_tr_b16 v[110:111], v9 offset:0
    ds_read_b64_tr_b16 v[182:183], v10 offset:0
    ds_read_b64_tr_b16 v[190:191], v11 offset:0
    ds_read_b64_tr_b16 v[198:199], v12 offset:0
    ds_read_b64_tr_b16 v[118:119], v13 offset:0
    s_waitcnt lgkmcnt(0)
    s_waitcnt vmcnt(0)
    s_barrier
    ds_read_b64_tr_b16 v[206:207], v4 offset:24576
    ds_read_b64_tr_b16 v[214:215], v5 offset:24576
    ds_read_b64_tr_b16 v[126:127], v6 offset:24576
    ds_read_b64_tr_b16 v[222:223], v7 offset:24576
    ds_read_b64_tr_b16 v[230:231], v8 offset:24576
    ds_read_b64_tr_b16 v[238:239], v9 offset:24576
    ds_read_b64_tr_b16 v[134:135], v10 offset:24576
    ds_read_b64_tr_b16 v[246:247], v11 offset:24576
    ds_read_b64_tr_b16 v[254:255], v12 offset:24576
    ds_read_b64_tr_b16 v[142:143], v13 offset:24576
    s_waitcnt lgkmcnt(0)
    s_branch Lpw_126
Lpw_129:
    s_waitcnt vmcnt(30)
    s_barrier
    v_add_u32 v13, 0, v10
    v_add_u32 v14, 0, v11
    v_add_u32 v15, 0, v12
    ds_read_b64_tr_b16 v[24:25], v13 offset:0
    ds_read_b64_tr_b16 v[40:41], v14 offset:0
    ds_read_b64_tr_b16 v[56:57], v15 offset:0
    ds_read_b64_tr_b16 v[26:27], v13 offset:384
    ds_read_b64_tr_b16 v[42:43], v14 offset:384
    ds_read_b64_tr_b16 v[58:59], v15 offset:384
    ds_read_b64_tr_b16 v[28:29], v13 offset:12288
    ds_read_b64_tr_b16 v[44:45], v14 offset:12288
    ds_read_b64_tr_b16 v[60:61], v15 offset:12288
    ds_read_b64_tr_b16 v[30:31], v13 offset:12672
    ds_read_b64_tr_b16 v[46:47], v14 offset:12672
    ds_read_b64_tr_b16 v[62:63], v15 offset:12672
    s_waitcnt lgkmcnt(0)
    s_barrier
    s_mul_i32 s37, s92, 3
    s_add_u32 m0, s90, 0
    s_nop 0
    buffer_load_dwordx4 v4, s[16:19], s37 offen nt lds
    s_add_u32 m0, s90, 1024
    s_nop 0
    buffer_load_dwordx4 v5, s[16:19], s37 offen nt lds
    s_add_u32 m0, s90, 2048
    s_nop 0
    buffer_load_dwordx4 v6, s[16:19], s37 offen nt lds
    s_add_u32 m0, s90, 3072
    s_nop 0
    buffer_load_dwordx4 v7, s[16:19], s37 offen nt lds
    s_add_u32 m0, s90, 4096
    s_nop 0
    buffer_load_dwordx4 v8, s[16:19], s37 offen nt lds
    s_add_u32 m0, s90, 5120
    s_nop 0
    buffer_load_dwordx4 v9, s[16:19], s37 offen nt lds
    s_waitcnt vmcnt(30)
    s_barrier
    v_add_u32 v13, 24576, v10
    v_add_u32 v14, 24576, v11
    v_add_u32 v15, 24576, v12
    ds_read_b64_tr_b16 a[72:73], v13 offset:0
    ds_read_b64_tr_b16 a[112:113], v14 offset:0
    ds_read_b64_tr_b16 a[152:153], v15 offset:0
    ds_read_b64_tr_b16 a[74:75], v13 offset:384
    ds_read_b64_tr_b16 a[114:115], v14 offset:384
    ds_read_b64_tr_b16 a[154:155], v15 offset:384
    ds_read_b64_tr_b16 a[76:77], v13 offset:12288
    ds_read_b64_tr_b16 a[116:117], v14 offset:12288
    ds_read_b64_tr_b16 a[156:157], v15 offset:12288
    ds_read_b64_tr_b16 a[78:79], v13 offset:12672
    ds_read_b64_tr_b16 a[118:119], v14 offset:12672
    ds_read_b64_tr_b16 a[158:159], v15 offset:12672
    s_waitcnt lgkmcnt(0)
    s_barrier
    s_mul_i32 s37, s92, 2
    s_add_u32 m0, s90, 24576
    s_nop 0
    buffer_load_dwordx4 v4, s[16:19], s37 offen nt lds
    s_add_u32 m0, s90, 25600
    s_nop 0
    buffer_load_dwordx4 v5, s[16:19], s37 offen nt lds
    s_add_u32 m0, s90, 26624
    s_nop 0
    buffer_load_dwordx4 v6, s[16:19], s37 offen nt lds
    s_add_u32 m0, s90, 27648
    s_nop 0
    buffer_load_dwordx4 v7, s[16:19], s37 offen nt lds
    s_add_u32 m0, s90, 28672
    s_nop 0
    buffer_load_dwordx4 v8, s[16:19], s37 offen nt lds
    s_add_u32 m0, s90, 29696
    s_nop 0
    buffer_load_dwordx4 v9, s[16:19], s37 offen nt lds
    s_waitcnt vmcnt(30)
    s_barrier
    v_add_u32 v13, 49152, v10
    v_add_u32 v14, 49152, v11
    v_add_u32 v15, 49152, v12
    ds_read_b64_tr_b16 a[48:49], v13 offset:0
    ds_read_b64_tr_b16 a[56:57], v14 offset:0
    ds_read_b64_tr_b16 a[64:65], v15 offset:0
    ds_read_b64_tr_b16 a[50:51], v13 offset:384
    ds_read_b64_tr_b16 a[58:59], v14 offset:384
    ds_read_b64_tr_b16 a[66:67], v15 offset:384
    ds_read_b64_tr_b16 a[52:53], v13 offset:12288
    ds_read_b64_tr_b16 a[60:61], v14 offset:12288
    ds_read_b64_tr_b16 a[68:69], v15 offset:12288
    ds_read_b64_tr_b16 a[54:55], v13 offset:12672
    ds_read_b64_tr_b16 a[62:63], v14 offset:12672
    ds_read_b64_tr_b16 a[70:71], v15 offset:12672
    s_waitcnt lgkmcnt(0)
    s_barrier
    s_mul_i32 s37, s92, 1
    s_add_u32 m0, s90, 49152
    s_nop 0
    buffer_load_dwordx4 v4, s[16:19], s37 offen nt lds
    s_add_u32 m0, s90, 50176
    s_nop 0
    buffer_load_dwordx4 v5, s[16:19], s37 offen nt lds
    s_add_u32 m0, s90, 51200
    s_nop 0
    buffer_load_dwordx4 v6, s[16:19], s37 offen nt lds
    s_add_u32 m0, s90, 52224
    s_nop 0
    buffer_load_dwordx4 v7, s[16:19], s37 offen nt lds
    s_add_u32 m0, s90, 53248
    s_nop 0
    buffer_load_dwordx4 v8, s[16:19], s37 offen nt lds
    s_add_u32 m0, s90, 54272
    s_nop 0
    buffer_load_dwordx4 v9, s[16:19], s37 offen nt lds
    s_waitcnt vmcnt(30)
    s_barrier
    v_add_u32 v13, 73728, v10
    v_add_u32 v14, 73728, v11
    v_add_u32 v15, 73728, v12
    ds_read_b64_tr_b16 a[24:25], v13 offset:0
    ds_read_b64_tr_b16 a[32:33], v14 offset:0
    ds_read_b64_tr_b16 a[40:41], v15 offset:0
    ds_read_b64_tr_b16 a[26:27], v13 offset:384
    ds_read_b64_tr_b16 a[34:35], v14 offset:384
    ds_read_b64_tr_b16 a[42:43], v15 offset:384
    ds_read_b64_tr_b16 a[28:29], v13 offset:12288
    ds_read_b64_tr_b16 a[36:37], v14 offset:12288
    ds_read_b64_tr_b16 a[44:45], v15 offset:12288
    ds_read_b64_tr_b16 a[30:31], v13 offset:12672
    ds_read_b64_tr_b16 a[38:39], v14 offset:12672
    ds_read_b64_tr_b16 a[46:47], v15 offset:12672
    s_waitcnt lgkmcnt(0)
    s_barrier
    s_mul_i32 s37, s92, 0
    s_add_u32 m0, s90, 73728
    s_nop 0
    buffer_load_dwordx4 v4, s[16:19], s37 offen nt lds
    s_add_u32 m0, s90, 74752
    s_nop 0
    buffer_load_dwordx4 v5, s[16:19], s37 offen nt lds
    s_add_u32 m0, s90, 75776
    s_nop 0
    buffer_load_dwordx4 v6, s[16:19], s37 offen nt lds
    s_add_u32 m0, s90, 76800
    s_nop 0
    buffer_load_dwordx4 v7, s[16:19], s37 offen nt lds
    s_add_u32 m0, s90, 77824
    s_nop 0
    buffer_load_dwordx4 v8, s[16:19], s37 offen nt lds
    s_add_u32 m0, s90, 78848
    s_nop 0
    buffer_load_dwordx4 v9, s[16:19], s37 offen nt lds
    s_waitcnt vmcnt(30)
    s_barrier
    v_add_u32 v13, 98304, v10
    v_add_u32 v14, 98304, v11
    v_add_u32 v15, 98304, v12
    ds_read_b64_tr_b16 a[0:1], v13 offset:0
    ds_read_b64_tr_b16 a[8:9], v14 offset:0
    ds_read_b64_tr_b16 a[16:17], v15 offset:0
    ds_read_b64_tr_b16 a[2:3], v13 offset:384
    ds_read_b64_tr_b16 a[10:11], v14 offset:384
    ds_read_b64_tr_b16 a[18:19], v15 offset:384
    ds_read_b64_tr_b16 a[4:5], v13 offset:12288
    ds_read_b64_tr_b16 a[12:13], v14 offset:12288
    ds_read_b64_tr_b16 a[20:21], v15 offset:12288
    ds_read_b64_tr_b16 a[6:7], v13 offset:12672
    ds_read_b64_tr_b16 a[14:15], v14 offset:12672
    ds_read_b64_tr_b16 a[22:23], v15 offset:12672
    s_waitcnt lgkmcnt(0)
    s_barrier
    s_add_u32 s37, s72, 0
    s_add_u32 m0, s91, 98304
    s_nop 0
    buffer_load_dwordx4 v19, s[20:23], s37 offen nt lds
    s_add_u32 m0, s91, 99328
    s_nop 0
    buffer_load_dwordx4 v20, s[20:23], s37 offen nt lds
    s_add_u32 m0, s91, 100352
    s_nop 0
    buffer_load_dwordx4 v21, s[20:23], s37 offen nt lds
    s_add_u32 m0, s91, 101376
    s_nop 0
    buffer_load_dwordx4 v22, s[20:23], s37 offen nt lds
    s_add_u32 m0, s91, 102400
    s_nop 0
    buffer_load_dwordx4 v23, s[20:23], s37 offen nt lds
    s_waitcnt vmcnt(29)
    s_barrier
    v_add_u32 v13, 122880, v10
    v_add_u32 v14, 122880, v11
    v_add_u32 v15, 122880, v12
    ds_read_b64_tr_b16 a[104:105], v13 offset:0
    ds_read_b64_tr_b16 a[144:145], v14 offset:0
    ds_read_b64_tr_b16 a[184:185], v15 offset:0
    ds_read_b64_tr_b16 a[106:107], v13 offset:384
    ds_read_b64_tr_b16 a[146:147], v14 offset:384
    ds_read_b64_tr_b16 a[186:187], v15 offset:384
    ds_read_b64_tr_b16 a[108:109], v13 offset:12288
    ds_read_b64_tr_b16 a[148:149], v14 offset:12288
    ds_read_b64_tr_b16 a[188:189], v15 offset:12288
    ds_read_b64_tr_b16 a[110:111], v13 offset:12672
    ds_read_b64_tr_b16 a[150:151], v14 offset:12672
    ds_read_b64_tr_b16 a[190:191], v15 offset:12672
    s_waitcnt lgkmcnt(0)
    s_barrier
    s_add_u32 s37, s72, 20480
    s_add_u32 m0, s91, 122880
    s_nop 0
    buffer_load_dwordx4 v19, s[20:23], s37 offen nt lds
    s_add_u32 m0, s91, 123904
    s_nop 0
    buffer_load_dwordx4 v20, s[20:23], s37 offen nt lds
    s_add_u32 m0, s91, 124928
    s_nop 0
    buffer_load_dwordx4 v21, s[20:23], s37 offen nt lds
    s_add_u32 m0, s91, 125952
    s_nop 0
    buffer_load_dwordx4 v22, s[20:23], s37 offen nt lds
    s_add_u32 m0, s91, 126976
    s_nop 0
    buffer_load_dwordx4 v23, s[20:23], s37 offen nt lds
    s_waitcnt vmcnt(28)
    s_barrier
    v_add_u32 v13, 0, v10
    v_add_u32 v14, 0, v11
    v_add_u32 v15, 0, v12
    ds_read_b64_tr_b16 v[32:33], v13 offset:0
    ds_read_b64_tr_b16 v[48:49], v14 offset:0
    ds_read_b64_tr_b16 v[64:65], v15 offset:0
    ds_read_b64_tr_b16 v[34:35], v13 offset:384
    ds_read_b64_tr_b16 v[50:51], v14 offset:384
    ds_read_b64_tr_b16 v[66:67], v15 offset:384
    ds_read_b64_tr_b16 v[36:37], v13 offset:12288
    ds_read_b64_tr_b16 v[52:53], v14 offset:12288
    ds_read_b64_tr_b16 v[68:69], v15 offset:12288
    ds_read_b64_tr_b16 v[38:39], v13 offset:12672
    ds_read_b64_tr_b16 v[54:55], v14 offset:12672
    ds_read_b64_tr_b16 v[70:71], v15 offset:12672
    s_waitcnt lgkmcnt(0)
    s_barrier
    s_add_u32 s37, s72, 40960
    s_add_u32 m0, s91, 0
    s_nop 0
    buffer_load_dwordx4 v19, s[20:23], s37 offen nt lds
    s_add_u32 m0, s91, 1024
    s_nop 0
    buffer_load_dwordx4 v20, s[20:23], s37 offen nt lds
    s_add_u32 m0, s91, 2048
    s_nop 0
    buffer_load_dwordx4 v21, s[20:23], s37 offen nt lds
    s_add_u32 m0, s91, 3072
    s_nop 0
    buffer_load_dwordx4 v22, s[20:23], s37 offen nt lds
    s_add_u32 m0, s91, 4096
    s_nop 0
    buffer_load_dwordx4 v23, s[20:23], s37 offen nt lds
    s_waitcnt vmcnt(27)
    s_barrier
    v_add_u32 v13, 24576, v10
    v_add_u32 v14, 24576, v11
    v_add_u32 v15, 24576, v12
    ds_read_b64_tr_b16 a[96:97], v13 offset:0
    ds_read_b64_tr_b16 a[136:137], v14 offset:0
    ds_read_b64_tr_b16 a[176:177], v15 offset:0
    ds_read_b64_tr_b16 a[98:99], v13 offset:384
    ds_read_b64_tr_b16 a[138:139], v14 offset:384
    ds_read_b64_tr_b16 a[178:179], v15 offset:384
    ds_read_b64_tr_b16 a[100:101], v13 offset:12288
    ds_read_b64_tr_b16 a[140:141], v14 offset:12288
    ds_read_b64_tr_b16 a[180:181], v15 offset:12288
    ds_read_b64_tr_b16 a[102:103], v13 offset:12672
    ds_read_b64_tr_b16 a[142:143], v14 offset:12672
    ds_read_b64_tr_b16 a[182:183], v15 offset:12672
    s_waitcnt lgkmcnt(0)
    s_barrier
    s_add_u32 s37, s72, 61440
    s_add_u32 m0, s91, 24576
    s_nop 0
    buffer_load_dwordx4 v19, s[20:23], s37 offen nt lds
    s_add_u32 m0, s91, 25600
    s_nop 0
    buffer_load_dwordx4 v20, s[20:23], s37 offen nt lds
    s_add_u32 m0, s91, 26624
    s_nop 0
    buffer_load_dwordx4 v21, s[20:23], s37 offen nt lds
    s_add_u32 m0, s91, 27648
    s_nop 0
    buffer_load_dwordx4 v22, s[20:23], s37 offen nt lds
    s_add_u32 m0, s91, 28672
    s_nop 0
    buffer_load_dwordx4 v23, s[20:23], s37 offen nt lds
    s_waitcnt vmcnt(26)
    s_barrier
    v_add_u32 v13, 49152, v10
    v_add_u32 v14, 49152, v11
    v_add_u32 v15, 49152, v12
    ds_read_b64_tr_b16 a[88:89], v13 offset:0
    ds_read_b64_tr_b16 a[128:129], v14 offset:0
    ds_read_b64_tr_b16 a[168:169], v15 offset:0
    ds_read_b64_tr_b16 a[90:91], v13 offset:384
    ds_read_b64_tr_b16 a[130:131], v14 offset:384
    ds_read_b64_tr_b16 a[170:171], v15 offset:384
    ds_read_b64_tr_b16 a[92:93], v13 offset:12288
    ds_read_b64_tr_b16 a[132:133], v14 offset:12288
    ds_read_b64_tr_b16 a[172:173], v15 offset:12288
    ds_read_b64_tr_b16 a[94:95], v13 offset:12672
    ds_read_b64_tr_b16 a[134:135], v14 offset:12672
    ds_read_b64_tr_b16 a[174:175], v15 offset:12672
    s_waitcnt lgkmcnt(0)
    s_barrier
    s_add_u32 s37, s72, 81920
    s_add_u32 m0, s91, 49152
    s_nop 0
    buffer_load_dwordx4 v19, s[20:23], s37 offen nt lds
    s_add_u32 m0, s91, 50176
    s_nop 0
    buffer_load_dwordx4 v20, s[20:23], s37 offen nt lds
    s_add_u32 m0, s91, 51200
    s_nop 0
    buffer_load_dwordx4 v21, s[20:23], s37 offen nt lds
    s_add_u32 m0, s91, 52224
    s_nop 0
    buffer_load_dwordx4 v22, s[20:23], s37 offen nt lds
    s_add_u32 m0, s91, 53248
    s_nop 0
    buffer_load_dwordx4 v23, s[20:23], s37 offen nt lds
    s_waitcnt vmcnt(25)
    s_barrier
    v_add_u32 v13, 73728, v10
    v_add_u32 v14, 73728, v11
    v_add_u32 v15, 73728, v12
    ds_read_b64_tr_b16 a[80:81], v13 offset:0
    ds_read_b64_tr_b16 a[120:121], v14 offset:0
    ds_read_b64_tr_b16 a[160:161], v15 offset:0
    ds_read_b64_tr_b16 a[82:83], v13 offset:384
    ds_read_b64_tr_b16 a[122:123], v14 offset:384
    ds_read_b64_tr_b16 a[162:163], v15 offset:384
    ds_read_b64_tr_b16 a[84:85], v13 offset:12288
    ds_read_b64_tr_b16 a[124:125], v14 offset:12288
    ds_read_b64_tr_b16 a[164:165], v15 offset:12288
    ds_read_b64_tr_b16 a[86:87], v13 offset:12672
    ds_read_b64_tr_b16 a[126:127], v14 offset:12672
    ds_read_b64_tr_b16 a[166:167], v15 offset:12672
    s_waitcnt lgkmcnt(0)
    s_barrier
    s_add_u32 s37, s72, 102400
    s_add_u32 m0, s91, 73728
    s_nop 0
    buffer_load_dwordx4 v19, s[20:23], s37 offen nt lds
    s_add_u32 m0, s91, 74752
    s_nop 0
    buffer_load_dwordx4 v20, s[20:23], s37 offen nt lds
    s_add_u32 m0, s91, 75776
    s_nop 0
    buffer_load_dwordx4 v21, s[20:23], s37 offen nt lds
    s_add_u32 m0, s91, 76800
    s_nop 0
    buffer_load_dwordx4 v22, s[20:23], s37 offen nt lds
    s_add_u32 m0, s91, 77824
    s_nop 0
    buffer_load_dwordx4 v23, s[20:23], s37 offen nt lds
    s_waitcnt vmcnt(25)
    s_barrier
    v_lshrrev_b32 v14, 2, v1
    v_mul_u32_u24 v17, 1280, v14
    v_and_b32 v15, 1, v1
    v_lshl_add_u32 v17, v15, 3, v17
    v_and_b32 v14, 7, v14
    v_lshlrev_b32 v14, 1, v14
    v_bfe_u32 v15, v1, 1, 1
    s_mul_i32 s37, s4, 20
    v_add_u32 v15, s37, v15
    v_add_u32 v16, 0, v15
    v_xor_b32 v16, v16, v14
    v_lshl_add_u32 v4, v16, 4, v17
    v_add_u32 v16, 2, v15
    v_xor_b32 v16, v16, v14
    v_lshl_add_u32 v5, v16, 4, v17
    v_add_u32 v16, 4, v15
    v_xor_b32 v16, v16, v14
    v_lshl_add_u32 v6, v16, 4, v17
    v_add_u32 v16, 6, v15
    v_xor_b32 v16, v16, v14
    v_lshl_add_u32 v7, v16, 4, v17
    v_add_u32 v16, 8, v15
    v_xor_b32 v16, v16, v14
    v_lshl_add_u32 v8, v16, 4, v17
    v_add_u32 v16, 10, v15
    v_xor_b32 v16, v16, v14
    v_lshl_add_u32 v9, v16, 4, v17
    v_add_u32 v16, 12, v15
    v_xor_b32 v16, v16, v14
    v_lshl_add_u32 v10, v16, 4, v17
    v_add_u32 v16, 14, v15
    v_xor_b32 v16, v16, v14
    v_lshl_add_u32 v11, v16, 4, v17
    v_add_u32 v16, 16, v15
    v_xor_b32 v16, v16, v14
    v_lshl_add_u32 v12, v16, 4, v17
    v_add_u32 v16, 18, v15
    v_xor_b32 v16, v16, v14
    v_lshl_add_u32 v13, v16, 4, v17
    v_add_u32 v4, 98304, v4
    v_add_u32 v5, 98304, v5
    v_add_u32 v6, 98304, v6
    v_add_u32 v7, 98304, v7
    v_add_u32 v8, 98304, v8
    v_add_u32 v9, 98304, v9
    v_add_u32 v10, 98304, v10
    v_add_u32 v11, 98304, v11
    v_add_u32 v12, 98304, v12
    v_add_u32 v13, 98304, v13
    ds_read_b64_tr_b16 a[192:193], v4 offset:0
    ds_read_b64_tr_b16 v[72:73], v5 offset:0
    ds_read_b64_tr_b16 a[200:201], v6 offset:0
    ds_read_b64_tr_b16 a[208:209], v7 offset:0
    ds_read_b64_tr_b16 a[216:217], v8 offset:0
    ds_read_b64_tr_b16 v[80:81], v9 offset:0
    ds_read_b64_tr_b16 a[224:225], v10 offset:0
    ds_read_b64_tr_b16 a[232:233], v11 offset:0
    ds_read_b64_tr_b16 v[88:89], v12 offset:0
    ds_read_b64_tr_b16 a[240:241], v13 offset:0
    s_waitcnt lgkmcnt(0)
    s_barrier
    s_add_u32 s37, s72, 122880
    s_add_u32 m0, s91, 98304
    s_nop 0
    buffer_load_dwordx4 v19, s[20:23], s37 offen nt lds
    s_add_u32 m0, s91, 99328
    s_nop 0
    buffer_load_dwordx4 v20, s[20:23], s37 offen nt lds
    s_add_u32 m0, s91, 100352
    s_nop 0
    buffer_load_dwordx4 v21, s[20:23], s37 offen nt lds
    s_add_u32 m0, s91, 101376
    s_nop 0
    buffer_load_dwordx4 v22, s[20:23], s37 offen nt lds
    s_add_u32 m0, s91, 102400
    s_nop 0
    buffer_load_dwordx4 v23, s[20:23], s37 offen nt lds
    s_waitcnt vmcnt(25)
    s_barrier
    ds_read_b64_tr_b16 a[248:249], v4 offset:24576
    ds_read_b64_tr_b16 v[152:153], v5 offset:24576
    ds_read_b64_tr_b16 v[96:97], v6 offset:24576
    ds_read_b64_tr_b16 v[160:161], v7 offset:24576
    ds_read_b64_tr_b16 v[168:169], v8 offset:24576
    ds_read_b64_tr_b16 v[104:105], v9 offset:24576
    ds_read_b64_tr_b16 v[176:177], v10 offset:24576
    ds_read_b64_tr_b16 v[184:185], v11 offset:24576
    ds_read_b64_tr_b16 v[192:193], v12 offset:24576
    ds_read_b64_tr_b16 v[112:113], v13 offset:24576
    s_waitcnt lgkmcnt(0)
    s_barrier
    s_add_u32 s37, s72, 143360
    s_add_u32 m0, s91, 122880
    s_nop 0
    buffer_load_dwordx4 v19, s[20:23], s37 offen nt lds
    s_add_u32 m0, s91, 123904
    s_nop 0
    buffer_load_dwordx4 v20, s[20:23], s37 offen nt lds
    s_add_u32 m0, s91, 124928
    s_nop 0
    buffer_load_dwordx4 v21, s[20:23], s37 offen nt lds
    s_add_u32 m0, s91, 125952
    s_nop 0
    buffer_load_dwordx4 v22, s[20:23], s37 offen nt lds
    s_add_u32 m0, s91, 126976
    s_nop 0
    buffer_load_dwordx4 v23, s[20:23], s37 offen nt lds
    s_waitcnt vmcnt(25)
    s_barrier
    v_add_u32 v4, -98304, v4
    v_add_u32 v5, -98304, v5
    v_add_u32 v6, -98304, v6
    v_add_u32 v7, -98304, v7
    v_add_u32 v8, -98304, v8
    v_add_u32 v9, -98304, v9
    v_add_u32 v10, -98304, v10
    v_add_u32 v11, -98304, v11
    v_add_u32 v12, -98304, v12
    v_add_u32 v13, -98304, v13
    ds_read_b64_tr_b16 v[200:201], v4 offset:0
    ds_read_b64_tr_b16 v[208:209], v5 offset:0
    ds_read_b64_tr_b16 v[120:121], v6 offset:0
    ds_read_b64_tr_b16 v[216:217], v7 offset:0
    ds_read_b64_tr_b16 v[224:225], v8 offset:0
    ds_read_b64_tr_b16 v[232:233], v9 offset:0
    ds_read_b64_tr_b16 v[128:129], v10 offset:0
    ds_read_b64_tr_b16 v[240:241], v11 offset:0
    ds_read_b64_tr_b16 v[248:249], v12 offset:0
    ds_read_b64_tr_b16 v[136:137], v13 offset:0
    s_waitcnt lgkmcnt(0)
    s_barrier
    s_add_u32 s37, s72, 163840
    s_add_u32 m0, s91, 0
    s_nop 0
    buffer_load_dwordx4 v19, s[20:23], s37 offen nt lds
    s_add_u32 m0, s91, 1024
    s_nop 0
    buffer_load_dwordx4 v20, s[20:23], s37 offen nt lds
    s_add_u32 m0, s91, 2048
    s_nop 0
    buffer_load_dwordx4 v21, s[20:23], s37 offen nt lds
    s_add_u32 m0, s91, 3072
    s_nop 0
    buffer_load_dwordx4 v22, s[20:23], s37 offen nt lds
    s_add_u32 m0, s91, 4096
    s_nop 0
    buffer_load_dwordx4 v23, s[20:23], s37 offen nt lds
    s_waitcnt vmcnt(25)
    s_barrier
    ds_read_b64_tr_b16 a[194:195], v4 offset:24576
    ds_read_b64_tr_b16 v[74:75], v5 offset:24576
    ds_read_b64_tr_b16 a[202:203], v6 offset:24576
    ds_read_b64_tr_b16 a[210:211], v7 offset:24576
    ds_read_b64_tr_b16 a[218:219], v8 offset:24576
    ds_read_b64_tr_b16 v[82:83], v9 offset:24576
    ds_read_b64_tr_b16 a[226:227], v10 offset:24576
    ds_read_b64_tr_b16 a[234:235], v11 offset:24576
    ds_read_b64_tr_b16 v[90:91], v12 offset:24576
    ds_read_b64_tr_b16 a[242:243], v13 offset:24576
    s_waitcnt lgkmcnt(0)
    s_barrier
    s_add_u32 s37, s72, 184320
    s_add_u32 m0, s91, 24576
    s_nop 0
    buffer_load_dwordx4 v19, s[20:23], s37 offen nt lds
    s_add_u32 m0, s91, 25600
    s_nop 0
    buffer_load_dwordx4 v20, s[20:23], s37 offen nt lds
    s_add_u32 m0, s91, 26624
    s_nop 0
    buffer_load_dwordx4 v21, s[20:23], s37 offen nt lds
    s_add_u32 m0, s91, 27648
    s_nop 0
    buffer_load_dwordx4 v22, s[20:23], s37 offen nt lds
    s_add_u32 m0, s91, 28672
    s_nop 0
    buffer_load_dwordx4 v23, s[20:23], s37 offen nt lds
    s_waitcnt vmcnt(25)
    s_barrier
    v_add_u32 v4, 49152, v4
    v_add_u32 v5, 49152, v5
    v_add_u32 v6, 49152, v6
    v_add_u32 v7, 49152, v7
    v_add_u32 v8, 49152, v8
    v_add_u32 v9, 49152, v9
    v_add_u32 v10, 49152, v10
    v_add_u32 v11, 49152, v11
    v_add_u32 v12, 49152, v12
    v_add_u32 v13, 49152, v13
    ds_read_b64_tr_b16 a[250:251], v4 offset:0
    ds_read_b64_tr_b16 v[154:155], v5 offset:0
    ds_read_b64_tr_b16 v[98:99], v6 offset:0
    ds_read_b64_tr_b16 v[162:163], v7 offset:0
    ds_read_b64_tr_b16 v[170:171], v8 offset:0
    ds_read_b64_tr_b16 v[106:107], v9 offset:0
    ds_read_b64_tr_b16 v[178:179], v10 offset:0
    ds_read_b64_tr_b16 v[186:187], v11 offset:0
    ds_read_b64_tr_b16 v[194:195], v12 offset:0
    ds_read_b64_tr_b16 v[114:115], v13 offset:0
    s_waitcnt lgkmcnt(0)
    s_barrier
    s_add_u32 s37, s72, 204800
    s_add_u32 m0, s91, 49152
    s_nop 0
    buffer_load_dwordx4 v19, s[20:23], s37 offen nt lds
    s_add_u32 m0, s91, 50176
    s_nop 0
    buffer_load_dwordx4 v20, s[20:23], s37 offen nt lds
    s_add_u32 m0, s91, 51200
    s_nop 0
    buffer_load_dwordx4 v21, s[20:23], s37 offen nt lds
    s_add_u32 m0, s91, 52224
    s_nop 0
    buffer_load_dwordx4 v22, s[20:23], s37 offen nt lds
    s_add_u32 m0, s91, 53248
    s_nop 0
    buffer_load_dwordx4 v23, s[20:23], s37 offen nt lds
    s_waitcnt vmcnt(25)
    s_barrier
    ds_read_b64_tr_b16 v[202:203], v4 offset:24576
    ds_read_b64_tr_b16 v[210:211], v5 offset:24576
    ds_read_b64_tr_b16 v[122:123], v6 offset:24576
    ds_read_b64_tr_b16 v[218:219], v7 offset:24576
    ds_read_b64_tr_b16 v[226:227], v8 offset:24576
    ds_read_b64_tr_b16 v[234:235], v9 offset:24576
    ds_read_b64_tr_b16 v[130:131], v10 offset:24576
    ds_read_b64_tr_b16 v[242:243], v11 offset:24576
    ds_read_b64_tr_b16 v[250:251], v12 offset:24576
    ds_read_b64_tr_b16 v[138:139], v13 offset:24576
    s_waitcnt lgkmcnt(0)
    s_barrier
    s_add_u32 s37, s72, 225280
    s_add_u32 m0, s91, 73728
    s_nop 0
    buffer_load_dwordx4 v19, s[20:23], s37 offen nt lds
    s_add_u32 m0, s91, 74752
    s_nop 0
    buffer_load_dwordx4 v20, s[20:23], s37 offen nt lds
    s_add_u32 m0, s91, 75776
    s_nop 0
    buffer_load_dwordx4 v21, s[20:23], s37 offen nt lds
    s_add_u32 m0, s91, 76800
    s_nop 0
    buffer_load_dwordx4 v22, s[20:23], s37 offen nt lds
    s_add_u32 m0, s91, 77824
    s_nop 0
    buffer_load_dwordx4 v23, s[20:23], s37 offen nt lds
    s_waitcnt vmcnt(25)
    s_barrier
    v_add_u32 v4, 49152, v4
    v_add_u32 v5, 49152, v5
    v_add_u32 v6, 49152, v6
    v_add_u32 v7, 49152, v7
    v_add_u32 v8, 49152, v8
    v_add_u32 v9, 49152, v9
    v_add_u32 v10, 49152, v10
    v_add_u32 v11, 49152, v11
    v_add_u32 v12, 49152, v12
    v_add_u32 v13, 49152, v13
    ds_read_b64_tr_b16 a[196:197], v4 offset:0
    ds_read_b64_tr_b16 v[76:77], v5 offset:0
    ds_read_b64_tr_b16 a[204:205], v6 offset:0
    ds_read_b64_tr_b16 a[212:213], v7 offset:0
    ds_read_b64_tr_b16 a[220:221], v8 offset:0
    ds_read_b64_tr_b16 v[84:85], v9 offset:0
    ds_read_b64_tr_b16 a[228:229], v10 offset:0
    ds_read_b64_tr_b16 a[236:237], v11 offset:0
    ds_read_b64_tr_b16 v[92:93], v12 offset:0
    ds_read_b64_tr_b16 a[244:245], v13 offset:0
    s_waitcnt lgkmcnt(0)
    s_waitcnt vmcnt(20)
    s_barrier
    ds_read_b64_tr_b16 a[252:253], v4 offset:24576
    ds_read_b64_tr_b16 v[156:157], v5 offset:24576
    ds_read_b64_tr_b16 v[100:101], v6 offset:24576
    ds_read_b64_tr_b16 v[164:165], v7 offset:24576
    ds_read_b64_tr_b16 v[172:173], v8 offset:24576
    ds_read_b64_tr_b16 v[108:109], v9 offset:24576
    ds_read_b64_tr_b16 v[180:181], v10 offset:24576
    ds_read_b64_tr_b16 v[188:189], v11 offset:24576
    ds_read_b64_tr_b16 v[196:197], v12 offset:24576
    ds_read_b64_tr_b16 v[116:117], v13 offset:24576
    s_waitcnt lgkmcnt(0)
    s_waitcnt vmcnt(15)
    s_barrier
    v_add_u32 v4, -98304, v4
    v_add_u32 v5, -98304, v5
    v_add_u32 v6, -98304, v6
    v_add_u32 v7, -98304, v7
    v_add_u32 v8, -98304, v8
    v_add_u32 v9, -98304, v9
    v_add_u32 v10, -98304, v10
    v_add_u32 v11, -98304, v11
    v_add_u32 v12, -98304, v12
    v_add_u32 v13, -98304, v13
    ds_read_b64_tr_b16 v[204:205], v4 offset:0
    ds_read_b64_tr_b16 v[212:213], v5 offset:0
    ds_read_b64_tr_b16 v[124:125], v6 offset:0
    ds_read_b64_tr_b16 v[220:221], v7 offset:0
    ds_read_b64_tr_b16 v[228:229], v8 offset:0
    ds_read_b64_tr_b16 v[236:237], v9 offset:0
    ds_read_b64_tr_b16 v[132:133], v10 offset:0
    ds_read_b64_tr_b16 v[244:245], v11 offset:0
    ds_read_b64_tr_b16 v[252:253], v12 offset:0
    ds_read_b64_tr_b16 v[140:141], v13 offset:0
    s_waitcnt lgkmcnt(0)
    s_waitcnt vmcnt(10)
    s_barrier
    ds_read_b64_tr_b16 a[198:199], v4 offset:24576
    ds_read_b64_tr_b16 v[78:79], v5 offset:24576
    ds_read_b64_tr_b16 a[206:207], v6 offset:24576
    ds_read_b64_tr_b16 a[214:215], v7 offset:24576
    ds_read_b64_tr_b16 a[222:223], v8 offset:24576
    ds_read_b64_tr_b16 v[86:87], v9 offset:24576
    ds_read_b64_tr_b16 a[230:231], v10 offset:24576
    ds_read_b64_tr_b16 a[238:239], v11 offset:24576
    ds_read_b64_tr_b16 v[94:95], v12 offset:24576
    ds_read_b64_tr_b16 a[246:247], v13 offset:24576
    s_waitcnt lgkmcnt(0)
    s_waitcnt vmcnt(5)
    s_barrier
    v_add_u32 v4, 49152, v4
    v_add_u32 v5, 49152, v5
    v_add_u32 v6, 49152, v6
    v_add_u32 v7, 49152, v7
    v_add_u32 v8, 49152, v8
    v_add_u32 v9, 49152, v9
    v_add_u32 v10, 49152, v10
    v_add_u32 v11, 49152, v11
    v_add_u32 v12, 49152, v12
    v_add_u32 v13, 49152, v13
    ds_read_b64_tr_b16 a[254:255], v4 offset:0
    ds_read_b64_tr_b16 v[158:159], v5 offset:0
    ds_read_b64_tr_b16 v[102:103], v6 offset:0
    ds_read_b64_tr_b16 v[166:167], v7 offset:0
    ds_read_b64_tr_b16 v[174:175], v8 offset:0
    ds_read_b64_tr_b16 v[110:111], v9 offset:0
    ds_read_b64_tr_b16 v[182:183], v10 offset:0
    ds_read_b64_tr_b16 v[190:191], v11 offset:0
    ds_read_b64_tr_b16 v[198:199], v12 offset:0
    ds_read_b64_tr_b16 v[118:119], v13 offset:0
    s_waitcnt lgkmcnt(0)
    s_waitcnt vmcnt(0)
    s_barrier
    ds_read_b64_tr_b16 v[206:207], v4 offset:24576
    ds_read_b64_tr_b16 v[214:215], v5 offset:24576
    ds_read_b64_tr_b16 v[126:127], v6 offset:24576
    ds_read_b64_tr_b16 v[222:223], v7 offset:24576
    ds_read_b64_tr_b16 v[230:231], v8 offset:24576
    ds_read_b64_tr_b16 v[238:239], v9 offset:24576
    ds_read_b64_tr_b16 v[134:135], v10 offset:24576
    ds_read_b64_tr_b16 v[246:247], v11 offset:24576
    ds_read_b64_tr_b16 v[254:255], v12 offset:24576
    ds_read_b64_tr_b16 v[142:143], v13 offset:24576
    s_waitcnt lgkmcnt(0)
    s_branch Lpw_126
Lpw_130:
    s_waitcnt vmcnt(30)
    s_barrier
    v_add_u32 v13, 0, v10
    v_add_u32 v14, 0, v11
    v_add_u32 v15, 0, v12
    ds_read_b64_tr_b16 a[48:49], v13 offset:0
    ds_read_b64_tr_b16 a[56:57], v14 offset:0
    ds_read_b64_tr_b16 a[64:65], v15 offset:0
    ds_read_b64_tr_b16 a[50:51], v13 offset:384
    ds_read_b64_tr_b16 a[58:59], v14 offset:384
    ds_read_b64_tr_b16 a[66:67], v15 offset:384
    ds_read_b64_tr_b16 a[52:53], v13 offset:12288
    ds_read_b64_tr_b16 a[60:61], v14 offset:12288
    ds_read_b64_tr_b16 a[68:69], v15 offset:12288
    ds_read_b64_tr_b16 a[54:55], v13 offset:12672
    ds_read_b64_tr_b16 a[62:63], v14 offset:12672
    ds_read_b64_tr_b16 a[70:71], v15 offset:12672
    s_waitcnt lgkmcnt(0)
    s_barrier
    s_mul_i32 s37, s92, 3
    s_add_u32 m0, s90, 0
    s_nop 0
    buffer_load_dwordx4 v4, s[16:19], s37 offen nt lds
    s_add_u32 m0, s90, 1024
    s_nop 0
    buffer_load_dwordx4 v5, s[16:19], s37 offen nt lds
    s_add_u32 m0, s90, 2048
    s_nop 0
    buffer_load_dwordx4 v6, s[16:19], s37 offen nt lds
    s_add_u32 m0, s90, 3072
    s_nop 0
    buffer_load_dwordx4 v7, s[16:19], s37 offen nt lds
    s_add_u32 m0, s90, 4096
    s_nop 0
    buffer_load_dwordx4 v8, s[16:19], s37 offen nt lds
    s_add_u32 m0, s90, 5120
    s_nop 0
    buffer_load_dwordx4 v9, s[16:19], s37 offen nt lds
    s_waitcnt vmcnt(30)
    s_barrier
    v_add_u32 v13, 24576, v10
    v_add_u32 v14, 24576, v11
    v_add_u32 v15, 24576, v12
    ds_read_b64_tr_b16 a[24:25], v13 offset:0
    ds_read_b64_tr_b16 a[32:33], v14 offset:0
    ds_read_b64_tr_b16 a[40:41], v15 offset:0
    ds_read_b64_tr_b16 a[26:27], v13 offset:384
    ds_read_b64_tr_b16 a[34:35], v14 offset:384
    ds_read_b64_tr_b16 a[42:43], v15 offset:384
    ds_read_b64_tr_b16 a[28:29], v13 offset:12288
    ds_read_b64_tr_b16 a[36:37], v14 offset:12288
    ds_read_b64_tr_b16 a[44:45], v15 offset:12288
    ds_read_b64_tr_b16 a[30:31], v13 offset:12672
    ds_read_b64_tr_b16 a[38:39], v14 offset:12672
    ds_read_b64_tr_b16 a[46:47], v15 offset:12672
    s_waitcnt lgkmcnt(0)
    s_barrier
    s_mul_i32 s37, s92, 2
    s_add_u32 m0, s90, 24576
    s_nop 0
    buffer_load_dwordx4 v4, s[16:19], s37 offen nt lds
    s_add_u32 m0, s90, 25600
    s_nop 0
    buffer_load_dwordx4 v5, s[16:19], s37 offen nt lds
    s_add_u32 m0, s90, 26624
    s_nop 0
    buffer_load_dwordx4 v6, s[16:19], s37 offen nt lds
    s_add_u32 m0, s90, 27648
    s_nop 0
    buffer_load_dwordx4 v7, s[16:19], s37 offen nt lds
    s_add_u32 m0, s90, 28672
    s_nop 0
    buffer_load_dwordx4 v8, s[16:19], s37 offen nt lds
    s_add_u32 m0, s90, 29696
    s_nop 0
    buffer_load_dwordx4 v9, s[16:19], s37 offen nt lds
    s_waitcnt vmcnt(30)
    s_barrier
    v_add_u32 v13, 49152, v10
    v_add_u32 v14, 49152, v11
    v_add_u32 v15, 49152, v12
    ds_read_b64_tr_b16 a[0:1], v13 offset:0
    ds_read_b64_tr_b16 a[8:9], v14 offset:0
    ds_read_b64_tr_b16 a[16:17], v15 offset:0
    ds_read_b64_tr_b16 a[2:3], v13 offset:384
    ds_read_b64_tr_b16 a[10:11], v14 offset:384
    ds_read_b64_tr_b16 a[18:19], v15 offset:384
    ds_read_b64_tr_b16 a[4:5], v13 offset:12288
    ds_read_b64_tr_b16 a[12:13], v14 offset:12288
    ds_read_b64_tr_b16 a[20:21], v15 offset:12288
    ds_read_b64_tr_b16 a[6:7], v13 offset:12672
    ds_read_b64_tr_b16 a[14:15], v14 offset:12672
    ds_read_b64_tr_b16 a[22:23], v15 offset:12672
    s_waitcnt lgkmcnt(0)
    s_barrier
    s_mul_i32 s37, s92, 1
    s_add_u32 m0, s90, 49152
    s_nop 0
    buffer_load_dwordx4 v4, s[16:19], s37 offen nt lds
    s_add_u32 m0, s90, 50176
    s_nop 0
    buffer_load_dwordx4 v5, s[16:19], s37 offen nt lds
    s_add_u32 m0, s90, 51200
    s_nop 0
    buffer_load_dwordx4 v6, s[16:19], s37 offen nt lds
    s_add_u32 m0, s90, 52224
    s_nop 0
    buffer_load_dwordx4 v7, s[16:19], s37 offen nt lds
    s_add_u32 m0, s90, 53248
    s_nop 0
    buffer_load_dwordx4 v8, s[16:19], s37 offen nt lds
    s_add_u32 m0, s90, 54272
    s_nop 0
    buffer_load_dwordx4 v9, s[16:19], s37 offen nt lds
    s_waitcnt vmcnt(30)
    s_barrier
    v_add_u32 v13, 73728, v10
    v_add_u32 v14, 73728, v11
    v_add_u32 v15, 73728, v12
    ds_read_b64_tr_b16 a[104:105], v13 offset:0
    ds_read_b64_tr_b16 a[144:145], v14 offset:0
    ds_read_b64_tr_b16 a[184:185], v15 offset:0
    ds_read_b64_tr_b16 a[106:107], v13 offset:384
    ds_read_b64_tr_b16 a[146:147], v14 offset:384
    ds_read_b64_tr_b16 a[186:187], v15 offset:384
    ds_read_b64_tr_b16 a[108:109], v13 offset:12288
    ds_read_b64_tr_b16 a[148:149], v14 offset:12288
    ds_read_b64_tr_b16 a[188:189], v15 offset:12288
    ds_read_b64_tr_b16 a[110:111], v13 offset:12672
    ds_read_b64_tr_b16 a[150:151], v14 offset:12672
    ds_read_b64_tr_b16 a[190:191], v15 offset:12672
    s_waitcnt lgkmcnt(0)
    s_barrier
    s_mul_i32 s37, s92, 0
    s_add_u32 m0, s90, 73728
    s_nop 0
    buffer_load_dwordx4 v4, s[16:19], s37 offen nt lds
    s_add_u32 m0, s90, 74752
    s_nop 0
    buffer_load_dwordx4 v5, s[16:19], s37 offen nt lds
    s_add_u32 m0, s90, 75776
    s_nop 0
    buffer_load_dwordx4 v6, s[16:19], s37 offen nt lds
    s_add_u32 m0, s90, 76800
    s_nop 0
    buffer_load_dwordx4 v7, s[16:19], s37 offen nt lds
    s_add_u32 m0, s90, 77824
    s_nop 0
    buffer_load_dwordx4 v8, s[16:19], s37 offen nt lds
    s_add_u32 m0, s90, 78848
    s_nop 0
    buffer_load_dwordx4 v9, s[16:19], s37 offen nt lds
    s_waitcnt vmcnt(30)
    s_barrier
    v_add_u32 v13, 98304, v10
    v_add_u32 v14, 98304, v11
    v_add_u32 v15, 98304, v12
    ds_read_b64_tr_b16 v[32:33], v13 offset:0
    ds_read_b64_tr_b16 v[48:49], v14 offset:0
    ds_read_b64_tr_b16 v[64:65], v15 offset:0
    ds_read_b64_tr_b16 v[34:35], v13 offset:384
    ds_read_b64_tr_b16 v[50:51], v14 offset:384
    ds_read_b64_tr_b16 v[66:67], v15 offset:384
    ds_read_b64_tr_b16 v[36:37], v13 offset:12288
    ds_read_b64_tr_b16 v[52:53], v14 offset:12288
    ds_read_b64_tr_b16 v[68:69], v15 offset:12288
    ds_read_b64_tr_b16 v[38:39], v13 offset:12672
    ds_read_b64_tr_b16 v[54:55], v14 offset:12672
    ds_read_b64_tr_b16 v[70:71], v15 offset:12672
    s_waitcnt lgkmcnt(0)
    s_barrier
    s_add_u32 s37, s72, 0
    s_add_u32 m0, s91, 98304
    s_nop 0
    buffer_load_dwordx4 v19, s[20:23], s37 offen nt lds
    s_add_u32 m0, s91, 99328
    s_nop 0
    buffer_load_dwordx4 v20, s[20:23], s37 offen nt lds
    s_add_u32 m0, s91, 100352
    s_nop 0
    buffer_load_dwordx4 v21, s[20:23], s37 offen nt lds
    s_add_u32 m0, s91, 101376
    s_nop 0
    buffer_load_dwordx4 v22, s[20:23], s37 offen nt lds
    s_add_u32 m0, s91, 102400
    s_nop 0
    buffer_load_dwordx4 v23, s[20:23], s37 offen nt lds
    s_waitcnt vmcnt(29)
    s_barrier
    v_add_u32 v13, 122880, v10
    v_add_u32 v14, 122880, v11
    v_add_u32 v15, 122880, v12
    ds_read_b64_tr_b16 a[96:97], v13 offset:0
    ds_read_b64_tr_b16 a[136:137], v14 offset:0
    ds_read_b64_tr_b16 a[176:177], v15 offset:0
    ds_read_b64_tr_b16 a[98:99], v13 offset:384
    ds_read_b64_tr_b16 a[138:139], v14 offset:384
    ds_read_b64_tr_b16 a[178:179], v15 offset:384
    ds_read_b64_tr_b16 a[100:101], v13 offset:12288
    ds_read_b64_tr_b16 a[140:141], v14 offset:12288
    ds_read_b64_tr_b16 a[180:181], v15 offset:12288
    ds_read_b64_tr_b16 a[102:103], v13 offset:12672
    ds_read_b64_tr_b16 a[142:143], v14 offset:12672
    ds_read_b64_tr_b16 a[182:183], v15 offset:12672
    s_waitcnt lgkmcnt(0)
    s_barrier
    s_add_u32 s37, s72, 20480
    s_add_u32 m0, s91, 122880
    s_nop 0
    buffer_load_dwordx4 v19, s[20:23], s37 offen nt lds
    s_add_u32 m0, s91, 123904
    s_nop 0
    buffer_load_dwordx4 v20, s[20:23], s37 offen nt lds
    s_add_u32 m0, s91, 124928
    s_nop 0
    buffer_load_dwordx4 v21, s[20:23], s37 offen nt lds
    s_add_u32 m0, s91, 125952
    s_nop 0
    buffer_load_dwordx4 v22, s[20:23], s37 offen nt lds
    s_add_u32 m0, s91, 126976
    s_nop 0
    buffer_load_dwordx4 v23, s[20:23], s37 offen nt lds
    s_waitcnt vmcnt(28)
    s_barrier
    v_add_u32 v13, 0, v10
    v_add_u32 v14, 0, v11
    v_add_u32 v15, 0, v12
    ds_read_b64_tr_b16 a[88:89], v13 offset:0
    ds_read_b64_tr_b16 a[128:129], v14 offset:0
    ds_read_b64_tr_b16 a[168:169], v15 offset:0
    ds_read_b64_tr_b16 a[90:91], v13 offset:384
    ds_read_b64_tr_b16 a[130:131], v14 offset:384
    ds_read_b64_tr_b16 a[170:171], v15 offset:384
    ds_read_b64_tr_b16 a[92:93], v13 offset:12288
    ds_read_b64_tr_b16 a[132:133], v14 offset:12288
    ds_read_b64_tr_b16 a[172:173], v15 offset:12288
    ds_read_b64_tr_b16 a[94:95], v13 offset:12672
    ds_read_b64_tr_b16 a[134:135], v14 offset:12672
    ds_read_b64_tr_b16 a[174:175], v15 offset:12672
    s_waitcnt lgkmcnt(0)
    s_barrier
    s_add_u32 s37, s72, 40960
    s_add_u32 m0, s91, 0
    s_nop 0
    buffer_load_dwordx4 v19, s[20:23], s37 offen nt lds
    s_add_u32 m0, s91, 1024
    s_nop 0
    buffer_load_dwordx4 v20, s[20:23], s37 offen nt lds
    s_add_u32 m0, s91, 2048
    s_nop 0
    buffer_load_dwordx4 v21, s[20:23], s37 offen nt lds
    s_add_u32 m0, s91, 3072
    s_nop 0
    buffer_load_dwordx4 v22, s[20:23], s37 offen nt lds
    s_add_u32 m0, s91, 4096
    s_nop 0
    buffer_load_dwordx4 v23, s[20:23], s37 offen nt lds
    s_waitcnt vmcnt(27)
    s_barrier
    v_add_u32 v13, 24576, v10
    v_add_u32 v14, 24576, v11
    v_add_u32 v15, 24576, v12
    ds_read_b64_tr_b16 a[80:81], v13 offset:0
    ds_read_b64_tr_b16 a[120:121], v14 offset:0
    ds_read_b64_tr_b16 a[160:161], v15 offset:0
    ds_read_b64_tr_b16 a[82:83], v13 offset:384
    ds_read_b64_tr_b16 a[122:123], v14 offset:384
    ds_read_b64_tr_b16 a[162:163], v15 offset:384
    ds_read_b64_tr_b16 a[84:85], v13 offset:12288
    ds_read_b64_tr_b16 a[124:125], v14 offset:12288
    ds_read_b64_tr_b16 a[164:165], v15 offset:12288
    ds_read_b64_tr_b16 a[86:87], v13 offset:12672
    ds_read_b64_tr_b16 a[126:127], v14 offset:12672
    ds_read_b64_tr_b16 a[166:167], v15 offset:12672
    s_waitcnt lgkmcnt(0)
    s_barrier
    s_add_u32 s37, s72, 61440
    s_add_u32 m0, s91, 24576
    s_nop 0
    buffer_load_dwordx4 v19, s[20:23], s37 offen nt lds
    s_add_u32 m0, s91, 25600
    s_nop 0
    buffer_load_dwordx4 v20, s[20:23], s37 offen nt lds
    s_add_u32 m0, s91, 26624
    s_nop 0
    buffer_load_dwordx4 v21, s[20:23], s37 offen nt lds
    s_add_u32 m0, s91, 27648
    s_nop 0
    buffer_load_dwordx4 v22, s[20:23], s37 offen nt lds
    s_add_u32 m0, s91, 28672
    s_nop 0
    buffer_load_dwordx4 v23, s[20:23], s37 offen nt lds
    s_waitcnt vmcnt(26)
    s_barrier
    v_add_u32 v13, 49152, v10
    v_add_u32 v14, 49152, v11
    v_add_u32 v15, 49152, v12
    ds_read_b64_tr_b16 v[24:25], v13 offset:0
    ds_read_b64_tr_b16 v[40:41], v14 offset:0
    ds_read_b64_tr_b16 v[56:57], v15 offset:0
    ds_read_b64_tr_b16 v[26:27], v13 offset:384
    ds_read_b64_tr_b16 v[42:43], v14 offset:384
    ds_read_b64_tr_b16 v[58:59], v15 offset:384
    ds_read_b64_tr_b16 v[28:29], v13 offset:12288
    ds_read_b64_tr_b16 v[44:45], v14 offset:12288
    ds_read_b64_tr_b16 v[60:61], v15 offset:12288
    ds_read_b64_tr_b16 v[30:31], v13 offset:12672
    ds_read_b64_tr_b16 v[46:47], v14 offset:12672
    ds_read_b64_tr_b16 v[62:63], v15 offset:12672
    s_waitcnt lgkmcnt(0)
    s_barrier
    s_add_u32 s37, s72, 81920
    s_add_u32 m0, s91, 49152
    s_nop 0
    buffer_load_dwordx4 v19, s[20:23], s37 offen nt lds
    s_add_u32 m0, s91, 50176
    s_nop 0
    buffer_load_dwordx4 v20, s[20:23], s37 offen nt lds
    s_add_u32 m0, s91, 51200
    s_nop 0
    buffer_load_dwordx4 v21, s[20:23], s37 offen nt lds
    s_add_u32 m0, s91, 52224
    s_nop 0
    buffer_load_dwordx4 v22, s[20:23], s37 offen nt lds
    s_add_u32 m0, s91, 53248
    s_nop 0
    buffer_load_dwordx4 v23, s[20:23], s37 offen nt lds
    s_waitcnt vmcnt(25)
    s_barrier
    v_add_u32 v13, 73728, v10
    v_add_u32 v14, 73728, v11
    v_add_u32 v15, 73728, v12
    ds_read_b64_tr_b16 a[72:73], v13 offset:0
    ds_read_b64_tr_b16 a[112:113], v14 offset:0
    ds_read_b64_tr_b16 a[152:153], v15 offset:0
    ds_read_b64_tr_b16 a[74:75], v13 offset:384
    ds_read_b64_tr_b16 a[114:115], v14 offset:384
    ds_read_b64_tr_b16 a[154:155], v15 offset:384
    ds_read_b64_tr_b16 a[76:77], v13 offset:12288
    ds_read_b64_tr_b16 a[116:117], v14 offset:12288
    ds_read_b64_tr_b16 a[156:157], v15 offset:12288
    ds_read_b64_tr_b16 a[78:79], v13 offset:12672
    ds_read_b64_tr_b16 a[118:119], v14 offset:12672
    ds_read_b64_tr_b16 a[158:159], v15 offset:12672
    s_waitcnt lgkmcnt(0)
    s_barrier
    s_add_u32 s37, s72, 102400
    s_add_u32 m0, s91, 73728
    s_nop 0
    buffer_load_dwordx4 v19, s[20:23], s37 offen nt lds
    s_add_u32 m0, s91, 74752
    s_nop 0
    buffer_load_dwordx4 v20, s[20:23], s37 offen nt lds
    s_add_u32 m0, s91, 75776
    s_nop 0
    buffer_load_dwordx4 v21, s[20:23], s37 offen nt lds
    s_add_u32 m0, s91, 76800
    s_nop 0
    buffer_load_dwordx4 v22, s[20:23], s37 offen nt lds
    s_add_u32 m0, s91, 77824
    s_nop 0
    buffer_load_dwordx4 v23, s[20:23], s37 offen nt lds
    s_waitcnt vmcnt(25)
    s_barrier
    v_lshrrev_b32 v14, 2, v1
    v_mul_u32_u24 v17, 1280, v14
    v_and_b32 v15, 1, v1
    v_lshl_add_u32 v17, v15, 3, v17
    v_and_b32 v14, 7, v14
    v_lshlrev_b32 v14, 1, v14
    v_bfe_u32 v15, v1, 1, 1
    s_mul_i32 s37, s4, 20
    v_add_u32 v15, s37, v15
    v_add_u32 v16, 0, v15
    v_xor_b32 v16, v16, v14
    v_lshl_add_u32 v4, v16, 4, v17
    v_add_u32 v16, 2, v15
    v_xor_b32 v16, v16, v14
    v_lshl_add_u32 v5, v16, 4, v17
    v_add_u32 v16, 4, v15
    v_xor_b32 v16, v16, v14
    v_lshl_add_u32 v6, v16, 4, v17
    v_add_u32 v16, 6, v15
    v_xor_b32 v16, v16, v14
    v_lshl_add_u32 v7, v16, 4, v17
    v_add_u32 v16, 8, v15
    v_xor_b32 v16, v16, v14
    v_lshl_add_u32 v8, v16, 4, v17
    v_add_u32 v16, 10, v15
    v_xor_b32 v16, v16, v14
    v_lshl_add_u32 v9, v16, 4, v17
    v_add_u32 v16, 12, v15
    v_xor_b32 v16, v16, v14
    v_lshl_add_u32 v10, v16, 4, v17
    v_add_u32 v16, 14, v15
    v_xor_b32 v16, v16, v14
    v_lshl_add_u32 v11, v16, 4, v17
    v_add_u32 v16, 16, v15
    v_xor_b32 v16, v16, v14
    v_lshl_add_u32 v12, v16, 4, v17
    v_add_u32 v16, 18, v15
    v_xor_b32 v16, v16, v14
    v_lshl_add_u32 v13, v16, 4, v17
    v_add_u32 v4, 98304, v4
    v_add_u32 v5, 98304, v5
    v_add_u32 v6, 98304, v6
    v_add_u32 v7, 98304, v7
    v_add_u32 v8, 98304, v8
    v_add_u32 v9, 98304, v9
    v_add_u32 v10, 98304, v10
    v_add_u32 v11, 98304, v11
    v_add_u32 v12, 98304, v12
    v_add_u32 v13, 98304, v13
    ds_read_b64_tr_b16 a[192:193], v4 offset:0
    ds_read_b64_tr_b16 v[72:73], v5 offset:0
    ds_read_b64_tr_b16 a[200:201], v6 offset:0
    ds_read_b64_tr_b16 a[208:209], v7 offset:0
    ds_read_b64_tr_b16 a[216:217], v8 offset:0
    ds_read_b64_tr_b16 v[80:81], v9 offset:0
    ds_read_b64_tr_b16 a[224:225], v10 offset:0
    ds_read_b64_tr_b16 a[232:233], v11 offset:0
    ds_read_b64_tr_b16 v[88:89], v12 offset:0
    ds_read_b64_tr_b16 a[240:241], v13 offset:0
    s_waitcnt lgkmcnt(0)
    s_barrier
    s_add_u32 s37, s72, 122880
    s_add_u32 m0, s91, 98304
    s_nop 0
    buffer_load_dwordx4 v19, s[20:23], s37 offen nt lds
    s_add_u32 m0, s91, 99328
    s_nop 0
    buffer_load_dwordx4 v20, s[20:23], s37 offen nt lds
    s_add_u32 m0, s91, 100352
    s_nop 0
    buffer_load_dwordx4 v21, s[20:23], s37 offen nt lds
    s_add_u32 m0, s91, 101376
    s_nop 0
    buffer_load_dwordx4 v22, s[20:23], s37 offen nt lds
    s_add_u32 m0, s91, 102400
    s_nop 0
    buffer_load_dwordx4 v23, s[20:23], s37 offen nt lds
    s_waitcnt vmcnt(25)
    s_barrier
    ds_read_b64_tr_b16 a[248:249], v4 offset:24576
    ds_read_b64_tr_b16 v[152:153], v5 offset:24576
    ds_read_b64_tr_b16 v[96:97], v6 offset:24576
    ds_read_b64_tr_b16 v[160:161], v7 offset:24576
    ds_read_b64_tr_b16 v[168:169], v8 offset:24576
    ds_read_b64_tr_b16 v[104:105], v9 offset:24576
    ds_read_b64_tr_b16 v[176:177], v10 offset:24576
    ds_read_b64_tr_b16 v[184:185], v11 offset:24576
    ds_read_b64_tr_b16 v[192:193], v12 offset:24576
    ds_read_b64_tr_b16 v[112:113], v13 offset:24576
    s_waitcnt lgkmcnt(0)
    s_barrier
    s_add_u32 s37, s72, 143360
    s_add_u32 m0, s91, 122880
    s_nop 0
    buffer_load_dwordx4 v19, s[20:23], s37 offen nt lds
    s_add_u32 m0, s91, 123904
    s_nop 0
    buffer_load_dwordx4 v20, s[20:23], s37 offen nt lds
    s_add_u32 m0, s91, 124928
    s_nop 0
    buffer_load_dwordx4 v21, s[20:23], s37 offen nt lds
    s_add_u32 m0, s91, 125952
    s_nop 0
    buffer_load_dwordx4 v22, s[20:23], s37 offen nt lds
    s_add_u32 m0, s91, 126976
    s_nop 0
    buffer_load_dwordx4 v23, s[20:23], s37 offen nt lds
    s_waitcnt vmcnt(25)
    s_barrier
    v_add_u32 v4, -98304, v4
    v_add_u32 v5, -98304, v5
    v_add_u32 v6, -98304, v6
    v_add_u32 v7, -98304, v7
    v_add_u32 v8, -98304, v8
    v_add_u32 v9, -98304, v9
    v_add_u32 v10, -98304, v10
    v_add_u32 v11, -98304, v11
    v_add_u32 v12, -98304, v12
    v_add_u32 v13, -98304, v13
    ds_read_b64_tr_b16 v[200:201], v4 offset:0
    ds_read_b64_tr_b16 v[208:209], v5 offset:0
    ds_read_b64_tr_b16 v[120:121], v6 offset:0
    ds_read_b64_tr_b16 v[216:217], v7 offset:0
    ds_read_b64_tr_b16 v[224:225], v8 offset:0
    ds_read_b64_tr_b16 v[232:233], v9 offset:0
    ds_read_b64_tr_b16 v[128:129], v10 offset:0
    ds_read_b64_tr_b16 v[240:241], v11 offset:0
    ds_read_b64_tr_b16 v[248:249], v12 offset:0
    ds_read_b64_tr_b16 v[136:137], v13 offset:0
    s_waitcnt lgkmcnt(0)
    s_barrier
    s_add_u32 s37, s72, 163840
    s_add_u32 m0, s91, 0
    s_nop 0
    buffer_load_dwordx4 v19, s[20:23], s37 offen nt lds
    s_add_u32 m0, s91, 1024
    s_nop 0
    buffer_load_dwordx4 v20, s[20:23], s37 offen nt lds
    s_add_u32 m0, s91, 2048
    s_nop 0
    buffer_load_dwordx4 v21, s[20:23], s37 offen nt lds
    s_add_u32 m0, s91, 3072
    s_nop 0
    buffer_load_dwordx4 v22, s[20:23], s37 offen nt lds
    s_add_u32 m0, s91, 4096
    s_nop 0
    buffer_load_dwordx4 v23, s[20:23], s37 offen nt lds
    s_waitcnt vmcnt(25)
    s_barrier
    ds_read_b64_tr_b16 a[194:195], v4 offset:24576
    ds_read_b64_tr_b16 v[74:75], v5 offset:24576
    ds_read_b64_tr_b16 a[202:203], v6 offset:24576
    ds_read_b64_tr_b16 a[210:211], v7 offset:24576
    ds_read_b64_tr_b16 a[218:219], v8 offset:24576
    ds_read_b64_tr_b16 v[82:83], v9 offset:24576
    ds_read_b64_tr_b16 a[226:227], v10 offset:24576
    ds_read_b64_tr_b16 a[234:235], v11 offset:24576
    ds_read_b64_tr_b16 v[90:91], v12 offset:24576
    ds_read_b64_tr_b16 a[242:243], v13 offset:24576
    s_waitcnt lgkmcnt(0)
    s_barrier
    s_add_u32 s37, s72, 184320
    s_add_u32 m0, s91, 24576
    s_nop 0
    buffer_load_dwordx4 v19, s[20:23], s37 offen nt lds
    s_add_u32 m0, s91, 25600
    s_nop 0
    buffer_load_dwordx4 v20, s[20:23], s37 offen nt lds
    s_add_u32 m0, s91, 26624
    s_nop 0
    buffer_load_dwordx4 v21, s[20:23], s37 offen nt lds
    s_add_u32 m0, s91, 27648
    s_nop 0
    buffer_load_dwordx4 v22, s[20:23], s37 offen nt lds
    s_add_u32 m0, s91, 28672
    s_nop 0
    buffer_load_dwordx4 v23, s[20:23], s37 offen nt lds
    s_waitcnt vmcnt(25)
    s_barrier
    v_add_u32 v4, 49152, v4
    v_add_u32 v5, 49152, v5
    v_add_u32 v6, 49152, v6
    v_add_u32 v7, 49152, v7
    v_add_u32 v8, 49152, v8
    v_add_u32 v9, 49152, v9
    v_add_u32 v10, 49152, v10
    v_add_u32 v11, 49152, v11
    v_add_u32 v12, 49152, v12
    v_add_u32 v13, 49152, v13
    ds_read_b64_tr_b16 a[250:251], v4 offset:0
    ds_read_b64_tr_b16 v[154:155], v5 offset:0
    ds_read_b64_tr_b16 v[98:99], v6 offset:0
    ds_read_b64_tr_b16 v[162:163], v7 offset:0
    ds_read_b64_tr_b16 v[170:171], v8 offset:0
    ds_read_b64_tr_b16 v[106:107], v9 offset:0
    ds_read_b64_tr_b16 v[178:179], v10 offset:0
    ds_read_b64_tr_b16 v[186:187], v11 offset:0
    ds_read_b64_tr_b16 v[194:195], v12 offset:0
    ds_read_b64_tr_b16 v[114:115], v13 offset:0
    s_waitcnt lgkmcnt(0)
    s_barrier
    s_add_u32 s37, s72, 204800
    s_add_u32 m0, s91, 49152
    s_nop 0
    buffer_load_dwordx4 v19, s[20:23], s37 offen nt lds
    s_add_u32 m0, s91, 50176
    s_nop 0
    buffer_load_dwordx4 v20, s[20:23], s37 offen nt lds
    s_add_u32 m0, s91, 51200
    s_nop 0
    buffer_load_dwordx4 v21, s[20:23], s37 offen nt lds
    s_add_u32 m0, s91, 52224
    s_nop 0
    buffer_load_dwordx4 v22, s[20:23], s37 offen nt lds
    s_add_u32 m0, s91, 53248
    s_nop 0
    buffer_load_dwordx4 v23, s[20:23], s37 offen nt lds
    s_waitcnt vmcnt(25)
    s_barrier
    ds_read_b64_tr_b16 v[202:203], v4 offset:24576
    ds_read_b64_tr_b16 v[210:211], v5 offset:24576
    ds_read_b64_tr_b16 v[122:123], v6 offset:24576
    ds_read_b64_tr_b16 v[218:219], v7 offset:24576
    ds_read_b64_tr_b16 v[226:227], v8 offset:24576
    ds_read_b64_tr_b16 v[234:235], v9 offset:24576
    ds_read_b64_tr_b16 v[130:131], v10 offset:24576
    ds_read_b64_tr_b16 v[242:243], v11 offset:24576
    ds_read_b64_tr_b16 v[250:251], v12 offset:24576
    ds_read_b64_tr_b16 v[138:139], v13 offset:24576
    s_waitcnt lgkmcnt(0)
    s_barrier
    s_add_u32 s37, s72, 225280
    s_add_u32 m0, s91, 73728
    s_nop 0
    buffer_load_dwordx4 v19, s[20:23], s37 offen nt lds
    s_add_u32 m0, s91, 74752
    s_nop 0
    buffer_load_dwordx4 v20, s[20:23], s37 offen nt lds
    s_add_u32 m0, s91, 75776
    s_nop 0
    buffer_load_dwordx4 v21, s[20:23], s37 offen nt lds
    s_add_u32 m0, s91, 76800
    s_nop 0
    buffer_load_dwordx4 v22, s[20:23], s37 offen nt lds
    s_add_u32 m0, s91, 77824
    s_nop 0
    buffer_load_dwordx4 v23, s[20:23], s37 offen nt lds
    s_waitcnt vmcnt(25)
    s_barrier
    v_add_u32 v4, 49152, v4
    v_add_u32 v5, 49152, v5
    v_add_u32 v6, 49152, v6
    v_add_u32 v7, 49152, v7
    v_add_u32 v8, 49152, v8
    v_add_u32 v9, 49152, v9
    v_add_u32 v10, 49152, v10
    v_add_u32 v11, 49152, v11
    v_add_u32 v12, 49152, v12
    v_add_u32 v13, 49152, v13
    ds_read_b64_tr_b16 a[196:197], v4 offset:0
    ds_read_b64_tr_b16 v[76:77], v5 offset:0
    ds_read_b64_tr_b16 a[204:205], v6 offset:0
    ds_read_b64_tr_b16 a[212:213], v7 offset:0
    ds_read_b64_tr_b16 a[220:221], v8 offset:0
    ds_read_b64_tr_b16 v[84:85], v9 offset:0
    ds_read_b64_tr_b16 a[228:229], v10 offset:0
    ds_read_b64_tr_b16 a[236:237], v11 offset:0
    ds_read_b64_tr_b16 v[92:93], v12 offset:0
    ds_read_b64_tr_b16 a[244:245], v13 offset:0
    s_waitcnt lgkmcnt(0)
    s_waitcnt vmcnt(20)
    s_barrier
    ds_read_b64_tr_b16 a[252:253], v4 offset:24576
    ds_read_b64_tr_b16 v[156:157], v5 offset:24576
    ds_read_b64_tr_b16 v[100:101], v6 offset:24576
    ds_read_b64_tr_b16 v[164:165], v7 offset:24576
    ds_read_b64_tr_b16 v[172:173], v8 offset:24576
    ds_read_b64_tr_b16 v[108:109], v9 offset:24576
    ds_read_b64_tr_b16 v[180:181], v10 offset:24576
    ds_read_b64_tr_b16 v[188:189], v11 offset:24576
    ds_read_b64_tr_b16 v[196:197], v12 offset:24576
    ds_read_b64_tr_b16 v[116:117], v13 offset:24576
    s_waitcnt lgkmcnt(0)
    s_waitcnt vmcnt(15)
    s_barrier
    v_add_u32 v4, -98304, v4
    v_add_u32 v5, -98304, v5
    v_add_u32 v6, -98304, v6
    v_add_u32 v7, -98304, v7
    v_add_u32 v8, -98304, v8
    v_add_u32 v9, -98304, v9
    v_add_u32 v10, -98304, v10
    v_add_u32 v11, -98304, v11
    v_add_u32 v12, -98304, v12
    v_add_u32 v13, -98304, v13
    ds_read_b64_tr_b16 v[204:205], v4 offset:0
    ds_read_b64_tr_b16 v[212:213], v5 offset:0
    ds_read_b64_tr_b16 v[124:125], v6 offset:0
    ds_read_b64_tr_b16 v[220:221], v7 offset:0
    ds_read_b64_tr_b16 v[228:229], v8 offset:0
    ds_read_b64_tr_b16 v[236:237], v9 offset:0
    ds_read_b64_tr_b16 v[132:133], v10 offset:0
    ds_read_b64_tr_b16 v[244:245], v11 offset:0
    ds_read_b64_tr_b16 v[252:253], v12 offset:0
    ds_read_b64_tr_b16 v[140:141], v13 offset:0
    s_waitcnt lgkmcnt(0)
    s_waitcnt vmcnt(10)
    s_barrier
    ds_read_b64_tr_b16 a[198:199], v4 offset:24576
    ds_read_b64_tr_b16 v[78:79], v5 offset:24576
    ds_read_b64_tr_b16 a[206:207], v6 offset:24576
    ds_read_b64_tr_b16 a[214:215], v7 offset:24576
    ds_read_b64_tr_b16 a[222:223], v8 offset:24576
    ds_read_b64_tr_b16 v[86:87], v9 offset:24576
    ds_read_b64_tr_b16 a[230:231], v10 offset:24576
    ds_read_b64_tr_b16 a[238:239], v11 offset:24576
    ds_read_b64_tr_b16 v[94:95], v12 offset:24576
    ds_read_b64_tr_b16 a[246:247], v13 offset:24576
    s_waitcnt lgkmcnt(0)
    s_waitcnt vmcnt(5)
    s_barrier
    v_add_u32 v4, 49152, v4
    v_add_u32 v5, 49152, v5
    v_add_u32 v6, 49152, v6
    v_add_u32 v7, 49152, v7
    v_add_u32 v8, 49152, v8
    v_add_u32 v9, 49152, v9
    v_add_u32 v10, 49152, v10
    v_add_u32 v11, 49152, v11
    v_add_u32 v12, 49152, v12
    v_add_u32 v13, 49152, v13
    ds_read_b64_tr_b16 a[254:255], v4 offset:0
    ds_read_b64_tr_b16 v[158:159], v5 offset:0
    ds_read_b64_tr_b16 v[102:103], v6 offset:0
    ds_read_b64_tr_b16 v[166:167], v7 offset:0
    ds_read_b64_tr_b16 v[174:175], v8 offset:0
    ds_read_b64_tr_b16 v[110:111], v9 offset:0
    ds_read_b64_tr_b16 v[182:183], v10 offset:0
    ds_read_b64_tr_b16 v[190:191], v11 offset:0
    ds_read_b64_tr_b16 v[198:199], v12 offset:0
    ds_read_b64_tr_b16 v[118:119], v13 offset:0
    s_waitcnt lgkmcnt(0)
    s_waitcnt vmcnt(0)
    s_barrier
    ds_read_b64_tr_b16 v[206:207], v4 offset:24576
    ds_read_b64_tr_b16 v[214:215], v5 offset:24576
    ds_read_b64_tr_b16 v[126:127], v6 offset:24576
    ds_read_b64_tr_b16 v[222:223], v7 offset:24576
    ds_read_b64_tr_b16 v[230:231], v8 offset:24576
    ds_read_b64_tr_b16 v[238:239], v9 offset:24576
    ds_read_b64_tr_b16 v[134:135], v10 offset:24576
    ds_read_b64_tr_b16 v[246:247], v11 offset:24576
    ds_read_b64_tr_b16 v[254:255], v12 offset:24576
    ds_read_b64_tr_b16 v[142:143], v13 offset:24576
    s_waitcnt lgkmcnt(0)
Lpw_126:
    s_mul_i32 s37, s4, 30720
    v_lshlrev_b32 v9, 4, v1
    s_add_u32 s37, s37, 16384
    v_add_u32 v9, s37, v9
    s_barrier
    ds_write_b128 v9, v[24:27] offset:0
    ds_write_b128 v9, v[28:31] offset:1024
    ds_write_b128 v9, v[32:35] offset:2048
    ds_write_b128 v9, v[36:39] offset:3072
    ds_write_b128 v9, v[40:43] offset:4096
    ds_write_b128 v9, v[44:47] offset:5120
    ds_write_b128 v9, v[48:51] offset:6144
    ds_write_b128 v9, v[52:55] offset:7168
    ds_write_b128 v9, v[56:59] offset:8192
    ds_write_b128 v9, v[60:63] offset:9216
    ds_write_b128 v9, v[64:67] offset:10240
    ds_write_b128 v9, v[68:71] offset:11264
    ds_write_b128 v9, v[72:75] offset:12288
    ds_write_b128 v9, v[76:79] offset:13312
    ds_write_b128 v9, v[80:83] offset:14336
    ds_write_b128 v9, v[84:87] offset:15360
    ds_write_b128 v9, v[88:91] offset:16384
    ds_write_b128 v9, v[92:95] offset:17408
    ds_write_b128 v9, v[96:99] offset:18432
    ds_write_b128 v9, v[100:103] offset:19456
    ds_write_b128 v9, v[104:107] offset:20480
    ds_write_b128 v9, v[108:111] offset:21504
    ds_write_b128 v9, v[112:115] offset:22528
    ds_write_b128 v9, v[116:119] offset:23552
    ds_write_b128 v9, v[120:123] offset:24576
    ds_write_b128 v9, v[124:127] offset:25600
    ds_write_b128 v9, v[128:131] offset:26624
    ds_write_b128 v9, v[132:135] offset:27648
    ds_write_b128 v9, v[136:139] offset:28672
    ds_write_b128 v9, v[140:143] offset:29696
    s_waitcnt lgkmcnt(0)
    s_mul_i32 s37, s4, 5
    s_lshr_b32 s37, s37, 1
    v_lshlrev_b32 v8, 4, v1
    s_lshl_b32 s38, s37, 10
    v_add_u32 v0, s38, v8
    s_add_u32 s38, s37, 3
    s_cmp_ge_u32 s38, 10
    s_cselect_b32 s39, 10, 0
    s_sub_u32 s38, s38, s39
    s_lshl_b32 s38, s38, 10
    v_add_u32 v4, s38, v8
    s_add_u32 s38, s37, 5
    s_cmp_ge_u32 s38, 10
    s_cselect_b32 s39, 10, 0
    s_sub_u32 s38, s38, s39
    s_lshl_b32 s38, s38, 10
    v_add_u32 v5, s38, v8
    s_add_u32 s38, s37, 8
    s_cmp_ge_u32 s38, 10
    s_cselect_b32 s39, 10, 0
    s_sub_u32 s38, s38, s39
    s_lshl_b32 s38, s38, 10
    v_add_u32 v6, s38, v8
    v_and_b32 v7, 2, v1
    v_cmp_eq_u32 vcc, 0, v7
    v_mov_b32 v7, 0xeeee
    v_mov_b32 v112, 0x4444
    v_cndmask_b32 v7, v7, v112, vcc
    v_and_b32 v112, 8, v1
    v_cmp_eq_u32 vcc, 0, v112
    v_mov_b32 v112, 0xeeee
    v_mov_b32 v113, 0x4444
    v_cndmask_b32 v2, v112, v113, vcc
    v_and_b32 v112, 15, v1
    v_lshrrev_b32 v113, 4, v1
    v_and_b32 v114, 1, v113
    v_lshrrev_b32 v115, 1, v113
    v_lshrrev_b32 v116, 2, v112
    v_and_b32 v117, 3, v112
    v_lshl_add_u32 v116, v116, 3, v117
    v_lshlrev_b32 v10, 4, v116
    v_lshl_add_u32 v10, v113, 2, v10
    s_lshr_b32 s37, s4, 1
    s_lshl_b32 s37, s37, 9
    s_and_b32 s38, s4, 1
    s_lshl_b32 s38, s38, 6
    s_add_u32 s37, s37, s38
    s_add_u32 s37, s37, 10240
    v_add_u32 v10, s37, v10
    v_lshlrev_b32 v11, 8, v113
    v_bfe_u32 v116, v1, 3, 1
    v_lshl_add_u32 v11, v116, 6, v11
    v_bfe_u32 v116, v1, 2, 1
    v_lshl_add_u32 v11, v116, 4, v11
    v_bfe_u32 v116, v1, 1, 1
    v_lshl_add_u32 v11, v116, 5, v11
    v_and_b32 v116, 1, v1
    v_lshl_add_u32 v11, v116, 3, v11
    v_add_u32 v11, 10240, v11
    v_lshlrev_b32 v117, 4, v112
    v_lshl_add_u32 v12, v115, 8, v117
    v_lshl_add_u32 v12, v114, 3, v12
    v_add_u32 v12, s75, v12
    v_lshl_add_u32 v116, v114, 1, v115
    v_lshl_add_u32 v15, v116, 8, v117
    v_add_u32 v15, s75, v15
    v_bfe_u32 v116, v1, 4, 1
    v_lshlrev_b32 v116, 2, v116
    v_and_b32 v117, 15, v1
    v_sub_u32 v116, v117, v116
    v_mov_b32 v124, 0
    v_mov_b32 v117, 0x3f80
    v_cmp_eq_u32 vcc, 0, v116
    s_nop 1
    v_cndmask_b32 v124, v124, v117, vcc
    v_mov_b32 v117, 0x3f800000
    v_cmp_eq_u32 vcc, 1, v116
    s_nop 1
    v_cndmask_b32 v124, v124, v117, vcc
    v_mov_b32 v125, 0
    v_mov_b32 v117, 0x3f80
    v_cmp_eq_u32 vcc, 2, v116
    s_nop 1
    v_cndmask_b32 v125, v125, v117, vcc
    v_mov_b32 v117, 0x3f800000
    v_cmp_eq_u32 vcc, 3, v116
    s_nop 1
    v_cndmask_b32 v125, v125, v117, vcc
    v_mov_b32 v126, 0
    v_mov_b32 v117, 0x3f80
    v_cmp_eq_u32 vcc, 8, v116
    s_nop 1
    v_cndmask_b32 v126, v126, v117, vcc
    v_mov_b32 v117, 0x3f800000
    v_cmp_eq_u32 vcc, 9, v116
    s_nop 1
    v_cndmask_b32 v126, v126, v117, vcc
    v_mov_b32 v127, 0
    v_mov_b32 v117, 0x3f80
    v_cmp_eq_u32 vcc, 10, v116
    s_nop 1
    v_cndmask_b32 v127, v127, v117, vcc
    v_mov_b32 v117, 0x3f800000
    v_cmp_eq_u32 vcc, 11, v116
    s_nop 1
    v_cndmask_b32 v127, v127, v117, vcc
    v_mov_b32 v16, -1
    v_mov_b32 v17, -1
    v_mov_b32 v18, -1
    v_mov_b32 v19, -1
    v_mov_b32 v14, s76
    v_mov_b32 v113, 36
    s_cmp_lg_u32 s4, 0
    s_cbranch_scc1 Lwik_133
Lwi_131:
    buffer_load_dword v112, v113, s[28:31], 0 offen sc1
    s_waitcnt vmcnt(0)
    v_readfirstlane_b32 s37, v112
    s_nop 0
    s_and_b32 s38, s37, 0x200ffff
    s_cmp_eq_u32 s38, 0x2000100
    s_cbranch_scc1 Lwid_132
    s_sleep 6
    s_sub_u32 s36, s36, 1
    s_cbranch_scc0 Lwi_131
    s_mov_b32 s36, 0
Lwid_132:
    v_mov_b32 v113, 163836
    ds_write_b32 v113, v112
    s_waitcnt lgkmcnt(0)
Lwik_133:
    s_waitcnt vmcnt(0)
    s_barrier
    v_mov_b32 v113, 163836
    ds_read_b32 v112, v113
    s_waitcnt lgkmcnt(0)
    v_readfirstlane_b32 s37, v112
    s_nop 0
    s_bfe_u32 s7, s37, 0x80010
    s_bfe_u32 s37, s37, 0x10018
    s_xor_b32 s37, s37, 1
    s_lshl_b32 s37, s37, 13
    s_lshl_b32 s70, s6, 15
    s_add_u32 s70, s70, s37
    s_cmp_ge_u32 s4, 2
    s_cselect_b32 s37, 11264, 0
    s_add_u32 s70, s70, s37
    s_add_u32 s70, s70, 222298112
    s_mov_b32 s66, 0
    s_cmp_lg_u32 s7, 0
    s_cbranch_scc1 L_RV_slow
L_RV_fast:
    ds_read_b128 v[128:131], v9 offset:0
    ds_read_b128 v[132:135], v9 offset:1024
    ds_read_b128 v[136:139], v9 offset:2048
    ds_read_b128 v[140:143], v9 offset:3072
    ds_read_b128 v[144:147], v9 offset:4096
    ds_read_b128 v[148:151], v9 offset:5120
    v_mov_b32 v20, 0
    v_mov_b32 v21, 0
    v_mov_b32 v22, 0
    v_mov_b32 v23, 0
    v_mov_b32 v24, 0
    v_mov_b32 v25, 0
    v_mov_b32 v26, 0
    v_mov_b32 v27, 0
    v_mov_b32 v28, 0
    v_mov_b32 v29, 0
    v_mov_b32 v30, 0
    v_mov_b32 v31, 0
    v_mov_b32 v32, 0
    v_mov_b32 v33, 0
    v_mov_b32 v34, 0
    v_mov_b32 v35, 0
    v_mov_b32 v36, 0
    v_mov_b32 v37, 0
    v_mov_b32 v38, 0
    v_mov_b32 v39, 0
    v_mov_b32 v40, 0
    v_mov_b32 v41, 0
    v_mov_b32 v42, 0
    v_mov_b32 v43, 0
    v_mov_b32 v44, 0
    v_mov_b32 v45, 0
    v_mov_b32 v46, 0
    v_mov_b32 v47, 0
    v_mov_b32 v48, 0
    v_mov_b32 v49, 0
    v_mov_b32 v50, 0
    v_mov_b32 v51, 0
    v_mov_b32 v52, 0
    v_mov_b32 v53, 0
    v_mov_b32 v54, 0
    v_mov_b32 v55, 0
    v_mov_b32 v56, 0
    v_mov_b32 v57, 0
    v_mov_b32 v58, 0
    v_mov_b32 v59, 0
    v_mov_b32 v60, 0
    v_mov_b32 v61, 0
    v_mov_b32 v62, 0
    v_mov_b32 v63, 0
    v_mov_b32 v64, 0
    v_mov_b32 v65, 0
    v_mov_b32 v66, 0
    v_mov_b32 v67, 0
    v_mov_b32 v68, 0
    v_mov_b32 v69, 0
    v_mov_b32 v70, 0
    v_mov_b32 v71, 0
    s_sleep 8
    s_add_u32 s37, s66, 0
    s_and_b32 s37, s37, 3
    s_lshl_b32 s37, s37, 17
    s_add_u32 s71, s70, s37
    v_mov_b32 v72, -1
    v_mov_b32 v73, -1
    v_mov_b32 v74, -1
    v_mov_b32 v75, -1
    v_mov_b32 v76, -1
    v_mov_b32 v77, -1
    v_mov_b32 v78, -1
    v_mov_b32 v79, -1
    v_mov_b32 v80, -1
    v_mov_b32 v81, -1
    v_mov_b32 v82, -1
    v_mov_b32 v83, -1
    s_waitcnt vmcnt(0)
    buffer_load_dwordx4 v[72:75], v0, s[8:11], s71 offen offset:0 sc1
    buffer_load_dwordx4 v[76:79], v0, s[8:11], s71 offen offset:1024 sc1
    buffer_load_dwordx4 v[80:83], v0, s[8:11], s71 offen offset:2048 sc1
    s_sleep 2
    buffer_load_dwordx4 v[72:75], v0, s[8:11], s71 offen offset:0 sc1
    buffer_load_dwordx4 v[76:79], v0, s[8:11], s71 offen offset:1024 sc1
    buffer_load_dwordx4 v[80:83], v0, s[8:11], s71 offen offset:2048 sc1
Lmp_134:
    s_waitcnt vmcnt(3)
    v_max3_u32 v108, v72, v73, v74
    v_max3_u32 v108, v108, v75, v76
    v_max3_u32 v108, v108, v77, v78
    v_max3_u32 v108, v108, v79, v80
    v_max3_u32 v108, v108, v81, v82
    v_max3_u32 v108, v108, v83, v83
    v_cmp_eq_u32 vcc, -1, v108
    ds_write_b128 v0, v[72:75] offset:0
    s_cbranch_vccnz Lmpr_136
Lmpd_135:
    v_smfmac_f32_16x16x64_bf16 v[20:23], v[72:75], a[0:7], v7
    ds_write_b128 v0, v[76:79] offset:1024
    v_smfmac_f32_16x16x64_bf16 v[24:27], v[72:75], a[8:15], v7
    ds_write_b128 v0, v[80:83] offset:2048
    v_smfmac_f32_16x16x64_bf16 v[28:31], v[72:75], a[16:23], v7
    v_smfmac_f32_16x16x64_bf16 v[20:23], v[76:79], a[24:31], v7
    v_smfmac_f32_16x16x64_bf16 v[24:27], v[76:79], a[32:39], v7
    v_smfmac_f32_16x16x64_bf16 v[28:31], v[76:79], a[40:47], v7
    s_waitcnt lgkmcnt(0)
    s_barrier
    ds_read_b128 v[84:87], v4 offset:0
    ds_read_b128 v[88:91], v4 offset:1024
    ds_read_b128 v[92:95], v5 offset:0
    v_smfmac_f32_16x16x64_bf16 v[20:23], v[80:83], a[48:55], v7
    ds_read_b128 v[96:99], v5 offset:1024
    ds_read_b128 v[100:103], v5 offset:2048
    ds_read_b128 v[104:107], v6 offset:0
    v_smfmac_f32_16x16x64_bf16 v[24:27], v[80:83], a[56:63], v7
    ds_read_b128 v[108:111], v6 offset:1024
    v_smfmac_f32_16x16x64_bf16 v[28:31], v[80:83], a[64:71], v7
    s_waitcnt lgkmcnt(6)
    v_smfmac_f32_16x16x64_bf16 v[20:23], v[84:87], a[72:79], v7
    s_waitcnt lgkmcnt(5)
    v_smfmac_f32_16x16x64_bf16 v[20:23], v[88:91], v[128:135], v7
    s_waitcnt lgkmcnt(4)
    ds_read_b128 v[128:131], v9 offset:6144
    v_smfmac_f32_16x16x64_bf16 v[20:23], v[92:95], a[80:87], v7
    s_waitcnt lgkmcnt(4)
    ds_read_b128 v[132:135], v9 offset:7168
    v_smfmac_f32_16x16x64_bf16 v[20:23], v[96:99], a[88:95], v7
    s_waitcnt lgkmcnt(4)
    v_smfmac_f32_16x16x64_bf16 v[20:23], v[100:103], a[96:103], v7
    s_waitcnt lgkmcnt(3)
    v_smfmac_f32_16x16x64_bf16 v[20:23], v[104:107], v[136:143], v7
    s_waitcnt lgkmcnt(2)
    ds_read_b128 v[136:139], v9 offset:8192
    v_smfmac_f32_16x16x64_bf16 v[20:23], v[108:111], a[104:111], v7
    ds_read_b128 v[140:143], v9 offset:9216
    v_smfmac_f32_16x16x64_bf16 v[24:27], v[84:87], a[112:119], v7
    s_nop 1
    v_smfmac_f32_16x16x64_bf16 v[24:27], v[88:91], v[144:151], v7
    ds_read_b128 v[144:147], v9 offset:10240
    s_nop 1
    v_add_f32 v20, v20, v22
    v_smfmac_f32_16x16x64_bf16 v[24:27], v[92:95], a[120:127], v7
    ds_read_b128 v[148:151], v9 offset:11264
    v_add_f32 v21, v21, v23
    v_smfmac_f32_16x16x64_bf16 v[24:27], v[96:99], a[128:135], v7
    v_cvt_pk_bf16_f32 v20, v20, v21
    v_smfmac_f32_16x16x64_bf16 v[24:27], v[100:103], a[136:143], v7
    s_waitcnt lgkmcnt(4)
    ds_write_b32 v10, v20 offset:0
    v_smfmac_f32_16x16x64_bf16 v[24:27], v[104:107], v[128:135], v7
    ds_read_b128 v[128:131], v9 offset:12288
    v_smfmac_f32_16x16x64_bf16 v[24:27], v[108:111], a[144:151], v7
    ds_read_b128 v[132:135], v9 offset:13312
    v_smfmac_f32_16x16x64_bf16 v[28:31], v[84:87], a[152:159], v7
    s_waitcnt lgkmcnt(5)
    v_smfmac_f32_16x16x64_bf16 v[28:31], v[88:91], v[136:143], v7
    s_waitcnt lgkmcnt(2)
    s_barrier
    ds_read_b64_tr_b16 v[112:113], v11 offset:0
    v_smfmac_f32_16x16x64_bf16 v[28:31], v[92:95], a[160:167], v7
    ds_read_b64_tr_b16 v[114:115], v11 offset:128
    v_add_f32 v24, v24, v26
    v_smfmac_f32_16x16x64_bf16 v[28:31], v[96:99], a[168:175], v7
    ds_read_b128 v[136:139], v9 offset:14336
    v_add_f32 v25, v25, v27
    v_smfmac_f32_16x16x64_bf16 v[28:31], v[100:103], a[176:183], v7
    ds_read_b128 v[140:143], v9 offset:15360
    v_cvt_pk_bf16_f32 v24, v24, v25
    v_smfmac_f32_16x16x64_bf16 v[28:31], v[104:107], v[144:151], v7
    ds_write_b32 v10, v24 offset:1024
    v_smfmac_f32_16x16x64_bf16 v[28:31], v[108:111], a[184:191], v7
    s_waitcnt lgkmcnt(3)
    ds_read_b128 v[144:147], v9 offset:16384
    v_smfmac_f32_16x16x64_bf16 v[32:35], v[112:115], a[192:199], v2
    ds_read_b128 v[148:151], v9 offset:17408
    v_smfmac_f32_16x16x64_bf16 v[36:39], v[112:115], v[128:135], v2
    ds_read_b128 v[128:131], v9 offset:18432
    v_smfmac_f32_16x16x64_bf16 v[40:43], v[112:115], a[200:207], v2
    ds_read_b128 v[132:135], v9 offset:19456
    v_add_f32 v28, v28, v30
    v_smfmac_f32_16x16x64_bf16 v[44:47], v[112:115], a[208:215], v2
    v_add_f32 v29, v29, v31
    v_smfmac_f32_16x16x64_bf16 v[48:51], v[112:115], a[216:223], v2
    s_waitcnt lgkmcnt(5)
    v_cvt_pk_bf16_f32 v28, v28, v29
    v_smfmac_f32_16x16x64_bf16 v[52:55], v[112:115], v[136:143], v2
    ds_write_b32 v10, v28 offset:2048
    s_waitcnt lgkmcnt(0)
    s_barrier
    ds_read_b64_tr_b16 v[116:117], v11 offset:1024
    v_smfmac_f32_16x16x64_bf16 v[56:59], v[112:115], a[224:231], v2
    ds_read_b64_tr_b16 v[118:119], v11 offset:1152
    v_smfmac_f32_16x16x64_bf16 v[60:63], v[112:115], a[232:239], v2
    ds_read_b128 v[136:139], v9 offset:20480
    v_smfmac_f32_16x16x64_bf16 v[64:67], v[112:115], v[144:151], v2
    ds_read_b128 v[140:143], v9 offset:21504
    v_smfmac_f32_16x16x64_bf16 v[68:71], v[112:115], a[240:247], v2
    s_waitcnt lgkmcnt(2)
    ds_read_b128 v[144:147], v9 offset:22528
    v_smfmac_f32_16x16x64_bf16 v[32:35], v[116:119], a[248:255], v2
    ds_read_b128 v[148:151], v9 offset:23552
    v_smfmac_f32_16x16x64_bf16 v[36:39], v[116:119], v[152:159], v2
    v_smfmac_f32_16x16x64_bf16 v[40:43], v[116:119], v[128:135], v2
    ds_read_b128 v[128:131], v9 offset:24576
    v_smfmac_f32_16x16x64_bf16 v[44:47], v[116:119], v[160:167], v2
    s_barrier
    ds_read_b64_tr_b16 v[120:121], v11 offset:2048
    v_smfmac_f32_16x16x64_bf16 v[48:51], v[116:119], v[168:175], v2
    s_waitcnt lgkmcnt(4)
    ds_read_b64_tr_b16 v[122:123], v11 offset:2176
    v_smfmac_f32_16x16x64_bf16 v[52:55], v[116:119], v[136:143], v2
    ds_read_b128 v[132:135], v9 offset:25600
    v_smfmac_f32_16x16x64_bf16 v[56:59], v[116:119], v[176:183], v2
    ds_read_b128 v[136:139], v9 offset:26624
    v_smfmac_f32_16x16x64_bf16 v[60:63], v[116:119], v[184:191], v2
    ds_read_b128 v[140:143], v9 offset:27648
    v_smfmac_f32_16x16x64_bf16 v[64:67], v[116:119], v[192:199], v2
    s_waitcnt lgkmcnt(6)
    s_waitcnt vmcnt(0)
    v_smfmac_f32_16x16x64_bf16 v[68:71], v[116:119], v[144:151], v2
    s_waitcnt lgkmcnt(3)
    ds_read_b128 v[144:147], v9 offset:28672
    v_smfmac_f32_16x16x64_bf16 v[32:35], v[120:123], v[200:207], v2
    ds_read_b128 v[148:151], v9 offset:29696
    v_smfmac_f32_16x16x64_bf16 v[36:39], v[120:123], v[208:215], v2
    s_waitcnt lgkmcnt(4)
    v_smfmac_f32_16x16x64_bf16 v[40:43], v[120:123], v[128:135], v2
    s_nop 0
    v_smfmac_f32_16x16x64_bf16 v[44:47], v[120:123], v[216:223], v2
    s_nop 1
    v_cvt_pk_bf16_f32 v32, v32, v33
    v_smfmac_f32_16x16x64_bf16 v[48:51], v[120:123], v[224:231], v2
    v_cvt_pk_bf16_f32 v33, v34, v35
    v_smfmac_f32_16x16x64_bf16 v[52:55], v[120:123], v[232:239], v2
    s_waitcnt lgkmcnt(2)
    v_cvt_pk_bf16_f32 v34, v36, v37
    v_smfmac_f32_16x16x64_bf16 v[56:59], v[120:123], v[136:143], v2
    v_cvt_pk_bf16_f32 v35, v38, v39
    v_smfmac_f32_16x16x64_bf16 v[60:63], v[120:123], v[240:247], v2
    v_cvt_pk_bf16_f32 v40, v40, v41
    v_smfmac_f32_16x16x64_bf16 v[64:67], v[120:123], v[248:255], v2
    s_waitcnt lgkmcnt(0)
    v_cvt_pk_bf16_f32 v41, v42, v43
    v_smfmac_f32_16x16x64_bf16 v[68:71], v[120:123], v[144:151], v2
    v_cvt_pk_bf16_f32 v42, v44, v45
    v_mfma_f32_16x16x32_bf16 v[36:39], v[124:127], v[32:35], 0
    v_cvt_pk_bf16_f32 v43, v46, v47
    v_cvt_pk_bf16_f32 v48, v48, v49
    v_cvt_pk_bf16_f32 v49, v50, v51
    v_mfma_f32_16x16x32_bf16 v[44:47], v[124:127], v[40:43], 0
    v_cvt_pk_bf16_f32 v50, v52, v53
    v_cvt_pk_bf16_f32 v51, v54, v55
    v_cvt_pk_bf16_f32 v56, v56, v57
    v_cvt_pk_bf16_f32 v57, v58, v59
    v_mfma_f32_16x16x32_bf16 v[52:55], v[124:127], v[48:51], 0
    v_cvt_pk_bf16_f32 v58, v60, v61
    v_cvt_pk_bf16_f32 v59, v62, v63
    v_cvt_pk_bf16_f32 v72, v36, v37
    v_cvt_pk_bf16_f32 v73, v38, v39
    v_mfma_f32_16x16x32_bf16 v[60:63], v[124:127], v[56:59], 0
    v_cvt_pk_bf16_f32 v64, v64, v65
    v_cvt_pk_bf16_f32 v65, v66, v67
    v_cvt_pk_bf16_f32 v66, v68, v69
    v_cvt_pk_bf16_f32 v67, v70, v71
    v_cvt_pk_bf16_f32 v74, v44, v45
    v_cvt_pk_bf16_f32 v75, v46, v47
    v_mfma_f32_16x16x32_bf16 v[68:71], v[124:127], v[64:67], 0
    v_permlane16_swap_b32 v72, v74
    v_permlane16_swap_b32 v73, v75
    buffer_store_dwordx4 v[72:75], v15, s[8:11], s73 offen offset:0
    v_cvt_pk_bf16_f32 v76, v52, v53
    v_cvt_pk_bf16_f32 v77, v54, v55
    v_cvt_pk_bf16_f32 v78, v60, v61
    v_cvt_pk_bf16_f32 v79, v62, v63
    s_nop 0
    v_permlane16_swap_b32 v76, v78
    v_permlane16_swap_b32 v77, v79
    buffer_store_dwordx4 v[76:79], v15, s[8:11], s73 offen offset:1024
    v_cvt_pk_bf16_f32 v80, v68, v69
    v_cvt_pk_bf16_f32 v81, v70, v71
    buffer_store_dwordx2 v[80:81], v12, s[8:11], s73 offen offset:2048
    s_barrier
    s_add_u32 s37, s78, s75
    buffer_store_dwordx4 v[16:19], v8, s[8:11], s37 offen offset:0
    buffer_store_dwordx4 v[16:19], v8, s[8:11], s37 offen offset:1024
    buffer_store_dwordx4 v[16:19], v8, s[8:11], s37 offen offset:1536
    s_max_u32 s37, s66, 3
    s_sub_u32 s37, s37, 3
    v_mov_b32 v13, s37
    s_mov_b64 exec, 1
    buffer_atomic_umax v13, v14, s[28:31], 0 offen
    s_mov_b64 exec, -1
    s_mov_b32 s37, s73
    s_mov_b32 s73, s74
    s_mov_b32 s74, s78
    s_mov_b32 s78, s37
    s_add_u32 s66, s66, 1
    s_cmp_lt_u32 s66, 64
    s_cbranch_scc1 L_RV_fast
    s_branch L_RV_fin
Lmpr_136:
    v_max3_u32 v108, v72, v73, v74
    v_max_u32 v108, v108, v75
    v_cmp_eq_u32 s[56:57], -1, v108
    v_max3_u32 v108, v76, v77, v78
    v_max_u32 v108, v108, v79
    v_cmp_eq_u32 s[58:59], -1, v108
    v_max3_u32 v108, v80, v81, v82
    v_max_u32 v108, v108, v83
    v_cmp_eq_u32 s[60:61], -1, v108
    s_mov_b64 exec, s[56:57]
    buffer_load_dwordx4 v[72:75], v0, s[8:11], s71 offen offset:0 sc1
    s_mov_b64 exec, s[58:59]
    buffer_load_dwordx4 v[76:79], v0, s[8:11], s71 offen offset:1024 sc1
    s_mov_b64 exec, s[60:61]
    buffer_load_dwordx4 v[80:83], v0, s[8:11], s71 offen offset:2048 sc1
    s_mov_b64 exec, -1
    s_sub_u32 s36, s36, 1
    s_cbranch_scc0 Lmp_134
    s_mov_b32 s36, 0
    s_waitcnt vmcnt(0)
    s_branch Lmpd_135
L_RV_slow:
    ds_read_b128 v[128:131], v9 offset:0
    ds_read_b128 v[132:135], v9 offset:1024
    ds_read_b128 v[136:139], v9 offset:2048
    ds_read_b128 v[140:143], v9 offset:3072
    ds_read_b128 v[144:147], v9 offset:4096
    ds_read_b128 v[148:151], v9 offset:5120
    v_mov_b32 v20, 0
    v_mov_b32 v21, 0
    v_mov_b32 v22, 0
    v_mov_b32 v23, 0
    v_mov_b32 v24, 0
    v_mov_b32 v25, 0
    v_mov_b32 v26, 0
    v_mov_b32 v27, 0
    v_mov_b32 v28, 0
    v_mov_b32 v29, 0
    v_mov_b32 v30, 0
    v_mov_b32 v31, 0
    v_mov_b32 v32, 0
    v_mov_b32 v33, 0
    v_mov_b32 v34, 0
    v_mov_b32 v35, 0
    v_mov_b32 v36, 0
    v_mov_b32 v37, 0
    v_mov_b32 v38, 0
    v_mov_b32 v39, 0
    v_mov_b32 v40, 0
    v_mov_b32 v41, 0
    v_mov_b32 v42, 0
    v_mov_b32 v43, 0
    v_mov_b32 v44, 0
    v_mov_b32 v45, 0
    v_mov_b32 v46, 0
    v_mov_b32 v47, 0
    v_mov_b32 v48, 0
    v_mov_b32 v49, 0
    v_mov_b32 v50, 0
    v_mov_b32 v51, 0
    v_mov_b32 v52, 0
    v_mov_b32 v53, 0
    v_mov_b32 v54, 0
    v_mov_b32 v55, 0
    v_mov_b32 v56, 0
    v_mov_b32 v57, 0
    v_mov_b32 v58, 0
    v_mov_b32 v59, 0
    v_mov_b32 v60, 0
    v_mov_b32 v61, 0
    v_mov_b32 v62, 0
    v_mov_b32 v63, 0
    v_mov_b32 v64, 0
    v_mov_b32 v65, 0
    v_mov_b32 v66, 0
    v_mov_b32 v67, 0
    v_mov_b32 v68, 0
    v_mov_b32 v69, 0
    v_mov_b32 v70, 0
    v_mov_b32 v71, 0
    s_sleep 8
    s_add_u32 s37, s66, 0
    s_and_b32 s37, s37, 3
    s_lshl_b32 s37, s37, 17
    s_add_u32 s71, s70, s37
    v_mov_b32 v72, -1
    v_mov_b32 v73, -1
    v_mov_b32 v74, -1
    v_mov_b32 v75, -1
    v_mov_b32 v76, -1
    v_mov_b32 v77, -1
    v_mov_b32 v78, -1
    v_mov_b32 v79, -1
    v_mov_b32 v80, -1
    v_mov_b32 v81, -1
    v_mov_b32 v82, -1
    v_mov_b32 v83, -1
    s_waitcnt vmcnt(0)
    buffer_load_dwordx4 v[72:75], v0, s[8:11], s71 offen offset:0 sc1
    buffer_load_dwordx4 v[76:79], v0, s[8:11], s71 offen offset:1024 sc1
    buffer_load_dwordx4 v[80:83], v0, s[8:11], s71 offen offset:2048 sc1
    s_sleep 2
    buffer_load_dwordx4 v[72:75], v0, s[8:11], s71 offen offset:0 sc1
    buffer_load_dwordx4 v[76:79], v0, s[8:11], s71 offen offset:1024 sc1
    buffer_load_dwordx4 v[80:83], v0, s[8:11], s71 offen offset:2048 sc1
Lmp_137:
    s_waitcnt vmcnt(3)
    v_max3_u32 v108, v72, v73, v74
    v_max3_u32 v108, v108, v75, v76
    v_max3_u32 v108, v108, v77, v78
    v_max3_u32 v108, v108, v79, v80
    v_max3_u32 v108, v108, v81, v82
    v_max3_u32 v108, v108, v83, v83
    v_cmp_eq_u32 vcc, -1, v108
    ds_write_b128 v0, v[72:75] offset:0
    s_cbranch_vccnz Lmpr_139
Lmpd_138:
    v_smfmac_f32_16x16x64_bf16 v[20:23], v[72:75], a[0:7], v7
    ds_write_b128 v0, v[76:79] offset:1024
    v_smfmac_f32_16x16x64_bf16 v[24:27], v[72:75], a[8:15], v7
    ds_write_b128 v0, v[80:83] offset:2048
    v_smfmac_f32_16x16x64_bf16 v[28:31], v[72:75], a[16:23], v7
    v_smfmac_f32_16x16x64_bf16 v[20:23], v[76:79], a[24:31], v7
    v_smfmac_f32_16x16x64_bf16 v[24:27], v[76:79], a[32:39], v7
    v_smfmac_f32_16x16x64_bf16 v[28:31], v[76:79], a[40:47], v7
    s_waitcnt lgkmcnt(0)
    s_barrier
    ds_read_b128 v[84:87], v4 offset:0
    ds_read_b128 v[88:91], v4 offset:1024
    ds_read_b128 v[92:95], v5 offset:0
    v_smfmac_f32_16x16x64_bf16 v[20:23], v[80:83], a[48:55], v7
    ds_read_b128 v[96:99], v5 offset:1024
    ds_read_b128 v[100:103], v5 offset:2048
    ds_read_b128 v[104:107], v6 offset:0
    v_smfmac_f32_16x16x64_bf16 v[24:27], v[80:83], a[56:63], v7
    ds_read_b128 v[108:111], v6 offset:1024
    v_smfmac_f32_16x16x64_bf16 v[28:31], v[80:83], a[64:71], v7
    s_waitcnt lgkmcnt(6)
    v_smfmac_f32_16x16x64_bf16 v[20:23], v[84:87], a[72:79], v7
    s_waitcnt lgkmcnt(5)
    v_smfmac_f32_16x16x64_bf16 v[20:23], v[88:91], v[128:135], v7
    s_waitcnt lgkmcnt(4)
    ds_read_b128 v[128:131], v9 offset:6144
    v_smfmac_f32_16x16x64_bf16 v[20:23], v[92:95], a[80:87], v7
    s_waitcnt lgkmcnt(4)
    ds_read_b128 v[132:135], v9 offset:7168
    v_smfmac_f32_16x16x64_bf16 v[20:23], v[96:99], a[88:95], v7
    s_waitcnt lgkmcnt(4)
    v_smfmac_f32_16x16x64_bf16 v[20:23], v[100:103], a[96:103], v7
    s_waitcnt lgkmcnt(3)
    v_smfmac_f32_16x16x64_bf16 v[20:23], v[104:107], v[136:143], v7
    s_waitcnt lgkmcnt(2)
    ds_read_b128 v[136:139], v9 offset:8192
    v_smfmac_f32_16x16x64_bf16 v[20:23], v[108:111], a[104:111], v7
    ds_read_b128 v[140:143], v9 offset:9216
    v_smfmac_f32_16x16x64_bf16 v[24:27], v[84:87], a[112:119], v7
    s_nop 1
    v_smfmac_f32_16x16x64_bf16 v[24:27], v[88:91], v[144:151], v7
    ds_read_b128 v[144:147], v9 offset:10240
    s_nop 1
    v_add_f32 v20, v20, v22
    v_smfmac_f32_16x16x64_bf16 v[24:27], v[92:95], a[120:127], v7
    ds_read_b128 v[148:151], v9 offset:11264
    v_add_f32 v21, v21, v23
    v_smfmac_f32_16x16x64_bf16 v[24:27], v[96:99], a[128:135], v7
    v_cvt_pk_bf16_f32 v20, v20, v21
    v_smfmac_f32_16x16x64_bf16 v[24:27], v[100:103], a[136:143], v7
    s_waitcnt lgkmcnt(4)
    ds_write_b32 v10, v20 offset:0
    v_smfmac_f32_16x16x64_bf16 v[24:27], v[104:107], v[128:135], v7
    ds_read_b128 v[128:131], v9 offset:12288
    v_smfmac_f32_16x16x64_bf16 v[24:27], v[108:111], a[144:151], v7
    ds_read_b128 v[132:135], v9 offset:13312
    v_smfmac_f32_16x16x64_bf16 v[28:31], v[84:87], a[152:159], v7
    s_waitcnt lgkmcnt(5)
    v_smfmac_f32_16x16x64_bf16 v[28:31], v[88:91], v[136:143], v7
    s_waitcnt lgkmcnt(2)
    s_barrier
    ds_read_b64_tr_b16 v[112:113], v11 offset:0
    v_smfmac_f32_16x16x64_bf16 v[28:31], v[92:95], a[160:167], v7
    ds_read_b64_tr_b16 v[114:115], v11 offset:128
    v_add_f32 v24, v24, v26
    v_smfmac_f32_16x16x64_bf16 v[28:31], v[96:99], a[168:175], v7
    ds_read_b128 v[136:139], v9 offset:14336
    v_add_f32 v25, v25, v27
    v_smfmac_f32_16x16x64_bf16 v[28:31], v[100:103], a[176:183], v7
    ds_read_b128 v[140:143], v9 offset:15360
    v_cvt_pk_bf16_f32 v24, v24, v25
    v_smfmac_f32_16x16x64_bf16 v[28:31], v[104:107], v[144:151], v7
    ds_write_b32 v10, v24 offset:1024
    v_smfmac_f32_16x16x64_bf16 v[28:31], v[108:111], a[184:191], v7
    s_waitcnt lgkmcnt(3)
    ds_read_b128 v[144:147], v9 offset:16384
    v_smfmac_f32_16x16x64_bf16 v[32:35], v[112:115], a[192:199], v2
    ds_read_b128 v[148:151], v9 offset:17408
    v_smfmac_f32_16x16x64_bf16 v[36:39], v[112:115], v[128:135], v2
    ds_read_b128 v[128:131], v9 offset:18432
    v_smfmac_f32_16x16x64_bf16 v[40:43], v[112:115], a[200:207], v2
    ds_read_b128 v[132:135], v9 offset:19456
    v_add_f32 v28, v28, v30
    v_smfmac_f32_16x16x64_bf16 v[44:47], v[112:115], a[208:215], v2
    v_add_f32 v29, v29, v31
    v_smfmac_f32_16x16x64_bf16 v[48:51], v[112:115], a[216:223], v2
    s_waitcnt lgkmcnt(5)
    v_cvt_pk_bf16_f32 v28, v28, v29
    v_smfmac_f32_16x16x64_bf16 v[52:55], v[112:115], v[136:143], v2
    ds_write_b32 v10, v28 offset:2048
    s_waitcnt lgkmcnt(0)
    s_barrier
    ds_read_b64_tr_b16 v[116:117], v11 offset:1024
    v_smfmac_f32_16x16x64_bf16 v[56:59], v[112:115], a[224:231], v2
    ds_read_b64_tr_b16 v[118:119], v11 offset:1152
    v_smfmac_f32_16x16x64_bf16 v[60:63], v[112:115], a[232:239], v2
    ds_read_b128 v[136:139], v9 offset:20480
    v_smfmac_f32_16x16x64_bf16 v[64:67], v[112:115], v[144:151], v2
    ds_read_b128 v[140:143], v9 offset:21504
    v_smfmac_f32_16x16x64_bf16 v[68:71], v[112:115], a[240:247], v2
    s_waitcnt lgkmcnt(2)
    ds_read_b128 v[144:147], v9 offset:22528
    v_smfmac_f32_16x16x64_bf16 v[32:35], v[116:119], a[248:255], v2
    ds_read_b128 v[148:151], v9 offset:23552
    v_smfmac_f32_16x16x64_bf16 v[36:39], v[116:119], v[152:159], v2
    v_smfmac_f32_16x16x64_bf16 v[40:43], v[116:119], v[128:135], v2
    ds_read_b128 v[128:131], v9 offset:24576
    v_smfmac_f32_16x16x64_bf16 v[44:47], v[116:119], v[160:167], v2
    s_barrier
    ds_read_b64_tr_b16 v[120:121], v11 offset:2048
    v_smfmac_f32_16x16x64_bf16 v[48:51], v[116:119], v[168:175], v2
    s_waitcnt lgkmcnt(4)
    ds_read_b64_tr_b16 v[122:123], v11 offset:2176
    v_smfmac_f32_16x16x64_bf16 v[52:55], v[116:119], v[136:143], v2
    ds_read_b128 v[132:135], v9 offset:25600
    v_smfmac_f32_16x16x64_bf16 v[56:59], v[116:119], v[176:183], v2
    ds_read_b128 v[136:139], v9 offset:26624
    v_smfmac_f32_16x16x64_bf16 v[60:63], v[116:119], v[184:191], v2
    ds_read_b128 v[140:143], v9 offset:27648
    v_smfmac_f32_16x16x64_bf16 v[64:67], v[116:119], v[192:199], v2
    s_waitcnt lgkmcnt(6)
    s_waitcnt vmcnt(0)
    v_smfmac_f32_16x16x64_bf16 v[68:71], v[116:119], v[144:151], v2
    s_waitcnt lgkmcnt(3)
    ds_read_b128 v[144:147], v9 offset:28672
    v_smfmac_f32_16x16x64_bf16 v[32:35], v[120:123], v[200:207], v2
    ds_read_b128 v[148:151], v9 offset:29696
    v_smfmac_f32_16x16x64_bf16 v[36:39], v[120:123], v[208:215], v2
    s_waitcnt lgkmcnt(4)
    v_smfmac_f32_16x16x64_bf16 v[40:43], v[120:123], v[128:135], v2
    s_nop 0
    v_smfmac_f32_16x16x64_bf16 v[44:47], v[120:123], v[216:223], v2
    s_nop 1
    v_cvt_pk_bf16_f32 v32, v32, v33
    v_smfmac_f32_16x16x64_bf16 v[48:51], v[120:123], v[224:231], v2
    v_cvt_pk_bf16_f32 v33, v34, v35
    v_smfmac_f32_16x16x64_bf16 v[52:55], v[120:123], v[232:239], v2
    s_waitcnt lgkmcnt(2)
    v_cvt_pk_bf16_f32 v34, v36, v37
    v_smfmac_f32_16x16x64_bf16 v[56:59], v[120:123], v[136:143], v2
    v_cvt_pk_bf16_f32 v35, v38, v39
    v_smfmac_f32_16x16x64_bf16 v[60:63], v[120:123], v[240:247], v2
    v_cvt_pk_bf16_f32 v40, v40, v41
    v_smfmac_f32_16x16x64_bf16 v[64:67], v[120:123], v[248:255], v2
    s_waitcnt lgkmcnt(0)
    v_cvt_pk_bf16_f32 v41, v42, v43
    v_smfmac_f32_16x16x64_bf16 v[68:71], v[120:123], v[144:151], v2
    v_cvt_pk_bf16_f32 v42, v44, v45
    v_mfma_f32_16x16x32_bf16 v[36:39], v[124:127], v[32:35], 0
    v_cvt_pk_bf16_f32 v43, v46, v47
    v_cvt_pk_bf16_f32 v48, v48, v49
    v_cvt_pk_bf16_f32 v49, v50, v51
    v_mfma_f32_16x16x32_bf16 v[44:47], v[124:127], v[40:43], 0
    v_cvt_pk_bf16_f32 v50, v52, v53
    v_cvt_pk_bf16_f32 v51, v54, v55
    v_cvt_pk_bf16_f32 v56, v56, v57
    v_cvt_pk_bf16_f32 v57, v58, v59
    v_mfma_f32_16x16x32_bf16 v[52:55], v[124:127], v[48:51], 0
    v_cvt_pk_bf16_f32 v58, v60, v61
    v_cvt_pk_bf16_f32 v59, v62, v63
    v_cvt_pk_bf16_f32 v72, v36, v37
    v_cvt_pk_bf16_f32 v73, v38, v39
    v_mfma_f32_16x16x32_bf16 v[60:63], v[124:127], v[56:59], 0
    v_cvt_pk_bf16_f32 v64, v64, v65
    v_cvt_pk_bf16_f32 v65, v66, v67
    v_cvt_pk_bf16_f32 v66, v68, v69
    v_cvt_pk_bf16_f32 v67, v70, v71
    v_cvt_pk_bf16_f32 v74, v44, v45
    v_cvt_pk_bf16_f32 v75, v46, v47
    v_mfma_f32_16x16x32_bf16 v[68:71], v[124:127], v[64:67], 0
    v_permlane16_swap_b32 v72, v74
    v_permlane16_swap_b32 v73, v75
    buffer_store_dwordx4 v[72:75], v15, s[8:11], s73 offen offset:0 sc1
    v_cvt_pk_bf16_f32 v76, v52, v53
    v_cvt_pk_bf16_f32 v77, v54, v55
    v_cvt_pk_bf16_f32 v78, v60, v61
    v_cvt_pk_bf16_f32 v79, v62, v63
    s_nop 0
    v_permlane16_swap_b32 v76, v78
    v_permlane16_swap_b32 v77, v79
    buffer_store_dwordx4 v[76:79], v15, s[8:11], s73 offen offset:1024 sc1
    v_cvt_pk_bf16_f32 v80, v68, v69
    v_cvt_pk_bf16_f32 v81, v70, v71
    buffer_store_dwordx2 v[80:81], v12, s[8:11], s73 offen offset:2048 sc1
    s_barrier
    s_add_u32 s37, s78, s75
    buffer_store_dwordx4 v[16:19], v8, s[8:11], s37 offen offset:0 sc1
    buffer_store_dwordx4 v[16:19], v8, s[8:11], s37 offen offset:1024 sc1
    buffer_store_dwordx4 v[16:19], v8, s[8:11], s37 offen offset:1536 sc1
    s_max_u32 s37, s66, 3
    s_sub_u32 s37, s37, 3
    v_mov_b32 v13, s37
    s_mov_b64 exec, 1
    buffer_atomic_umax v13, v14, s[28:31], 0 offen
    s_mov_b64 exec, -1
    s_mov_b32 s37, s73
    s_mov_b32 s73, s74
    s_mov_b32 s74, s78
    s_mov_b32 s78, s37
    s_add_u32 s66, s66, 1
    s_cmp_lt_u32 s66, 64
    s_cbranch_scc1 L_RV_slow
    s_branch L_RV_fin
Lmpr_139:
    v_max3_u32 v108, v72, v73, v74
    v_max_u32 v108, v108, v75
    v_cmp_eq_u32 s[56:57], -1, v108
    v_max3_u32 v108, v76, v77, v78
    v_max_u32 v108, v108, v79
    v_cmp_eq_u32 s[58:59], -1, v108
    v_max3_u32 v108, v80, v81, v82
    v_max_u32 v108, v108, v83
    v_cmp_eq_u32 s[60:61], -1, v108
    s_mov_b64 exec, s[56:57]
    buffer_load_dwordx4 v[72:75], v0, s[8:11], s71 offen offset:0 sc1
    s_mov_b64 exec, s[58:59]
    buffer_load_dwordx4 v[76:79], v0, s[8:11], s71 offen offset:1024 sc1
    s_mov_b64 exec, s[60:61]
    buffer_load_dwordx4 v[80:83], v0, s[8:11], s71 offen offset:2048 sc1
    s_mov_b64 exec, -1
    s_sub_u32 s36, s36, 1
    s_cbranch_scc0 Lmp_137
    s_mov_b32 s36, 0
    s_waitcnt vmcnt(0)
    s_branch Lmpd_138
L_RV_fin:
    s_waitcnt vmcnt(0)
    s_cmp_lg_u32 s36, 0
    s_cbranch_scc1 Lfin_140
    s_mov_b64 exec, 1
    v_mov_b32 v2, 1
    v_mov_b32 v3, 44
    buffer_atomic_add v2, v3, s[28:31], 0 offen
    s_mov_b64 exec, -1
Lfin_140:
    s_endpgm
L_end:
    s_endpgm
.section .rodata,"a"
.p2align 6
.amdhsa_kernel parallel_sum__memory_aug_recurrent_mem_tr__dense_activation_relu__prompt_kernel
  .amdhsa_next_free_vgpr 512
  .amdhsa_next_free_sgpr 102
  .amdhsa_accum_offset 256
  .amdhsa_group_segment_fixed_size 0
  .amdhsa_float_denorm_mode_32 3
  .amdhsa_kernarg_size 104
  .amdhsa_user_sgpr_count 2
  .amdhsa_user_sgpr_kernarg_segment_ptr 1
  .amdhsa_system_sgpr_workgroup_id_x 1
.end_amdhsa_kernel
```
